```python
import torch

def _softmax(x, axis=-1):
    return torch.softmax(x, dim=axis)
def _gelu(x):
    return torch.nn.functional.gelu(x, approximate="tanh")
def _silu(x):
    return torch.nn.functional.silu(x)
def _sigmoid(x):
    return torch.sigmoid(x)
def _layernorm(x, axis=-1, eps=1e-5):
    m = x.mean(dim=axis, keepdim=True)
    v = x.var(dim=axis, keepdim=True, unbiased=False)
    return (x - m) / torch.sqrt(v + eps)
def _scatter_add(tgt, idx, src, axis=0):
    return tgt.clone().index_add_(axis, idx, src)
def _segment_sum(src, seg, n):
    out = torch.zeros((n,) + src.shape[1:], dtype=src.dtype)
    return out.index_add_(0, seg, src)
def _pad(x, pw):
    flat = tuple(v for pair in reversed(pw) for v in pair)
    return torch.nn.functional.pad(x, flat)

kernel_name = 'standalone__deep_cross_pnn__recsys'

def setup_inputs():

    _w = (lambda a: (lambda t: t.to(torch.bfloat16) if t.is_floating_point() else t)(torch.as_tensor(a)))
    B, F, D, V = 16384, 100, 64, min(100000, 100000)
    H = 4 * D
    return {
        "idx": _w((lambda lo, hi, *s: torch.randint(lo, hi, s))(0, V, B, F).to(torch.int64)),
        "table": _w((lambda *s: torch.randn(*s, dtype=torch.bfloat16) * 1.6)(V, D) * (D ** -0.5)),
        "w_p": _w((lambda *s: torch.randn(*s, dtype=torch.bfloat16) * 0.05)(F * F) * ((F * F) ** -0.5)),
        "w1": _w((lambda *s: torch.randn(*s, dtype=torch.bfloat16) * 1.6)(F * D, H) * ((F * D) ** -0.5)),
        "b1": _w((lambda *s: torch.randn(*s, dtype=torch.bfloat16) * 12.8)(H) * 0.01),
        "w2": _w((lambda *s: torch.randn(*s, dtype=torch.bfloat16) * 0.05)(H) * (H ** -0.5)),
        "b2": _w((lambda *s: torch.randn(*s, dtype=torch.bfloat16) * 1.6)(1) * 0.01),
    }

def reference(idx, table, w_p, w1, b1, w2, b2):
    emb = table[idx]
    B = emb.shape[0]; F = emb.shape[1]; D = emb.shape[2]
    ip = torch.einsum('bid,bjd->bij', emb, emb)
    ip = ip.reshape(B, F * F)
    logit_p = ip @ w_p
    z = emb.reshape(B, F * D)
    h = _gelu(z @ w1 + b1)
    logit_d = h @ w2 + b2
    return logit_p + logit_d
```

```asm
; @launch grid=(256,1,1) block=(512,1,1) lds=163840
.amdgcn_target "amdgcn-amd-amdhsa--gfx950"
.text
.globl standalone__deep_cross_pnn__recsys_kernel
.p2align 8
.type standalone__deep_cross_pnn__recsys_kernel,@function
standalone__deep_cross_pnn__recsys_kernel:
    s_cmp_ge_u32 s2, 256
    s_cbranch_scc1 L_end
    s_load_dwordx16 s[4:19], s[0:1], 0
    s_load_dwordx4 s[20:23], s[0:1], 64
    v_lshrrev_b32 v1, 6, v0
    v_and_b32 v0, 63, v0
    v_readfirstlane_b32 s3, v1
    s_lshr_b32 s24, s2, 4
    s_lshl_b32 s24, s24, 3
    s_and_b32 s27, s2, 7
    s_add_u32 s24, s24, s27
    s_lshr_b32 s25, s2, 3
    s_and_b32 s25, s25, 1
    s_lshl_b32 s26, s24, 7
    s_and_b32 s27, s3, 3
    s_lshl_b32 s31, s27, 12
    s_cmp_ge_u32 s3, 4
    s_mov_b32 s3, s27
    s_waitcnt lgkmcnt(0)
    s_cbranch_scc0 L_gwave
L_rwave:
    s_nop 1
    s_setprio 2
    s_mov_b32 s36, s4
    s_mov_b32 s37, s5
    s_mov_b32 s38, 6553600
    s_mov_b32 s39, 0x00020000
    v_lshrrev_b32 v80, 3, v0
    v_and_b32 v81, 7, v0
    s_mov_b32 s40, 3200
    s_mov_b32 s41, 6400
    s_mov_b32 s42, 9600
    s_lshl_b32 s27, s3, 5
    s_lshl_b32 s28, s25, 6
    s_xor_b32 s27, s27, s28
    s_add_u32 s27, s27, s26
    s_mul_i32 s30, s25, 200
    v_add_u32 v84, s27, v80
    v_mul_u32_u24 v84, 400, v84
    v_lshl_add_u32 v114, v81, 4, v84
    v_add_u32 v114, s30, v114
    v_min_u32 v85, 1, v81
    v_lshl_add_u32 v85, v85, 4, v84
    v_add_u32 v85, s30, v85
    buffer_load_dwordx4 v[32:35], v85, s[36:39], 0 offen
    buffer_load_dwordx4 v[36:39], v85, s[36:39], s40 offen
    buffer_load_dwordx4 v[40:43], v85, s[36:39], s41 offen
    buffer_load_dwordx4 v[44:47], v85, s[36:39], s42 offen
    s_barrier
    s_mov_b32 s76, s10
    s_mov_b32 s77, s11
    s_mov_b32 s78, 3276800
    s_mov_b32 s79, 0x00020000
    v_and_b32 v82, 15, v0
    v_lshrrev_b32 v83, 4, v0
    s_lshl_b32 s27, s3, 7
    v_lshl_add_u32 v86, v82, 3, s27
    v_lshl_add_u32 v79, v83, 12, v86
    s_sub_u32 s63, s2, 200
    s_cselect_b32 s63, s2, s63
    s_lshl_b32 s63, s63, 14
    s_lshl_b32 s27, s3, 4
    s_add_u32 s27, s27, s28
    s_add_u32 s27, s27, s26
    s_mul_i32 s27, s27, 400
    v_lshl_add_u32 v11, v0, 2, s27
    buffer_load_dwordx2 v[176:177], v79, s[76:79], s63 offen
    buffer_load_dwordx2 v[178:179], v79, s[76:79], s63 offen offset:512
    buffer_load_dwordx2 v[180:181], v79, s[76:79], s63 offen offset:1024
    buffer_load_dwordx2 v[182:183], v79, s[76:79], s63 offen offset:1536
    buffer_load_dwordx2 v[184:185], v79, s[76:79], s63 offen offset:2048
    buffer_load_dwordx2 v[186:187], v79, s[76:79], s63 offen offset:2560
    buffer_load_dwordx2 v[188:189], v79, s[76:79], s63 offen offset:3072
    buffer_load_dwordx2 v[190:191], v79, s[76:79], s63 offen offset:3584
    buffer_load_dword v48, v11, s[36:39], 0 offen offset:0
    buffer_load_dword v49, v11, s[36:39], 0 offen offset:256
    buffer_load_dword v50, v11, s[36:39], 0 offen offset:400
    buffer_load_dword v51, v11, s[36:39], 0 offen offset:656
    s_mov_b32 s32, s6
    s_mov_b32 s33, s7
    s_mov_b32 s34, 12800000
    s_mov_b32 s35, 0x00020000
    s_mov_b32 s80, s22
    s_mov_b32 s81, s23
    s_mov_b32 s82, 24248320
    s_mov_b32 s83, 0x00020000
    s_mov_b32 s64, s20
    s_mov_b32 s65, s21
    s_mov_b32 s66, 256
    s_mov_b32 s67, 0x00020000
    s_mov_b32 s68, 0x05040100
    s_mov_b32 s69, 0x07060302
    s_add_u32 s27, s31, 20971520
    v_lshl_add_u32 v76, v0, 4, s27
    s_lshl_b32 s27, s3, 8
    s_lshl_b32 s29, s2, 10
    s_add_u32 s29, s29, s27
    s_add_u32 s29, s29, 16777216
    v_lshl_add_u32 v77, v0, 2, s29
    v_mov_b32 v78, 0
    v_lshrrev_b32 v84, 1, v80
    v_xor_b32 v84, v84, v81
    v_lshlrev_b32 v2, 4, v84
    v_xor_b32 v3, 64, v2
    v_mov_b32 v12, 0
    v_mov_b32 v13, 0
    v_mov_b32 v14, 0
    v_mov_b32 v15, 0
    v_lshl_add_u32 v84, v81, 3, v80
    v_lshlrev_b32 v4, 2, v84
    v_lshlrev_b32 v5, 4, v0
    v_add_u32 v5, 82944, v5
    v_add_u32 v85, 4, v84
    v_and_b32 v85, 15, v85
    v_and_b32 v84, 48, v84
    v_or_b32 v84, v84, v85
    v_lshlrev_b32 v61, 2, v84
    v_lshrrev_b32 v84, 1, v80
    v_add_u32 v84, 2, v84
    v_xor_b32 v84, v84, v81
    v_lshlrev_b32 v62, 4, v84
    v_xor_b32 v63, 64, v62
    s_lshl_b32 s50, s3, 13
    s_add_u32 s50, s50, 98304
    v_lshrrev_b32 v84, 1, v82
    v_xor_b32 v84, v84, v83
    v_lshl_add_u32 v85, v82, 7, s50
    v_lshl_add_u32 v7, v84, 4, v85
    v_xor_b32 v8, 64, v7
    v_lshrrev_b32 v84, 2, v82
    v_add_u32 v85, 1, v84
    v_min_u32 v85, 3, v85
    v_min_u32 v86, 1, v84
    v_xor_b32 v86, 1, v86
    v_lshlrev_b32 v60, 9, v86
    v_lshl_add_u32 v9, v86, 11, v7
    v_lshl_add_u32 v56, v84, 11, v7
    v_lshl_add_u32 v58, v85, 11, v7
    v_lshl_add_u32 v10, v86, 11, v8
    v_lshl_add_u32 v57, v84, 11, v8
    v_lshl_add_u32 v59, v85, 11, v8
    s_lshl_b32 s27, s3, 2
    s_add_u32 s27, s27, 81920
    v_lshlrev_b32 v116, 2, v0
    v_add_u32 v116, 82176, v116
    s_nop 0
    v_writelane_b32 v116, s27, 0
    v_mov_b32 v117, 1
    s_mov_b32 s51, 1048576
    v_and_b32 v84, 3, v0
    v_lshlrev_b32 v84, 2, v84
    v_add_u32 v118, 81920, v84
    s_mov_b32 s44, 0xfff0fff0
    s_mov_b32 s45, 0xfff0fff0
    s_not_b64 s[46:47], s[44:45]
    s_waitcnt vmcnt(15)
    v_lshlrev_b32 v32, 7, v32
    v_lshlrev_b32 v33, 7, v33
    v_lshlrev_b32 v34, 7, v34
    v_lshlrev_b32 v35, 7, v35
    s_waitcnt vmcnt(14)
    v_lshlrev_b32 v36, 7, v36
    v_lshlrev_b32 v37, 7, v37
    v_lshlrev_b32 v38, 7, v38
    v_lshlrev_b32 v39, 7, v39
    s_waitcnt vmcnt(13)
    v_lshlrev_b32 v40, 7, v40
    v_lshlrev_b32 v41, 7, v41
    v_lshlrev_b32 v42, 7, v42
    v_lshlrev_b32 v43, 7, v43
    s_waitcnt vmcnt(12)
    v_lshlrev_b32 v44, 7, v44
    v_lshlrev_b32 v45, 7, v45
    v_lshlrev_b32 v46, 7, v46
    v_lshlrev_b32 v47, 7, v47
    s_add_u32 m0, s31, 0
    v_or_b32_dpp v12, v32, v2 row_newbcast:0 row_mask:0xf bank_mask:0x3
    v_or_b32_dpp v12, v32, v2 row_newbcast:8 row_mask:0xf bank_mask:0xc
    buffer_load_dwordx4 v12, s[32:35], 0 offen lds
    s_add_u32 m0, s31, 1024
    v_or_b32_dpp v13, v36, v3 row_newbcast:0 row_mask:0xf bank_mask:0x3
    v_or_b32_dpp v13, v36, v3 row_newbcast:8 row_mask:0xf bank_mask:0xc
    buffer_load_dwordx4 v13, s[32:35], 0 offen lds
    s_add_u32 m0, s31, 2048
    v_or_b32_dpp v14, v40, v2 row_newbcast:0 row_mask:0xf bank_mask:0x3
    v_or_b32_dpp v14, v40, v2 row_newbcast:8 row_mask:0xf bank_mask:0xc
    buffer_load_dwordx4 v14, s[32:35], 0 offen lds
    s_add_u32 m0, s31, 3072
    v_or_b32_dpp v15, v44, v3 row_newbcast:0 row_mask:0xf bank_mask:0x3
    v_or_b32_dpp v15, v44, v3 row_newbcast:8 row_mask:0xf bank_mask:0xc
    buffer_load_dwordx4 v15, s[32:35], 0 offen lds
    s_add_u32 m0, s31, 16384
    v_or_b32_dpp v12, v33, v2 row_newbcast:0 row_mask:0xf bank_mask:0x3
    v_or_b32_dpp v12, v33, v2 row_newbcast:8 row_mask:0xf bank_mask:0xc
    buffer_load_dwordx4 v12, s[32:35], 0 offen lds
    s_add_u32 m0, s31, 17408
    v_or_b32_dpp v13, v37, v3 row_newbcast:0 row_mask:0xf bank_mask:0x3
    v_or_b32_dpp v13, v37, v3 row_newbcast:8 row_mask:0xf bank_mask:0xc
    buffer_load_dwordx4 v13, s[32:35], 0 offen lds
    s_add_u32 m0, s31, 18432
    v_or_b32_dpp v14, v41, v2 row_newbcast:0 row_mask:0xf bank_mask:0x3
    v_or_b32_dpp v14, v41, v2 row_newbcast:8 row_mask:0xf bank_mask:0xc
    buffer_load_dwordx4 v14, s[32:35], 0 offen lds
    s_add_u32 m0, s31, 19456
    v_or_b32_dpp v15, v45, v3 row_newbcast:0 row_mask:0xf bank_mask:0x3
    v_or_b32_dpp v15, v45, v3 row_newbcast:8 row_mask:0xf bank_mask:0xc
    buffer_load_dwordx4 v15, s[32:35], 0 offen lds
    s_waitcnt vmcnt(4)
    ds_add_u32 v116, v117
    buffer_store_dword v78, v77, s[80:83], 0 offen sc1
    v_perm_b32 v192, v178, v176, s68
    v_perm_b32 v193, v182, v180, s68
    v_perm_b32 v194, v186, v184, s68
    v_perm_b32 v195, v190, v188, s68
    buffer_store_dwordx4 v[192:195], v76, s[80:83], s63 offen sc1
    v_perm_b32 v196, v178, v176, s69
    v_perm_b32 v197, v182, v180, s69
    v_perm_b32 v198, v186, v184, s69
    v_perm_b32 v199, v190, v188, s69
    buffer_store_dwordx4 v[196:199], v76, s[80:83], s63 offen offset:1024 sc1
    v_perm_b32 v200, v179, v177, s68
    v_perm_b32 v201, v183, v181, s68
    v_perm_b32 v202, v187, v185, s68
    v_perm_b32 v203, v191, v189, s68
    buffer_store_dwordx4 v[200:203], v76, s[80:83], s63 offen offset:2048 sc1
    v_perm_b32 v204, v179, v177, s69
    v_perm_b32 v205, v183, v181, s69
    v_perm_b32 v206, v187, v185, s69
    v_perm_b32 v207, v191, v189, s69
    buffer_store_dwordx4 v[204:207], v76, s[80:83], s63 offen offset:3072 sc1
    s_add_u32 m0, s31, 32768
    v_or_b32_dpp v12, v34, v2 row_newbcast:0 row_mask:0xf bank_mask:0x3
    v_or_b32_dpp v12, v34, v2 row_newbcast:8 row_mask:0xf bank_mask:0xc
    buffer_load_dwordx4 v12, s[32:35], 0 offen lds
    s_add_u32 m0, s31, 33792
    v_or_b32_dpp v13, v38, v3 row_newbcast:0 row_mask:0xf bank_mask:0x3
    v_or_b32_dpp v13, v38, v3 row_newbcast:8 row_mask:0xf bank_mask:0xc
    buffer_load_dwordx4 v13, s[32:35], 0 offen lds
    s_add_u32 m0, s31, 34816
    v_or_b32_dpp v14, v42, v2 row_newbcast:0 row_mask:0xf bank_mask:0x3
    v_or_b32_dpp v14, v42, v2 row_newbcast:8 row_mask:0xf bank_mask:0xc
    buffer_load_dwordx4 v14, s[32:35], 0 offen lds
    s_add_u32 m0, s31, 35840
    v_or_b32_dpp v15, v46, v3 row_newbcast:0 row_mask:0xf bank_mask:0x3
    v_or_b32_dpp v15, v46, v3 row_newbcast:8 row_mask:0xf bank_mask:0xc
    buffer_load_dwordx4 v15, s[32:35], 0 offen lds
    s_waitcnt vmcnt(9)
    ds_add_u32 v116, v117
    s_add_u32 m0, s31, 49152
    v_or_b32_dpp v12, v35, v2 row_newbcast:0 row_mask:0xf bank_mask:0x3
    v_or_b32_dpp v12, v35, v2 row_newbcast:8 row_mask:0xf bank_mask:0xc
    buffer_load_dwordx4 v12, s[32:35], 0 offen lds
    s_add_u32 m0, s31, 50176
    v_or_b32_dpp v13, v39, v3 row_newbcast:0 row_mask:0xf bank_mask:0x3
    v_or_b32_dpp v13, v39, v3 row_newbcast:8 row_mask:0xf bank_mask:0xc
    buffer_load_dwordx4 v13, s[32:35], 0 offen lds
    s_add_u32 m0, s31, 51200
    v_or_b32_dpp v14, v43, v2 row_newbcast:0 row_mask:0xf bank_mask:0x3
    v_or_b32_dpp v14, v43, v2 row_newbcast:8 row_mask:0xf bank_mask:0xc
    buffer_load_dwordx4 v14, s[32:35], 0 offen lds
    s_add_u32 m0, s31, 52224
    v_or_b32_dpp v15, v47, v3 row_newbcast:0 row_mask:0xf bank_mask:0x3
    v_or_b32_dpp v15, v47, v3 row_newbcast:8 row_mask:0xf bank_mask:0xc
    buffer_load_dwordx4 v15, s[32:35], 0 offen lds
    s_waitcnt vmcnt(4)
    ds_add_u32 v116, v117
    s_add_u32 m0, s31, 65536
    v_or_b32_dpp v12, v32, v2 row_newbcast:1 row_mask:0xf bank_mask:0x3
    v_or_b32_dpp v12, v32, v2 row_newbcast:9 row_mask:0xf bank_mask:0xc
    buffer_load_dwordx4 v12, s[32:35], 0 offen lds
    s_add_u32 m0, s31, 66560
    v_or_b32_dpp v13, v36, v3 row_newbcast:1 row_mask:0xf bank_mask:0x3
    v_or_b32_dpp v13, v36, v3 row_newbcast:9 row_mask:0xf bank_mask:0xc
    buffer_load_dwordx4 v13, s[32:35], 0 offen lds
    s_add_u32 m0, s31, 67584
    v_or_b32_dpp v14, v40, v2 row_newbcast:1 row_mask:0xf bank_mask:0x3
    v_or_b32_dpp v14, v40, v2 row_newbcast:9 row_mask:0xf bank_mask:0xc
    buffer_load_dwordx4 v14, s[32:35], 0 offen lds
    s_add_u32 m0, s31, 68608
    v_or_b32_dpp v15, v44, v3 row_newbcast:1 row_mask:0xf bank_mask:0x3
    v_or_b32_dpp v15, v44, v3 row_newbcast:9 row_mask:0xf bank_mask:0xc
    buffer_load_dwordx4 v15, s[32:35], 0 offen lds
    s_waitcnt vmcnt(4)
    ds_add_u32 v116, v117
    v_mov_b32 v77, 81968
    v_mov_b32 v79, s2
    s_mov_b64 exec, 1
    ds_add_rtn_u32 v78, v77, v117
    s_waitcnt lgkmcnt(0)
    v_cmp_eq_u32 s[60:61], 3, v78
    s_mov_b64 exec, -1
    v_lshlrev_b32 v76, 3, v79
    v_lshlrev_b32 v76, v76, v117
    v_and_b32 v79, 0xfc, v79
    v_lshlrev_b32 v77, 2, v0
    s_mov_b64 exec, s[60:61]
    s_cbranch_execz L_rsg
    buffer_atomic_or v76, v79, s[64:67], 0 offen sc1
L_rsg:
    s_mov_b64 exec, -1
    ds_read_b32 v94, v118 offset:32
    s_waitcnt lgkmcnt(0)
    v_cmp_gt_u32 vcc, 2, v94
    s_nop 1
    s_cbranch_vccnz L_rs0
L_rb0:
    ds_read_b128 v[96:99], v5 offset:0
    ds_read_b128 v[100:103], v5 offset:2048
    ds_read_b128 v[104:107], v5 offset:4096
    ds_read_b128 v[120:123], v5 offset:5120
    ds_read_b128 v[124:127], v5 offset:6144
    ds_read_b128 v[128:131], v5 offset:7168
    ds_read_b128 v[132:135], v5 offset:8192
    ds_read_b128 v[136:139], v5 offset:9216
    ds_read_b128 v[140:143], v5 offset:10240
    ds_read_b128 v[144:147], v5 offset:11264
    ds_read_b128 v[148:151], v5 offset:12288
    ds_read_b128 v[152:155], v5 offset:13312
    ds_read_b128 v[156:159], v5 offset:14336
    ds_read_b128 v[160:163], v5 offset:35840
    ds_read_b128 v[164:167], v5 offset:36864
    ds_read_b128 v[168:171], v5 offset:37888
    ds_read_b128 v[68:71], v5 offset:38912
    ds_read_b128 v[72:75], v5 offset:39936
    ds_read_b128 v[248:251], v5 offset:40960
    ds_read_b128 v[252:255], v5 offset:41984
    ds_read_b128 v[240:243], v5 offset:43008
    ds_read_b128 v[244:247], v5 offset:44032
    ds_read_b128 v[64:67], v5 offset:45056
    ds_add_u32 v116, v117 offset:80
    ds_read_b32 v94, v118 offset:16
    s_waitcnt lgkmcnt(0)
    v_cmp_gt_u32 vcc, 1, v94
    s_nop 1
    s_cbranch_vccnz L_rs1
L_rb1:
    s_add_u32 m0, s31, 0
    v_or_b32_dpp v12, v33, v2 row_newbcast:1 row_mask:0xf bank_mask:0x3
    v_or_b32_dpp v12, v33, v2 row_newbcast:9 row_mask:0xf bank_mask:0xc
    buffer_load_dwordx4 v12, s[32:35], 0 offen lds
    s_add_u32 m0, s31, 1024
    v_or_b32_dpp v13, v37, v3 row_newbcast:1 row_mask:0xf bank_mask:0x3
    v_or_b32_dpp v13, v37, v3 row_newbcast:9 row_mask:0xf bank_mask:0xc
    buffer_load_dwordx4 v13, s[32:35], 0 offen lds
    s_add_u32 m0, s31, 2048
    v_or_b32_dpp v14, v41, v2 row_newbcast:1 row_mask:0xf bank_mask:0x3
    v_or_b32_dpp v14, v41, v2 row_newbcast:9 row_mask:0xf bank_mask:0xc
    buffer_load_dwordx4 v14, s[32:35], 0 offen lds
    s_add_u32 m0, s31, 3072
    v_or_b32_dpp v15, v45, v3 row_newbcast:1 row_mask:0xf bank_mask:0x3
    v_or_b32_dpp v15, v45, v3 row_newbcast:9 row_mask:0xf bank_mask:0xc
    buffer_load_dwordx4 v15, s[32:35], 0 offen lds
    buffer_load_dwordx4 v[16:19], v114, s[36:39], 0 offen offset:0
    buffer_load_dwordx4 v[20:23], v114, s[36:39], s40 offen offset:0
    buffer_load_dwordx4 v[24:27], v114, s[36:39], s41 offen offset:0
    buffer_load_dwordx4 v[28:31], v114, s[36:39], s42 offen offset:0
    s_waitcnt vmcnt(8)
    ds_add_u32 v116, v117
    v_lshlrev_b32 v48, 7, v48
    ds_bpermute_b32 v48, v4, v48
    v_lshlrev_b32 v49, 7, v49
    ds_bpermute_b32 v49, v4, v49
    s_add_u32 m0, s50, 32768
    s_waitcnt lgkmcnt(1)
    v_or_b32_dpp v12, v48, v2 row_newbcast:0 row_mask:0xf bank_mask:0x3
    v_or_b32_dpp v12, v48, v2 row_newbcast:8 row_mask:0xf bank_mask:0xc
    buffer_load_dwordx4 v12, s[32:35], 0 offen lds
    s_add_u32 m0, s50, 33792
    v_or_b32_dpp v13, v48, v3 row_newbcast:1 row_mask:0xf bank_mask:0x3
    v_or_b32_dpp v13, v48, v3 row_newbcast:9 row_mask:0xf bank_mask:0xc
    buffer_load_dwordx4 v13, s[32:35], 0 offen lds
    s_add_u32 m0, s50, 35328
    v_or_b32_dpp v14, v48, v2 row_newbcast:2 row_mask:0xf bank_mask:0x3
    v_or_b32_dpp v14, v48, v2 row_newbcast:10 row_mask:0xf bank_mask:0xc
    buffer_load_dwordx4 v14, s[32:35], 0 offen lds
    s_add_u32 m0, s50, 36352
    v_or_b32_dpp v15, v48, v3 row_newbcast:3 row_mask:0xf bank_mask:0x3
    v_or_b32_dpp v15, v48, v3 row_newbcast:11 row_mask:0xf bank_mask:0xc
    buffer_load_dwordx4 v15, s[32:35], 0 offen lds
    s_add_u32 m0, s50, 37888
    v_or_b32_dpp v12, v48, v2 row_newbcast:4 row_mask:0xf bank_mask:0x3
    v_or_b32_dpp v12, v48, v2 row_newbcast:12 row_mask:0xf bank_mask:0xc
    buffer_load_dwordx4 v12, s[32:35], 0 offen lds
    s_add_u32 m0, s50, 38912
    v_or_b32_dpp v13, v48, v3 row_newbcast:5 row_mask:0xf bank_mask:0x3
    v_or_b32_dpp v13, v48, v3 row_newbcast:13 row_mask:0xf bank_mask:0xc
    buffer_load_dwordx4 v13, s[32:35], 0 offen lds
    s_add_u32 m0, s50, 40448
    s_waitcnt lgkmcnt(0)
    v_or_b32_dpp v14, v49, v2 row_newbcast:4 row_mask:0xf bank_mask:0x3
    v_or_b32_dpp v14, v49, v2 row_newbcast:12 row_mask:0xf bank_mask:0xc
    s_mov_b32 exec_hi, 0
    buffer_load_dwordx4 v14, s[32:35], 0 offen lds
    s_mov_b32 exec_hi, -1
    v_lshlrev_b32 v50, 7, v50
    ds_bpermute_b32 v50, v61, v50
    v_lshlrev_b32 v51, 7, v51
    ds_bpermute_b32 v51, v61, v51
    ds_read_b32 v94, v118 offset:16
    s_waitcnt lgkmcnt(0)
    v_cmp_gt_u32 vcc, 2, v94
    s_nop 1
    s_cbranch_vccnz L_rs2
L_rb2:
    s_add_u32 m0, s31, 16384
    v_or_b32_dpp v15, v34, v2 row_newbcast:1 row_mask:0xf bank_mask:0x3
    v_or_b32_dpp v15, v34, v2 row_newbcast:9 row_mask:0xf bank_mask:0xc
    buffer_load_dwordx4 v15, s[32:35], 0 offen lds
    s_add_u32 m0, s31, 17408
    v_or_b32_dpp v12, v38, v3 row_newbcast:1 row_mask:0xf bank_mask:0x3
    v_or_b32_dpp v12, v38, v3 row_newbcast:9 row_mask:0xf bank_mask:0xc
    buffer_load_dwordx4 v12, s[32:35], 0 offen lds
    s_add_u32 m0, s31, 18432
    v_or_b32_dpp v13, v42, v2 row_newbcast:1 row_mask:0xf bank_mask:0x3
    v_or_b32_dpp v13, v42, v2 row_newbcast:9 row_mask:0xf bank_mask:0xc
    buffer_load_dwordx4 v13, s[32:35], 0 offen lds
    s_add_u32 m0, s31, 19456
    v_or_b32_dpp v14, v46, v3 row_newbcast:1 row_mask:0xf bank_mask:0x3
    v_or_b32_dpp v14, v46, v3 row_newbcast:9 row_mask:0xf bank_mask:0xc
    buffer_load_dwordx4 v14, s[32:35], 0 offen lds
    ds_read_b32 v94, v118 offset:80
    s_waitcnt lgkmcnt(0)
    v_cmp_gt_u32 vcc, 1, v94
    s_nop 1
    s_cbranch_vccnz L_rs3
L_rb3:
    v_lshl_add_u32 v80, v0, 3, s50
    v_mov_b32 v82, 0
    v_mov_b32 v83, 0
    ds_write_b64 v80, v[82:83] offset:7680
    s_add_u32 m0, s50, 0
    v_or_b32_dpp v15, v48, v2 row_newbcast:6 row_mask:0xf bank_mask:0x3
    v_or_b32_dpp v15, v48, v2 row_newbcast:14 row_mask:0xf bank_mask:0xc
    buffer_load_dwordx4 v15, s[32:35], 0 offen lds
    s_add_u32 m0, s50, 1024
    v_or_b32_dpp v12, v48, v3 row_newbcast:7 row_mask:0xf bank_mask:0x3
    v_or_b32_dpp v12, v48, v3 row_newbcast:15 row_mask:0xf bank_mask:0xc
    buffer_load_dwordx4 v12, s[32:35], 0 offen lds
    s_add_u32 m0, s50, 2560
    v_or_b32_dpp v13, v49, v2 row_newbcast:0 row_mask:0xf bank_mask:0x3
    v_or_b32_dpp v13, v49, v2 row_newbcast:8 row_mask:0xf bank_mask:0xc
    buffer_load_dwordx4 v13, s[32:35], 0 offen lds
    s_add_u32 m0, s50, 3584
    v_or_b32_dpp v14, v49, v3 row_newbcast:1 row_mask:0xf bank_mask:0x3
    v_or_b32_dpp v14, v49, v3 row_newbcast:9 row_mask:0xf bank_mask:0xc
    buffer_load_dwordx4 v14, s[32:35], 0 offen lds
    buffer_load_dword v52, v11, s[36:39], 0 offen offset:800
    buffer_load_dword v53, v11, s[36:39], 0 offen offset:1056
    s_add_u32 m0, s50, 5120
    v_or_b32_dpp v15, v49, v2 row_newbcast:2 row_mask:0xf bank_mask:0x3
    v_or_b32_dpp v15, v49, v2 row_newbcast:10 row_mask:0xf bank_mask:0xc
    buffer_load_dwordx4 v15, s[32:35], 0 offen lds
    s_add_u32 m0, s50, 6144
    v_or_b32_dpp v12, v49, v3 row_newbcast:3 row_mask:0xf bank_mask:0x3
    v_or_b32_dpp v12, v49, v3 row_newbcast:11 row_mask:0xf bank_mask:0xc
    buffer_load_dwordx4 v12, s[32:35], 0 offen lds
    s_waitcnt vmcnt(23)
    ds_add_u32 v116, v117
    ds_read_b32 v119, v118 offset:16
    s_waitcnt lgkmcnt(0)
    v_cmp_gt_u32 vcc, 3, v119
    s_nop 0
    s_cbranch_vccnz L_rs4
L_rb4:
    s_add_u32 m0, s31, 32768
    v_or_b32_dpp v13, v35, v2 row_newbcast:1 row_mask:0xf bank_mask:0x3
    v_or_b32_dpp v13, v35, v2 row_newbcast:9 row_mask:0xf bank_mask:0xc
    buffer_load_dwordx4 v13, s[32:35], 0 offen lds
    s_waitcnt vmcnt(13)
    s_mov_b64 exec, s[46:47]
    ds_read_b128 v[232:235], v7 offset:40448
    ds_read_b128 v[236:239], v8 offset:40448
    s_mov_b64 exec, -1
    s_add_u32 m0, s31, 33792
    v_or_b32_dpp v14, v39, v3 row_newbcast:1 row_mask:0xf bank_mask:0x3
    v_or_b32_dpp v14, v39, v3 row_newbcast:9 row_mask:0xf bank_mask:0xc
    buffer_load_dwordx4 v14, s[32:35], 0 offen lds
    ds_read_b128 v[176:179], v7 offset:32768
    ds_read_b128 v[180:183], v8 offset:32768
    v_mov_b32 v78, 0x01010101
    s_cmp_lg_u32 s3, 0
    s_cbranch_scc1 L_rgi
    buffer_load_dword v78, v77, s[64:67], 0 offen sc1
L_rgi:
    s_waitcnt lgkmcnt(0)
    s_add_u32 m0, s50, 33280
    v_or_b32_dpp v15, v50, v62 row_newbcast:0 row_mask:0xf bank_mask:0x3
    v_or_b32_dpp v15, v50, v62 row_newbcast:8 row_mask:0xf bank_mask:0xc
    buffer_load_dwordx4 v15, s[32:35], 0 offen lds
    s_add_u32 m0, s50, 34304
    v_or_b32_dpp v12, v50, v63 row_newbcast:1 row_mask:0xf bank_mask:0x3
    v_or_b32_dpp v12, v50, v63 row_newbcast:9 row_mask:0xf bank_mask:0xc
    buffer_load_dwordx4 v12, s[32:35], 0 offen lds
    s_waitcnt vmcnt(12)
    ds_add_u32 v116, v117
    ds_read_b128 v[184:187], v7 offset:35328
    ds_read_b128 v[188:191], v8 offset:35328
    s_add_u32 m0, s31, 34816
    v_or_b32_dpp v13, v43, v2 row_newbcast:1 row_mask:0xf bank_mask:0x3
    v_or_b32_dpp v13, v43, v2 row_newbcast:9 row_mask:0xf bank_mask:0xc
    buffer_load_dwordx4 v13, s[32:35], 0 offen lds
    s_waitcnt lgkmcnt(0)
    s_add_u32 m0, s50, 35840
    v_or_b32_dpp v14, v50, v62 row_newbcast:2 row_mask:0xf bank_mask:0x3
    v_or_b32_dpp v14, v50, v62 row_newbcast:10 row_mask:0xf bank_mask:0xc
    buffer_load_dwordx4 v14, s[32:35], 0 offen lds
    s_add_u32 m0, s50, 36864
    v_or_b32_dpp v15, v50, v63 row_newbcast:3 row_mask:0xf bank_mask:0x3
    v_or_b32_dpp v15, v50, v63 row_newbcast:11 row_mask:0xf bank_mask:0xc
    buffer_load_dwordx4 v15, s[32:35], 0 offen lds
    s_mov_b64 exec, s[44:45]
    v_mov_b64 v[232:233], v[176:177]
    v_mov_b64 v[234:235], v[178:179]
    v_mov_b64 v[236:237], v[180:181]
    v_mov_b64 v[238:239], v[182:183]
    s_mov_b64 exec, -1
    s_add_u32 m0, s31, 35840
    v_or_b32_dpp v12, v47, v3 row_newbcast:1 row_mask:0xf bank_mask:0x3
    v_or_b32_dpp v12, v47, v3 row_newbcast:9 row_mask:0xf bank_mask:0xc
    buffer_load_dwordx4 v12, s[32:35], 0 offen lds
    ds_read_b128 v[192:195], v7 offset:37888
    ds_read_b128 v[196:199], v8 offset:37888
    v_mfma_f32_16x16x32_bf16 v[80:83], v[176:179], v[232:235], 0
    v_mfma_f32_16x16x32_bf16 v[80:83], v[180:183], v[236:239], v[80:83]
    v_lshlrev_b32 v16, 7, v16
    v_lshlrev_b32 v17, 7, v17
    v_lshlrev_b32 v18, 7, v18
    v_lshlrev_b32 v19, 7, v19
    v_lshlrev_b32 v20, 7, v20
    v_lshlrev_b32 v21, 7, v21
    v_lshlrev_b32 v22, 7, v22
    v_lshlrev_b32 v23, 7, v23
    v_lshlrev_b32 v24, 7, v24
    v_lshlrev_b32 v25, 7, v25
    v_lshlrev_b32 v26, 7, v26
    v_lshlrev_b32 v27, 7, v27
    v_lshlrev_b32 v28, 7, v28
    v_lshlrev_b32 v29, 7, v29
    v_lshlrev_b32 v30, 7, v30
    v_lshlrev_b32 v31, 7, v31
    s_waitcnt vmcnt(6)
    v_cmp_ne_u32 vcc, 16843009, v78
    s_mov_b32 s27, 40000
    s_nop 0
    s_cbranch_vccz L_rg2
L_rg1:
    buffer_load_dword v78, v77, s[64:67], 0 offen sc1
    s_waitcnt vmcnt(0)
    v_cmp_ne_u32 vcc, 16843009, v78
    s_sub_u32 s27, s27, 1
    s_cbranch_scc1 L_rg2
    s_cbranch_vccnz L_rg1
L_rg2:
    ds_add_u32 v116, v117 offset:64
    ds_read_b32 v119, v118 offset:16
    s_waitcnt lgkmcnt(2)
    s_add_u32 m0, s50, 38400
    v_or_b32_dpp v13, v50, v62 row_newbcast:4 row_mask:0xf bank_mask:0x3
    v_or_b32_dpp v13, v50, v62 row_newbcast:12 row_mask:0xf bank_mask:0xc
    buffer_load_dwordx4 v13, s[32:35], 0 offen lds
    s_add_u32 m0, s50, 39424
    v_or_b32_dpp v14, v50, v63 row_newbcast:5 row_mask:0xf bank_mask:0x3
    v_or_b32_dpp v14, v50, v63 row_newbcast:13 row_mask:0xf bank_mask:0xc
    buffer_load_dwordx4 v14, s[32:35], 0 offen lds
    s_mov_b64 exec, s[44:45]
    v_mov_b64 v[232:233], v[184:185]
    v_mov_b64 v[234:235], v[186:187]
    v_mov_b64 v[236:237], v[188:189]
    v_mov_b64 v[238:239], v[190:191]
    s_mov_b64 exec, -1
    v_mfma_f32_16x16x32_bf16 v[84:87], v[176:179], v[184:187], 0
    v_mfma_f32_16x16x32_bf16 v[84:87], v[180:183], v[188:191], v[84:87]
    s_waitcnt lgkmcnt(0)
    v_cmp_gt_u32 vcc, 4, v119
    s_nop 0
    s_cbranch_vccnz L_rs5
L_rb5:
    s_add_u32 m0, s31, 49152
    v_or_b32_dpp v15, v16, v2 row_newbcast:2 row_mask:0xf bank_mask:0x3
    v_or_b32_dpp v15, v16, v2 row_newbcast:10 row_mask:0xf bank_mask:0xc
    buffer_load_dwordx4 v15, s[32:35], 0 offen lds
    v_mfma_f32_16x16x32_bf16 v[88:91], v[184:187], v[232:235], 0
    v_mfma_f32_16x16x32_bf16 v[88:91], v[188:191], v[236:239], v[88:91]
    v_mul_f32 v108, v80, v104
    v_mul_f32 v109, v81, v105
    v_mul_f32 v110, v82, v106
    v_mul_f32 v111, v83, v107
    s_add_u32 m0, s31, 50176
    v_or_b32_dpp v12, v20, v3 row_newbcast:2 row_mask:0xf bank_mask:0x3
    v_or_b32_dpp v12, v20, v3 row_newbcast:10 row_mask:0xf bank_mask:0xc
    buffer_load_dwordx4 v12, s[32:35], 0 offen lds
    ds_read_b128 v[200:203], v56 offset:32768
    ds_read_b128 v[204:207], v57 offset:32768
    v_mfma_f32_16x16x32_bf16 v[92:95], v[176:179], v[192:195], 0
    v_mfma_f32_16x16x32_bf16 v[92:95], v[180:183], v[196:199], v[92:95]
    v_fmac_f32 v108, v84, v120
    v_fmac_f32 v109, v85, v121
    v_fmac_f32 v110, v86, v122
    v_fmac_f32 v111, v87, v123
    s_waitcnt vmcnt(4)
    ds_add_u32 v116, v117
    s_waitcnt lgkmcnt(1)
    s_add_u32 m0, s50, 39936
    v_or_b32_dpp v13, v51, v63 row_newbcast:5 row_mask:0xf bank_mask:0x3
    v_or_b32_dpp v13, v51, v63 row_newbcast:13 row_mask:0xf bank_mask:0xc
    s_mov_b32 exec_lo, 0
    buffer_load_dwordx4 v13, s[32:35], 0 offen lds
    s_mov_b32 exec_lo, -1
    v_lshlrev_b32 v52, 7, v52
    ds_bpermute_b32 v52, v4, v52
    v_lshlrev_b32 v53, 7, v53
    ds_bpermute_b32 v53, v4, v53
    ds_read_b128 v[208:211], v7
    ds_read_b128 v[212:215], v8
    s_mov_b64 exec, s[44:45]
    v_mov_b64 v[232:233], v[192:193]
    v_mov_b64 v[234:235], v[194:195]
    v_mov_b64 v[236:237], v[196:197]
    v_mov_b64 v[238:239], v[198:199]
    s_mov_b64 exec, -1
    v_mfma_f32_16x16x32_bf16 v[80:83], v[184:187], v[192:195], 0
    v_mfma_f32_16x16x32_bf16 v[80:83], v[188:191], v[196:199], v[80:83]
    v_fmac_f32 v108, v88, v124
    v_fmac_f32 v109, v89, v125
    v_fmac_f32 v110, v90, v126
    v_fmac_f32 v111, v91, v127
    s_add_u32 m0, s31, 51200
    v_or_b32_dpp v14, v24, v2 row_newbcast:2 row_mask:0xf bank_mask:0x3
    v_or_b32_dpp v14, v24, v2 row_newbcast:10 row_mask:0xf bank_mask:0xc
    buffer_load_dwordx4 v14, s[32:35], 0 offen lds
    s_waitcnt lgkmcnt(0)
    s_add_u32 m0, s50, 512
    v_or_b32_dpp v15, v50, v62 row_newbcast:6 row_mask:0xf bank_mask:0x3
    v_or_b32_dpp v15, v50, v62 row_newbcast:14 row_mask:0xf bank_mask:0xc
    buffer_load_dwordx4 v15, s[32:35], 0 offen lds
    s_add_u32 m0, s50, 1536
    v_or_b32_dpp v12, v50, v63 row_newbcast:7 row_mask:0xf bank_mask:0x3
    v_or_b32_dpp v12, v50, v63 row_newbcast:15 row_mask:0xf bank_mask:0xc
    buffer_load_dwordx4 v12, s[32:35], 0 offen lds
    v_mfma_f32_16x16x32_bf16 v[84:87], v[192:195], v[232:235], 0
    v_mfma_f32_16x16x32_bf16 v[84:87], v[196:199], v[236:239], v[84:87]
    v_fmac_f32 v108, v92, v128
    v_fmac_f32 v109, v93, v129
    v_fmac_f32 v110, v94, v130
    v_fmac_f32 v111, v95, v131
    s_add_u32 m0, s31, 52224
    v_or_b32_dpp v13, v28, v3 row_newbcast:2 row_mask:0xf bank_mask:0x3
    v_or_b32_dpp v13, v28, v3 row_newbcast:10 row_mask:0xf bank_mask:0xc
    buffer_load_dwordx4 v13, s[32:35], 0 offen lds
    v_mfma_f32_16x16x32_bf16 v[88:91], v[200:203], v[200:203], 0
    v_mfma_f32_16x16x32_bf16 v[88:91], v[204:207], v[204:207], v[88:91]
    v_fmac_f32 v108, v80, v132
    v_fmac_f32 v109, v81, v133
    v_fmac_f32 v110, v82, v134
    v_fmac_f32 v111, v83, v135
    s_mov_b64 exec, s[44:45]
    v_mov_b64 v[232:233], v[208:209]
    v_mov_b64 v[234:235], v[210:211]
    v_mov_b64 v[236:237], v[212:213]
    v_mov_b64 v[238:239], v[214:215]
    s_mov_b64 exec, -1
    v_mfma_f32_16x16x32_bf16 v[92:95], v[176:179], v[208:211], 0
    v_mfma_f32_16x16x32_bf16 v[92:95], v[180:183], v[212:215], v[92:95]
    v_fmac_f32 v108, v84, v136
    v_fmac_f32 v109, v85, v137
    v_fmac_f32 v110, v86, v138
    v_fmac_f32 v111, v87, v139
    ds_read_b32 v119, v118 offset:16
    ds_read_b128 v[216:219], v7 offset:2560
    ds_read_b128 v[220:223], v8 offset:2560
    v_mfma_f32_16x16x32_bf16 v[80:83], v[208:211], v[232:235], 0
    v_mfma_f32_16x16x32_bf16 v[80:83], v[212:215], v[236:239], v[80:83]
    v_fmac_f32 v108, v88, v96
    v_fmac_f32 v109, v89, v97
    v_fmac_f32 v110, v90, v98
    v_fmac_f32 v111, v91, v99
    s_waitcnt lgkmcnt(2)
    v_cmp_gt_u32 vcc, 5, v119
    s_nop 0
    s_cbranch_vccnz L_rs6
L_rb6:
    s_add_u32 m0, s31, 65536
    v_or_b32_dpp v14, v17, v2 row_newbcast:2 row_mask:0xf bank_mask:0x3
    v_or_b32_dpp v14, v17, v2 row_newbcast:10 row_mask:0xf bank_mask:0xc
    buffer_load_dwordx4 v14, s[32:35], 0 offen lds
    s_waitcnt lgkmcnt(0)
    s_add_u32 m0, s50, 3072
    v_or_b32_dpp v15, v51, v62 row_newbcast:0 row_mask:0xf bank_mask:0x3
    v_or_b32_dpp v15, v51, v62 row_newbcast:8 row_mask:0xf bank_mask:0xc
    buffer_load_dwordx4 v15, s[32:35], 0 offen lds
    s_add_u32 m0, s50, 4096
    v_or_b32_dpp v12, v51, v63 row_newbcast:1 row_mask:0xf bank_mask:0x3
    v_or_b32_dpp v12, v51, v63 row_newbcast:9 row_mask:0xf bank_mask:0xc
    buffer_load_dwordx4 v12, s[32:35], 0 offen lds
    buffer_load_dword v54, v11, s[36:39], 0 offen offset:1200
    buffer_load_dword v55, v11, s[36:39], 0 offen offset:1456
    v_mfma_f32_16x16x32_bf16 v[84:87], v[184:187], v[208:211], 0
    v_mfma_f32_16x16x32_bf16 v[84:87], v[188:191], v[212:215], v[84:87]
    v_fmac_f32 v108, v92, v140
    v_fmac_f32 v109, v93, v141
    v_fmac_f32 v110, v94, v142
    v_fmac_f32 v111, v95, v143
    s_add_u32 m0, s31, 66560
    v_or_b32_dpp v13, v21, v3 row_newbcast:2 row_mask:0xf bank_mask:0x3
    v_or_b32_dpp v13, v21, v3 row_newbcast:10 row_mask:0xf bank_mask:0xc
    buffer_load_dwordx4 v13, s[32:35], 0 offen lds
    v_mfma_f32_16x16x32_bf16 v[88:91], v[192:195], v[208:211], 0
    v_mfma_f32_16x16x32_bf16 v[88:91], v[196:199], v[212:215], v[88:91]
    v_fmac_f32 v108, v80, v144
    v_fmac_f32 v109, v81, v145
    v_fmac_f32 v110, v82, v146
    v_fmac_f32 v111, v83, v147
    s_waitcnt vmcnt(6)
    ds_add_u32 v116, v117
    s_mov_b64 exec, s[44:45]
    v_mov_b64 v[232:233], v[216:217]
    v_mov_b64 v[234:235], v[218:219]
    v_mov_b64 v[236:237], v[220:221]
    v_mov_b64 v[238:239], v[222:223]
    s_mov_b64 exec, -1
    v_mfma_f32_16x16x32_bf16 v[92:95], v[176:179], v[216:219], 0
    v_mfma_f32_16x16x32_bf16 v[92:95], v[180:183], v[220:223], v[92:95]
    v_fmac_f32 v108, v84, v148
    v_fmac_f32 v109, v85, v149
    v_fmac_f32 v110, v86, v150
    v_fmac_f32 v111, v87, v151
    s_add_u32 m0, s31, 67584
    v_or_b32_dpp v14, v25, v2 row_newbcast:2 row_mask:0xf bank_mask:0x3
    v_or_b32_dpp v14, v25, v2 row_newbcast:10 row_mask:0xf bank_mask:0xc
    buffer_load_dwordx4 v14, s[32:35], 0 offen lds
    v_mfma_f32_16x16x32_bf16 v[80:83], v[216:219], v[232:235], 0
    v_mfma_f32_16x16x32_bf16 v[80:83], v[220:223], v[236:239], v[80:83]
    v_fmac_f32 v108, v88, v152
    v_fmac_f32 v109, v89, v153
    v_fmac_f32 v110, v90, v154
    v_fmac_f32 v111, v91, v155
    s_add_u32 m0, s31, 68608
    v_or_b32_dpp v15, v29, v3 row_newbcast:2 row_mask:0xf bank_mask:0x3
    v_or_b32_dpp v15, v29, v3 row_newbcast:10 row_mask:0xf bank_mask:0xc
    buffer_load_dwordx4 v15, s[32:35], 0 offen lds
    ds_read_b128 v[224:227], v7 offset:5120
    ds_read_b128 v[228:231], v8 offset:5120
    v_mfma_f32_16x16x32_bf16 v[84:87], v[184:187], v[216:219], 0
    v_mfma_f32_16x16x32_bf16 v[84:87], v[188:191], v[220:223], v[84:87]
    v_fmac_f32 v108, v92, v156
    v_fmac_f32 v109, v93, v157
    v_fmac_f32 v110, v94, v158
    v_fmac_f32 v111, v95, v159
    ds_read_b32 v119, v118 offset:16
    s_waitcnt lgkmcnt(1)
    s_add_u32 m0, s50, 5632
    v_or_b32_dpp v12, v51, v62 row_newbcast:2 row_mask:0xf bank_mask:0x3
    v_or_b32_dpp v12, v51, v62 row_newbcast:10 row_mask:0xf bank_mask:0xc
    buffer_load_dwordx4 v12, s[32:35], 0 offen lds
    s_add_u32 m0, s50, 6656
    v_or_b32_dpp v13, v51, v63 row_newbcast:3 row_mask:0xf bank_mask:0x3
    v_or_b32_dpp v13, v51, v63 row_newbcast:11 row_mask:0xf bank_mask:0xc
    buffer_load_dwordx4 v13, s[32:35], 0 offen lds
    v_mfma_f32_16x16x32_bf16 v[88:91], v[192:195], v[216:219], 0
    v_mfma_f32_16x16x32_bf16 v[88:91], v[196:199], v[220:223], v[88:91]
    v_fmac_f32 v108, v80, v160
    v_fmac_f32 v109, v81, v161
    v_fmac_f32 v110, v82, v162
    v_fmac_f32 v111, v83, v163
    s_waitcnt lgkmcnt(0)
    v_cmp_gt_u32 vcc, 6, v119
    s_nop 0
    s_cbranch_vccnz L_rs7
L_rb7:
    s_add_u32 m0, s31, 0
    v_or_b32_dpp v14, v18, v2 row_newbcast:2 row_mask:0xf bank_mask:0x3
    v_or_b32_dpp v14, v18, v2 row_newbcast:10 row_mask:0xf bank_mask:0xc
    buffer_load_dwordx4 v14, s[32:35], 0 offen lds
    v_mfma_f32_16x16x32_bf16 v[92:95], v[208:211], v[216:219], 0
    v_mfma_f32_16x16x32_bf16 v[92:95], v[212:215], v[220:223], v[92:95]
    v_fmac_f32 v108, v84, v164
    v_fmac_f32 v109, v85, v165
    v_fmac_f32 v110, v86, v166
    v_fmac_f32 v111, v87, v167
    s_add_u32 m0, s31, 1024
    v_or_b32_dpp v15, v22, v3 row_newbcast:2 row_mask:0xf bank_mask:0x3
    v_or_b32_dpp v15, v22, v3 row_newbcast:10 row_mask:0xf bank_mask:0xc
    buffer_load_dwordx4 v15, s[32:35], 0 offen lds
    ds_read_b128 v[200:203], v56
    ds_read_b128 v[204:207], v57
    s_mov_b64 exec, s[44:45]
    v_mov_b64 v[232:233], v[224:225]
    v_mov_b64 v[234:235], v[226:227]
    v_mov_b64 v[236:237], v[228:229]
    v_mov_b64 v[238:239], v[230:231]
    s_mov_b64 exec, -1
    v_mfma_f32_16x16x32_bf16 v[80:83], v[176:179], v[224:227], 0
    v_mfma_f32_16x16x32_bf16 v[80:83], v[180:183], v[228:231], v[80:83]
    v_fmac_f32 v108, v88, v168
    v_fmac_f32 v109, v89, v169
    v_fmac_f32 v110, v90, v170
    v_fmac_f32 v111, v91, v171
    s_waitcnt vmcnt(4)
    ds_add_u32 v116, v117
    v_mfma_f32_16x16x32_bf16 v[84:87], v[224:227], v[232:235], 0
    v_mfma_f32_16x16x32_bf16 v[84:87], v[228:231], v[236:239], v[84:87]
    v_fmac_f32 v108, v92, v68
    v_fmac_f32 v109, v93, v69
    v_fmac_f32 v110, v94, v70
    v_fmac_f32 v111, v95, v71
    s_add_u32 m0, s31, 2048
    v_or_b32_dpp v12, v26, v2 row_newbcast:2 row_mask:0xf bank_mask:0x3
    v_or_b32_dpp v12, v26, v2 row_newbcast:10 row_mask:0xf bank_mask:0xc
    buffer_load_dwordx4 v12, s[32:35], 0 offen lds
    s_mov_b64 exec, s[46:47]
    ds_read_b128 v[232:235], v7 offset:40448
    ds_read_b128 v[236:239], v8 offset:40448
    s_mov_b64 exec, -1
    v_mfma_f32_16x16x32_bf16 v[88:91], v[184:187], v[224:227], 0
    v_mfma_f32_16x16x32_bf16 v[88:91], v[188:191], v[228:231], v[88:91]
    v_fmac_f32 v108, v80, v72
    v_fmac_f32 v109, v81, v73
    v_fmac_f32 v110, v82, v74
    v_fmac_f32 v111, v83, v75
    s_add_u32 m0, s31, 3072
    v_or_b32_dpp v13, v30, v3 row_newbcast:2 row_mask:0xf bank_mask:0x3
    v_or_b32_dpp v13, v30, v3 row_newbcast:10 row_mask:0xf bank_mask:0xc
    buffer_load_dwordx4 v13, s[32:35], 0 offen lds
    ds_read_b128 v[176:179], v9 offset:32768
    ds_read_b128 v[180:183], v10 offset:32768
    s_waitcnt lgkmcnt(6)
    v_mfma_f32_16x16x32_bf16 v[92:95], v[200:203], v[200:203], 0
    s_waitcnt lgkmcnt(5)
    v_mfma_f32_16x16x32_bf16 v[92:95], v[204:207], v[204:207], v[92:95]
    v_fmac_f32 v108, v84, v248
    v_fmac_f32 v109, v85, v249
    v_fmac_f32 v110, v86, v250
    v_fmac_f32 v111, v87, v251
    s_waitcnt lgkmcnt(0)
    s_add_u32 m0, s50, 32768
    v_or_b32_dpp v14, v52, v2 row_newbcast:0 row_mask:0xf bank_mask:0x3
    v_or_b32_dpp v14, v52, v2 row_newbcast:8 row_mask:0xf bank_mask:0xc
    buffer_load_dwordx4 v14, s[32:35], 0 offen lds
    s_add_u32 m0, s50, 33792
    v_or_b32_dpp v15, v52, v3 row_newbcast:1 row_mask:0xf bank_mask:0x3
    v_or_b32_dpp v15, v52, v3 row_newbcast:9 row_mask:0xf bank_mask:0xc
    buffer_load_dwordx4 v15, s[32:35], 0 offen lds
    v_mfma_f32_16x16x32_bf16 v[80:83], v[192:195], v[224:227], 0
    v_mfma_f32_16x16x32_bf16 v[80:83], v[196:199], v[228:231], v[80:83]
    v_fmac_f32 v108, v88, v252
    v_fmac_f32 v109, v89, v253
    v_fmac_f32 v110, v90, v254
    v_fmac_f32 v111, v91, v255
    ds_read_b32 v119, v118 offset:16
    ds_read_b128 v[184:187], v9 offset:35328
    ds_read_b128 v[188:191], v10 offset:35328
    v_mfma_f32_16x16x32_bf16 v[84:87], v[208:211], v[224:227], 0
    v_mfma_f32_16x16x32_bf16 v[84:87], v[212:215], v[228:231], v[84:87]
    v_fmac_f32 v108, v92, v100
    v_fmac_f32 v109, v93, v101
    v_fmac_f32 v110, v94, v102
    v_fmac_f32 v111, v95, v103
    s_waitcnt lgkmcnt(2)
    v_cmp_gt_u32 vcc, 7, v119
    s_nop 0
    s_cbranch_vccnz L_rs8
L_rb8:
    s_add_u32 m0, s31, 16384
    v_or_b32_dpp v12, v19, v2 row_newbcast:2 row_mask:0xf bank_mask:0x3
    v_or_b32_dpp v12, v19, v2 row_newbcast:10 row_mask:0xf bank_mask:0xc
    buffer_load_dwordx4 v12, s[32:35], 0 offen lds
    s_waitcnt lgkmcnt(0)
    s_add_u32 m0, s50, 35328
    v_or_b32_dpp v13, v52, v2 row_newbcast:2 row_mask:0xf bank_mask:0x3
    v_or_b32_dpp v13, v52, v2 row_newbcast:10 row_mask:0xf bank_mask:0xc
    buffer_load_dwordx4 v13, s[32:35], 0 offen lds
    s_add_u32 m0, s50, 36352
    v_or_b32_dpp v14, v52, v3 row_newbcast:3 row_mask:0xf bank_mask:0x3
    v_or_b32_dpp v14, v52, v3 row_newbcast:11 row_mask:0xf bank_mask:0xc
    buffer_load_dwordx4 v14, s[32:35], 0 offen lds
    s_mov_b64 exec, s[44:45]
    v_mov_b64 v[232:233], v[176:177]
    v_mov_b64 v[234:235], v[178:179]
    v_mov_b64 v[236:237], v[180:181]
    v_mov_b64 v[238:239], v[182:183]
    s_mov_b64 exec, -1
    v_mfma_f32_16x16x32_bf16 v[88:91], v[216:219], v[224:227], 0
    v_mfma_f32_16x16x32_bf16 v[88:91], v[220:223], v[228:231], v[88:91]
    v_fmac_f32 v108, v80, v240
    v_fmac_f32 v109, v81, v241
    v_fmac_f32 v110, v82, v242
    v_fmac_f32 v111, v83, v243
    s_add_u32 m0, s31, 17408
    v_or_b32_dpp v15, v23, v3 row_newbcast:2 row_mask:0xf bank_mask:0x3
    v_or_b32_dpp v15, v23, v3 row_newbcast:10 row_mask:0xf bank_mask:0xc
    buffer_load_dwordx4 v15, s[32:35], 0 offen lds
    ds_read_b128 v[200:203], v9 offset:37888
    ds_read_b128 v[204:207], v10 offset:37888
    v_mfma_f32_16x16x32_bf16 v[92:95], v[176:179], v[232:235], 0
    v_mfma_f32_16x16x32_bf16 v[92:95], v[180:183], v[236:239], v[92:95]
    v_fmac_f32 v108, v84, v244
    v_fmac_f32 v109, v85, v245
    v_fmac_f32 v110, v86, v246
    v_fmac_f32 v111, v87, v247
    s_waitcnt vmcnt(6)
    ds_add_u32 v116, v117
    s_waitcnt lgkmcnt(1)
    s_add_u32 m0, s50, 37888
    v_or_b32_dpp v12, v52, v2 row_newbcast:4 row_mask:0xf bank_mask:0x3
    v_or_b32_dpp v12, v52, v2 row_newbcast:12 row_mask:0xf bank_mask:0xc
    buffer_load_dwordx4 v12, s[32:35], 0 offen lds
    s_add_u32 m0, s50, 38912
    v_or_b32_dpp v13, v52, v3 row_newbcast:5 row_mask:0xf bank_mask:0x3
    v_or_b32_dpp v13, v52, v3 row_newbcast:13 row_mask:0xf bank_mask:0xc
    buffer_load_dwordx4 v13, s[32:35], 0 offen lds
    s_mov_b64 exec, s[44:45]
    v_mov_b64 v[232:233], v[184:185]
    v_mov_b64 v[234:235], v[186:187]
    v_mov_b64 v[236:237], v[188:189]
    v_mov_b64 v[238:239], v[190:191]
    s_mov_b64 exec, -1
    v_mfma_f32_16x16x32_bf16 v[80:83], v[176:179], v[184:187], 0
    v_mfma_f32_16x16x32_bf16 v[80:83], v[180:183], v[188:191], v[80:83]
    v_fmac_f32 v108, v88, v64
    v_fmac_f32 v109, v89, v65
    v_fmac_f32 v110, v90, v66
    v_fmac_f32 v111, v91, v67
    v_add_f32 v112, v108, v109
    v_add_f32 v113, v110, v111
    v_add_f32 v112, v112, v113
    s_nop 1
    v_add_f32_dpp v112, v112, v112 row_shr:1 row_mask:0xf bank_mask:0xf
    s_nop 1
    v_add_f32_dpp v112, v112, v112 row_shr:2 row_mask:0xf bank_mask:0xf
    s_nop 1
    v_add_f32_dpp v112, v112, v112 row_shr:4 row_mask:0xf bank_mask:0xf
    s_nop 1
    v_add_f32_dpp v112, v112, v112 row_shr:8 row_mask:0xf bank_mask:0xf
    s_nop 1
    v_add_f32_dpp v112, v112, v112 row_bcast:15 row_mask:0xa bank_mask:0xf
    s_nop 1
    v_add_f32_dpp v112, v112, v112 row_bcast:31 row_mask:0xc bank_mask:0xf
    s_nop 0
    v_readlane_b32 s52, v112, 63
    s_add_u32 m0, s31, 18432
    v_or_b32_dpp v14, v27, v2 row_newbcast:2 row_mask:0xf bank_mask:0x3
    v_or_b32_dpp v14, v27, v2 row_newbcast:10 row_mask:0xf bank_mask:0xc
    buffer_load_dwordx4 v14, s[32:35], 0 offen lds
    v_mfma_f32_16x16x32_bf16 v[84:87], v[184:187], v[232:235], 0
    v_mfma_f32_16x16x32_bf16 v[84:87], v[188:191], v[236:239], v[84:87]
    v_mul_f32 v108, v92, v104
    v_mul_f32 v109, v93, v105
    v_mul_f32 v110, v94, v106
    v_mul_f32 v111, v95, v107
    s_add_u32 m0, s31, 19456
    v_or_b32_dpp v15, v31, v3 row_newbcast:2 row_mask:0xf bank_mask:0x3
    v_or_b32_dpp v15, v31, v3 row_newbcast:10 row_mask:0xf bank_mask:0xc
    buffer_load_dwordx4 v15, s[32:35], 0 offen lds
    ds_read_b128 v[192:195], v58 offset:32768
    ds_read_b128 v[196:199], v59 offset:32768
    v_mfma_f32_16x16x32_bf16 v[88:91], v[176:179], v[200:203], 0
    v_mfma_f32_16x16x32_bf16 v[88:91], v[180:183], v[204:207], v[88:91]
    v_fmac_f32 v108, v80, v120
    v_fmac_f32 v109, v81, v121
    v_fmac_f32 v110, v82, v122
    v_fmac_f32 v111, v83, v123
    ds_read_b32 v119, v118 offset:16
    s_waitcnt lgkmcnt(1)
    s_add_u32 m0, s50, 40448
    v_or_b32_dpp v12, v53, v2 row_newbcast:4 row_mask:0xf bank_mask:0x3
    v_or_b32_dpp v12, v53, v2 row_newbcast:12 row_mask:0xf bank_mask:0xc
    s_mov_b32 exec_hi, 0
    buffer_load_dwordx4 v12, s[32:35], 0 offen lds
    s_mov_b32 exec_hi, -1
    v_lshlrev_b32 v54, 7, v54
    ds_bpermute_b32 v54, v61, v54
    v_lshlrev_b32 v55, 7, v55
    ds_bpermute_b32 v55, v61, v55
    ds_read_b128 v[208:211], v9
    ds_read_b128 v[212:215], v10
    s_mov_b64 exec, s[44:45]
    v_mov_b64 v[232:233], v[200:201]
    v_mov_b64 v[234:235], v[202:203]
    v_mov_b64 v[236:237], v[204:205]
    v_mov_b64 v[238:239], v[206:207]
    s_mov_b64 exec, -1
    v_mfma_f32_16x16x32_bf16 v[92:95], v[184:187], v[200:203], 0
    v_mfma_f32_16x16x32_bf16 v[92:95], v[188:191], v[204:207], v[92:95]
    v_fmac_f32 v108, v84, v124
    v_fmac_f32 v109, v85, v125
    v_fmac_f32 v110, v86, v126
    v_fmac_f32 v111, v87, v127
    s_waitcnt lgkmcnt(4)
    v_cmp_gt_u32 vcc, 8, v119
    s_nop 0
    s_cbranch_vccnz L_rs9
L_rb9:
    s_add_u32 m0, s31, 32768
    v_or_b32_dpp v13, v16, v2 row_newbcast:3 row_mask:0xf bank_mask:0x3
    v_or_b32_dpp v13, v16, v2 row_newbcast:11 row_mask:0xf bank_mask:0xc
    buffer_load_dwordx4 v13, s[32:35], 0 offen lds
    s_waitcnt lgkmcnt(0)
    s_add_u32 m0, s50, 0
    v_or_b32_dpp v14, v52, v2 row_newbcast:6 row_mask:0xf bank_mask:0x3
    v_or_b32_dpp v14, v52, v2 row_newbcast:14 row_mask:0xf bank_mask:0xc
    buffer_load_dwordx4 v14, s[32:35], 0 offen lds
    s_add_u32 m0, s50, 1024
    v_or_b32_dpp v15, v52, v3 row_newbcast:7 row_mask:0xf bank_mask:0x3
    v_or_b32_dpp v15, v52, v3 row_newbcast:15 row_mask:0xf bank_mask:0xc
    buffer_load_dwordx4 v15, s[32:35], 0 offen lds
    v_mfma_f32_16x16x32_bf16 v[80:83], v[200:203], v[232:235], 0
    v_mfma_f32_16x16x32_bf16 v[80:83], v[204:207], v[236:239], v[80:83]
    v_fmac_f32 v108, v88, v128
    v_fmac_f32 v109, v89, v129
    v_fmac_f32 v110, v90, v130
    v_fmac_f32 v111, v91, v131
    s_add_u32 m0, s31, 33792
    v_or_b32_dpp v12, v20, v3 row_newbcast:3 row_mask:0xf bank_mask:0x3
    v_or_b32_dpp v12, v20, v3 row_newbcast:11 row_mask:0xf bank_mask:0xc
    buffer_load_dwordx4 v12, s[32:35], 0 offen lds
    v_mfma_f32_16x16x32_bf16 v[84:87], v[192:195], v[192:195], 0
    v_mfma_f32_16x16x32_bf16 v[84:87], v[196:199], v[196:199], v[84:87]
    v_fmac_f32 v108, v92, v132
    v_fmac_f32 v109, v93, v133
    v_fmac_f32 v110, v94, v134
    v_fmac_f32 v111, v95, v135
    s_waitcnt vmcnt(5)
    ds_add_u32 v116, v117
    s_mov_b64 exec, s[44:45]
    v_mov_b64 v[232:233], v[208:209]
    v_mov_b64 v[234:235], v[210:211]
    v_mov_b64 v[236:237], v[212:213]
    v_mov_b64 v[238:239], v[214:215]
    s_mov_b64 exec, -1
    v_mfma_f32_16x16x32_bf16 v[88:91], v[176:179], v[208:211], 0
    v_mfma_f32_16x16x32_bf16 v[88:91], v[180:183], v[212:215], v[88:91]
    v_fmac_f32 v108, v80, v136
    v_fmac_f32 v109, v81, v137
    v_fmac_f32 v110, v82, v138
    v_fmac_f32 v111, v83, v139
    s_add_u32 m0, s31, 34816
    v_or_b32_dpp v13, v24, v2 row_newbcast:3 row_mask:0xf bank_mask:0x3
    v_or_b32_dpp v13, v24, v2 row_newbcast:11 row_mask:0xf bank_mask:0xc
    buffer_load_dwordx4 v13, s[32:35], 0 offen lds
    ds_read_b128 v[216:219], v9 offset:2560
    ds_read_b128 v[220:223], v10 offset:2560
    v_mfma_f32_16x16x32_bf16 v[92:95], v[208:211], v[232:235], 0
    v_mfma_f32_16x16x32_bf16 v[92:95], v[212:215], v[236:239], v[92:95]
    v_fmac_f32 v108, v84, v96
    v_fmac_f32 v109, v85, v97
    v_fmac_f32 v110, v86, v98
    v_fmac_f32 v111, v87, v99
    s_add_u32 m0, s31, 35840
    v_or_b32_dpp v14, v28, v3 row_newbcast:3 row_mask:0xf bank_mask:0x3
    v_or_b32_dpp v14, v28, v3 row_newbcast:11 row_mask:0xf bank_mask:0xc
    buffer_load_dwordx4 v14, s[32:35], 0 offen lds
    s_waitcnt lgkmcnt(0)
    s_add_u32 m0, s50, 2560
    v_or_b32_dpp v15, v53, v2 row_newbcast:0 row_mask:0xf bank_mask:0x3
    v_or_b32_dpp v15, v53, v2 row_newbcast:8 row_mask:0xf bank_mask:0xc
    buffer_load_dwordx4 v15, s[32:35], 0 offen lds
    s_add_u32 m0, s50, 3584
    v_or_b32_dpp v12, v53, v3 row_newbcast:1 row_mask:0xf bank_mask:0x3
    v_or_b32_dpp v12, v53, v3 row_newbcast:9 row_mask:0xf bank_mask:0xc
    buffer_load_dwordx4 v12, s[32:35], 0 offen lds
    buffer_load_dword v48, v11, s[36:39], 0 offen offset:1600
    buffer_load_dword v49, v11, s[36:39], 0 offen offset:1856
    v_mfma_f32_16x16x32_bf16 v[80:83], v[184:187], v[208:211], 0
    v_mfma_f32_16x16x32_bf16 v[80:83], v[188:191], v[212:215], v[80:83]
    v_fmac_f32 v108, v88, v140
    v_fmac_f32 v109, v89, v141
    v_fmac_f32 v110, v90, v142
    v_fmac_f32 v111, v91, v143
    v_mfma_f32_16x16x32_bf16 v[84:87], v[200:203], v[208:211], 0
    v_mfma_f32_16x16x32_bf16 v[84:87], v[204:207], v[212:215], v[84:87]
    v_fmac_f32 v108, v92, v144
    v_fmac_f32 v109, v93, v145
    v_fmac_f32 v110, v94, v146
    v_fmac_f32 v111, v95, v147
    ds_read_b32 v119, v118 offset:16
    s_mov_b64 exec, s[44:45]
    v_mov_b64 v[232:233], v[216:217]
    v_mov_b64 v[234:235], v[218:219]
    v_mov_b64 v[236:237], v[220:221]
    v_mov_b64 v[238:239], v[222:223]
    s_mov_b64 exec, -1
    v_mfma_f32_16x16x32_bf16 v[88:91], v[176:179], v[216:219], 0
    v_mfma_f32_16x16x32_bf16 v[88:91], v[180:183], v[220:223], v[88:91]
    v_fmac_f32 v108, v80, v148
    v_fmac_f32 v109, v81, v149
    v_fmac_f32 v110, v82, v150
    v_fmac_f32 v111, v83, v151
    s_waitcnt lgkmcnt(0)
    v_cmp_gt_u32 vcc, 9, v119
    s_nop 0
    s_cbranch_vccnz L_rs10
L_rb10:
    s_add_u32 m0, s31, 49152
    v_or_b32_dpp v13, v17, v2 row_newbcast:3 row_mask:0xf bank_mask:0x3
    v_or_b32_dpp v13, v17, v2 row_newbcast:11 row_mask:0xf bank_mask:0xc
    buffer_load_dwordx4 v13, s[32:35], 0 offen lds
    v_mfma_f32_16x16x32_bf16 v[92:95], v[216:219], v[232:235], 0
    v_mfma_f32_16x16x32_bf16 v[92:95], v[220:223], v[236:239], v[92:95]
    v_fmac_f32 v108, v84, v152
    v_fmac_f32 v109, v85, v153
    v_fmac_f32 v110, v86, v154
    v_fmac_f32 v111, v87, v155
    s_add_u32 m0, s31, 50176
    v_or_b32_dpp v14, v21, v3 row_newbcast:3 row_mask:0xf bank_mask:0x3
    v_or_b32_dpp v14, v21, v3 row_newbcast:11 row_mask:0xf bank_mask:0xc
    buffer_load_dwordx4 v14, s[32:35], 0 offen lds
    ds_read_b128 v[224:227], v9 offset:5120
    ds_read_b128 v[228:231], v10 offset:5120
    v_mfma_f32_16x16x32_bf16 v[80:83], v[184:187], v[216:219], 0
    v_mfma_f32_16x16x32_bf16 v[80:83], v[188:191], v[220:223], v[80:83]
    v_fmac_f32 v108, v88, v156
    v_fmac_f32 v109, v89, v157
    v_fmac_f32 v110, v90, v158
    v_fmac_f32 v111, v91, v159
    s_waitcnt vmcnt(6)
    ds_add_u32 v116, v117
    s_waitcnt lgkmcnt(1)
    s_add_u32 m0, s50, 5120
    v_or_b32_dpp v15, v53, v2 row_newbcast:2 row_mask:0xf bank_mask:0x3
    v_or_b32_dpp v15, v53, v2 row_newbcast:10 row_mask:0xf bank_mask:0xc
    buffer_load_dwordx4 v15, s[32:35], 0 offen lds
    s_add_u32 m0, s50, 6144
    v_or_b32_dpp v12, v53, v3 row_newbcast:3 row_mask:0xf bank_mask:0x3
    v_or_b32_dpp v12, v53, v3 row_newbcast:11 row_mask:0xf bank_mask:0xc
    buffer_load_dwordx4 v12, s[32:35], 0 offen lds
    v_mfma_f32_16x16x32_bf16 v[84:87], v[200:203], v[216:219], 0
    v_mfma_f32_16x16x32_bf16 v[84:87], v[204:207], v[220:223], v[84:87]
    v_fmac_f32 v108, v92, v160
    v_fmac_f32 v109, v93, v161
    v_fmac_f32 v110, v94, v162
    v_fmac_f32 v111, v95, v163
    s_add_u32 m0, s31, 51200
    v_or_b32_dpp v13, v25, v2 row_newbcast:3 row_mask:0xf bank_mask:0x3
    v_or_b32_dpp v13, v25, v2 row_newbcast:11 row_mask:0xf bank_mask:0xc
    buffer_load_dwordx4 v13, s[32:35], 0 offen lds
    v_mfma_f32_16x16x32_bf16 v[88:91], v[208:211], v[216:219], 0
    v_mfma_f32_16x16x32_bf16 v[88:91], v[212:215], v[220:223], v[88:91]
    v_fmac_f32 v108, v80, v164
    v_fmac_f32 v109, v81, v165
    v_fmac_f32 v110, v82, v166
    v_fmac_f32 v111, v83, v167
    s_add_u32 m0, s31, 52224
    v_or_b32_dpp v14, v29, v3 row_newbcast:3 row_mask:0xf bank_mask:0x3
    v_or_b32_dpp v14, v29, v3 row_newbcast:11 row_mask:0xf bank_mask:0xc
    buffer_load_dwordx4 v14, s[32:35], 0 offen lds
    ds_read_b128 v[192:195], v58
    ds_read_b128 v[196:199], v59
    s_mov_b64 exec, s[44:45]
    v_mov_b64 v[232:233], v[224:225]
    v_mov_b64 v[234:235], v[226:227]
    v_mov_b64 v[236:237], v[228:229]
    v_mov_b64 v[238:239], v[230:231]
    s_mov_b64 exec, -1
    v_mfma_f32_16x16x32_bf16 v[92:95], v[176:179], v[224:227], 0
    v_mfma_f32_16x16x32_bf16 v[92:95], v[180:183], v[228:231], v[92:95]
    v_fmac_f32 v108, v84, v168
    v_fmac_f32 v109, v85, v169
    v_fmac_f32 v110, v86, v170
    v_fmac_f32 v111, v87, v171
    v_mfma_f32_16x16x32_bf16 v[80:83], v[224:227], v[232:235], 0
    v_mfma_f32_16x16x32_bf16 v[80:83], v[228:231], v[236:239], v[80:83]
    v_fmac_f32 v108, v88, v68
    v_fmac_f32 v109, v89, v69
    v_fmac_f32 v110, v90, v70
    v_fmac_f32 v111, v91, v71
    ds_read_b32 v119, v118 offset:16
    s_mov_b64 exec, s[46:47]
    ds_read_b128 v[232:235], v7 offset:40448
    ds_read_b128 v[236:239], v8 offset:40448
    s_mov_b64 exec, -1
    v_mfma_f32_16x16x32_bf16 v[84:87], v[184:187], v[224:227], 0
    v_mfma_f32_16x16x32_bf16 v[84:87], v[188:191], v[228:231], v[84:87]
    v_fmac_f32 v108, v92, v72
    v_fmac_f32 v109, v93, v73
    v_fmac_f32 v110, v94, v74
    v_fmac_f32 v111, v95, v75
    s_waitcnt lgkmcnt(2)
    v_cmp_gt_u32 vcc, 10, v119
    s_nop 0
    s_cbranch_vccnz L_rs11
L_rb11:
    s_add_u32 m0, s31, 65536
    v_or_b32_dpp v15, v18, v2 row_newbcast:3 row_mask:0xf bank_mask:0x3
    v_or_b32_dpp v15, v18, v2 row_newbcast:11 row_mask:0xf bank_mask:0xc
    buffer_load_dwordx4 v15, s[32:35], 0 offen lds
    ds_read_b128 v[176:179], v7 offset:32768
    ds_read_b128 v[180:183], v8 offset:32768
    v_mfma_f32_16x16x32_bf16 v[88:91], v[192:195], v[192:195], 0
    v_mfma_f32_16x16x32_bf16 v[88:91], v[196:199], v[196:199], v[88:91]
    v_fmac_f32 v108, v80, v248
    v_fmac_f32 v109, v81, v249
    v_fmac_f32 v110, v82, v250
    v_fmac_f32 v111, v83, v251
    s_add_u32 m0, s31, 66560
    v_or_b32_dpp v12, v22, v3 row_newbcast:3 row_mask:0xf bank_mask:0x3
    v_or_b32_dpp v12, v22, v3 row_newbcast:11 row_mask:0xf bank_mask:0xc
    buffer_load_dwordx4 v12, s[32:35], 0 offen lds
    s_waitcnt lgkmcnt(0)
    s_add_u32 m0, s50, 33280
    v_or_b32_dpp v13, v54, v62 row_newbcast:0 row_mask:0xf bank_mask:0x3
    v_or_b32_dpp v13, v54, v62 row_newbcast:8 row_mask:0xf bank_mask:0xc
    buffer_load_dwordx4 v13, s[32:35], 0 offen lds
    s_add_u32 m0, s50, 34304
    v_or_b32_dpp v14, v54, v63 row_newbcast:1 row_mask:0xf bank_mask:0x3
    v_or_b32_dpp v14, v54, v63 row_newbcast:9 row_mask:0xf bank_mask:0xc
    buffer_load_dwordx4 v14, s[32:35], 0 offen lds
    v_mfma_f32_16x16x32_bf16 v[92:95], v[200:203], v[224:227], 0
    v_mfma_f32_16x16x32_bf16 v[92:95], v[204:207], v[228:231], v[92:95]
    v_fmac_f32 v108, v84, v252
    v_fmac_f32 v109, v85, v253
    v_fmac_f32 v110, v86, v254
    v_fmac_f32 v111, v87, v255
    s_waitcnt vmcnt(4)
    ds_add_u32 v116, v117
    ds_read_b128 v[184:187], v7 offset:35328
    ds_read_b128 v[188:191], v8 offset:35328
    v_mfma_f32_16x16x32_bf16 v[80:83], v[208:211], v[224:227], 0
    v_mfma_f32_16x16x32_bf16 v[80:83], v[212:215], v[228:231], v[80:83]
    v_fmac_f32 v108, v88, v100
    v_fmac_f32 v109, v89, v101
    v_fmac_f32 v110, v90, v102
    v_fmac_f32 v111, v91, v103
    s_add_u32 m0, s31, 67584
    v_or_b32_dpp v15, v26, v2 row_newbcast:3 row_mask:0xf bank_mask:0x3
    v_or_b32_dpp v15, v26, v2 row_newbcast:11 row_mask:0xf bank_mask:0xc
    buffer_load_dwordx4 v15, s[32:35], 0 offen lds
    s_waitcnt lgkmcnt(0)
    s_add_u32 m0, s50, 35840
    v_or_b32_dpp v12, v54, v62 row_newbcast:2 row_mask:0xf bank_mask:0x3
    v_or_b32_dpp v12, v54, v62 row_newbcast:10 row_mask:0xf bank_mask:0xc
    buffer_load_dwordx4 v12, s[32:35], 0 offen lds
    s_add_u32 m0, s50, 36864
    v_or_b32_dpp v13, v54, v63 row_newbcast:3 row_mask:0xf bank_mask:0x3
    v_or_b32_dpp v13, v54, v63 row_newbcast:11 row_mask:0xf bank_mask:0xc
    buffer_load_dwordx4 v13, s[32:35], 0 offen lds
    s_mov_b64 exec, s[44:45]
    v_mov_b64 v[232:233], v[176:177]
    v_mov_b64 v[234:235], v[178:179]
    v_mov_b64 v[236:237], v[180:181]
    v_mov_b64 v[238:239], v[182:183]
    s_mov_b64 exec, -1
    v_mfma_f32_16x16x32_bf16 v[84:87], v[216:219], v[224:227], 0
    v_mfma_f32_16x16x32_bf16 v[84:87], v[220:223], v[228:231], v[84:87]
    v_fmac_f32 v108, v92, v240
    v_fmac_f32 v109, v93, v241
    v_fmac_f32 v110, v94, v242
    v_fmac_f32 v111, v95, v243
    s_add_u32 m0, s31, 68608
    v_or_b32_dpp v14, v30, v3 row_newbcast:3 row_mask:0xf bank_mask:0x3
    v_or_b32_dpp v14, v30, v3 row_newbcast:11 row_mask:0xf bank_mask:0xc
    buffer_load_dwordx4 v14, s[32:35], 0 offen lds
    ds_read_b128 v[192:195], v7 offset:37888
    ds_read_b128 v[196:199], v8 offset:37888
    v_mfma_f32_16x16x32_bf16 v[88:91], v[176:179], v[232:235], 0
    v_mfma_f32_16x16x32_bf16 v[88:91], v[180:183], v[236:239], v[88:91]
    v_fmac_f32 v108, v80, v244
    v_fmac_f32 v109, v81, v245
    v_fmac_f32 v110, v82, v246
    v_fmac_f32 v111, v83, v247
    ds_read_b32 v119, v118 offset:16
    s_waitcnt lgkmcnt(1)
    s_add_u32 m0, s50, 38400
    v_or_b32_dpp v15, v54, v62 row_newbcast:4 row_mask:0xf bank_mask:0x3
    v_or_b32_dpp v15, v54, v62 row_newbcast:12 row_mask:0xf bank_mask:0xc
    buffer_load_dwordx4 v15, s[32:35], 0 offen lds
    s_add_u32 m0, s50, 39424
    v_or_b32_dpp v12, v54, v63 row_newbcast:5 row_mask:0xf bank_mask:0x3
    v_or_b32_dpp v12, v54, v63 row_newbcast:13 row_mask:0xf bank_mask:0xc
    buffer_load_dwordx4 v12, s[32:35], 0 offen lds
    s_mov_b64 exec, s[44:45]
    v_mov_b64 v[232:233], v[184:185]
    v_mov_b64 v[234:235], v[186:187]
    v_mov_b64 v[236:237], v[188:189]
    v_mov_b64 v[238:239], v[190:191]
    s_mov_b64 exec, -1
    v_mfma_f32_16x16x32_bf16 v[92:95], v[176:179], v[184:187], 0
    v_mfma_f32_16x16x32_bf16 v[92:95], v[180:183], v[188:191], v[92:95]
    v_fmac_f32 v108, v84, v64
    v_fmac_f32 v109, v85, v65
    v_fmac_f32 v110, v86, v66
    v_fmac_f32 v111, v87, v67
    v_add_f32 v112, v108, v109
    v_add_f32 v113, v110, v111
    v_add_f32 v112, v112, v113
    s_nop 1
    v_add_f32_dpp v112, v112, v112 row_shr:1 row_mask:0xf bank_mask:0xf
    s_nop 1
    v_add_f32_dpp v112, v112, v112 row_shr:2 row_mask:0xf bank_mask:0xf
    s_nop 1
    v_add_f32_dpp v112, v112, v112 row_shr:4 row_mask:0xf bank_mask:0xf
    s_nop 1
    v_add_f32_dpp v112, v112, v112 row_shr:8 row_mask:0xf bank_mask:0xf
    s_nop 1
    v_add_f32_dpp v112, v112, v112 row_bcast:15 row_mask:0xa bank_mask:0xf
    s_nop 1
    v_add_f32_dpp v112, v112, v112 row_bcast:31 row_mask:0xc bank_mask:0xf
    s_nop 0
    v_readlane_b32 s53, v112, 63
    s_waitcnt lgkmcnt(0)
    v_cmp_gt_u32 vcc, 11, v119
    s_nop 0
    s_cbranch_vccnz L_rs12
L_rb12:
    s_add_u32 m0, s31, 0
    v_or_b32_dpp v13, v19, v2 row_newbcast:3 row_mask:0xf bank_mask:0x3
    v_or_b32_dpp v13, v19, v2 row_newbcast:11 row_mask:0xf bank_mask:0xc
    buffer_load_dwordx4 v13, s[32:35], 0 offen lds
    v_mfma_f32_16x16x32_bf16 v[80:83], v[184:187], v[232:235], 0
    v_mfma_f32_16x16x32_bf16 v[80:83], v[188:191], v[236:239], v[80:83]
    v_mul_f32 v108, v88, v104
    v_mul_f32 v109, v89, v105
    v_mul_f32 v110, v90, v106
    v_mul_f32 v111, v91, v107
    s_add_u32 m0, s31, 1024
    v_or_b32_dpp v14, v23, v3 row_newbcast:3 row_mask:0xf bank_mask:0x3
    v_or_b32_dpp v14, v23, v3 row_newbcast:11 row_mask:0xf bank_mask:0xc
    buffer_load_dwordx4 v14, s[32:35], 0 offen lds
    ds_read_b128 v[200:203], v56 offset:32768
    ds_read_b128 v[204:207], v57 offset:32768
    v_mfma_f32_16x16x32_bf16 v[84:87], v[176:179], v[192:195], 0
    v_mfma_f32_16x16x32_bf16 v[84:87], v[180:183], v[196:199], v[84:87]
    v_fmac_f32 v108, v92, v120
    v_fmac_f32 v109, v93, v121
    v_fmac_f32 v110, v94, v122
    v_fmac_f32 v111, v95, v123
    s_waitcnt vmcnt(4)
    ds_add_u32 v116, v117
    s_waitcnt lgkmcnt(1)
    s_add_u32 m0, s50, 39936
    v_or_b32_dpp v15, v55, v63 row_newbcast:5 row_mask:0xf bank_mask:0x3
    v_or_b32_dpp v15, v55, v63 row_newbcast:13 row_mask:0xf bank_mask:0xc
    s_mov_b32 exec_lo, 0
    buffer_load_dwordx4 v15, s[32:35], 0 offen lds
    s_mov_b32 exec_lo, -1
    v_lshlrev_b32 v48, 7, v48
    ds_bpermute_b32 v48, v4, v48
    v_lshlrev_b32 v49, 7, v49
    ds_bpermute_b32 v49, v4, v49
    ds_read_b128 v[208:211], v7
    ds_read_b128 v[212:215], v8
    s_mov_b64 exec, s[44:45]
    v_mov_b64 v[232:233], v[192:193]
    v_mov_b64 v[234:235], v[194:195]
    v_mov_b64 v[236:237], v[196:197]
    v_mov_b64 v[238:239], v[198:199]
    s_mov_b64 exec, -1
    v_mfma_f32_16x16x32_bf16 v[88:91], v[184:187], v[192:195], 0
    v_mfma_f32_16x16x32_bf16 v[88:91], v[188:191], v[196:199], v[88:91]
    v_fmac_f32 v108, v80, v124
    v_fmac_f32 v109, v81, v125
    v_fmac_f32 v110, v82, v126
    v_fmac_f32 v111, v83, v127
    s_add_u32 m0, s31, 2048
    v_or_b32_dpp v12, v27, v2 row_newbcast:3 row_mask:0xf bank_mask:0x3
    v_or_b32_dpp v12, v27, v2 row_newbcast:11 row_mask:0xf bank_mask:0xc
    buffer_load_dwordx4 v12, s[32:35], 0 offen lds
    s_waitcnt lgkmcnt(0)
    s_add_u32 m0, s50, 512
    v_or_b32_dpp v13, v54, v62 row_newbcast:6 row_mask:0xf bank_mask:0x3
    v_or_b32_dpp v13, v54, v62 row_newbcast:14 row_mask:0xf bank_mask:0xc
    buffer_load_dwordx4 v13, s[32:35], 0 offen lds
    s_add_u32 m0, s50, 1536
    v_or_b32_dpp v14, v54, v63 row_newbcast:7 row_mask:0xf bank_mask:0x3
    v_or_b32_dpp v14, v54, v63 row_newbcast:15 row_mask:0xf bank_mask:0xc
    buffer_load_dwordx4 v14, s[32:35], 0 offen lds
    v_mfma_f32_16x16x32_bf16 v[92:95], v[192:195], v[232:235], 0
    v_mfma_f32_16x16x32_bf16 v[92:95], v[196:199], v[236:239], v[92:95]
    v_fmac_f32 v108, v84, v128
    v_fmac_f32 v109, v85, v129
    v_fmac_f32 v110, v86, v130
    v_fmac_f32 v111, v87, v131
    s_add_u32 m0, s31, 3072
    v_or_b32_dpp v15, v31, v3 row_newbcast:3 row_mask:0xf bank_mask:0x3
    v_or_b32_dpp v15, v31, v3 row_newbcast:11 row_mask:0xf bank_mask:0xc
    buffer_load_dwordx4 v15, s[32:35], 0 offen lds
    v_mfma_f32_16x16x32_bf16 v[80:83], v[200:203], v[200:203], 0
    v_mfma_f32_16x16x32_bf16 v[80:83], v[204:207], v[204:207], v[80:83]
    v_fmac_f32 v108, v88, v132
    v_fmac_f32 v109, v89, v133
    v_fmac_f32 v110, v90, v134
    v_fmac_f32 v111, v91, v135
    s_mov_b64 exec, s[44:45]
    v_mov_b64 v[232:233], v[208:209]
    v_mov_b64 v[234:235], v[210:211]
    v_mov_b64 v[236:237], v[212:213]
    v_mov_b64 v[238:239], v[214:215]
    s_mov_b64 exec, -1
    v_mfma_f32_16x16x32_bf16 v[84:87], v[176:179], v[208:211], 0
    v_mfma_f32_16x16x32_bf16 v[84:87], v[180:183], v[212:215], v[84:87]
    v_fmac_f32 v108, v92, v136
    v_fmac_f32 v109, v93, v137
    v_fmac_f32 v110, v94, v138
    v_fmac_f32 v111, v95, v139
    ds_read_b32 v119, v118 offset:16
    ds_read_b128 v[216:219], v7 offset:2560
    ds_read_b128 v[220:223], v8 offset:2560
    v_mfma_f32_16x16x32_bf16 v[88:91], v[208:211], v[232:235], 0
    v_mfma_f32_16x16x32_bf16 v[88:91], v[212:215], v[236:239], v[88:91]
    v_fmac_f32 v108, v80, v96
    v_fmac_f32 v109, v81, v97
    v_fmac_f32 v110, v82, v98
    v_fmac_f32 v111, v83, v99
    s_waitcnt lgkmcnt(2)
    v_cmp_gt_u32 vcc, 12, v119
    s_nop 0
    s_cbranch_vccnz L_rs13
L_rb13:
    s_add_u32 m0, s31, 16384
    v_or_b32_dpp v12, v16, v2 row_newbcast:4 row_mask:0xf bank_mask:0x3
    v_or_b32_dpp v12, v16, v2 row_newbcast:12 row_mask:0xf bank_mask:0xc
    buffer_load_dwordx4 v12, s[32:35], 0 offen lds
    s_waitcnt lgkmcnt(0)
    s_add_u32 m0, s50, 3072
    v_or_b32_dpp v13, v55, v62 row_newbcast:0 row_mask:0xf bank_mask:0x3
    v_or_b32_dpp v13, v55, v62 row_newbcast:8 row_mask:0xf bank_mask:0xc
    buffer_load_dwordx4 v13, s[32:35], 0 offen lds
    s_add_u32 m0, s50, 4096
    v_or_b32_dpp v14, v55, v63 row_newbcast:1 row_mask:0xf bank_mask:0x3
    v_or_b32_dpp v14, v55, v63 row_newbcast:9 row_mask:0xf bank_mask:0xc
    buffer_load_dwordx4 v14, s[32:35], 0 offen lds
    buffer_load_dword v50, v11, s[36:39], 0 offen offset:2000
    buffer_load_dword v51, v11, s[36:39], 0 offen offset:2256
    v_mfma_f32_16x16x32_bf16 v[92:95], v[184:187], v[208:211], 0
    v_mfma_f32_16x16x32_bf16 v[92:95], v[188:191], v[212:215], v[92:95]
    v_fmac_f32 v108, v84, v140
    v_fmac_f32 v109, v85, v141
    v_fmac_f32 v110, v86, v142
    v_fmac_f32 v111, v87, v143
    s_add_u32 m0, s31, 17408
    v_or_b32_dpp v15, v20, v3 row_newbcast:4 row_mask:0xf bank_mask:0x3
    v_or_b32_dpp v15, v20, v3 row_newbcast:12 row_mask:0xf bank_mask:0xc
    buffer_load_dwordx4 v15, s[32:35], 0 offen lds
    v_mfma_f32_16x16x32_bf16 v[80:83], v[192:195], v[208:211], 0
    v_mfma_f32_16x16x32_bf16 v[80:83], v[196:199], v[212:215], v[80:83]
    v_fmac_f32 v108, v88, v144
    v_fmac_f32 v109, v89, v145
    v_fmac_f32 v110, v90, v146
    v_fmac_f32 v111, v91, v147
    s_waitcnt vmcnt(6)
    ds_add_u32 v116, v117
    s_mov_b64 exec, s[44:45]
    v_mov_b64 v[232:233], v[216:217]
    v_mov_b64 v[234:235], v[218:219]
    v_mov_b64 v[236:237], v[220:221]
    v_mov_b64 v[238:239], v[222:223]
    s_mov_b64 exec, -1
    v_mfma_f32_16x16x32_bf16 v[84:87], v[176:179], v[216:219], 0
    v_mfma_f32_16x16x32_bf16 v[84:87], v[180:183], v[220:223], v[84:87]
    v_fmac_f32 v108, v92, v148
    v_fmac_f32 v109, v93, v149
    v_fmac_f32 v110, v94, v150
    v_fmac_f32 v111, v95, v151
    s_add_u32 m0, s31, 18432
    v_or_b32_dpp v12, v24, v2 row_newbcast:4 row_mask:0xf bank_mask:0x3
    v_or_b32_dpp v12, v24, v2 row_newbcast:12 row_mask:0xf bank_mask:0xc
    buffer_load_dwordx4 v12, s[32:35], 0 offen lds
    v_mfma_f32_16x16x32_bf16 v[88:91], v[216:219], v[232:235], 0
    v_mfma_f32_16x16x32_bf16 v[88:91], v[220:223], v[236:239], v[88:91]
    v_fmac_f32 v108, v80, v152
    v_fmac_f32 v109, v81, v153
    v_fmac_f32 v110, v82, v154
    v_fmac_f32 v111, v83, v155
    s_add_u32 m0, s31, 19456
    v_or_b32_dpp v13, v28, v3 row_newbcast:4 row_mask:0xf bank_mask:0x3
    v_or_b32_dpp v13, v28, v3 row_newbcast:12 row_mask:0xf bank_mask:0xc
    buffer_load_dwordx4 v13, s[32:35], 0 offen lds
    ds_read_b128 v[224:227], v7 offset:5120
    ds_read_b128 v[228:231], v8 offset:5120
    v_mfma_f32_16x16x32_bf16 v[92:95], v[184:187], v[216:219], 0
    v_mfma_f32_16x16x32_bf16 v[92:95], v[188:191], v[220:223], v[92:95]
    v_fmac_f32 v108, v84, v156
    v_fmac_f32 v109, v85, v157
    v_fmac_f32 v110, v86, v158
    v_fmac_f32 v111, v87, v159
    v_and_b32 v6, 7, v0
    v_max_u32 v6, 4, v6
    v_lshlrev_b32 v6, 4, v6
    v_sub_u32 v114, v114, v6
    v_add_u32 v114, 64, v114
    buffer_load_dwordx4 v[32:35], v114, s[36:39], 0 offen offset:128
    ds_read_b32 v119, v118 offset:16
    s_waitcnt lgkmcnt(1)
    s_add_u32 m0, s50, 5632
    v_or_b32_dpp v14, v55, v62 row_newbcast:2 row_mask:0xf bank_mask:0x3
    v_or_b32_dpp v14, v55, v62 row_newbcast:10 row_mask:0xf bank_mask:0xc
    buffer_load_dwordx4 v14, s[32:35], 0 offen lds
    s_add_u32 m0, s50, 6656
    v_or_b32_dpp v15, v55, v63 row_newbcast:3 row_mask:0xf bank_mask:0x3
    v_or_b32_dpp v15, v55, v63 row_newbcast:11 row_mask:0xf bank_mask:0xc
    buffer_load_dwordx4 v15, s[32:35], 0 offen lds
    v_mfma_f32_16x16x32_bf16 v[80:83], v[192:195], v[216:219], 0
    v_mfma_f32_16x16x32_bf16 v[80:83], v[196:199], v[220:223], v[80:83]
    v_fmac_f32 v108, v88, v160
    v_fmac_f32 v109, v89, v161
    v_fmac_f32 v110, v90, v162
    v_fmac_f32 v111, v91, v163
    s_waitcnt lgkmcnt(0)
    v_cmp_gt_u32 vcc, 13, v119
    s_nop 0
    s_cbranch_vccnz L_rs14
L_rb14:
    s_add_u32 m0, s31, 32768
    v_or_b32_dpp v12, v17, v2 row_newbcast:4 row_mask:0xf bank_mask:0x3
    v_or_b32_dpp v12, v17, v2 row_newbcast:12 row_mask:0xf bank_mask:0xc
    buffer_load_dwordx4 v12, s[32:35], 0 offen lds
    v_mfma_f32_16x16x32_bf16 v[84:87], v[208:211], v[216:219], 0
    v_mfma_f32_16x16x32_bf16 v[84:87], v[212:215], v[220:223], v[84:87]
    v_fmac_f32 v108, v92, v164
    v_fmac_f32 v109, v93, v165
    v_fmac_f32 v110, v94, v166
    v_fmac_f32 v111, v95, v167
    s_add_u32 m0, s31, 33792
    v_or_b32_dpp v13, v21, v3 row_newbcast:4 row_mask:0xf bank_mask:0x3
    v_or_b32_dpp v13, v21, v3 row_newbcast:12 row_mask:0xf bank_mask:0xc
    buffer_load_dwordx4 v13, s[32:35], 0 offen lds
    ds_read_b128 v[200:203], v56
    ds_read_b128 v[204:207], v57
    s_mov_b64 exec, s[44:45]
    v_mov_b64 v[232:233], v[224:225]
    v_mov_b64 v[234:235], v[226:227]
    v_mov_b64 v[236:237], v[228:229]
    v_mov_b64 v[238:239], v[230:231]
    s_mov_b64 exec, -1
    v_mfma_f32_16x16x32_bf16 v[88:91], v[176:179], v[224:227], 0
    v_mfma_f32_16x16x32_bf16 v[88:91], v[180:183], v[228:231], v[88:91]
    v_fmac_f32 v108, v80, v168
    v_fmac_f32 v109, v81, v169
    v_fmac_f32 v110, v82, v170
    v_fmac_f32 v111, v83, v171
    s_waitcnt vmcnt(5)
    ds_add_u32 v116, v117
    v_mfma_f32_16x16x32_bf16 v[92:95], v[224:227], v[232:235], 0
    v_mfma_f32_16x16x32_bf16 v[92:95], v[228:231], v[236:239], v[92:95]
    v_fmac_f32 v108, v84, v68
    v_fmac_f32 v109, v85, v69
    v_fmac_f32 v110, v86, v70
    v_fmac_f32 v111, v87, v71
    s_add_u32 m0, s31, 34816
    v_or_b32_dpp v14, v25, v2 row_newbcast:4 row_mask:0xf bank_mask:0x3
    v_or_b32_dpp v14, v25, v2 row_newbcast:12 row_mask:0xf bank_mask:0xc
    buffer_load_dwordx4 v14, s[32:35], 0 offen lds
    s_mov_b64 exec, s[46:47]
    ds_read_b128 v[232:235], v7 offset:40448
    ds_read_b128 v[236:239], v8 offset:40448
    s_mov_b64 exec, -1
    v_mfma_f32_16x16x32_bf16 v[80:83], v[184:187], v[224:227], 0
    v_mfma_f32_16x16x32_bf16 v[80:83], v[188:191], v[228:231], v[80:83]
    v_fmac_f32 v108, v88, v72
    v_fmac_f32 v109, v89, v73
    v_fmac_f32 v110, v90, v74
    v_fmac_f32 v111, v91, v75
    s_add_u32 m0, s31, 35840
    v_or_b32_dpp v15, v29, v3 row_newbcast:4 row_mask:0xf bank_mask:0x3
    v_or_b32_dpp v15, v29, v3 row_newbcast:12 row_mask:0xf bank_mask:0xc
    buffer_load_dwordx4 v15, s[32:35], 0 offen lds
    ds_read_b128 v[176:179], v9 offset:32768
    ds_read_b128 v[180:183], v10 offset:32768
    s_waitcnt lgkmcnt(6)
    v_mfma_f32_16x16x32_bf16 v[84:87], v[200:203], v[200:203], 0
    s_waitcnt lgkmcnt(5)
    v_mfma_f32_16x16x32_bf16 v[84:87], v[204:207], v[204:207], v[84:87]
    v_fmac_f32 v108, v92, v248
    v_fmac_f32 v109, v93, v249
    v_fmac_f32 v110, v94, v250
    v_fmac_f32 v111, v95, v251
    s_waitcnt lgkmcnt(0)
    s_add_u32 m0, s50, 32768
    v_or_b32_dpp v12, v48, v2 row_newbcast:0 row_mask:0xf bank_mask:0x3
    v_or_b32_dpp v12, v48, v2 row_newbcast:8 row_mask:0xf bank_mask:0xc
    buffer_load_dwordx4 v12, s[32:35], 0 offen lds
    s_add_u32 m0, s50, 33792
    v_or_b32_dpp v13, v48, v3 row_newbcast:1 row_mask:0xf bank_mask:0x3
    v_or_b32_dpp v13, v48, v3 row_newbcast:9 row_mask:0xf bank_mask:0xc
    buffer_load_dwordx4 v13, s[32:35], 0 offen lds
    v_mfma_f32_16x16x32_bf16 v[88:91], v[192:195], v[224:227], 0
    v_mfma_f32_16x16x32_bf16 v[88:91], v[196:199], v[228:231], v[88:91]
    v_fmac_f32 v108, v80, v252
    v_fmac_f32 v109, v81, v253
    v_fmac_f32 v110, v82, v254
    v_fmac_f32 v111, v83, v255
    ds_read_b32 v119, v118 offset:16
    ds_read_b128 v[184:187], v9 offset:35328
    ds_read_b128 v[188:191], v10 offset:35328
    v_mfma_f32_16x16x32_bf16 v[92:95], v[208:211], v[224:227], 0
    v_mfma_f32_16x16x32_bf16 v[92:95], v[212:215], v[228:231], v[92:95]
    v_fmac_f32 v108, v84, v100
    v_fmac_f32 v109, v85, v101
    v_fmac_f32 v110, v86, v102
    v_fmac_f32 v111, v87, v103
    s_waitcnt lgkmcnt(2)
    v_cmp_gt_u32 vcc, 14, v119
    s_nop 0
    s_cbranch_vccnz L_rs15
L_rb15:
    s_add_u32 m0, s31, 49152
    v_or_b32_dpp v14, v18, v2 row_newbcast:4 row_mask:0xf bank_mask:0x3
    v_or_b32_dpp v14, v18, v2 row_newbcast:12 row_mask:0xf bank_mask:0xc
    buffer_load_dwordx4 v14, s[32:35], 0 offen lds
    s_waitcnt lgkmcnt(0)
    s_add_u32 m0, s50, 35328
    v_or_b32_dpp v15, v48, v2 row_newbcast:2 row_mask:0xf bank_mask:0x3
    v_or_b32_dpp v15, v48, v2 row_newbcast:10 row_mask:0xf bank_mask:0xc
    buffer_load_dwordx4 v15, s[32:35], 0 offen lds
    s_add_u32 m0, s50, 36352
    v_or_b32_dpp v12, v48, v3 row_newbcast:3 row_mask:0xf bank_mask:0x3
    v_or_b32_dpp v12, v48, v3 row_newbcast:11 row_mask:0xf bank_mask:0xc
    buffer_load_dwordx4 v12, s[32:35], 0 offen lds
    s_mov_b64 exec, s[44:45]
    v_mov_b64 v[232:233], v[176:177]
    v_mov_b64 v[234:235], v[178:179]
    v_mov_b64 v[236:237], v[180:181]
    v_mov_b64 v[238:239], v[182:183]
    s_mov_b64 exec, -1
    v_mfma_f32_16x16x32_bf16 v[80:83], v[216:219], v[224:227], 0
    v_mfma_f32_16x16x32_bf16 v[80:83], v[220:223], v[228:231], v[80:83]
    v_fmac_f32 v108, v88, v240
    v_fmac_f32 v109, v89, v241
    v_fmac_f32 v110, v90, v242
    v_fmac_f32 v111, v91, v243
    s_add_u32 m0, s31, 50176
    v_or_b32_dpp v13, v22, v3 row_newbcast:4 row_mask:0xf bank_mask:0x3
    v_or_b32_dpp v13, v22, v3 row_newbcast:12 row_mask:0xf bank_mask:0xc
    buffer_load_dwordx4 v13, s[32:35], 0 offen lds
    ds_read_b128 v[200:203], v9 offset:37888
    ds_read_b128 v[204:207], v10 offset:37888
    v_mfma_f32_16x16x32_bf16 v[84:87], v[176:179], v[232:235], 0
    v_mfma_f32_16x16x32_bf16 v[84:87], v[180:183], v[236:239], v[84:87]
    v_fmac_f32 v108, v92, v244
    v_fmac_f32 v109, v93, v245
    v_fmac_f32 v110, v94, v246
    v_fmac_f32 v111, v95, v247
    s_waitcnt vmcnt(6)
    ds_add_u32 v116, v117
    s_waitcnt lgkmcnt(1)
    s_add_u32 m0, s50, 37888
    v_or_b32_dpp v14, v48, v2 row_newbcast:4 row_mask:0xf bank_mask:0x3
    v_or_b32_dpp v14, v48, v2 row_newbcast:12 row_mask:0xf bank_mask:0xc
    buffer_load_dwordx4 v14, s[32:35], 0 offen lds
    s_add_u32 m0, s50, 38912
    v_or_b32_dpp v15, v48, v3 row_newbcast:5 row_mask:0xf bank_mask:0x3
    v_or_b32_dpp v15, v48, v3 row_newbcast:13 row_mask:0xf bank_mask:0xc
    buffer_load_dwordx4 v15, s[32:35], 0 offen lds
    s_mov_b64 exec, s[44:45]
    v_mov_b64 v[232:233], v[184:185]
    v_mov_b64 v[234:235], v[186:187]
    v_mov_b64 v[236:237], v[188:189]
    v_mov_b64 v[238:239], v[190:191]
    s_mov_b64 exec, -1
    v_mfma_f32_16x16x32_bf16 v[88:91], v[176:179], v[184:187], 0
    v_mfma_f32_16x16x32_bf16 v[88:91], v[180:183], v[188:191], v[88:91]
    v_fmac_f32 v108, v80, v64
    v_fmac_f32 v109, v81, v65
    v_fmac_f32 v110, v82, v66
    v_fmac_f32 v111, v83, v67
    v_add_f32 v112, v108, v109
    v_add_f32 v113, v110, v111
    v_add_f32 v112, v112, v113
    s_nop 1
    v_add_f32_dpp v112, v112, v112 row_shr:1 row_mask:0xf bank_mask:0xf
    s_nop 1
    v_add_f32_dpp v112, v112, v112 row_shr:2 row_mask:0xf bank_mask:0xf
    s_nop 1
    v_add_f32_dpp v112, v112, v112 row_shr:4 row_mask:0xf bank_mask:0xf
    s_nop 1
    v_add_f32_dpp v112, v112, v112 row_shr:8 row_mask:0xf bank_mask:0xf
    s_nop 1
    v_add_f32_dpp v112, v112, v112 row_bcast:15 row_mask:0xa bank_mask:0xf
    s_nop 1
    v_add_f32_dpp v112, v112, v112 row_bcast:31 row_mask:0xc bank_mask:0xf
    s_nop 0
    v_readlane_b32 s54, v112, 63
    s_add_u32 m0, s31, 51200
    v_or_b32_dpp v12, v26, v2 row_newbcast:4 row_mask:0xf bank_mask:0x3
    v_or_b32_dpp v12, v26, v2 row_newbcast:12 row_mask:0xf bank_mask:0xc
    buffer_load_dwordx4 v12, s[32:35], 0 offen lds
    v_mfma_f32_16x16x32_bf16 v[92:95], v[184:187], v[232:235], 0
    v_mfma_f32_16x16x32_bf16 v[92:95], v[188:191], v[236:239], v[92:95]
    v_mul_f32 v108, v84, v104
    v_mul_f32 v109, v85, v105
    v_mul_f32 v110, v86, v106
    v_mul_f32 v111, v87, v107
    s_add_u32 m0, s31, 52224
    v_or_b32_dpp v13, v30, v3 row_newbcast:4 row_mask:0xf bank_mask:0x3
    v_or_b32_dpp v13, v30, v3 row_newbcast:12 row_mask:0xf bank_mask:0xc
    buffer_load_dwordx4 v13, s[32:35], 0 offen lds
    ds_read_b128 v[192:195], v58 offset:32768
    ds_read_b128 v[196:199], v59 offset:32768
    v_mfma_f32_16x16x32_bf16 v[80:83], v[176:179], v[200:203], 0
    v_mfma_f32_16x16x32_bf16 v[80:83], v[180:183], v[204:207], v[80:83]
    v_fmac_f32 v108, v88, v120
    v_fmac_f32 v109, v89, v121
    v_fmac_f32 v110, v90, v122
    v_fmac_f32 v111, v91, v123
    ds_read_b32 v119, v118 offset:16
    s_waitcnt lgkmcnt(1)
    s_add_u32 m0, s50, 40448
    v_or_b32_dpp v14, v49, v2 row_newbcast:4 row_mask:0xf bank_mask:0x3
    v_or_b32_dpp v14, v49, v2 row_newbcast:12 row_mask:0xf bank_mask:0xc
    s_mov_b32 exec_hi, 0
    buffer_load_dwordx4 v14, s[32:35], 0 offen lds
    s_mov_b32 exec_hi, -1
    v_lshlrev_b32 v50, 7, v50
    ds_bpermute_b32 v50, v61, v50
    v_lshlrev_b32 v51, 7, v51
    ds_bpermute_b32 v51, v61, v51
    ds_read_b128 v[208:211], v9
    ds_read_b128 v[212:215], v10
    s_mov_b64 exec, s[44:45]
    v_mov_b64 v[232:233], v[200:201]
    v_mov_b64 v[234:235], v[202:203]
    v_mov_b64 v[236:237], v[204:205]
    v_mov_b64 v[238:239], v[206:207]
    s_mov_b64 exec, -1
    v_mfma_f32_16x16x32_bf16 v[84:87], v[184:187], v[200:203], 0
    v_mfma_f32_16x16x32_bf16 v[84:87], v[188:191], v[204:207], v[84:87]
    v_fmac_f32 v108, v92, v124
    v_fmac_f32 v109, v93, v125
    v_fmac_f32 v110, v94, v126
    v_fmac_f32 v111, v95, v127
    s_waitcnt lgkmcnt(4)
    v_cmp_gt_u32 vcc, 15, v119
    s_nop 0
    s_cbranch_vccnz L_rs16
L_rb16:
    s_add_u32 m0, s31, 65536
    v_or_b32_dpp v15, v19, v2 row_newbcast:4 row_mask:0xf bank_mask:0x3
    v_or_b32_dpp v15, v19, v2 row_newbcast:12 row_mask:0xf bank_mask:0xc
    buffer_load_dwordx4 v15, s[32:35], 0 offen lds
    s_waitcnt lgkmcnt(0)
    s_add_u32 m0, s50, 0
    v_or_b32_dpp v12, v48, v2 row_newbcast:6 row_mask:0xf bank_mask:0x3
    v_or_b32_dpp v12, v48, v2 row_newbcast:14 row_mask:0xf bank_mask:0xc
    buffer_load_dwordx4 v12, s[32:35], 0 offen lds
    s_add_u32 m0, s50, 1024
    v_or_b32_dpp v13, v48, v3 row_newbcast:7 row_mask:0xf bank_mask:0x3
    v_or_b32_dpp v13, v48, v3 row_newbcast:15 row_mask:0xf bank_mask:0xc
    buffer_load_dwordx4 v13, s[32:35], 0 offen lds
    v_mfma_f32_16x16x32_bf16 v[88:91], v[200:203], v[232:235], 0
    v_mfma_f32_16x16x32_bf16 v[88:91], v[204:207], v[236:239], v[88:91]
    v_fmac_f32 v108, v80, v128
    v_fmac_f32 v109, v81, v129
    v_fmac_f32 v110, v82, v130
    v_fmac_f32 v111, v83, v131
    s_add_u32 m0, s31, 66560
    v_or_b32_dpp v14, v23, v3 row_newbcast:4 row_mask:0xf bank_mask:0x3
    v_or_b32_dpp v14, v23, v3 row_newbcast:12 row_mask:0xf bank_mask:0xc
    buffer_load_dwordx4 v14, s[32:35], 0 offen lds
    v_mfma_f32_16x16x32_bf16 v[92:95], v[192:195], v[192:195], 0
    v_mfma_f32_16x16x32_bf16 v[92:95], v[196:199], v[196:199], v[92:95]
    v_fmac_f32 v108, v84, v132
    v_fmac_f32 v109, v85, v133
    v_fmac_f32 v110, v86, v134
    v_fmac_f32 v111, v87, v135
    s_waitcnt vmcnt(5)
    ds_add_u32 v116, v117
    s_mov_b64 exec, s[44:45]
    v_mov_b64 v[232:233], v[208:209]
    v_mov_b64 v[234:235], v[210:211]
    v_mov_b64 v[236:237], v[212:213]
    v_mov_b64 v[238:239], v[214:215]
    s_mov_b64 exec, -1
    v_mfma_f32_16x16x32_bf16 v[80:83], v[176:179], v[208:211], 0
    v_mfma_f32_16x16x32_bf16 v[80:83], v[180:183], v[212:215], v[80:83]
    v_fmac_f32 v108, v88, v136
    v_fmac_f32 v109, v89, v137
    v_fmac_f32 v110, v90, v138
    v_fmac_f32 v111, v91, v139
    s_add_u32 m0, s31, 67584
    v_or_b32_dpp v15, v27, v2 row_newbcast:4 row_mask:0xf bank_mask:0x3
    v_or_b32_dpp v15, v27, v2 row_newbcast:12 row_mask:0xf bank_mask:0xc
    buffer_load_dwordx4 v15, s[32:35], 0 offen lds
    ds_read_b128 v[216:219], v9 offset:2560
    ds_read_b128 v[220:223], v10 offset:2560
    v_mfma_f32_16x16x32_bf16 v[84:87], v[208:211], v[232:235], 0
    v_mfma_f32_16x16x32_bf16 v[84:87], v[212:215], v[236:239], v[84:87]
    v_fmac_f32 v108, v92, v96
    v_fmac_f32 v109, v93, v97
    v_fmac_f32 v110, v94, v98
    v_fmac_f32 v111, v95, v99
    s_add_u32 m0, s31, 68608
    v_or_b32_dpp v12, v31, v3 row_newbcast:4 row_mask:0xf bank_mask:0x3
    v_or_b32_dpp v12, v31, v3 row_newbcast:12 row_mask:0xf bank_mask:0xc
    buffer_load_dwordx4 v12, s[32:35], 0 offen lds
    s_waitcnt lgkmcnt(0)
    s_add_u32 m0, s50, 2560
    v_or_b32_dpp v13, v49, v2 row_newbcast:0 row_mask:0xf bank_mask:0x3
    v_or_b32_dpp v13, v49, v2 row_newbcast:8 row_mask:0xf bank_mask:0xc
    buffer_load_dwordx4 v13, s[32:35], 0 offen lds
    s_add_u32 m0, s50, 3584
    v_or_b32_dpp v14, v49, v3 row_newbcast:1 row_mask:0xf bank_mask:0x3
    v_or_b32_dpp v14, v49, v3 row_newbcast:9 row_mask:0xf bank_mask:0xc
    buffer_load_dwordx4 v14, s[32:35], 0 offen lds
    buffer_load_dword v52, v11, s[36:39], 0 offen offset:2400
    buffer_load_dword v53, v11, s[36:39], 0 offen offset:2656
    v_mfma_f32_16x16x32_bf16 v[88:91], v[184:187], v[208:211], 0
    v_mfma_f32_16x16x32_bf16 v[88:91], v[188:191], v[212:215], v[88:91]
    v_fmac_f32 v108, v80, v140
    v_fmac_f32 v109, v81, v141
    v_fmac_f32 v110, v82, v142
    v_fmac_f32 v111, v83, v143
    buffer_load_dwordx4 v[36:39], v114, s[36:39], s40 offen offset:128
    v_mfma_f32_16x16x32_bf16 v[92:95], v[200:203], v[208:211], 0
    v_mfma_f32_16x16x32_bf16 v[92:95], v[204:207], v[212:215], v[92:95]
    v_fmac_f32 v108, v84, v144
    v_fmac_f32 v109, v85, v145
    v_fmac_f32 v110, v86, v146
    v_fmac_f32 v111, v87, v147
    ds_read_b32 v119, v118 offset:16
    s_mov_b64 exec, s[44:45]
    v_mov_b64 v[232:233], v[216:217]
    v_mov_b64 v[234:235], v[218:219]
    v_mov_b64 v[236:237], v[220:221]
    v_mov_b64 v[238:239], v[222:223]
    s_mov_b64 exec, -1
    v_mfma_f32_16x16x32_bf16 v[80:83], v[176:179], v[216:219], 0
    v_mfma_f32_16x16x32_bf16 v[80:83], v[180:183], v[220:223], v[80:83]
    v_fmac_f32 v108, v88, v148
    v_fmac_f32 v109, v89, v149
    v_fmac_f32 v110, v90, v150
    v_fmac_f32 v111, v91, v151
    s_waitcnt lgkmcnt(0)
    v_cmp_gt_u32 vcc, 16, v119
    s_nop 0
    s_cbranch_vccnz L_rs17
L_rb17:
    s_add_u32 m0, s31, 0
    v_or_b32_dpp v15, v16, v2 row_newbcast:5 row_mask:0xf bank_mask:0x3
    v_or_b32_dpp v15, v16, v2 row_newbcast:13 row_mask:0xf bank_mask:0xc
    buffer_load_dwordx4 v15, s[32:35], 0 offen lds
    v_mfma_f32_16x16x32_bf16 v[84:87], v[216:219], v[232:235], 0
    v_mfma_f32_16x16x32_bf16 v[84:87], v[220:223], v[236:239], v[84:87]
    v_fmac_f32 v108, v92, v152
    v_fmac_f32 v109, v93, v153
    v_fmac_f32 v110, v94, v154
    v_fmac_f32 v111, v95, v155
    s_add_u32 m0, s31, 1024
    v_or_b32_dpp v12, v20, v3 row_newbcast:5 row_mask:0xf bank_mask:0x3
    v_or_b32_dpp v12, v20, v3 row_newbcast:13 row_mask:0xf bank_mask:0xc
    buffer_load_dwordx4 v12, s[32:35], 0 offen lds
    ds_read_b128 v[224:227], v9 offset:5120
    ds_read_b128 v[228:231], v10 offset:5120
    v_mfma_f32_16x16x32_bf16 v[88:91], v[184:187], v[216:219], 0
    v_mfma_f32_16x16x32_bf16 v[88:91], v[188:191], v[220:223], v[88:91]
    v_fmac_f32 v108, v80, v156
    v_fmac_f32 v109, v81, v157
    v_fmac_f32 v110, v82, v158
    v_fmac_f32 v111, v83, v159
    s_waitcnt vmcnt(7)
    ds_add_u32 v116, v117
    s_waitcnt lgkmcnt(1)
    s_add_u32 m0, s50, 5120
    v_or_b32_dpp v13, v49, v2 row_newbcast:2 row_mask:0xf bank_mask:0x3
    v_or_b32_dpp v13, v49, v2 row_newbcast:10 row_mask:0xf bank_mask:0xc
    buffer_load_dwordx4 v13, s[32:35], 0 offen lds
    s_add_u32 m0, s50, 6144
    v_or_b32_dpp v14, v49, v3 row_newbcast:3 row_mask:0xf bank_mask:0x3
    v_or_b32_dpp v14, v49, v3 row_newbcast:11 row_mask:0xf bank_mask:0xc
    buffer_load_dwordx4 v14, s[32:35], 0 offen lds
    v_mfma_f32_16x16x32_bf16 v[92:95], v[200:203], v[216:219], 0
    v_mfma_f32_16x16x32_bf16 v[92:95], v[204:207], v[220:223], v[92:95]
    v_fmac_f32 v108, v84, v160
    v_fmac_f32 v109, v85, v161
    v_fmac_f32 v110, v86, v162
    v_fmac_f32 v111, v87, v163
    s_add_u32 m0, s31, 2048
    v_or_b32_dpp v15, v24, v2 row_newbcast:5 row_mask:0xf bank_mask:0x3
    v_or_b32_dpp v15, v24, v2 row_newbcast:13 row_mask:0xf bank_mask:0xc
    buffer_load_dwordx4 v15, s[32:35], 0 offen lds
    v_mfma_f32_16x16x32_bf16 v[80:83], v[208:211], v[216:219], 0
    v_mfma_f32_16x16x32_bf16 v[80:83], v[212:215], v[220:223], v[80:83]
    v_fmac_f32 v108, v88, v164
    v_fmac_f32 v109, v89, v165
    v_fmac_f32 v110, v90, v166
    v_fmac_f32 v111, v91, v167
    s_add_u32 m0, s31, 3072
    v_or_b32_dpp v12, v28, v3 row_newbcast:5 row_mask:0xf bank_mask:0x3
    v_or_b32_dpp v12, v28, v3 row_newbcast:13 row_mask:0xf bank_mask:0xc
    buffer_load_dwordx4 v12, s[32:35], 0 offen lds
    ds_read_b128 v[192:195], v58
    ds_read_b128 v[196:199], v59
    s_mov_b64 exec, s[44:45]
    v_mov_b64 v[232:233], v[224:225]
    v_mov_b64 v[234:235], v[226:227]
    v_mov_b64 v[236:237], v[228:229]
    v_mov_b64 v[238:239], v[230:231]
    s_mov_b64 exec, -1
    v_mfma_f32_16x16x32_bf16 v[84:87], v[176:179], v[224:227], 0
    v_mfma_f32_16x16x32_bf16 v[84:87], v[180:183], v[228:231], v[84:87]
    v_fmac_f32 v108, v92, v168
    v_fmac_f32 v109, v93, v169
    v_fmac_f32 v110, v94, v170
    v_fmac_f32 v111, v95, v171
    v_mfma_f32_16x16x32_bf16 v[88:91], v[224:227], v[232:235], 0
    v_mfma_f32_16x16x32_bf16 v[88:91], v[228:231], v[236:239], v[88:91]
    v_fmac_f32 v108, v80, v68
    v_fmac_f32 v109, v81, v69
    v_fmac_f32 v110, v82, v70
    v_fmac_f32 v111, v83, v71
    ds_read_b32 v119, v118 offset:16
    s_mov_b64 exec, s[46:47]
    ds_read_b128 v[232:235], v7 offset:40448
    ds_read_b128 v[236:239], v8 offset:40448
    s_mov_b64 exec, -1
    v_mfma_f32_16x16x32_bf16 v[92:95], v[184:187], v[224:227], 0
    v_mfma_f32_16x16x32_bf16 v[92:95], v[188:191], v[228:231], v[92:95]
    v_fmac_f32 v108, v84, v72
    v_fmac_f32 v109, v85, v73
    v_fmac_f32 v110, v86, v74
    v_fmac_f32 v111, v87, v75
    s_waitcnt lgkmcnt(2)
    v_cmp_gt_u32 vcc, 17, v119
    s_nop 0
    s_cbranch_vccnz L_rs18
L_rb18:
    s_add_u32 m0, s31, 16384
    v_or_b32_dpp v13, v17, v2 row_newbcast:5 row_mask:0xf bank_mask:0x3
    v_or_b32_dpp v13, v17, v2 row_newbcast:13 row_mask:0xf bank_mask:0xc
    buffer_load_dwordx4 v13, s[32:35], 0 offen lds
    ds_read_b128 v[176:179], v7 offset:32768
    ds_read_b128 v[180:183], v8 offset:32768
    v_mfma_f32_16x16x32_bf16 v[80:83], v[192:195], v[192:195], 0
    v_mfma_f32_16x16x32_bf16 v[80:83], v[196:199], v[196:199], v[80:83]
    v_fmac_f32 v108, v88, v248
    v_fmac_f32 v109, v89, v249
    v_fmac_f32 v110, v90, v250
    v_fmac_f32 v111, v91, v251
    s_add_u32 m0, s31, 17408
    v_or_b32_dpp v14, v21, v3 row_newbcast:5 row_mask:0xf bank_mask:0x3
    v_or_b32_dpp v14, v21, v3 row_newbcast:13 row_mask:0xf bank_mask:0xc
    buffer_load_dwordx4 v14, s[32:35], 0 offen lds
    s_waitcnt lgkmcnt(0)
    s_add_u32 m0, s50, 33280
    v_or_b32_dpp v15, v50, v62 row_newbcast:0 row_mask:0xf bank_mask:0x3
    v_or_b32_dpp v15, v50, v62 row_newbcast:8 row_mask:0xf bank_mask:0xc
    buffer_load_dwordx4 v15, s[32:35], 0 offen lds
    s_add_u32 m0, s50, 34304
    v_or_b32_dpp v12, v50, v63 row_newbcast:1 row_mask:0xf bank_mask:0x3
    v_or_b32_dpp v12, v50, v63 row_newbcast:9 row_mask:0xf bank_mask:0xc
    buffer_load_dwordx4 v12, s[32:35], 0 offen lds
    v_mfma_f32_16x16x32_bf16 v[84:87], v[200:203], v[224:227], 0
    v_mfma_f32_16x16x32_bf16 v[84:87], v[204:207], v[228:231], v[84:87]
    v_fmac_f32 v108, v92, v252
    v_fmac_f32 v109, v93, v253
    v_fmac_f32 v110, v94, v254
    v_fmac_f32 v111, v95, v255
    s_waitcnt vmcnt(4)
    ds_add_u32 v116, v117
    ds_read_b128 v[184:187], v7 offset:35328
    ds_read_b128 v[188:191], v8 offset:35328
    v_mfma_f32_16x16x32_bf16 v[88:91], v[208:211], v[224:227], 0
    v_mfma_f32_16x16x32_bf16 v[88:91], v[212:215], v[228:231], v[88:91]
    v_fmac_f32 v108, v80, v100
    v_fmac_f32 v109, v81, v101
    v_fmac_f32 v110, v82, v102
    v_fmac_f32 v111, v83, v103
    s_add_u32 m0, s31, 18432
    v_or_b32_dpp v13, v25, v2 row_newbcast:5 row_mask:0xf bank_mask:0x3
    v_or_b32_dpp v13, v25, v2 row_newbcast:13 row_mask:0xf bank_mask:0xc
    buffer_load_dwordx4 v13, s[32:35], 0 offen lds
    s_waitcnt lgkmcnt(0)
    s_add_u32 m0, s50, 35840
    v_or_b32_dpp v14, v50, v62 row_newbcast:2 row_mask:0xf bank_mask:0x3
    v_or_b32_dpp v14, v50, v62 row_newbcast:10 row_mask:0xf bank_mask:0xc
    buffer_load_dwordx4 v14, s[32:35], 0 offen lds
    s_add_u32 m0, s50, 36864
    v_or_b32_dpp v15, v50, v63 row_newbcast:3 row_mask:0xf bank_mask:0x3
    v_or_b32_dpp v15, v50, v63 row_newbcast:11 row_mask:0xf bank_mask:0xc
    buffer_load_dwordx4 v15, s[32:35], 0 offen lds
    s_mov_b64 exec, s[44:45]
    v_mov_b64 v[232:233], v[176:177]
    v_mov_b64 v[234:235], v[178:179]
    v_mov_b64 v[236:237], v[180:181]
    v_mov_b64 v[238:239], v[182:183]
    s_mov_b64 exec, -1
    v_mfma_f32_16x16x32_bf16 v[92:95], v[216:219], v[224:227], 0
    v_mfma_f32_16x16x32_bf16 v[92:95], v[220:223], v[228:231], v[92:95]
    v_fmac_f32 v108, v84, v240
    v_fmac_f32 v109, v85, v241
    v_fmac_f32 v110, v86, v242
    v_fmac_f32 v111, v87, v243
    s_add_u32 m0, s31, 19456
    v_or_b32_dpp v12, v29, v3 row_newbcast:5 row_mask:0xf bank_mask:0x3
    v_or_b32_dpp v12, v29, v3 row_newbcast:13 row_mask:0xf bank_mask:0xc
    buffer_load_dwordx4 v12, s[32:35], 0 offen lds
    ds_read_b128 v[192:195], v7 offset:37888
    ds_read_b128 v[196:199], v8 offset:37888
    v_mfma_f32_16x16x32_bf16 v[80:83], v[176:179], v[232:235], 0
    v_mfma_f32_16x16x32_bf16 v[80:83], v[180:183], v[236:239], v[80:83]
    v_fmac_f32 v108, v88, v244
    v_fmac_f32 v109, v89, v245
    v_fmac_f32 v110, v90, v246
    v_fmac_f32 v111, v91, v247
    ds_read_b32 v119, v118 offset:16
    s_waitcnt lgkmcnt(1)
    s_add_u32 m0, s50, 38400
    v_or_b32_dpp v13, v50, v62 row_newbcast:4 row_mask:0xf bank_mask:0x3
    v_or_b32_dpp v13, v50, v62 row_newbcast:12 row_mask:0xf bank_mask:0xc
    buffer_load_dwordx4 v13, s[32:35], 0 offen lds
    s_add_u32 m0, s50, 39424
    v_or_b32_dpp v14, v50, v63 row_newbcast:5 row_mask:0xf bank_mask:0x3
    v_or_b32_dpp v14, v50, v63 row_newbcast:13 row_mask:0xf bank_mask:0xc
    buffer_load_dwordx4 v14, s[32:35], 0 offen lds
    s_mov_b64 exec, s[44:45]
    v_mov_b64 v[232:233], v[184:185]
    v_mov_b64 v[234:235], v[186:187]
    v_mov_b64 v[236:237], v[188:189]
    v_mov_b64 v[238:239], v[190:191]
    s_mov_b64 exec, -1
    v_mfma_f32_16x16x32_bf16 v[84:87], v[176:179], v[184:187], 0
    v_mfma_f32_16x16x32_bf16 v[84:87], v[180:183], v[188:191], v[84:87]
    v_fmac_f32 v108, v92, v64
    v_fmac_f32 v109, v93, v65
    v_fmac_f32 v110, v94, v66
    v_fmac_f32 v111, v95, v67
    v_add_f32 v112, v108, v109
    v_add_f32 v113, v110, v111
    v_add_f32 v112, v112, v113
    s_nop 1
    v_add_f32_dpp v112, v112, v112 row_shr:1 row_mask:0xf bank_mask:0xf
    s_nop 1
    v_add_f32_dpp v112, v112, v112 row_shr:2 row_mask:0xf bank_mask:0xf
    s_nop 1
    v_add_f32_dpp v112, v112, v112 row_shr:4 row_mask:0xf bank_mask:0xf
    s_nop 1
    v_add_f32_dpp v112, v112, v112 row_shr:8 row_mask:0xf bank_mask:0xf
    s_nop 1
    v_add_f32_dpp v112, v112, v112 row_bcast:15 row_mask:0xa bank_mask:0xf
    s_nop 1
    v_add_f32_dpp v112, v112, v112 row_bcast:31 row_mask:0xc bank_mask:0xf
    s_nop 0
    v_readlane_b32 s55, v112, 63
    s_waitcnt lgkmcnt(0)
    v_cmp_gt_u32 vcc, 18, v119
    s_nop 0
    s_cbranch_vccnz L_rs19
L_rb19:
    s_add_u32 m0, s31, 32768
    v_or_b32_dpp v15, v18, v2 row_newbcast:5 row_mask:0xf bank_mask:0x3
    v_or_b32_dpp v15, v18, v2 row_newbcast:13 row_mask:0xf bank_mask:0xc
    buffer_load_dwordx4 v15, s[32:35], 0 offen lds
    v_mfma_f32_16x16x32_bf16 v[88:91], v[184:187], v[232:235], 0
    v_mfma_f32_16x16x32_bf16 v[88:91], v[188:191], v[236:239], v[88:91]
    v_mul_f32 v108, v80, v104
    v_mul_f32 v109, v81, v105
    v_mul_f32 v110, v82, v106
    v_mul_f32 v111, v83, v107
    s_add_u32 m0, s31, 33792
    v_or_b32_dpp v12, v22, v3 row_newbcast:5 row_mask:0xf bank_mask:0x3
    v_or_b32_dpp v12, v22, v3 row_newbcast:13 row_mask:0xf bank_mask:0xc
    buffer_load_dwordx4 v12, s[32:35], 0 offen lds
    ds_read_b128 v[200:203], v56 offset:32768
    ds_read_b128 v[204:207], v57 offset:32768
    v_mfma_f32_16x16x32_bf16 v[92:95], v[176:179], v[192:195], 0
    v_mfma_f32_16x16x32_bf16 v[92:95], v[180:183], v[196:199], v[92:95]
    v_fmac_f32 v108, v84, v120
    v_fmac_f32 v109, v85, v121
    v_fmac_f32 v110, v86, v122
    v_fmac_f32 v111, v87, v123
    s_waitcnt vmcnt(4)
    ds_add_u32 v116, v117
    s_waitcnt lgkmcnt(1)
    s_add_u32 m0, s50, 39936
    v_or_b32_dpp v13, v51, v63 row_newbcast:5 row_mask:0xf bank_mask:0x3
    v_or_b32_dpp v13, v51, v63 row_newbcast:13 row_mask:0xf bank_mask:0xc
    s_mov_b32 exec_lo, 0
    buffer_load_dwordx4 v13, s[32:35], 0 offen lds
    s_mov_b32 exec_lo, -1
    v_lshlrev_b32 v52, 7, v52
    ds_bpermute_b32 v52, v4, v52
    v_lshlrev_b32 v53, 7, v53
    ds_bpermute_b32 v53, v4, v53
    ds_read_b128 v[208:211], v7
    ds_read_b128 v[212:215], v8
    s_mov_b64 exec, s[44:45]
    v_mov_b64 v[232:233], v[192:193]
    v_mov_b64 v[234:235], v[194:195]
    v_mov_b64 v[236:237], v[196:197]
    v_mov_b64 v[238:239], v[198:199]
    s_mov_b64 exec, -1
    v_mfma_f32_16x16x32_bf16 v[80:83], v[184:187], v[192:195], 0
    v_mfma_f32_16x16x32_bf16 v[80:83], v[188:191], v[196:199], v[80:83]
    v_fmac_f32 v108, v88, v124
    v_fmac_f32 v109, v89, v125
    v_fmac_f32 v110, v90, v126
    v_fmac_f32 v111, v91, v127
    s_add_u32 m0, s31, 34816
    v_or_b32_dpp v14, v26, v2 row_newbcast:5 row_mask:0xf bank_mask:0x3
    v_or_b32_dpp v14, v26, v2 row_newbcast:13 row_mask:0xf bank_mask:0xc
    buffer_load_dwordx4 v14, s[32:35], 0 offen lds
    s_waitcnt lgkmcnt(0)
    s_add_u32 m0, s50, 512
    v_or_b32_dpp v15, v50, v62 row_newbcast:6 row_mask:0xf bank_mask:0x3
    v_or_b32_dpp v15, v50, v62 row_newbcast:14 row_mask:0xf bank_mask:0xc
    buffer_load_dwordx4 v15, s[32:35], 0 offen lds
    s_add_u32 m0, s50, 1536
    v_or_b32_dpp v12, v50, v63 row_newbcast:7 row_mask:0xf bank_mask:0x3
    v_or_b32_dpp v12, v50, v63 row_newbcast:15 row_mask:0xf bank_mask:0xc
    buffer_load_dwordx4 v12, s[32:35], 0 offen lds
    v_mfma_f32_16x16x32_bf16 v[84:87], v[192:195], v[232:235], 0
    v_mfma_f32_16x16x32_bf16 v[84:87], v[196:199], v[236:239], v[84:87]
    v_fmac_f32 v108, v92, v128
    v_fmac_f32 v109, v93, v129
    v_fmac_f32 v110, v94, v130
    v_fmac_f32 v111, v95, v131
    s_add_u32 m0, s31, 35840
    v_or_b32_dpp v13, v30, v3 row_newbcast:5 row_mask:0xf bank_mask:0x3
    v_or_b32_dpp v13, v30, v3 row_newbcast:13 row_mask:0xf bank_mask:0xc
    buffer_load_dwordx4 v13, s[32:35], 0 offen lds
    v_mfma_f32_16x16x32_bf16 v[88:91], v[200:203], v[200:203], 0
    v_mfma_f32_16x16x32_bf16 v[88:91], v[204:207], v[204:207], v[88:91]
    v_fmac_f32 v108, v80, v132
    v_fmac_f32 v109, v81, v133
    v_fmac_f32 v110, v82, v134
    v_fmac_f32 v111, v83, v135
    buffer_load_dwordx4 v[40:43], v114, s[36:39], s41 offen offset:128
    s_mov_b64 exec, s[44:45]
    v_mov_b64 v[232:233], v[208:209]
    v_mov_b64 v[234:235], v[210:211]
    v_mov_b64 v[236:237], v[212:213]
    v_mov_b64 v[238:239], v[214:215]
    s_mov_b64 exec, -1
    v_mfma_f32_16x16x32_bf16 v[92:95], v[176:179], v[208:211], 0
    v_mfma_f32_16x16x32_bf16 v[92:95], v[180:183], v[212:215], v[92:95]
    v_fmac_f32 v108, v84, v136
    v_fmac_f32 v109, v85, v137
    v_fmac_f32 v110, v86, v138
    v_fmac_f32 v111, v87, v139
    ds_read_b32 v119, v118 offset:16
    ds_read_b128 v[216:219], v7 offset:2560
    ds_read_b128 v[220:223], v8 offset:2560
    v_mfma_f32_16x16x32_bf16 v[80:83], v[208:211], v[232:235], 0
    v_mfma_f32_16x16x32_bf16 v[80:83], v[212:215], v[236:239], v[80:83]
    v_fmac_f32 v108, v88, v96
    v_fmac_f32 v109, v89, v97
    v_fmac_f32 v110, v90, v98
    v_fmac_f32 v111, v91, v99
    s_waitcnt lgkmcnt(2)
    v_cmp_gt_u32 vcc, 19, v119
    s_nop 0
    s_cbranch_vccnz L_rs20
L_rb20:
    s_add_u32 m0, s31, 49152
    v_or_b32_dpp v14, v19, v2 row_newbcast:5 row_mask:0xf bank_mask:0x3
    v_or_b32_dpp v14, v19, v2 row_newbcast:13 row_mask:0xf bank_mask:0xc
    buffer_load_dwordx4 v14, s[32:35], 0 offen lds
    s_waitcnt lgkmcnt(0)
    s_add_u32 m0, s50, 3072
    v_or_b32_dpp v15, v51, v62 row_newbcast:0 row_mask:0xf bank_mask:0x3
    v_or_b32_dpp v15, v51, v62 row_newbcast:8 row_mask:0xf bank_mask:0xc
    buffer_load_dwordx4 v15, s[32:35], 0 offen lds
    s_add_u32 m0, s50, 4096
    v_or_b32_dpp v12, v51, v63 row_newbcast:1 row_mask:0xf bank_mask:0x3
    v_or_b32_dpp v12, v51, v63 row_newbcast:9 row_mask:0xf bank_mask:0xc
    buffer_load_dwordx4 v12, s[32:35], 0 offen lds
    buffer_load_dword v54, v11, s[36:39], 0 offen offset:2800
    buffer_load_dword v55, v11, s[36:39], 0 offen offset:3056
    v_mfma_f32_16x16x32_bf16 v[84:87], v[184:187], v[208:211], 0
    v_mfma_f32_16x16x32_bf16 v[84:87], v[188:191], v[212:215], v[84:87]
    v_fmac_f32 v108, v92, v140
    v_fmac_f32 v109, v93, v141
    v_fmac_f32 v110, v94, v142
    v_fmac_f32 v111, v95, v143
    s_add_u32 m0, s31, 50176
    v_or_b32_dpp v13, v23, v3 row_newbcast:5 row_mask:0xf bank_mask:0x3
    v_or_b32_dpp v13, v23, v3 row_newbcast:13 row_mask:0xf bank_mask:0xc
    buffer_load_dwordx4 v13, s[32:35], 0 offen lds
    v_mfma_f32_16x16x32_bf16 v[88:91], v[192:195], v[208:211], 0
    v_mfma_f32_16x16x32_bf16 v[88:91], v[196:199], v[212:215], v[88:91]
    v_fmac_f32 v108, v80, v144
    v_fmac_f32 v109, v81, v145
    v_fmac_f32 v110, v82, v146
    v_fmac_f32 v111, v83, v147
    s_waitcnt vmcnt(7)
    ds_add_u32 v116, v117
    s_mov_b64 exec, s[44:45]
    v_mov_b64 v[232:233], v[216:217]
    v_mov_b64 v[234:235], v[218:219]
    v_mov_b64 v[236:237], v[220:221]
    v_mov_b64 v[238:239], v[222:223]
    s_mov_b64 exec, -1
    v_mfma_f32_16x16x32_bf16 v[92:95], v[176:179], v[216:219], 0
    v_mfma_f32_16x16x32_bf16 v[92:95], v[180:183], v[220:223], v[92:95]
    v_fmac_f32 v108, v84, v148
    v_fmac_f32 v109, v85, v149
    v_fmac_f32 v110, v86, v150
    v_fmac_f32 v111, v87, v151
    s_add_u32 m0, s31, 51200
    v_or_b32_dpp v14, v27, v2 row_newbcast:5 row_mask:0xf bank_mask:0x3
    v_or_b32_dpp v14, v27, v2 row_newbcast:13 row_mask:0xf bank_mask:0xc
    buffer_load_dwordx4 v14, s[32:35], 0 offen lds
    v_mfma_f32_16x16x32_bf16 v[80:83], v[216:219], v[232:235], 0
    v_mfma_f32_16x16x32_bf16 v[80:83], v[220:223], v[236:239], v[80:83]
    v_fmac_f32 v108, v88, v152
    v_fmac_f32 v109, v89, v153
    v_fmac_f32 v110, v90, v154
    v_fmac_f32 v111, v91, v155
    s_add_u32 m0, s31, 52224
    v_or_b32_dpp v15, v31, v3 row_newbcast:5 row_mask:0xf bank_mask:0x3
    v_or_b32_dpp v15, v31, v3 row_newbcast:13 row_mask:0xf bank_mask:0xc
    buffer_load_dwordx4 v15, s[32:35], 0 offen lds
    ds_read_b128 v[224:227], v7 offset:5120
    ds_read_b128 v[228:231], v8 offset:5120
    v_mfma_f32_16x16x32_bf16 v[84:87], v[184:187], v[216:219], 0
    v_mfma_f32_16x16x32_bf16 v[84:87], v[188:191], v[220:223], v[84:87]
    v_fmac_f32 v108, v92, v156
    v_fmac_f32 v109, v93, v157
    v_fmac_f32 v110, v94, v158
    v_fmac_f32 v111, v95, v159
    ds_read_b32 v119, v118 offset:16
    s_waitcnt lgkmcnt(1)
    s_add_u32 m0, s50, 5632
    v_or_b32_dpp v12, v51, v62 row_newbcast:2 row_mask:0xf bank_mask:0x3
    v_or_b32_dpp v12, v51, v62 row_newbcast:10 row_mask:0xf bank_mask:0xc
    buffer_load_dwordx4 v12, s[32:35], 0 offen lds
    s_add_u32 m0, s50, 6656
    v_or_b32_dpp v13, v51, v63 row_newbcast:3 row_mask:0xf bank_mask:0x3
    v_or_b32_dpp v13, v51, v63 row_newbcast:11 row_mask:0xf bank_mask:0xc
    buffer_load_dwordx4 v13, s[32:35], 0 offen lds
    v_mfma_f32_16x16x32_bf16 v[88:91], v[192:195], v[216:219], 0
    v_mfma_f32_16x16x32_bf16 v[88:91], v[196:199], v[220:223], v[88:91]
    v_fmac_f32 v108, v80, v160
    v_fmac_f32 v109, v81, v161
    v_fmac_f32 v110, v82, v162
    v_fmac_f32 v111, v83, v163
    s_waitcnt lgkmcnt(0)
    v_cmp_gt_u32 vcc, 20, v119
    s_nop 0
    s_cbranch_vccnz L_rs21
L_rb21:
    s_add_u32 m0, s31, 65536
    v_or_b32_dpp v14, v16, v2 row_newbcast:6 row_mask:0xf bank_mask:0x3
    v_or_b32_dpp v14, v16, v2 row_newbcast:14 row_mask:0xf bank_mask:0xc
    buffer_load_dwordx4 v14, s[32:35], 0 offen lds
    v_mfma_f32_16x16x32_bf16 v[92:95], v[208:211], v[216:219], 0
    v_mfma_f32_16x16x32_bf16 v[92:95], v[212:215], v[220:223], v[92:95]
    v_fmac_f32 v108, v84, v164
    v_fmac_f32 v109, v85, v165
    v_fmac_f32 v110, v86, v166
    v_fmac_f32 v111, v87, v167
    s_add_u32 m0, s31, 66560
    v_or_b32_dpp v15, v20, v3 row_newbcast:6 row_mask:0xf bank_mask:0x3
    v_or_b32_dpp v15, v20, v3 row_newbcast:14 row_mask:0xf bank_mask:0xc
    buffer_load_dwordx4 v15, s[32:35], 0 offen lds
    ds_read_b128 v[200:203], v56
    ds_read_b128 v[204:207], v57
    s_mov_b64 exec, s[44:45]
    v_mov_b64 v[232:233], v[224:225]
    v_mov_b64 v[234:235], v[226:227]
    v_mov_b64 v[236:237], v[228:229]
    v_mov_b64 v[238:239], v[230:231]
    s_mov_b64 exec, -1
    v_mfma_f32_16x16x32_bf16 v[80:83], v[176:179], v[224:227], 0
    v_mfma_f32_16x16x32_bf16 v[80:83], v[180:183], v[228:231], v[80:83]
    v_fmac_f32 v108, v88, v168
    v_fmac_f32 v109, v89, v169
    v_fmac_f32 v110, v90, v170
    v_fmac_f32 v111, v91, v171
    s_waitcnt vmcnt(4)
    ds_add_u32 v116, v117
    v_mfma_f32_16x16x32_bf16 v[84:87], v[224:227], v[232:235], 0
    v_mfma_f32_16x16x32_bf16 v[84:87], v[228:231], v[236:239], v[84:87]
    v_fmac_f32 v108, v92, v68
    v_fmac_f32 v109, v93, v69
    v_fmac_f32 v110, v94, v70
    v_fmac_f32 v111, v95, v71
    s_add_u32 m0, s31, 67584
    v_or_b32_dpp v12, v24, v2 row_newbcast:6 row_mask:0xf bank_mask:0x3
    v_or_b32_dpp v12, v24, v2 row_newbcast:14 row_mask:0xf bank_mask:0xc
    buffer_load_dwordx4 v12, s[32:35], 0 offen lds
    s_mov_b64 exec, s[46:47]
    ds_read_b128 v[232:235], v7 offset:40448
    ds_read_b128 v[236:239], v8 offset:40448
    s_mov_b64 exec, -1
    v_mfma_f32_16x16x32_bf16 v[88:91], v[184:187], v[224:227], 0
    v_mfma_f32_16x16x32_bf16 v[88:91], v[188:191], v[228:231], v[88:91]
    v_fmac_f32 v108, v80, v72
    v_fmac_f32 v109, v81, v73
    v_fmac_f32 v110, v82, v74
    v_fmac_f32 v111, v83, v75
    s_add_u32 m0, s31, 68608
    v_or_b32_dpp v13, v28, v3 row_newbcast:6 row_mask:0xf bank_mask:0x3
    v_or_b32_dpp v13, v28, v3 row_newbcast:14 row_mask:0xf bank_mask:0xc
    buffer_load_dwordx4 v13, s[32:35], 0 offen lds
    ds_read_b128 v[176:179], v9 offset:32768
    ds_read_b128 v[180:183], v10 offset:32768
    s_waitcnt lgkmcnt(6)
    v_mfma_f32_16x16x32_bf16 v[92:95], v[200:203], v[200:203], 0
    s_waitcnt lgkmcnt(5)
    v_mfma_f32_16x16x32_bf16 v[92:95], v[204:207], v[204:207], v[92:95]
    v_fmac_f32 v108, v84, v248
    v_fmac_f32 v109, v85, v249
    v_fmac_f32 v110, v86, v250
    v_fmac_f32 v111, v87, v251
    s_waitcnt lgkmcnt(0)
    s_add_u32 m0, s50, 32768
    v_or_b32_dpp v14, v52, v2 row_newbcast:0 row_mask:0xf bank_mask:0x3
    v_or_b32_dpp v14, v52, v2 row_newbcast:8 row_mask:0xf bank_mask:0xc
    buffer_load_dwordx4 v14, s[32:35], 0 offen lds
    s_add_u32 m0, s50, 33792
    v_or_b32_dpp v15, v52, v3 row_newbcast:1 row_mask:0xf bank_mask:0x3
    v_or_b32_dpp v15, v52, v3 row_newbcast:9 row_mask:0xf bank_mask:0xc
    buffer_load_dwordx4 v15, s[32:35], 0 offen lds
    v_mfma_f32_16x16x32_bf16 v[80:83], v[192:195], v[224:227], 0
    v_mfma_f32_16x16x32_bf16 v[80:83], v[196:199], v[228:231], v[80:83]
    v_fmac_f32 v108, v88, v252
    v_fmac_f32 v109, v89, v253
    v_fmac_f32 v110, v90, v254
    v_fmac_f32 v111, v91, v255
    ds_read_b32 v119, v118 offset:16
    ds_read_b128 v[184:187], v9 offset:35328
    ds_read_b128 v[188:191], v10 offset:35328
    v_mfma_f32_16x16x32_bf16 v[84:87], v[208:211], v[224:227], 0
    v_mfma_f32_16x16x32_bf16 v[84:87], v[212:215], v[228:231], v[84:87]
    v_fmac_f32 v108, v92, v100
    v_fmac_f32 v109, v93, v101
    v_fmac_f32 v110, v94, v102
    v_fmac_f32 v111, v95, v103
    s_waitcnt lgkmcnt(2)
    v_cmp_gt_u32 vcc, 21, v119
    s_nop 0
    s_cbranch_vccnz L_rs22
L_rb22:
    s_add_u32 m0, s31, 0
    v_or_b32_dpp v12, v17, v2 row_newbcast:6 row_mask:0xf bank_mask:0x3
    v_or_b32_dpp v12, v17, v2 row_newbcast:14 row_mask:0xf bank_mask:0xc
    buffer_load_dwordx4 v12, s[32:35], 0 offen lds
    s_waitcnt lgkmcnt(0)
    s_add_u32 m0, s50, 35328
    v_or_b32_dpp v13, v52, v2 row_newbcast:2 row_mask:0xf bank_mask:0x3
    v_or_b32_dpp v13, v52, v2 row_newbcast:10 row_mask:0xf bank_mask:0xc
    buffer_load_dwordx4 v13, s[32:35], 0 offen lds
    s_add_u32 m0, s50, 36352
    v_or_b32_dpp v14, v52, v3 row_newbcast:3 row_mask:0xf bank_mask:0x3
    v_or_b32_dpp v14, v52, v3 row_newbcast:11 row_mask:0xf bank_mask:0xc
    buffer_load_dwordx4 v14, s[32:35], 0 offen lds
    s_mov_b64 exec, s[44:45]
    v_mov_b64 v[232:233], v[176:177]
    v_mov_b64 v[234:235], v[178:179]
    v_mov_b64 v[236:237], v[180:181]
    v_mov_b64 v[238:239], v[182:183]
    s_mov_b64 exec, -1
    v_mfma_f32_16x16x32_bf16 v[88:91], v[216:219], v[224:227], 0
    v_mfma_f32_16x16x32_bf16 v[88:91], v[220:223], v[228:231], v[88:91]
    v_fmac_f32 v108, v80, v240
    v_fmac_f32 v109, v81, v241
    v_fmac_f32 v110, v82, v242
    v_fmac_f32 v111, v83, v243
    s_add_u32 m0, s31, 1024
    v_or_b32_dpp v15, v21, v3 row_newbcast:6 row_mask:0xf bank_mask:0x3
    v_or_b32_dpp v15, v21, v3 row_newbcast:14 row_mask:0xf bank_mask:0xc
    buffer_load_dwordx4 v15, s[32:35], 0 offen lds
    ds_read_b128 v[200:203], v9 offset:37888
    ds_read_b128 v[204:207], v10 offset:37888
    v_mfma_f32_16x16x32_bf16 v[92:95], v[176:179], v[232:235], 0
    v_mfma_f32_16x16x32_bf16 v[92:95], v[180:183], v[236:239], v[92:95]
    v_fmac_f32 v108, v84, v244
    v_fmac_f32 v109, v85, v245
    v_fmac_f32 v110, v86, v246
    v_fmac_f32 v111, v87, v247
    s_waitcnt vmcnt(6)
    ds_add_u32 v116, v117
    s_waitcnt lgkmcnt(1)
    s_add_u32 m0, s50, 37888
    v_or_b32_dpp v12, v52, v2 row_newbcast:4 row_mask:0xf bank_mask:0x3
    v_or_b32_dpp v12, v52, v2 row_newbcast:12 row_mask:0xf bank_mask:0xc
    buffer_load_dwordx4 v12, s[32:35], 0 offen lds
    s_add_u32 m0, s50, 38912
    v_or_b32_dpp v13, v52, v3 row_newbcast:5 row_mask:0xf bank_mask:0x3
    v_or_b32_dpp v13, v52, v3 row_newbcast:13 row_mask:0xf bank_mask:0xc
    buffer_load_dwordx4 v13, s[32:35], 0 offen lds
    s_mov_b64 exec, s[44:45]
    v_mov_b64 v[232:233], v[184:185]
    v_mov_b64 v[234:235], v[186:187]
    v_mov_b64 v[236:237], v[188:189]
    v_mov_b64 v[238:239], v[190:191]
    s_mov_b64 exec, -1
    v_mfma_f32_16x16x32_bf16 v[80:83], v[176:179], v[184:187], 0
    v_mfma_f32_16x16x32_bf16 v[80:83], v[180:183], v[188:191], v[80:83]
    v_fmac_f32 v108, v88, v64
    v_fmac_f32 v109, v89, v65
    v_fmac_f32 v110, v90, v66
    v_fmac_f32 v111, v91, v67
    v_add_f32 v112, v108, v109
    v_add_f32 v113, v110, v111
    v_add_f32 v112, v112, v113
    s_nop 1
    v_add_f32_dpp v112, v112, v112 row_shr:1 row_mask:0xf bank_mask:0xf
    s_nop 1
    v_add_f32_dpp v112, v112, v112 row_shr:2 row_mask:0xf bank_mask:0xf
    s_nop 1
    v_add_f32_dpp v112, v112, v112 row_shr:4 row_mask:0xf bank_mask:0xf
    s_nop 1
    v_add_f32_dpp v112, v112, v112 row_shr:8 row_mask:0xf bank_mask:0xf
    s_nop 1
    v_add_f32_dpp v112, v112, v112 row_bcast:15 row_mask:0xa bank_mask:0xf
    s_nop 1
    v_add_f32_dpp v112, v112, v112 row_bcast:31 row_mask:0xc bank_mask:0xf
    s_nop 0
    v_readlane_b32 s56, v112, 63
    s_add_u32 m0, s31, 2048
    v_or_b32_dpp v14, v25, v2 row_newbcast:6 row_mask:0xf bank_mask:0x3
    v_or_b32_dpp v14, v25, v2 row_newbcast:14 row_mask:0xf bank_mask:0xc
    buffer_load_dwordx4 v14, s[32:35], 0 offen lds
    v_mfma_f32_16x16x32_bf16 v[84:87], v[184:187], v[232:235], 0
    v_mfma_f32_16x16x32_bf16 v[84:87], v[188:191], v[236:239], v[84:87]
    v_mul_f32 v108, v92, v104
    v_mul_f32 v109, v93, v105
    v_mul_f32 v110, v94, v106
    v_mul_f32 v111, v95, v107
    s_add_u32 m0, s31, 3072
    v_or_b32_dpp v15, v29, v3 row_newbcast:6 row_mask:0xf bank_mask:0x3
    v_or_b32_dpp v15, v29, v3 row_newbcast:14 row_mask:0xf bank_mask:0xc
    buffer_load_dwordx4 v15, s[32:35], 0 offen lds
    ds_read_b128 v[192:195], v58 offset:32768
    ds_read_b128 v[196:199], v59 offset:32768
    v_mfma_f32_16x16x32_bf16 v[88:91], v[176:179], v[200:203], 0
    v_mfma_f32_16x16x32_bf16 v[88:91], v[180:183], v[204:207], v[88:91]
    v_fmac_f32 v108, v80, v120
    v_fmac_f32 v109, v81, v121
    v_fmac_f32 v110, v82, v122
    v_fmac_f32 v111, v83, v123
    buffer_load_dwordx4 v[44:47], v114, s[36:39], s42 offen offset:128
    s_waitcnt lgkmcnt(0)
    s_add_u32 m0, s50, 40448
    v_or_b32_dpp v12, v53, v2 row_newbcast:4 row_mask:0xf bank_mask:0x3
    v_or_b32_dpp v12, v53, v2 row_newbcast:12 row_mask:0xf bank_mask:0xc
    s_mov_b32 exec_hi, 0
    buffer_load_dwordx4 v12, s[32:35], 0 offen lds
    s_mov_b32 exec_hi, -1
    v_lshlrev_b32 v54, 7, v54
    ds_bpermute_b32 v54, v61, v54
    v_lshlrev_b32 v55, 7, v55
    ds_bpermute_b32 v55, v61, v55
    ds_read_b128 v[208:211], v9
    ds_read_b128 v[212:215], v10
    s_mov_b64 exec, s[44:45]
    v_mov_b64 v[232:233], v[200:201]
    v_mov_b64 v[234:235], v[202:203]
    v_mov_b64 v[236:237], v[204:205]
    v_mov_b64 v[238:239], v[206:207]
    s_mov_b64 exec, -1
    v_mfma_f32_16x16x32_bf16 v[92:95], v[184:187], v[200:203], 0
    v_mfma_f32_16x16x32_bf16 v[92:95], v[188:191], v[204:207], v[92:95]
    v_fmac_f32 v108, v84, v124
    v_fmac_f32 v109, v85, v125
    v_fmac_f32 v110, v86, v126
    v_fmac_f32 v111, v87, v127
    ds_read_b32 v119, v118 offset:16
    s_waitcnt lgkmcnt(1)
    s_add_u32 m0, s50, 0
    v_or_b32_dpp v13, v52, v2 row_newbcast:6 row_mask:0xf bank_mask:0x3
    v_or_b32_dpp v13, v52, v2 row_newbcast:14 row_mask:0xf bank_mask:0xc
    buffer_load_dwordx4 v13, s[32:35], 0 offen lds
    s_add_u32 m0, s50, 1024
    v_or_b32_dpp v14, v52, v3 row_newbcast:7 row_mask:0xf bank_mask:0x3
    v_or_b32_dpp v14, v52, v3 row_newbcast:15 row_mask:0xf bank_mask:0xc
    buffer_load_dwordx4 v14, s[32:35], 0 offen lds
    v_mfma_f32_16x16x32_bf16 v[80:83], v[200:203], v[232:235], 0
    v_mfma_f32_16x16x32_bf16 v[80:83], v[204:207], v[236:239], v[80:83]
    v_fmac_f32 v108, v88, v128
    v_fmac_f32 v109, v89, v129
    v_fmac_f32 v110, v90, v130
    v_fmac_f32 v111, v91, v131
    s_waitcnt lgkmcnt(0)
    v_cmp_gt_u32 vcc, 22, v119
    s_nop 0
    s_cbranch_vccnz L_rs23
L_rb23:
    s_add_u32 m0, s31, 16384
    v_or_b32_dpp v15, v18, v2 row_newbcast:6 row_mask:0xf bank_mask:0x3
    v_or_b32_dpp v15, v18, v2 row_newbcast:14 row_mask:0xf bank_mask:0xc
    buffer_load_dwordx4 v15, s[32:35], 0 offen lds
    v_mfma_f32_16x16x32_bf16 v[84:87], v[192:195], v[192:195], 0
    v_mfma_f32_16x16x32_bf16 v[84:87], v[196:199], v[196:199], v[84:87]
    v_fmac_f32 v108, v92, v132
    v_fmac_f32 v109, v93, v133
    v_fmac_f32 v110, v94, v134
    v_fmac_f32 v111, v95, v135
    s_add_u32 m0, s31, 17408
    v_or_b32_dpp v12, v22, v3 row_newbcast:6 row_mask:0xf bank_mask:0x3
    v_or_b32_dpp v12, v22, v3 row_newbcast:14 row_mask:0xf bank_mask:0xc
    buffer_load_dwordx4 v12, s[32:35], 0 offen lds
    s_mov_b64 exec, s[44:45]
    v_mov_b64 v[232:233], v[208:209]
    v_mov_b64 v[234:235], v[210:211]
    v_mov_b64 v[236:237], v[212:213]
    v_mov_b64 v[238:239], v[214:215]
    s_mov_b64 exec, -1
    v_mfma_f32_16x16x32_bf16 v[88:91], v[176:179], v[208:211], 0
    v_mfma_f32_16x16x32_bf16 v[88:91], v[180:183], v[212:215], v[88:91]
    v_fmac_f32 v108, v80, v136
    v_fmac_f32 v109, v81, v137
    v_fmac_f32 v110, v82, v138
    v_fmac_f32 v111, v83, v139
    s_waitcnt vmcnt(6)
    ds_add_u32 v116, v117
    ds_read_b128 v[216:219], v9 offset:2560
    ds_read_b128 v[220:223], v10 offset:2560
    v_mfma_f32_16x16x32_bf16 v[92:95], v[208:211], v[232:235], 0
    v_mfma_f32_16x16x32_bf16 v[92:95], v[212:215], v[236:239], v[92:95]
    v_fmac_f32 v108, v84, v96
    v_fmac_f32 v109, v85, v97
    v_fmac_f32 v110, v86, v98
    v_fmac_f32 v111, v87, v99
    s_add_u32 m0, s31, 18432
    v_or_b32_dpp v13, v26, v2 row_newbcast:6 row_mask:0xf bank_mask:0x3
    v_or_b32_dpp v13, v26, v2 row_newbcast:14 row_mask:0xf bank_mask:0xc
    buffer_load_dwordx4 v13, s[32:35], 0 offen lds
    s_waitcnt lgkmcnt(0)
    s_add_u32 m0, s50, 2560
    v_or_b32_dpp v14, v53, v2 row_newbcast:0 row_mask:0xf bank_mask:0x3
    v_or_b32_dpp v14, v53, v2 row_newbcast:8 row_mask:0xf bank_mask:0xc
    buffer_load_dwordx4 v14, s[32:35], 0 offen lds
    s_add_u32 m0, s50, 3584
    v_or_b32_dpp v15, v53, v3 row_newbcast:1 row_mask:0xf bank_mask:0x3
    v_or_b32_dpp v15, v53, v3 row_newbcast:9 row_mask:0xf bank_mask:0xc
    buffer_load_dwordx4 v15, s[32:35], 0 offen lds
    buffer_load_dword v48, v11, s[36:39], 0 offen offset:3200
    buffer_load_dword v49, v11, s[36:39], 0 offen offset:3456
    v_mfma_f32_16x16x32_bf16 v[80:83], v[184:187], v[208:211], 0
    v_mfma_f32_16x16x32_bf16 v[80:83], v[188:191], v[212:215], v[80:83]
    v_fmac_f32 v108, v88, v140
    v_fmac_f32 v109, v89, v141
    v_fmac_f32 v110, v90, v142
    v_fmac_f32 v111, v91, v143
    s_add_u32 m0, s31, 19456
    v_or_b32_dpp v12, v30, v3 row_newbcast:6 row_mask:0xf bank_mask:0x3
    v_or_b32_dpp v12, v30, v3 row_newbcast:14 row_mask:0xf bank_mask:0xc
    buffer_load_dwordx4 v12, s[32:35], 0 offen lds
    v_mfma_f32_16x16x32_bf16 v[84:87], v[200:203], v[208:211], 0
    v_mfma_f32_16x16x32_bf16 v[84:87], v[204:207], v[212:215], v[84:87]
    v_fmac_f32 v108, v92, v144
    v_fmac_f32 v109, v93, v145
    v_fmac_f32 v110, v94, v146
    v_fmac_f32 v111, v95, v147
    ds_read_b32 v119, v118 offset:16
    s_mov_b64 exec, s[44:45]
    v_mov_b64 v[232:233], v[216:217]
    v_mov_b64 v[234:235], v[218:219]
    v_mov_b64 v[236:237], v[220:221]
    v_mov_b64 v[238:239], v[222:223]
    s_mov_b64 exec, -1
    v_mfma_f32_16x16x32_bf16 v[88:91], v[176:179], v[216:219], 0
    v_mfma_f32_16x16x32_bf16 v[88:91], v[180:183], v[220:223], v[88:91]
    v_fmac_f32 v108, v80, v148
    v_fmac_f32 v109, v81, v149
    v_fmac_f32 v110, v82, v150
    v_fmac_f32 v111, v83, v151
    s_waitcnt lgkmcnt(0)
    v_cmp_gt_u32 vcc, 23, v119
    s_nop 0
    s_cbranch_vccnz L_rs24
L_rb24:
    s_add_u32 m0, s31, 32768
    v_or_b32_dpp v13, v19, v2 row_newbcast:6 row_mask:0xf bank_mask:0x3
    v_or_b32_dpp v13, v19, v2 row_newbcast:14 row_mask:0xf bank_mask:0xc
    buffer_load_dwordx4 v13, s[32:35], 0 offen lds
    v_mfma_f32_16x16x32_bf16 v[92:95], v[216:219], v[232:235], 0
    v_mfma_f32_16x16x32_bf16 v[92:95], v[220:223], v[236:239], v[92:95]
    v_fmac_f32 v108, v84, v152
    v_fmac_f32 v109, v85, v153
    v_fmac_f32 v110, v86, v154
    v_fmac_f32 v111, v87, v155
    s_add_u32 m0, s31, 33792
    v_or_b32_dpp v14, v23, v3 row_newbcast:6 row_mask:0xf bank_mask:0x3
    v_or_b32_dpp v14, v23, v3 row_newbcast:14 row_mask:0xf bank_mask:0xc
    buffer_load_dwordx4 v14, s[32:35], 0 offen lds
    ds_read_b128 v[224:227], v9 offset:5120
    ds_read_b128 v[228:231], v10 offset:5120
    v_mfma_f32_16x16x32_bf16 v[80:83], v[184:187], v[216:219], 0
    v_mfma_f32_16x16x32_bf16 v[80:83], v[188:191], v[220:223], v[80:83]
    v_fmac_f32 v108, v88, v156
    v_fmac_f32 v109, v89, v157
    v_fmac_f32 v110, v90, v158
    v_fmac_f32 v111, v91, v159
    s_waitcnt vmcnt(2)
    ds_add_u32 v116, v117
    s_waitcnt lgkmcnt(1)
    s_add_u32 m0, s50, 5120
    v_or_b32_dpp v15, v53, v2 row_newbcast:2 row_mask:0xf bank_mask:0x3
    v_or_b32_dpp v15, v53, v2 row_newbcast:10 row_mask:0xf bank_mask:0xc
    buffer_load_dwordx4 v15, s[32:35], 0 offen lds
    s_add_u32 m0, s50, 6144
    v_or_b32_dpp v12, v53, v3 row_newbcast:3 row_mask:0xf bank_mask:0x3
    v_or_b32_dpp v12, v53, v3 row_newbcast:11 row_mask:0xf bank_mask:0xc
    buffer_load_dwordx4 v12, s[32:35], 0 offen lds
    v_mfma_f32_16x16x32_bf16 v[84:87], v[200:203], v[216:219], 0
    v_mfma_f32_16x16x32_bf16 v[84:87], v[204:207], v[220:223], v[84:87]
    v_fmac_f32 v108, v92, v160
    v_fmac_f32 v109, v93, v161
    v_fmac_f32 v110, v94, v162
    v_fmac_f32 v111, v95, v163
    s_add_u32 m0, s31, 34816
    v_or_b32_dpp v13, v27, v2 row_newbcast:6 row_mask:0xf bank_mask:0x3
    v_or_b32_dpp v13, v27, v2 row_newbcast:14 row_mask:0xf bank_mask:0xc
    buffer_load_dwordx4 v13, s[32:35], 0 offen lds
    v_mfma_f32_16x16x32_bf16 v[88:91], v[208:211], v[216:219], 0
    v_mfma_f32_16x16x32_bf16 v[88:91], v[212:215], v[220:223], v[88:91]
    v_fmac_f32 v108, v80, v164
    v_fmac_f32 v109, v81, v165
    v_fmac_f32 v110, v82, v166
    v_fmac_f32 v111, v83, v167
    s_add_u32 m0, s31, 35840
    v_or_b32_dpp v14, v31, v3 row_newbcast:6 row_mask:0xf bank_mask:0x3
    v_or_b32_dpp v14, v31, v3 row_newbcast:14 row_mask:0xf bank_mask:0xc
    buffer_load_dwordx4 v14, s[32:35], 0 offen lds
    ds_read_b128 v[192:195], v58
    ds_read_b128 v[196:199], v59
    s_mov_b64 exec, s[44:45]
    v_mov_b64 v[232:233], v[224:225]
    v_mov_b64 v[234:235], v[226:227]
    v_mov_b64 v[236:237], v[228:229]
    v_mov_b64 v[238:239], v[230:231]
    s_mov_b64 exec, -1
    v_mfma_f32_16x16x32_bf16 v[92:95], v[176:179], v[224:227], 0
    v_mfma_f32_16x16x32_bf16 v[92:95], v[180:183], v[228:231], v[92:95]
    v_fmac_f32 v108, v84, v168
    v_fmac_f32 v109, v85, v169
    v_fmac_f32 v110, v86, v170
    v_fmac_f32 v111, v87, v171
    v_mfma_f32_16x16x32_bf16 v[80:83], v[224:227], v[232:235], 0
    v_mfma_f32_16x16x32_bf16 v[80:83], v[228:231], v[236:239], v[80:83]
    v_fmac_f32 v108, v88, v68
    v_fmac_f32 v109, v89, v69
    v_fmac_f32 v110, v90, v70
    v_fmac_f32 v111, v91, v71
    ds_read_b32 v119, v118 offset:16
    s_mov_b64 exec, s[46:47]
    ds_read_b128 v[232:235], v7 offset:40448
    ds_read_b128 v[236:239], v8 offset:40448
    s_mov_b64 exec, -1
    v_mfma_f32_16x16x32_bf16 v[84:87], v[184:187], v[224:227], 0
    v_mfma_f32_16x16x32_bf16 v[84:87], v[188:191], v[228:231], v[84:87]
    v_fmac_f32 v108, v92, v72
    v_fmac_f32 v109, v93, v73
    v_fmac_f32 v110, v94, v74
    v_fmac_f32 v111, v95, v75
    s_waitcnt lgkmcnt(2)
    v_cmp_gt_u32 vcc, 24, v119
    s_nop 0
    s_cbranch_vccnz L_rs25
L_rb25:
    s_add_u32 m0, s31, 49152
    v_or_b32_dpp v15, v16, v2 row_newbcast:7 row_mask:0xf bank_mask:0x3
    v_or_b32_dpp v15, v16, v2 row_newbcast:15 row_mask:0xf bank_mask:0xc
    buffer_load_dwordx4 v15, s[32:35], 0 offen lds
    ds_read_b128 v[176:179], v7 offset:32768
    ds_read_b128 v[180:183], v8 offset:32768
    v_mfma_f32_16x16x32_bf16 v[88:91], v[192:195], v[192:195], 0
    v_mfma_f32_16x16x32_bf16 v[88:91], v[196:199], v[196:199], v[88:91]
    v_fmac_f32 v108, v80, v248
    v_fmac_f32 v109, v81, v249
    v_fmac_f32 v110, v82, v250
    v_fmac_f32 v111, v83, v251
    s_add_u32 m0, s31, 50176
    v_or_b32_dpp v12, v20, v3 row_newbcast:7 row_mask:0xf bank_mask:0x3
    v_or_b32_dpp v12, v20, v3 row_newbcast:15 row_mask:0xf bank_mask:0xc
    buffer_load_dwordx4 v12, s[32:35], 0 offen lds
    s_waitcnt lgkmcnt(0)
    s_add_u32 m0, s50, 33280
    v_or_b32_dpp v13, v54, v62 row_newbcast:0 row_mask:0xf bank_mask:0x3
    v_or_b32_dpp v13, v54, v62 row_newbcast:8 row_mask:0xf bank_mask:0xc
    buffer_load_dwordx4 v13, s[32:35], 0 offen lds
    s_add_u32 m0, s50, 34304
    v_or_b32_dpp v14, v54, v63 row_newbcast:1 row_mask:0xf bank_mask:0x3
    v_or_b32_dpp v14, v54, v63 row_newbcast:9 row_mask:0xf bank_mask:0xc
    buffer_load_dwordx4 v14, s[32:35], 0 offen lds
    v_mfma_f32_16x16x32_bf16 v[92:95], v[200:203], v[224:227], 0
    v_mfma_f32_16x16x32_bf16 v[92:95], v[204:207], v[228:231], v[92:95]
    v_fmac_f32 v108, v84, v252
    v_fmac_f32 v109, v85, v253
    v_fmac_f32 v110, v86, v254
    v_fmac_f32 v111, v87, v255
    s_waitcnt vmcnt(4)
    ds_add_u32 v116, v117
    ds_read_b128 v[184:187], v7 offset:35328
    ds_read_b128 v[188:191], v8 offset:35328
    v_mfma_f32_16x16x32_bf16 v[80:83], v[208:211], v[224:227], 0
    v_mfma_f32_16x16x32_bf16 v[80:83], v[212:215], v[228:231], v[80:83]
    v_fmac_f32 v108, v88, v100
    v_fmac_f32 v109, v89, v101
    v_fmac_f32 v110, v90, v102
    v_fmac_f32 v111, v91, v103
    s_add_u32 m0, s31, 51200
    v_or_b32_dpp v15, v24, v2 row_newbcast:7 row_mask:0xf bank_mask:0x3
    v_or_b32_dpp v15, v24, v2 row_newbcast:15 row_mask:0xf bank_mask:0xc
    buffer_load_dwordx4 v15, s[32:35], 0 offen lds
    s_waitcnt lgkmcnt(0)
    s_add_u32 m0, s50, 35840
    v_or_b32_dpp v12, v54, v62 row_newbcast:2 row_mask:0xf bank_mask:0x3
    v_or_b32_dpp v12, v54, v62 row_newbcast:10 row_mask:0xf bank_mask:0xc
    buffer_load_dwordx4 v12, s[32:35], 0 offen lds
    s_add_u32 m0, s50, 36864
    v_or_b32_dpp v13, v54, v63 row_newbcast:3 row_mask:0xf bank_mask:0x3
    v_or_b32_dpp v13, v54, v63 row_newbcast:11 row_mask:0xf bank_mask:0xc
    buffer_load_dwordx4 v13, s[32:35], 0 offen lds
    s_mov_b64 exec, s[44:45]
    v_mov_b64 v[232:233], v[176:177]
    v_mov_b64 v[234:235], v[178:179]
    v_mov_b64 v[236:237], v[180:181]
    v_mov_b64 v[238:239], v[182:183]
    s_mov_b64 exec, -1
    v_mfma_f32_16x16x32_bf16 v[84:87], v[216:219], v[224:227], 0
    v_mfma_f32_16x16x32_bf16 v[84:87], v[220:223], v[228:231], v[84:87]
    v_fmac_f32 v108, v92, v240
    v_fmac_f32 v109, v93, v241
    v_fmac_f32 v110, v94, v242
    v_fmac_f32 v111, v95, v243
    s_add_u32 m0, s31, 52224
    v_or_b32_dpp v14, v28, v3 row_newbcast:7 row_mask:0xf bank_mask:0x3
    v_or_b32_dpp v14, v28, v3 row_newbcast:15 row_mask:0xf bank_mask:0xc
    buffer_load_dwordx4 v14, s[32:35], 0 offen lds
    ds_read_b128 v[192:195], v7 offset:37888
    ds_read_b128 v[196:199], v8 offset:37888
    v_mfma_f32_16x16x32_bf16 v[88:91], v[176:179], v[232:235], 0
    v_mfma_f32_16x16x32_bf16 v[88:91], v[180:183], v[236:239], v[88:91]
    v_fmac_f32 v108, v80, v244
    v_fmac_f32 v109, v81, v245
    v_fmac_f32 v110, v82, v246
    v_fmac_f32 v111, v83, v247
    ds_read_b32 v119, v118 offset:16
    s_waitcnt lgkmcnt(1)
    s_add_u32 m0, s50, 38400
    v_or_b32_dpp v15, v54, v62 row_newbcast:4 row_mask:0xf bank_mask:0x3
    v_or_b32_dpp v15, v54, v62 row_newbcast:12 row_mask:0xf bank_mask:0xc
    buffer_load_dwordx4 v15, s[32:35], 0 offen lds
    s_add_u32 m0, s50, 39424
    v_or_b32_dpp v12, v54, v63 row_newbcast:5 row_mask:0xf bank_mask:0x3
    v_or_b32_dpp v12, v54, v63 row_newbcast:13 row_mask:0xf bank_mask:0xc
    buffer_load_dwordx4 v12, s[32:35], 0 offen lds
    s_mov_b64 exec, s[44:45]
    v_mov_b64 v[232:233], v[184:185]
    v_mov_b64 v[234:235], v[186:187]
    v_mov_b64 v[236:237], v[188:189]
    v_mov_b64 v[238:239], v[190:191]
    s_mov_b64 exec, -1
    v_mfma_f32_16x16x32_bf16 v[92:95], v[176:179], v[184:187], 0
    v_mfma_f32_16x16x32_bf16 v[92:95], v[180:183], v[188:191], v[92:95]
    v_fmac_f32 v108, v84, v64
    v_fmac_f32 v109, v85, v65
    v_fmac_f32 v110, v86, v66
    v_fmac_f32 v111, v87, v67
    v_add_f32 v112, v108, v109
    v_add_f32 v113, v110, v111
    v_add_f32 v112, v112, v113
    s_nop 1
    v_add_f32_dpp v112, v112, v112 row_shr:1 row_mask:0xf bank_mask:0xf
    s_nop 1
    v_add_f32_dpp v112, v112, v112 row_shr:2 row_mask:0xf bank_mask:0xf
    s_nop 1
    v_add_f32_dpp v112, v112, v112 row_shr:4 row_mask:0xf bank_mask:0xf
    s_nop 1
    v_add_f32_dpp v112, v112, v112 row_shr:8 row_mask:0xf bank_mask:0xf
    s_nop 1
    v_add_f32_dpp v112, v112, v112 row_bcast:15 row_mask:0xa bank_mask:0xf
    s_nop 1
    v_add_f32_dpp v112, v112, v112 row_bcast:31 row_mask:0xc bank_mask:0xf
    s_nop 0
    v_readlane_b32 s57, v112, 63
    s_waitcnt lgkmcnt(0)
    v_cmp_gt_u32 vcc, 25, v119
    s_nop 0
    s_cbranch_vccnz L_rs26
L_rb26:
    s_add_u32 m0, s31, 65536
    v_or_b32_dpp v13, v17, v2 row_newbcast:7 row_mask:0xf bank_mask:0x3
    v_or_b32_dpp v13, v17, v2 row_newbcast:15 row_mask:0xf bank_mask:0xc
    buffer_load_dwordx4 v13, s[32:35], 0 offen lds
    v_mfma_f32_16x16x32_bf16 v[80:83], v[184:187], v[232:235], 0
    v_mfma_f32_16x16x32_bf16 v[80:83], v[188:191], v[236:239], v[80:83]
    v_mul_f32 v108, v88, v104
    v_mul_f32 v109, v89, v105
    v_mul_f32 v110, v90, v106
    v_mul_f32 v111, v91, v107
    s_add_u32 m0, s31, 66560
    v_or_b32_dpp v14, v21, v3 row_newbcast:7 row_mask:0xf bank_mask:0x3
    v_or_b32_dpp v14, v21, v3 row_newbcast:15 row_mask:0xf bank_mask:0xc
    buffer_load_dwordx4 v14, s[32:35], 0 offen lds
    ds_read_b128 v[200:203], v56 offset:32768
    ds_read_b128 v[204:207], v57 offset:32768
    v_mfma_f32_16x16x32_bf16 v[84:87], v[176:179], v[192:195], 0
    v_mfma_f32_16x16x32_bf16 v[84:87], v[180:183], v[196:199], v[84:87]
    v_fmac_f32 v108, v92, v120
    v_fmac_f32 v109, v93, v121
    v_fmac_f32 v110, v94, v122
    v_fmac_f32 v111, v95, v123
    s_waitcnt vmcnt(4)
    ds_add_u32 v116, v117
    s_waitcnt lgkmcnt(1)
    s_add_u32 m0, s50, 39936
    v_or_b32_dpp v15, v55, v63 row_newbcast:5 row_mask:0xf bank_mask:0x3
    v_or_b32_dpp v15, v55, v63 row_newbcast:13 row_mask:0xf bank_mask:0xc
    s_mov_b32 exec_lo, 0
    buffer_load_dwordx4 v15, s[32:35], 0 offen lds
    s_mov_b32 exec_lo, -1
    v_lshlrev_b32 v48, 7, v48
    ds_bpermute_b32 v48, v4, v48
    v_lshlrev_b32 v49, 7, v49
    ds_bpermute_b32 v49, v4, v49
    ds_read_b128 v[208:211], v7
    ds_read_b128 v[212:215], v8
    s_mov_b64 exec, s[44:45]
    v_mov_b64 v[232:233], v[192:193]
    v_mov_b64 v[234:235], v[194:195]
    v_mov_b64 v[236:237], v[196:197]
    v_mov_b64 v[238:239], v[198:199]
    s_mov_b64 exec, -1
    v_mfma_f32_16x16x32_bf16 v[88:91], v[184:187], v[192:195], 0
    v_mfma_f32_16x16x32_bf16 v[88:91], v[188:191], v[196:199], v[88:91]
    v_fmac_f32 v108, v80, v124
    v_fmac_f32 v109, v81, v125
    v_fmac_f32 v110, v82, v126
    v_fmac_f32 v111, v83, v127
    s_add_u32 m0, s31, 67584
    v_or_b32_dpp v12, v25, v2 row_newbcast:7 row_mask:0xf bank_mask:0x3
    v_or_b32_dpp v12, v25, v2 row_newbcast:15 row_mask:0xf bank_mask:0xc
    buffer_load_dwordx4 v12, s[32:35], 0 offen lds
    s_waitcnt lgkmcnt(0)
    s_add_u32 m0, s50, 512
    v_or_b32_dpp v13, v54, v62 row_newbcast:6 row_mask:0xf bank_mask:0x3
    v_or_b32_dpp v13, v54, v62 row_newbcast:14 row_mask:0xf bank_mask:0xc
    buffer_load_dwordx4 v13, s[32:35], 0 offen lds
    s_add_u32 m0, s50, 1536
    v_or_b32_dpp v14, v54, v63 row_newbcast:7 row_mask:0xf bank_mask:0x3
    v_or_b32_dpp v14, v54, v63 row_newbcast:15 row_mask:0xf bank_mask:0xc
    buffer_load_dwordx4 v14, s[32:35], 0 offen lds
    v_mfma_f32_16x16x32_bf16 v[92:95], v[192:195], v[232:235], 0
    v_mfma_f32_16x16x32_bf16 v[92:95], v[196:199], v[236:239], v[92:95]
    v_fmac_f32 v108, v84, v128
    v_fmac_f32 v109, v85, v129
    v_fmac_f32 v110, v86, v130
    v_fmac_f32 v111, v87, v131
    s_add_u32 m0, s31, 68608
    v_or_b32_dpp v15, v29, v3 row_newbcast:7 row_mask:0xf bank_mask:0x3
    v_or_b32_dpp v15, v29, v3 row_newbcast:15 row_mask:0xf bank_mask:0xc
    buffer_load_dwordx4 v15, s[32:35], 0 offen lds
    v_mfma_f32_16x16x32_bf16 v[80:83], v[200:203], v[200:203], 0
    v_mfma_f32_16x16x32_bf16 v[80:83], v[204:207], v[204:207], v[80:83]
    v_fmac_f32 v108, v88, v132
    v_fmac_f32 v109, v89, v133
    v_fmac_f32 v110, v90, v134
    v_fmac_f32 v111, v91, v135
    s_mov_b64 exec, s[44:45]
    v_mov_b64 v[232:233], v[208:209]
    v_mov_b64 v[234:235], v[210:211]
    v_mov_b64 v[236:237], v[212:213]
    v_mov_b64 v[238:239], v[214:215]
    s_mov_b64 exec, -1
    v_mfma_f32_16x16x32_bf16 v[84:87], v[176:179], v[208:211], 0
    v_mfma_f32_16x16x32_bf16 v[84:87], v[180:183], v[212:215], v[84:87]
    v_fmac_f32 v108, v92, v136
    v_fmac_f32 v109, v93, v137
    v_fmac_f32 v110, v94, v138
    v_fmac_f32 v111, v95, v139
    ds_read_b32 v119, v118 offset:16
    ds_read_b128 v[216:219], v7 offset:2560
    ds_read_b128 v[220:223], v8 offset:2560
    v_mfma_f32_16x16x32_bf16 v[88:91], v[208:211], v[232:235], 0
    v_mfma_f32_16x16x32_bf16 v[88:91], v[212:215], v[236:239], v[88:91]
    v_fmac_f32 v108, v80, v96
    v_fmac_f32 v109, v81, v97
    v_fmac_f32 v110, v82, v98
    v_fmac_f32 v111, v83, v99
    s_waitcnt lgkmcnt(2)
    v_cmp_gt_u32 vcc, 26, v119
    s_nop 0
    s_cbranch_vccnz L_rs27
L_rb27:
    s_add_u32 m0, s31, 0
    v_or_b32_dpp v12, v18, v2 row_newbcast:7 row_mask:0xf bank_mask:0x3
    v_or_b32_dpp v12, v18, v2 row_newbcast:15 row_mask:0xf bank_mask:0xc
    buffer_load_dwordx4 v12, s[32:35], 0 offen lds
    s_waitcnt lgkmcnt(0)
    s_add_u32 m0, s50, 3072
    v_or_b32_dpp v13, v55, v62 row_newbcast:0 row_mask:0xf bank_mask:0x3
    v_or_b32_dpp v13, v55, v62 row_newbcast:8 row_mask:0xf bank_mask:0xc
    buffer_load_dwordx4 v13, s[32:35], 0 offen lds
    s_add_u32 m0, s50, 4096
    v_or_b32_dpp v14, v55, v63 row_newbcast:1 row_mask:0xf bank_mask:0x3
    v_or_b32_dpp v14, v55, v63 row_newbcast:9 row_mask:0xf bank_mask:0xc
    buffer_load_dwordx4 v14, s[32:35], 0 offen lds
    buffer_load_dword v50, v11, s[36:39], 0 offen offset:3600
    buffer_load_dword v51, v11, s[36:39], 0 offen offset:3856
    v_mfma_f32_16x16x32_bf16 v[92:95], v[184:187], v[208:211], 0
    v_mfma_f32_16x16x32_bf16 v[92:95], v[188:191], v[212:215], v[92:95]
    v_fmac_f32 v108, v84, v140
    v_fmac_f32 v109, v85, v141
    v_fmac_f32 v110, v86, v142
    v_fmac_f32 v111, v87, v143
    s_add_u32 m0, s31, 1024
    v_or_b32_dpp v15, v22, v3 row_newbcast:7 row_mask:0xf bank_mask:0x3
    v_or_b32_dpp v15, v22, v3 row_newbcast:15 row_mask:0xf bank_mask:0xc
    buffer_load_dwordx4 v15, s[32:35], 0 offen lds
    v_mfma_f32_16x16x32_bf16 v[80:83], v[192:195], v[208:211], 0
    v_mfma_f32_16x16x32_bf16 v[80:83], v[196:199], v[212:215], v[80:83]
    v_fmac_f32 v108, v88, v144
    v_fmac_f32 v109, v89, v145
    v_fmac_f32 v110, v90, v146
    v_fmac_f32 v111, v91, v147
    s_waitcnt vmcnt(6)
    ds_add_u32 v116, v117
    s_mov_b64 exec, s[44:45]
    v_mov_b64 v[232:233], v[216:217]
    v_mov_b64 v[234:235], v[218:219]
    v_mov_b64 v[236:237], v[220:221]
    v_mov_b64 v[238:239], v[222:223]
    s_mov_b64 exec, -1
    v_mfma_f32_16x16x32_bf16 v[84:87], v[176:179], v[216:219], 0
    v_mfma_f32_16x16x32_bf16 v[84:87], v[180:183], v[220:223], v[84:87]
    v_fmac_f32 v108, v92, v148
    v_fmac_f32 v109, v93, v149
    v_fmac_f32 v110, v94, v150
    v_fmac_f32 v111, v95, v151
    s_add_u32 m0, s31, 2048
    v_or_b32_dpp v12, v26, v2 row_newbcast:7 row_mask:0xf bank_mask:0x3
    v_or_b32_dpp v12, v26, v2 row_newbcast:15 row_mask:0xf bank_mask:0xc
    buffer_load_dwordx4 v12, s[32:35], 0 offen lds
    v_mfma_f32_16x16x32_bf16 v[88:91], v[216:219], v[232:235], 0
    v_mfma_f32_16x16x32_bf16 v[88:91], v[220:223], v[236:239], v[88:91]
    v_fmac_f32 v108, v80, v152
    v_fmac_f32 v109, v81, v153
    v_fmac_f32 v110, v82, v154
    v_fmac_f32 v111, v83, v155
    s_add_u32 m0, s31, 3072
    v_or_b32_dpp v13, v30, v3 row_newbcast:7 row_mask:0xf bank_mask:0x3
    v_or_b32_dpp v13, v30, v3 row_newbcast:15 row_mask:0xf bank_mask:0xc
    buffer_load_dwordx4 v13, s[32:35], 0 offen lds
    ds_read_b128 v[224:227], v7 offset:5120
    ds_read_b128 v[228:231], v8 offset:5120
    v_mfma_f32_16x16x32_bf16 v[92:95], v[184:187], v[216:219], 0
    v_mfma_f32_16x16x32_bf16 v[92:95], v[188:191], v[220:223], v[92:95]
    v_fmac_f32 v108, v84, v156
    v_fmac_f32 v109, v85, v157
    v_fmac_f32 v110, v86, v158
    v_fmac_f32 v111, v87, v159
    v_lshlrev_b32 v32, 7, v32
    v_lshlrev_b32 v33, 7, v33
    v_lshlrev_b32 v34, 7, v34
    v_lshlrev_b32 v35, 7, v35
    v_lshlrev_b32 v36, 7, v36
    v_lshlrev_b32 v37, 7, v37
    v_lshlrev_b32 v38, 7, v38
    v_lshlrev_b32 v39, 7, v39
    v_lshlrev_b32 v40, 7, v40
    v_lshlrev_b32 v41, 7, v41
    v_lshlrev_b32 v42, 7, v42
    v_lshlrev_b32 v43, 7, v43
    v_lshlrev_b32 v44, 7, v44
    v_lshlrev_b32 v45, 7, v45
    v_lshlrev_b32 v46, 7, v46
    v_lshlrev_b32 v47, 7, v47
    ds_read_b32 v119, v118 offset:16
    s_waitcnt lgkmcnt(1)
    s_add_u32 m0, s50, 5632
    v_or_b32_dpp v14, v55, v62 row_newbcast:2 row_mask:0xf bank_mask:0x3
    v_or_b32_dpp v14, v55, v62 row_newbcast:10 row_mask:0xf bank_mask:0xc
    buffer_load_dwordx4 v14, s[32:35], 0 offen lds
    s_add_u32 m0, s50, 6656
    v_or_b32_dpp v15, v55, v63 row_newbcast:3 row_mask:0xf bank_mask:0x3
    v_or_b32_dpp v15, v55, v63 row_newbcast:11 row_mask:0xf bank_mask:0xc
    buffer_load_dwordx4 v15, s[32:35], 0 offen lds
    v_mfma_f32_16x16x32_bf16 v[80:83], v[192:195], v[216:219], 0
    v_mfma_f32_16x16x32_bf16 v[80:83], v[196:199], v[220:223], v[80:83]
    v_fmac_f32 v108, v88, v160
    v_fmac_f32 v109, v89, v161
    v_fmac_f32 v110, v90, v162
    v_fmac_f32 v111, v91, v163
    s_waitcnt lgkmcnt(0)
    v_cmp_gt_u32 vcc, 27, v119
    s_nop 0
    s_cbranch_vccnz L_rs28
L_rb28:
    s_add_u32 m0, s31, 16384
    v_or_b32_dpp v12, v19, v2 row_newbcast:7 row_mask:0xf bank_mask:0x3
    v_or_b32_dpp v12, v19, v2 row_newbcast:15 row_mask:0xf bank_mask:0xc
    buffer_load_dwordx4 v12, s[32:35], 0 offen lds
    v_mfma_f32_16x16x32_bf16 v[84:87], v[208:211], v[216:219], 0
    v_mfma_f32_16x16x32_bf16 v[84:87], v[212:215], v[220:223], v[84:87]
    v_fmac_f32 v108, v92, v164
    v_fmac_f32 v109, v93, v165
    v_fmac_f32 v110, v94, v166
    v_fmac_f32 v111, v95, v167
    s_add_u32 m0, s31, 17408
    v_or_b32_dpp v13, v23, v3 row_newbcast:7 row_mask:0xf bank_mask:0x3
    v_or_b32_dpp v13, v23, v3 row_newbcast:15 row_mask:0xf bank_mask:0xc
    buffer_load_dwordx4 v13, s[32:35], 0 offen lds
    ds_read_b128 v[200:203], v56
    ds_read_b128 v[204:207], v57
    s_mov_b64 exec, s[44:45]
    v_mov_b64 v[232:233], v[224:225]
    v_mov_b64 v[234:235], v[226:227]
    v_mov_b64 v[236:237], v[228:229]
    v_mov_b64 v[238:239], v[230:231]
    s_mov_b64 exec, -1
    v_mfma_f32_16x16x32_bf16 v[88:91], v[176:179], v[224:227], 0
    v_mfma_f32_16x16x32_bf16 v[88:91], v[180:183], v[228:231], v[88:91]
    v_fmac_f32 v108, v80, v168
    v_fmac_f32 v109, v81, v169
    v_fmac_f32 v110, v82, v170
    v_fmac_f32 v111, v83, v171
    s_waitcnt vmcnt(4)
    ds_add_u32 v116, v117
    v_mfma_f32_16x16x32_bf16 v[92:95], v[224:227], v[232:235], 0
    v_mfma_f32_16x16x32_bf16 v[92:95], v[228:231], v[236:239], v[92:95]
    v_fmac_f32 v108, v84, v68
    v_fmac_f32 v109, v85, v69
    v_fmac_f32 v110, v86, v70
    v_fmac_f32 v111, v87, v71
    s_add_u32 m0, s31, 18432
    v_or_b32_dpp v14, v27, v2 row_newbcast:7 row_mask:0xf bank_mask:0x3
    v_or_b32_dpp v14, v27, v2 row_newbcast:15 row_mask:0xf bank_mask:0xc
    buffer_load_dwordx4 v14, s[32:35], 0 offen lds
    s_mov_b64 exec, s[46:47]
    ds_read_b128 v[232:235], v7 offset:40448
    ds_read_b128 v[236:239], v8 offset:40448
    s_mov_b64 exec, -1
    v_mfma_f32_16x16x32_bf16 v[80:83], v[184:187], v[224:227], 0
    v_mfma_f32_16x16x32_bf16 v[80:83], v[188:191], v[228:231], v[80:83]
    v_fmac_f32 v108, v88, v72
    v_fmac_f32 v109, v89, v73
    v_fmac_f32 v110, v90, v74
    v_fmac_f32 v111, v91, v75
    s_add_u32 m0, s31, 19456
    v_or_b32_dpp v15, v31, v3 row_newbcast:7 row_mask:0xf bank_mask:0x3
    v_or_b32_dpp v15, v31, v3 row_newbcast:15 row_mask:0xf bank_mask:0xc
    buffer_load_dwordx4 v15, s[32:35], 0 offen lds
    ds_read_b128 v[176:179], v9 offset:32768
    ds_read_b128 v[180:183], v10 offset:32768
    s_waitcnt lgkmcnt(6)
    v_mfma_f32_16x16x32_bf16 v[84:87], v[200:203], v[200:203], 0
    s_waitcnt lgkmcnt(5)
    v_mfma_f32_16x16x32_bf16 v[84:87], v[204:207], v[204:207], v[84:87]
    v_fmac_f32 v108, v92, v248
    v_fmac_f32 v109, v93, v249
    v_fmac_f32 v110, v94, v250
    v_fmac_f32 v111, v95, v251
    s_waitcnt lgkmcnt(0)
    s_add_u32 m0, s50, 32768
    v_or_b32_dpp v12, v48, v2 row_newbcast:0 row_mask:0xf bank_mask:0x3
    v_or_b32_dpp v12, v48, v2 row_newbcast:8 row_mask:0xf bank_mask:0xc
    buffer_load_dwordx4 v12, s[32:35], 0 offen lds
    s_add_u32 m0, s50, 33792
    v_or_b32_dpp v13, v48, v3 row_newbcast:1 row_mask:0xf bank_mask:0x3
    v_or_b32_dpp v13, v48, v3 row_newbcast:9 row_mask:0xf bank_mask:0xc
    buffer_load_dwordx4 v13, s[32:35], 0 offen lds
    v_mfma_f32_16x16x32_bf16 v[88:91], v[192:195], v[224:227], 0
    v_mfma_f32_16x16x32_bf16 v[88:91], v[196:199], v[228:231], v[88:91]
    v_fmac_f32 v108, v80, v252
    v_fmac_f32 v109, v81, v253
    v_fmac_f32 v110, v82, v254
    v_fmac_f32 v111, v83, v255
    ds_read_b32 v119, v118 offset:16
    ds_read_b128 v[184:187], v9 offset:35328
    ds_read_b128 v[188:191], v10 offset:35328
    v_mfma_f32_16x16x32_bf16 v[92:95], v[208:211], v[224:227], 0
    v_mfma_f32_16x16x32_bf16 v[92:95], v[212:215], v[228:231], v[92:95]
    v_fmac_f32 v108, v84, v100
    v_fmac_f32 v109, v85, v101
    v_fmac_f32 v110, v86, v102
    v_fmac_f32 v111, v87, v103
    s_waitcnt lgkmcnt(2)
    v_cmp_gt_u32 vcc, 28, v119
    s_nop 0
    s_cbranch_vccnz L_rs29
L_rb29:
    s_add_u32 m0, s31, 32768
    v_or_b32_dpp v14, v32, v2 row_newbcast:0 row_mask:0xf bank_mask:0x3
    v_or_b32_dpp v14, v32, v2 row_newbcast:8 row_mask:0xf bank_mask:0xc
    buffer_load_dwordx4 v14, s[32:35], 0 offen lds
    s_waitcnt lgkmcnt(0)
    s_add_u32 m0, s50, 35328
    v_or_b32_dpp v15, v48, v2 row_newbcast:2 row_mask:0xf bank_mask:0x3
    v_or_b32_dpp v15, v48, v2 row_newbcast:10 row_mask:0xf bank_mask:0xc
    buffer_load_dwordx4 v15, s[32:35], 0 offen lds
    s_add_u32 m0, s50, 36352
    v_or_b32_dpp v12, v48, v3 row_newbcast:3 row_mask:0xf bank_mask:0x3
    v_or_b32_dpp v12, v48, v3 row_newbcast:11 row_mask:0xf bank_mask:0xc
    buffer_load_dwordx4 v12, s[32:35], 0 offen lds
    s_mov_b64 exec, s[44:45]
    v_mov_b64 v[232:233], v[176:177]
    v_mov_b64 v[234:235], v[178:179]
    v_mov_b64 v[236:237], v[180:181]
    v_mov_b64 v[238:239], v[182:183]
    s_mov_b64 exec, -1
    v_mfma_f32_16x16x32_bf16 v[80:83], v[216:219], v[224:227], 0
    v_mfma_f32_16x16x32_bf16 v[80:83], v[220:223], v[228:231], v[80:83]
    v_fmac_f32 v108, v88, v240
    v_fmac_f32 v109, v89, v241
    v_fmac_f32 v110, v90, v242
    v_fmac_f32 v111, v91, v243
    s_add_u32 m0, s31, 33792
    v_or_b32_dpp v13, v36, v3 row_newbcast:0 row_mask:0xf bank_mask:0x3
    v_or_b32_dpp v13, v36, v3 row_newbcast:8 row_mask:0xf bank_mask:0xc
    buffer_load_dwordx4 v13, s[32:35], 0 offen lds
    ds_read_b128 v[200:203], v9 offset:37888
    ds_read_b128 v[204:207], v10 offset:37888
    v_mfma_f32_16x16x32_bf16 v[84:87], v[176:179], v[232:235], 0
    v_mfma_f32_16x16x32_bf16 v[84:87], v[180:183], v[236:239], v[84:87]
    v_fmac_f32 v108, v92, v244
    v_fmac_f32 v109, v93, v245
    v_fmac_f32 v110, v94, v246
    v_fmac_f32 v111, v95, v247
    s_waitcnt vmcnt(6)
    ds_add_u32 v116, v117
    s_waitcnt lgkmcnt(1)
    s_add_u32 m0, s50, 37888
    v_or_b32_dpp v14, v48, v2 row_newbcast:4 row_mask:0xf bank_mask:0x3
    v_or_b32_dpp v14, v48, v2 row_newbcast:12 row_mask:0xf bank_mask:0xc
    buffer_load_dwordx4 v14, s[32:35], 0 offen lds
    s_add_u32 m0, s50, 38912
    v_or_b32_dpp v15, v48, v3 row_newbcast:5 row_mask:0xf bank_mask:0x3
    v_or_b32_dpp v15, v48, v3 row_newbcast:13 row_mask:0xf bank_mask:0xc
    buffer_load_dwordx4 v15, s[32:35], 0 offen lds
    s_mov_b64 exec, s[44:45]
    v_mov_b64 v[232:233], v[184:185]
    v_mov_b64 v[234:235], v[186:187]
    v_mov_b64 v[236:237], v[188:189]
    v_mov_b64 v[238:239], v[190:191]
    s_mov_b64 exec, -1
    v_mfma_f32_16x16x32_bf16 v[88:91], v[176:179], v[184:187], 0
    v_mfma_f32_16x16x32_bf16 v[88:91], v[180:183], v[188:191], v[88:91]
    v_fmac_f32 v108, v80, v64
    v_fmac_f32 v109, v81, v65
    v_fmac_f32 v110, v82, v66
    v_fmac_f32 v111, v83, v67
    v_add_f32 v112, v108, v109
    v_add_f32 v113, v110, v111
    v_add_f32 v112, v112, v113
    s_nop 1
    v_add_f32_dpp v112, v112, v112 row_shr:1 row_mask:0xf bank_mask:0xf
    s_nop 1
    v_add_f32_dpp v112, v112, v112 row_shr:2 row_mask:0xf bank_mask:0xf
    s_nop 1
    v_add_f32_dpp v112, v112, v112 row_shr:4 row_mask:0xf bank_mask:0xf
    s_nop 1
    v_add_f32_dpp v112, v112, v112 row_shr:8 row_mask:0xf bank_mask:0xf
    s_nop 1
    v_add_f32_dpp v112, v112, v112 row_bcast:15 row_mask:0xa bank_mask:0xf
    s_nop 1
    v_add_f32_dpp v112, v112, v112 row_bcast:31 row_mask:0xc bank_mask:0xf
    s_nop 0
    v_readlane_b32 s58, v112, 63
    s_add_u32 m0, s31, 34816
    v_or_b32_dpp v12, v40, v2 row_newbcast:0 row_mask:0xf bank_mask:0x3
    v_or_b32_dpp v12, v40, v2 row_newbcast:8 row_mask:0xf bank_mask:0xc
    buffer_load_dwordx4 v12, s[32:35], 0 offen lds
    v_mfma_f32_16x16x32_bf16 v[92:95], v[184:187], v[232:235], 0
    v_mfma_f32_16x16x32_bf16 v[92:95], v[188:191], v[236:239], v[92:95]
    v_mul_f32 v108, v84, v104
    v_mul_f32 v109, v85, v105
    v_mul_f32 v110, v86, v106
    v_mul_f32 v111, v87, v107
    s_add_u32 m0, s31, 35840
    v_or_b32_dpp v13, v44, v3 row_newbcast:0 row_mask:0xf bank_mask:0x3
    v_or_b32_dpp v13, v44, v3 row_newbcast:8 row_mask:0xf bank_mask:0xc
    buffer_load_dwordx4 v13, s[32:35], 0 offen lds
    ds_read_b128 v[192:195], v58 offset:32768
    ds_read_b128 v[196:199], v59 offset:32768
    v_mfma_f32_16x16x32_bf16 v[80:83], v[176:179], v[200:203], 0
    v_mfma_f32_16x16x32_bf16 v[80:83], v[180:183], v[204:207], v[80:83]
    v_fmac_f32 v108, v88, v120
    v_fmac_f32 v109, v89, v121
    v_fmac_f32 v110, v90, v122
    v_fmac_f32 v111, v91, v123
    s_waitcnt lgkmcnt(0)
    s_add_u32 m0, s50, 40448
    v_or_b32_dpp v14, v49, v2 row_newbcast:4 row_mask:0xf bank_mask:0x3
    v_or_b32_dpp v14, v49, v2 row_newbcast:12 row_mask:0xf bank_mask:0xc
    s_mov_b32 exec_hi, 0
    buffer_load_dwordx4 v14, s[32:35], 0 offen lds
    s_mov_b32 exec_hi, -1
    v_lshlrev_b32 v50, 7, v50
    ds_bpermute_b32 v50, v61, v50
    v_lshlrev_b32 v51, 7, v51
    ds_bpermute_b32 v51, v61, v51
    ds_read_b128 v[208:211], v9
    ds_read_b128 v[212:215], v10
    s_mov_b64 exec, s[44:45]
    v_mov_b64 v[232:233], v[200:201]
    v_mov_b64 v[234:235], v[202:203]
    v_mov_b64 v[236:237], v[204:205]
    v_mov_b64 v[238:239], v[206:207]
    s_mov_b64 exec, -1
    v_mfma_f32_16x16x32_bf16 v[84:87], v[184:187], v[200:203], 0
    v_mfma_f32_16x16x32_bf16 v[84:87], v[188:191], v[204:207], v[84:87]
    v_fmac_f32 v108, v92, v124
    v_fmac_f32 v109, v93, v125
    v_fmac_f32 v110, v94, v126
    v_fmac_f32 v111, v95, v127
    ds_read_b32 v119, v118 offset:16
    s_waitcnt lgkmcnt(1)
    s_add_u32 m0, s50, 0
    v_or_b32_dpp v15, v48, v2 row_newbcast:6 row_mask:0xf bank_mask:0x3
    v_or_b32_dpp v15, v48, v2 row_newbcast:14 row_mask:0xf bank_mask:0xc
    buffer_load_dwordx4 v15, s[32:35], 0 offen lds
    s_add_u32 m0, s50, 1024
    v_or_b32_dpp v12, v48, v3 row_newbcast:7 row_mask:0xf bank_mask:0x3
    v_or_b32_dpp v12, v48, v3 row_newbcast:15 row_mask:0xf bank_mask:0xc
    buffer_load_dwordx4 v12, s[32:35], 0 offen lds
    v_mfma_f32_16x16x32_bf16 v[88:91], v[200:203], v[232:235], 0
    v_mfma_f32_16x16x32_bf16 v[88:91], v[204:207], v[236:239], v[88:91]
    v_fmac_f32 v108, v80, v128
    v_fmac_f32 v109, v81, v129
    v_fmac_f32 v110, v82, v130
    v_fmac_f32 v111, v83, v131
    s_waitcnt lgkmcnt(0)
    v_cmp_gt_u32 vcc, 29, v119
    s_nop 0
    s_cbranch_vccnz L_rs30
L_rb30:
    s_add_u32 m0, s31, 49152
    v_or_b32_dpp v13, v33, v2 row_newbcast:0 row_mask:0xf bank_mask:0x3
    v_or_b32_dpp v13, v33, v2 row_newbcast:8 row_mask:0xf bank_mask:0xc
    buffer_load_dwordx4 v13, s[32:35], 0 offen lds
    v_mfma_f32_16x16x32_bf16 v[92:95], v[192:195], v[192:195], 0
    v_mfma_f32_16x16x32_bf16 v[92:95], v[196:199], v[196:199], v[92:95]
    v_fmac_f32 v108, v84, v132
    v_fmac_f32 v109, v85, v133
    v_fmac_f32 v110, v86, v134
    v_fmac_f32 v111, v87, v135
    s_add_u32 m0, s31, 50176
    v_or_b32_dpp v14, v37, v3 row_newbcast:0 row_mask:0xf bank_mask:0x3
    v_or_b32_dpp v14, v37, v3 row_newbcast:8 row_mask:0xf bank_mask:0xc
    buffer_load_dwordx4 v14, s[32:35], 0 offen lds
    s_mov_b64 exec, s[44:45]
    v_mov_b64 v[232:233], v[208:209]
    v_mov_b64 v[234:235], v[210:211]
    v_mov_b64 v[236:237], v[212:213]
    v_mov_b64 v[238:239], v[214:215]
    s_mov_b64 exec, -1
    v_mfma_f32_16x16x32_bf16 v[80:83], v[176:179], v[208:211], 0
    v_mfma_f32_16x16x32_bf16 v[80:83], v[180:183], v[212:215], v[80:83]
    v_fmac_f32 v108, v88, v136
    v_fmac_f32 v109, v89, v137
    v_fmac_f32 v110, v90, v138
    v_fmac_f32 v111, v91, v139
    s_waitcnt vmcnt(5)
    ds_add_u32 v116, v117
    ds_read_b128 v[216:219], v9 offset:2560
    ds_read_b128 v[220:223], v10 offset:2560
    v_mfma_f32_16x16x32_bf16 v[84:87], v[208:211], v[232:235], 0
    v_mfma_f32_16x16x32_bf16 v[84:87], v[212:215], v[236:239], v[84:87]
    v_fmac_f32 v108, v92, v96
    v_fmac_f32 v109, v93, v97
    v_fmac_f32 v110, v94, v98
    v_fmac_f32 v111, v95, v99
    s_add_u32 m0, s31, 51200
    v_or_b32_dpp v15, v41, v2 row_newbcast:0 row_mask:0xf bank_mask:0x3
    v_or_b32_dpp v15, v41, v2 row_newbcast:8 row_mask:0xf bank_mask:0xc
    buffer_load_dwordx4 v15, s[32:35], 0 offen lds
    s_waitcnt lgkmcnt(0)
    s_add_u32 m0, s50, 2560
    v_or_b32_dpp v12, v49, v2 row_newbcast:0 row_mask:0xf bank_mask:0x3
    v_or_b32_dpp v12, v49, v2 row_newbcast:8 row_mask:0xf bank_mask:0xc
    buffer_load_dwordx4 v12, s[32:35], 0 offen lds
    s_add_u32 m0, s50, 3584
    v_or_b32_dpp v13, v49, v3 row_newbcast:1 row_mask:0xf bank_mask:0x3
    v_or_b32_dpp v13, v49, v3 row_newbcast:9 row_mask:0xf bank_mask:0xc
    buffer_load_dwordx4 v13, s[32:35], 0 offen lds
    buffer_load_dword v52, v11, s[36:39], 0 offen offset:4000
    buffer_load_dword v53, v11, s[36:39], s40 offen offset:1056
    v_mfma_f32_16x16x32_bf16 v[88:91], v[184:187], v[208:211], 0
    v_mfma_f32_16x16x32_bf16 v[88:91], v[188:191], v[212:215], v[88:91]
    v_fmac_f32 v108, v80, v140
    v_fmac_f32 v109, v81, v141
    v_fmac_f32 v110, v82, v142
    v_fmac_f32 v111, v83, v143
    s_add_u32 m0, s31, 52224
    v_or_b32_dpp v14, v45, v3 row_newbcast:0 row_mask:0xf bank_mask:0x3
    v_or_b32_dpp v14, v45, v3 row_newbcast:8 row_mask:0xf bank_mask:0xc
    buffer_load_dwordx4 v14, s[32:35], 0 offen lds
    v_mfma_f32_16x16x32_bf16 v[92:95], v[200:203], v[208:211], 0
    v_mfma_f32_16x16x32_bf16 v[92:95], v[204:207], v[212:215], v[92:95]
    v_fmac_f32 v108, v84, v144
    v_fmac_f32 v109, v85, v145
    v_fmac_f32 v110, v86, v146
    v_fmac_f32 v111, v87, v147
    ds_read_b32 v119, v118 offset:16
    s_mov_b64 exec, s[44:45]
    v_mov_b64 v[232:233], v[216:217]
    v_mov_b64 v[234:235], v[218:219]
    v_mov_b64 v[236:237], v[220:221]
    v_mov_b64 v[238:239], v[222:223]
    s_mov_b64 exec, -1
    v_mfma_f32_16x16x32_bf16 v[80:83], v[176:179], v[216:219], 0
    v_mfma_f32_16x16x32_bf16 v[80:83], v[180:183], v[220:223], v[80:83]
    v_fmac_f32 v108, v88, v148
    v_fmac_f32 v109, v89, v149
    v_fmac_f32 v110, v90, v150
    v_fmac_f32 v111, v91, v151
    s_waitcnt lgkmcnt(0)
    v_cmp_gt_u32 vcc, 30, v119
    s_nop 0
    s_cbranch_vccnz L_rs31
L_rb31:
    s_add_u32 m0, s31, 65536
    v_or_b32_dpp v15, v34, v2 row_newbcast:0 row_mask:0xf bank_mask:0x3
    v_or_b32_dpp v15, v34, v2 row_newbcast:8 row_mask:0xf bank_mask:0xc
    buffer_load_dwordx4 v15, s[32:35], 0 offen lds
    v_mfma_f32_16x16x32_bf16 v[84:87], v[216:219], v[232:235], 0
    v_mfma_f32_16x16x32_bf16 v[84:87], v[220:223], v[236:239], v[84:87]
    v_fmac_f32 v108, v92, v152
    v_fmac_f32 v109, v93, v153
    v_fmac_f32 v110, v94, v154
    v_fmac_f32 v111, v95, v155
    s_add_u32 m0, s31, 66560
    v_or_b32_dpp v12, v38, v3 row_newbcast:0 row_mask:0xf bank_mask:0x3
    v_or_b32_dpp v12, v38, v3 row_newbcast:8 row_mask:0xf bank_mask:0xc
    buffer_load_dwordx4 v12, s[32:35], 0 offen lds
    ds_read_b128 v[224:227], v9 offset:5120
    ds_read_b128 v[228:231], v10 offset:5120
    v_mfma_f32_16x16x32_bf16 v[88:91], v[184:187], v[216:219], 0
    v_mfma_f32_16x16x32_bf16 v[88:91], v[188:191], v[220:223], v[88:91]
    v_fmac_f32 v108, v80, v156
    v_fmac_f32 v109, v81, v157
    v_fmac_f32 v110, v82, v158
    v_fmac_f32 v111, v83, v159
    s_waitcnt vmcnt(2)
    ds_add_u32 v116, v117
    s_waitcnt lgkmcnt(1)
    s_add_u32 m0, s50, 5120
    v_or_b32_dpp v13, v49, v2 row_newbcast:2 row_mask:0xf bank_mask:0x3
    v_or_b32_dpp v13, v49, v2 row_newbcast:10 row_mask:0xf bank_mask:0xc
    buffer_load_dwordx4 v13, s[32:35], 0 offen lds
    s_add_u32 m0, s50, 6144
    v_or_b32_dpp v14, v49, v3 row_newbcast:3 row_mask:0xf bank_mask:0x3
    v_or_b32_dpp v14, v49, v3 row_newbcast:11 row_mask:0xf bank_mask:0xc
    buffer_load_dwordx4 v14, s[32:35], 0 offen lds
    v_mfma_f32_16x16x32_bf16 v[92:95], v[200:203], v[216:219], 0
    v_mfma_f32_16x16x32_bf16 v[92:95], v[204:207], v[220:223], v[92:95]
    v_fmac_f32 v108, v84, v160
    v_fmac_f32 v109, v85, v161
    v_fmac_f32 v110, v86, v162
    v_fmac_f32 v111, v87, v163
    s_add_u32 m0, s31, 67584
    v_or_b32_dpp v15, v42, v2 row_newbcast:0 row_mask:0xf bank_mask:0x3
    v_or_b32_dpp v15, v42, v2 row_newbcast:8 row_mask:0xf bank_mask:0xc
    buffer_load_dwordx4 v15, s[32:35], 0 offen lds
    v_mfma_f32_16x16x32_bf16 v[80:83], v[208:211], v[216:219], 0
    v_mfma_f32_16x16x32_bf16 v[80:83], v[212:215], v[220:223], v[80:83]
    v_fmac_f32 v108, v88, v164
    v_fmac_f32 v109, v89, v165
    v_fmac_f32 v110, v90, v166
    v_fmac_f32 v111, v91, v167
    s_add_u32 m0, s31, 68608
    v_or_b32_dpp v12, v46, v3 row_newbcast:0 row_mask:0xf bank_mask:0x3
    v_or_b32_dpp v12, v46, v3 row_newbcast:8 row_mask:0xf bank_mask:0xc
    buffer_load_dwordx4 v12, s[32:35], 0 offen lds
    ds_read_b128 v[192:195], v58
    ds_read_b128 v[196:199], v59
    s_mov_b64 exec, s[44:45]
    v_mov_b64 v[232:233], v[224:225]
    v_mov_b64 v[234:235], v[226:227]
    v_mov_b64 v[236:237], v[228:229]
    v_mov_b64 v[238:239], v[230:231]
    s_mov_b64 exec, -1
    v_mfma_f32_16x16x32_bf16 v[84:87], v[176:179], v[224:227], 0
    v_mfma_f32_16x16x32_bf16 v[84:87], v[180:183], v[228:231], v[84:87]
    v_fmac_f32 v108, v92, v168
    v_fmac_f32 v109, v93, v169
    v_fmac_f32 v110, v94, v170
    v_fmac_f32 v111, v95, v171
    v_mfma_f32_16x16x32_bf16 v[88:91], v[224:227], v[232:235], 0
    v_mfma_f32_16x16x32_bf16 v[88:91], v[228:231], v[236:239], v[88:91]
    v_fmac_f32 v108, v80, v68
    v_fmac_f32 v109, v81, v69
    v_fmac_f32 v110, v82, v70
    v_fmac_f32 v111, v83, v71
    ds_read_b32 v119, v118 offset:16
    s_mov_b64 exec, s[46:47]
    ds_read_b128 v[232:235], v7 offset:40448
    ds_read_b128 v[236:239], v8 offset:40448
    s_mov_b64 exec, -1
    v_mfma_f32_16x16x32_bf16 v[92:95], v[184:187], v[224:227], 0
    v_mfma_f32_16x16x32_bf16 v[92:95], v[188:191], v[228:231], v[92:95]
    v_fmac_f32 v108, v84, v72
    v_fmac_f32 v109, v85, v73
    v_fmac_f32 v110, v86, v74
    v_fmac_f32 v111, v87, v75
    s_waitcnt lgkmcnt(2)
    v_cmp_gt_u32 vcc, 31, v119
    s_nop 0
    s_cbranch_vccnz L_rs32
L_rb32:
    s_add_u32 m0, s31, 0
    v_or_b32_dpp v13, v35, v2 row_newbcast:0 row_mask:0xf bank_mask:0x3
    v_or_b32_dpp v13, v35, v2 row_newbcast:8 row_mask:0xf bank_mask:0xc
    buffer_load_dwordx4 v13, s[32:35], 0 offen lds
    ds_read_b128 v[176:179], v7 offset:32768
    ds_read_b128 v[180:183], v8 offset:32768
    v_mfma_f32_16x16x32_bf16 v[80:83], v[192:195], v[192:195], 0
    v_mfma_f32_16x16x32_bf16 v[80:83], v[196:199], v[196:199], v[80:83]
    v_fmac_f32 v108, v88, v248
    v_fmac_f32 v109, v89, v249
    v_fmac_f32 v110, v90, v250
    v_fmac_f32 v111, v91, v251
    s_add_u32 m0, s31, 1024
    v_or_b32_dpp v14, v39, v3 row_newbcast:0 row_mask:0xf bank_mask:0x3
    v_or_b32_dpp v14, v39, v3 row_newbcast:8 row_mask:0xf bank_mask:0xc
    buffer_load_dwordx4 v14, s[32:35], 0 offen lds
    s_waitcnt lgkmcnt(0)
    s_add_u32 m0, s50, 33280
    v_or_b32_dpp v15, v50, v62 row_newbcast:0 row_mask:0xf bank_mask:0x3
    v_or_b32_dpp v15, v50, v62 row_newbcast:8 row_mask:0xf bank_mask:0xc
    buffer_load_dwordx4 v15, s[32:35], 0 offen lds
    s_add_u32 m0, s50, 34304
    v_or_b32_dpp v12, v50, v63 row_newbcast:1 row_mask:0xf bank_mask:0x3
    v_or_b32_dpp v12, v50, v63 row_newbcast:9 row_mask:0xf bank_mask:0xc
    buffer_load_dwordx4 v12, s[32:35], 0 offen lds
    v_mfma_f32_16x16x32_bf16 v[84:87], v[200:203], v[224:227], 0
    v_mfma_f32_16x16x32_bf16 v[84:87], v[204:207], v[228:231], v[84:87]
    v_fmac_f32 v108, v92, v252
    v_fmac_f32 v109, v93, v253
    v_fmac_f32 v110, v94, v254
    v_fmac_f32 v111, v95, v255
    s_waitcnt vmcnt(4)
    ds_add_u32 v116, v117
    ds_read_b128 v[184:187], v7 offset:35328
    ds_read_b128 v[188:191], v8 offset:35328
    v_mfma_f32_16x16x32_bf16 v[88:91], v[208:211], v[224:227], 0
    v_mfma_f32_16x16x32_bf16 v[88:91], v[212:215], v[228:231], v[88:91]
    v_fmac_f32 v108, v80, v100
    v_fmac_f32 v109, v81, v101
    v_fmac_f32 v110, v82, v102
    v_fmac_f32 v111, v83, v103
    s_add_u32 m0, s31, 2048
    v_or_b32_dpp v13, v43, v2 row_newbcast:0 row_mask:0xf bank_mask:0x3
    v_or_b32_dpp v13, v43, v2 row_newbcast:8 row_mask:0xf bank_mask:0xc
    buffer_load_dwordx4 v13, s[32:35], 0 offen lds
    s_waitcnt lgkmcnt(0)
    s_add_u32 m0, s50, 35840
    v_or_b32_dpp v14, v50, v62 row_newbcast:2 row_mask:0xf bank_mask:0x3
    v_or_b32_dpp v14, v50, v62 row_newbcast:10 row_mask:0xf bank_mask:0xc
    buffer_load_dwordx4 v14, s[32:35], 0 offen lds
    s_add_u32 m0, s50, 36864
    v_or_b32_dpp v15, v50, v63 row_newbcast:3 row_mask:0xf bank_mask:0x3
    v_or_b32_dpp v15, v50, v63 row_newbcast:11 row_mask:0xf bank_mask:0xc
    buffer_load_dwordx4 v15, s[32:35], 0 offen lds
    s_mov_b64 exec, s[44:45]
    v_mov_b64 v[232:233], v[176:177]
    v_mov_b64 v[234:235], v[178:179]
    v_mov_b64 v[236:237], v[180:181]
    v_mov_b64 v[238:239], v[182:183]
    s_mov_b64 exec, -1
    v_mfma_f32_16x16x32_bf16 v[92:95], v[216:219], v[224:227], 0
    v_mfma_f32_16x16x32_bf16 v[92:95], v[220:223], v[228:231], v[92:95]
    v_fmac_f32 v108, v84, v240
    v_fmac_f32 v109, v85, v241
    v_fmac_f32 v110, v86, v242
    v_fmac_f32 v111, v87, v243
    s_add_u32 m0, s31, 3072
    v_or_b32_dpp v12, v47, v3 row_newbcast:0 row_mask:0xf bank_mask:0x3
    v_or_b32_dpp v12, v47, v3 row_newbcast:8 row_mask:0xf bank_mask:0xc
    buffer_load_dwordx4 v12, s[32:35], 0 offen lds
    ds_read_b128 v[192:195], v7 offset:37888
    ds_read_b128 v[196:199], v8 offset:37888
    v_mfma_f32_16x16x32_bf16 v[80:83], v[176:179], v[232:235], 0
    v_mfma_f32_16x16x32_bf16 v[80:83], v[180:183], v[236:239], v[80:83]
    v_fmac_f32 v108, v88, v244
    v_fmac_f32 v109, v89, v245
    v_fmac_f32 v110, v90, v246
    v_fmac_f32 v111, v91, v247
    ds_read_b32 v119, v118 offset:16
    s_waitcnt lgkmcnt(1)
    s_add_u32 m0, s50, 38400
    v_or_b32_dpp v13, v50, v62 row_newbcast:4 row_mask:0xf bank_mask:0x3
    v_or_b32_dpp v13, v50, v62 row_newbcast:12 row_mask:0xf bank_mask:0xc
    buffer_load_dwordx4 v13, s[32:35], 0 offen lds
    s_add_u32 m0, s50, 39424
    v_or_b32_dpp v14, v50, v63 row_newbcast:5 row_mask:0xf bank_mask:0x3
    v_or_b32_dpp v14, v50, v63 row_newbcast:13 row_mask:0xf bank_mask:0xc
    buffer_load_dwordx4 v14, s[32:35], 0 offen lds
    s_mov_b64 exec, s[44:45]
    v_mov_b64 v[232:233], v[184:185]
    v_mov_b64 v[234:235], v[186:187]
    v_mov_b64 v[236:237], v[188:189]
    v_mov_b64 v[238:239], v[190:191]
    s_mov_b64 exec, -1
    v_mfma_f32_16x16x32_bf16 v[84:87], v[176:179], v[184:187], 0
    v_mfma_f32_16x16x32_bf16 v[84:87], v[180:183], v[188:191], v[84:87]
    v_fmac_f32 v108, v92, v64
    v_fmac_f32 v109, v93, v65
    v_fmac_f32 v110, v94, v66
    v_fmac_f32 v111, v95, v67
    v_add_f32 v112, v108, v109
    v_add_f32 v113, v110, v111
    v_add_f32 v112, v112, v113
    s_nop 1
    v_add_f32_dpp v112, v112, v112 row_shr:1 row_mask:0xf bank_mask:0xf
    s_nop 1
    v_add_f32_dpp v112, v112, v112 row_shr:2 row_mask:0xf bank_mask:0xf
    s_nop 1
    v_add_f32_dpp v112, v112, v112 row_shr:4 row_mask:0xf bank_mask:0xf
    s_nop 1
    v_add_f32_dpp v112, v112, v112 row_shr:8 row_mask:0xf bank_mask:0xf
    s_nop 1
    v_add_f32_dpp v112, v112, v112 row_bcast:15 row_mask:0xa bank_mask:0xf
    s_nop 1
    v_add_f32_dpp v112, v112, v112 row_bcast:31 row_mask:0xc bank_mask:0xf
    s_nop 0
    v_readlane_b32 s59, v112, 63
    s_waitcnt lgkmcnt(0)
    v_cmp_gt_u32 vcc, 32, v119
    s_nop 0
    s_cbranch_vccnz L_rs33
L_rb33:
    s_add_u32 m0, s31, 16384
    v_or_b32_dpp v15, v32, v2 row_newbcast:1 row_mask:0xf bank_mask:0x3
    v_or_b32_dpp v15, v32, v2 row_newbcast:9 row_mask:0xf bank_mask:0xc
    buffer_load_dwordx4 v15, s[32:35], 0 offen lds
    v_mfma_f32_16x16x32_bf16 v[88:91], v[184:187], v[232:235], 0
    v_mfma_f32_16x16x32_bf16 v[88:91], v[188:191], v[236:239], v[88:91]
    v_mul_f32 v108, v80, v104
    v_mul_f32 v109, v81, v105
    v_mul_f32 v110, v82, v106
    v_mul_f32 v111, v83, v107
    s_add_u32 m0, s31, 17408
    v_or_b32_dpp v12, v36, v3 row_newbcast:1 row_mask:0xf bank_mask:0x3
    v_or_b32_dpp v12, v36, v3 row_newbcast:9 row_mask:0xf bank_mask:0xc
    buffer_load_dwordx4 v12, s[32:35], 0 offen lds
    ds_read_b128 v[200:203], v56 offset:32768
    ds_read_b128 v[204:207], v57 offset:32768
    v_mfma_f32_16x16x32_bf16 v[92:95], v[176:179], v[192:195], 0
    v_mfma_f32_16x16x32_bf16 v[92:95], v[180:183], v[196:199], v[92:95]
    v_fmac_f32 v108, v84, v120
    v_fmac_f32 v109, v85, v121
    v_fmac_f32 v110, v86, v122
    v_fmac_f32 v111, v87, v123
    s_waitcnt vmcnt(4)
    ds_add_u32 v116, v117
    s_waitcnt lgkmcnt(1)
    s_add_u32 m0, s50, 39936
    v_or_b32_dpp v13, v51, v63 row_newbcast:5 row_mask:0xf bank_mask:0x3
    v_or_b32_dpp v13, v51, v63 row_newbcast:13 row_mask:0xf bank_mask:0xc
    s_mov_b32 exec_lo, 0
    buffer_load_dwordx4 v13, s[32:35], 0 offen lds
    s_mov_b32 exec_lo, -1
    v_lshlrev_b32 v52, 7, v52
    ds_bpermute_b32 v52, v4, v52
    v_lshlrev_b32 v53, 7, v53
    ds_bpermute_b32 v53, v4, v53
    ds_read_b128 v[208:211], v7
    ds_read_b128 v[212:215], v8
    s_mov_b64 exec, s[44:45]
    v_mov_b64 v[232:233], v[192:193]
    v_mov_b64 v[234:235], v[194:195]
    v_mov_b64 v[236:237], v[196:197]
    v_mov_b64 v[238:239], v[198:199]
    s_mov_b64 exec, -1
    v_mfma_f32_16x16x32_bf16 v[80:83], v[184:187], v[192:195], 0
    v_mfma_f32_16x16x32_bf16 v[80:83], v[188:191], v[196:199], v[80:83]
    v_fmac_f32 v108, v88, v124
    v_fmac_f32 v109, v89, v125
    v_fmac_f32 v110, v90, v126
    v_fmac_f32 v111, v91, v127
    s_add_u32 m0, s31, 18432
    v_or_b32_dpp v14, v40, v2 row_newbcast:1 row_mask:0xf bank_mask:0x3
    v_or_b32_dpp v14, v40, v2 row_newbcast:9 row_mask:0xf bank_mask:0xc
    buffer_load_dwordx4 v14, s[32:35], 0 offen lds
    s_waitcnt lgkmcnt(0)
    s_add_u32 m0, s50, 512
    v_or_b32_dpp v15, v50, v62 row_newbcast:6 row_mask:0xf bank_mask:0x3
    v_or_b32_dpp v15, v50, v62 row_newbcast:14 row_mask:0xf bank_mask:0xc
    buffer_load_dwordx4 v15, s[32:35], 0 offen lds
    s_add_u32 m0, s50, 1536
    v_or_b32_dpp v12, v50, v63 row_newbcast:7 row_mask:0xf bank_mask:0x3
    v_or_b32_dpp v12, v50, v63 row_newbcast:15 row_mask:0xf bank_mask:0xc
    buffer_load_dwordx4 v12, s[32:35], 0 offen lds
    v_mfma_f32_16x16x32_bf16 v[84:87], v[192:195], v[232:235], 0
    v_mfma_f32_16x16x32_bf16 v[84:87], v[196:199], v[236:239], v[84:87]
    v_fmac_f32 v108, v92, v128
    v_fmac_f32 v109, v93, v129
    v_fmac_f32 v110, v94, v130
    v_fmac_f32 v111, v95, v131
    s_add_u32 m0, s31, 19456
    v_or_b32_dpp v13, v44, v3 row_newbcast:1 row_mask:0xf bank_mask:0x3
    v_or_b32_dpp v13, v44, v3 row_newbcast:9 row_mask:0xf bank_mask:0xc
    buffer_load_dwordx4 v13, s[32:35], 0 offen lds
    v_mfma_f32_16x16x32_bf16 v[88:91], v[200:203], v[200:203], 0
    v_mfma_f32_16x16x32_bf16 v[88:91], v[204:207], v[204:207], v[88:91]
    v_fmac_f32 v108, v80, v132
    v_fmac_f32 v109, v81, v133
    v_fmac_f32 v110, v82, v134
    v_fmac_f32 v111, v83, v135
    s_mov_b64 exec, s[44:45]
    v_mov_b64 v[232:233], v[208:209]
    v_mov_b64 v[234:235], v[210:211]
    v_mov_b64 v[236:237], v[212:213]
    v_mov_b64 v[238:239], v[214:215]
    s_mov_b64 exec, -1
    v_mfma_f32_16x16x32_bf16 v[92:95], v[176:179], v[208:211], 0
    v_mfma_f32_16x16x32_bf16 v[92:95], v[180:183], v[212:215], v[92:95]
    v_fmac_f32 v108, v84, v136
    v_fmac_f32 v109, v85, v137
    v_fmac_f32 v110, v86, v138
    v_fmac_f32 v111, v87, v139
    ds_read_b32 v119, v118 offset:16
    ds_read_b128 v[216:219], v7 offset:2560
    ds_read_b128 v[220:223], v8 offset:2560
    v_mfma_f32_16x16x32_bf16 v[80:83], v[208:211], v[232:235], 0
    v_mfma_f32_16x16x32_bf16 v[80:83], v[212:215], v[236:239], v[80:83]
    v_fmac_f32 v108, v88, v96
    v_fmac_f32 v109, v89, v97
    v_fmac_f32 v110, v90, v98
    v_fmac_f32 v111, v91, v99
    s_waitcnt lgkmcnt(2)
    v_cmp_gt_u32 vcc, 33, v119
    s_nop 0
    s_cbranch_vccnz L_rs34
L_rb34:
    s_add_u32 m0, s31, 32768
    v_or_b32_dpp v14, v33, v2 row_newbcast:1 row_mask:0xf bank_mask:0x3
    v_or_b32_dpp v14, v33, v2 row_newbcast:9 row_mask:0xf bank_mask:0xc
    buffer_load_dwordx4 v14, s[32:35], 0 offen lds
    s_waitcnt lgkmcnt(0)
    s_add_u32 m0, s50, 3072
    v_or_b32_dpp v15, v51, v62 row_newbcast:0 row_mask:0xf bank_mask:0x3
    v_or_b32_dpp v15, v51, v62 row_newbcast:8 row_mask:0xf bank_mask:0xc
    buffer_load_dwordx4 v15, s[32:35], 0 offen lds
    s_add_u32 m0, s50, 4096
    v_or_b32_dpp v12, v51, v63 row_newbcast:1 row_mask:0xf bank_mask:0x3
    v_or_b32_dpp v12, v51, v63 row_newbcast:9 row_mask:0xf bank_mask:0xc
    buffer_load_dwordx4 v12, s[32:35], 0 offen lds
    buffer_load_dword v54, v11, s[36:39], s40 offen offset:1200
    buffer_load_dword v55, v11, s[36:39], s40 offen offset:1456
    v_mfma_f32_16x16x32_bf16 v[84:87], v[184:187], v[208:211], 0
    v_mfma_f32_16x16x32_bf16 v[84:87], v[188:191], v[212:215], v[84:87]
    v_fmac_f32 v108, v92, v140
    v_fmac_f32 v109, v93, v141
    v_fmac_f32 v110, v94, v142
    v_fmac_f32 v111, v95, v143
    s_add_u32 m0, s31, 33792
    v_or_b32_dpp v13, v37, v3 row_newbcast:1 row_mask:0xf bank_mask:0x3
    v_or_b32_dpp v13, v37, v3 row_newbcast:9 row_mask:0xf bank_mask:0xc
    buffer_load_dwordx4 v13, s[32:35], 0 offen lds
    v_mfma_f32_16x16x32_bf16 v[88:91], v[192:195], v[208:211], 0
    v_mfma_f32_16x16x32_bf16 v[88:91], v[196:199], v[212:215], v[88:91]
    v_fmac_f32 v108, v80, v144
    v_fmac_f32 v109, v81, v145
    v_fmac_f32 v110, v82, v146
    v_fmac_f32 v111, v83, v147
    s_waitcnt vmcnt(6)
    ds_add_u32 v116, v117
    s_mov_b64 exec, s[44:45]
    v_mov_b64 v[232:233], v[216:217]
    v_mov_b64 v[234:235], v[218:219]
    v_mov_b64 v[236:237], v[220:221]
    v_mov_b64 v[238:239], v[222:223]
    s_mov_b64 exec, -1
    v_mfma_f32_16x16x32_bf16 v[92:95], v[176:179], v[216:219], 0
    v_mfma_f32_16x16x32_bf16 v[92:95], v[180:183], v[220:223], v[92:95]
    v_fmac_f32 v108, v84, v148
    v_fmac_f32 v109, v85, v149
    v_fmac_f32 v110, v86, v150
    v_fmac_f32 v111, v87, v151
    s_add_u32 m0, s31, 34816
    v_or_b32_dpp v14, v41, v2 row_newbcast:1 row_mask:0xf bank_mask:0x3
    v_or_b32_dpp v14, v41, v2 row_newbcast:9 row_mask:0xf bank_mask:0xc
    buffer_load_dwordx4 v14, s[32:35], 0 offen lds
    v_mfma_f32_16x16x32_bf16 v[80:83], v[216:219], v[232:235], 0
    v_mfma_f32_16x16x32_bf16 v[80:83], v[220:223], v[236:239], v[80:83]
    v_fmac_f32 v108, v88, v152
    v_fmac_f32 v109, v89, v153
    v_fmac_f32 v110, v90, v154
    v_fmac_f32 v111, v91, v155
    s_add_u32 m0, s31, 35840
    v_or_b32_dpp v15, v45, v3 row_newbcast:1 row_mask:0xf bank_mask:0x3
    v_or_b32_dpp v15, v45, v3 row_newbcast:9 row_mask:0xf bank_mask:0xc
    buffer_load_dwordx4 v15, s[32:35], 0 offen lds
    ds_read_b128 v[224:227], v7 offset:5120
    ds_read_b128 v[228:231], v8 offset:5120
    v_mfma_f32_16x16x32_bf16 v[84:87], v[184:187], v[216:219], 0
    v_mfma_f32_16x16x32_bf16 v[84:87], v[188:191], v[220:223], v[84:87]
    v_fmac_f32 v108, v92, v156
    v_fmac_f32 v109, v93, v157
    v_fmac_f32 v110, v94, v158
    v_fmac_f32 v111, v95, v159
    s_waitcnt lgkmcnt(0)
    s_add_u32 m0, s50, 5632
    v_or_b32_dpp v12, v51, v62 row_newbcast:2 row_mask:0xf bank_mask:0x3
    v_or_b32_dpp v12, v51, v62 row_newbcast:10 row_mask:0xf bank_mask:0xc
    buffer_load_dwordx4 v12, s[32:35], 0 offen lds
    s_add_u32 m0, s50, 6656
    v_or_b32_dpp v13, v51, v63 row_newbcast:3 row_mask:0xf bank_mask:0x3
    v_or_b32_dpp v13, v51, v63 row_newbcast:11 row_mask:0xf bank_mask:0xc
    buffer_load_dwordx4 v13, s[32:35], 0 offen lds
    v_mfma_f32_16x16x32_bf16 v[88:91], v[192:195], v[216:219], 0
    v_mfma_f32_16x16x32_bf16 v[88:91], v[196:199], v[220:223], v[88:91]
    v_fmac_f32 v108, v80, v160
    v_fmac_f32 v109, v81, v161
    v_fmac_f32 v110, v82, v162
    v_fmac_f32 v111, v83, v163
    ds_read_b32 v119, v118 offset:16
    v_mfma_f32_16x16x32_bf16 v[92:95], v[208:211], v[216:219], 0
    v_mfma_f32_16x16x32_bf16 v[92:95], v[212:215], v[220:223], v[92:95]
    v_fmac_f32 v108, v84, v164
    v_fmac_f32 v109, v85, v165
    v_fmac_f32 v110, v86, v166
    v_fmac_f32 v111, v87, v167
    s_waitcnt lgkmcnt(0)
    v_cmp_gt_u32 vcc, 34, v119
    s_nop 0
    s_cbranch_vccnz L_rs35
L_rb35:
    s_add_u32 m0, s31, 49152
    v_or_b32_dpp v14, v34, v2 row_newbcast:1 row_mask:0xf bank_mask:0x3
    v_or_b32_dpp v14, v34, v2 row_newbcast:9 row_mask:0xf bank_mask:0xc
    buffer_load_dwordx4 v14, s[32:35], 0 offen lds
    ds_read_b128 v[200:203], v56
    ds_read_b128 v[204:207], v57
    s_mov_b64 exec, s[44:45]
    v_mov_b64 v[232:233], v[224:225]
    v_mov_b64 v[234:235], v[226:227]
    v_mov_b64 v[236:237], v[228:229]
    v_mov_b64 v[238:239], v[230:231]
    s_mov_b64 exec, -1
    v_mfma_f32_16x16x32_bf16 v[80:83], v[176:179], v[224:227], 0
    v_mfma_f32_16x16x32_bf16 v[80:83], v[180:183], v[228:231], v[80:83]
    v_fmac_f32 v108, v88, v168
    v_fmac_f32 v109, v89, v169
    v_fmac_f32 v110, v90, v170
    v_fmac_f32 v111, v91, v171
    s_add_u32 m0, s31, 50176
    v_or_b32_dpp v15, v38, v3 row_newbcast:1 row_mask:0xf bank_mask:0x3
    v_or_b32_dpp v15, v38, v3 row_newbcast:9 row_mask:0xf bank_mask:0xc
    buffer_load_dwordx4 v15, s[32:35], 0 offen lds
    v_mfma_f32_16x16x32_bf16 v[84:87], v[224:227], v[232:235], 0
    v_mfma_f32_16x16x32_bf16 v[84:87], v[228:231], v[236:239], v[84:87]
    v_fmac_f32 v108, v92, v68
    v_fmac_f32 v109, v93, v69
    v_fmac_f32 v110, v94, v70
    v_fmac_f32 v111, v95, v71
    s_waitcnt vmcnt(4)
    ds_add_u32 v116, v117
    s_mov_b64 exec, s[46:47]
    ds_read_b128 v[232:235], v7 offset:40448
    ds_read_b128 v[236:239], v8 offset:40448
    s_mov_b64 exec, -1
    v_mfma_f32_16x16x32_bf16 v[88:91], v[184:187], v[224:227], 0
    v_mfma_f32_16x16x32_bf16 v[88:91], v[188:191], v[228:231], v[88:91]
    v_fmac_f32 v108, v80, v72
    v_fmac_f32 v109, v81, v73
    v_fmac_f32 v110, v82, v74
    v_fmac_f32 v111, v83, v75
    s_add_u32 m0, s31, 51200
    v_or_b32_dpp v12, v42, v2 row_newbcast:1 row_mask:0xf bank_mask:0x3
    v_or_b32_dpp v12, v42, v2 row_newbcast:9 row_mask:0xf bank_mask:0xc
    buffer_load_dwordx4 v12, s[32:35], 0 offen lds
    ds_read_b128 v[176:179], v9 offset:32768
    ds_read_b128 v[180:183], v10 offset:32768
    s_waitcnt lgkmcnt(6)
    v_mfma_f32_16x16x32_bf16 v[92:95], v[200:203], v[200:203], 0
    s_waitcnt lgkmcnt(5)
    v_mfma_f32_16x16x32_bf16 v[92:95], v[204:207], v[204:207], v[92:95]
    v_fmac_f32 v108, v84, v248
    v_fmac_f32 v109, v85, v249
    v_fmac_f32 v110, v86, v250
    v_fmac_f32 v111, v87, v251
    s_add_u32 m0, s31, 52224
    v_or_b32_dpp v13, v46, v3 row_newbcast:1 row_mask:0xf bank_mask:0x3
    v_or_b32_dpp v13, v46, v3 row_newbcast:9 row_mask:0xf bank_mask:0xc
    buffer_load_dwordx4 v13, s[32:35], 0 offen lds
    s_waitcnt lgkmcnt(0)
    s_add_u32 m0, s50, 32768
    v_or_b32_dpp v14, v52, v2 row_newbcast:0 row_mask:0xf bank_mask:0x3
    v_or_b32_dpp v14, v52, v2 row_newbcast:8 row_mask:0xf bank_mask:0xc
    buffer_load_dwordx4 v14, s[32:35], 0 offen lds
    s_add_u32 m0, s50, 33792
    v_or_b32_dpp v15, v52, v3 row_newbcast:1 row_mask:0xf bank_mask:0x3
    v_or_b32_dpp v15, v52, v3 row_newbcast:9 row_mask:0xf bank_mask:0xc
    buffer_load_dwordx4 v15, s[32:35], 0 offen lds
    v_mfma_f32_16x16x32_bf16 v[80:83], v[192:195], v[224:227], 0
    v_mfma_f32_16x16x32_bf16 v[80:83], v[196:199], v[228:231], v[80:83]
    v_fmac_f32 v108, v88, v252
    v_fmac_f32 v109, v89, v253
    v_fmac_f32 v110, v90, v254
    v_fmac_f32 v111, v91, v255
    ds_read_b32 v119, v118 offset:16
    ds_read_b128 v[184:187], v9 offset:35328
    ds_read_b128 v[188:191], v10 offset:35328
    v_mfma_f32_16x16x32_bf16 v[84:87], v[208:211], v[224:227], 0
    v_mfma_f32_16x16x32_bf16 v[84:87], v[212:215], v[228:231], v[84:87]
    v_fmac_f32 v108, v92, v100
    v_fmac_f32 v109, v93, v101
    v_fmac_f32 v110, v94, v102
    v_fmac_f32 v111, v95, v103
    s_waitcnt lgkmcnt(2)
    v_cmp_gt_u32 vcc, 35, v119
    s_nop 0
    s_cbranch_vccnz L_rs36
L_rb36:
    s_add_u32 m0, s31, 65536
    v_or_b32_dpp v12, v35, v2 row_newbcast:1 row_mask:0xf bank_mask:0x3
    v_or_b32_dpp v12, v35, v2 row_newbcast:9 row_mask:0xf bank_mask:0xc
    buffer_load_dwordx4 v12, s[32:35], 0 offen lds
    s_waitcnt lgkmcnt(0)
    s_add_u32 m0, s50, 35328
    v_or_b32_dpp v13, v52, v2 row_newbcast:2 row_mask:0xf bank_mask:0x3
    v_or_b32_dpp v13, v52, v2 row_newbcast:10 row_mask:0xf bank_mask:0xc
    buffer_load_dwordx4 v13, s[32:35], 0 offen lds
    s_add_u32 m0, s50, 36352
    v_or_b32_dpp v14, v52, v3 row_newbcast:3 row_mask:0xf bank_mask:0x3
    v_or_b32_dpp v14, v52, v3 row_newbcast:11 row_mask:0xf bank_mask:0xc
    buffer_load_dwordx4 v14, s[32:35], 0 offen lds
    s_mov_b64 exec, s[44:45]
    v_mov_b64 v[232:233], v[176:177]
    v_mov_b64 v[234:235], v[178:179]
    v_mov_b64 v[236:237], v[180:181]
    v_mov_b64 v[238:239], v[182:183]
    s_mov_b64 exec, -1
    v_mfma_f32_16x16x32_bf16 v[88:91], v[216:219], v[224:227], 0
    v_mfma_f32_16x16x32_bf16 v[88:91], v[220:223], v[228:231], v[88:91]
    v_fmac_f32 v108, v80, v240
    v_fmac_f32 v109, v81, v241
    v_fmac_f32 v110, v82, v242
    v_fmac_f32 v111, v83, v243
    s_add_u32 m0, s31, 66560
    v_or_b32_dpp v15, v39, v3 row_newbcast:1 row_mask:0xf bank_mask:0x3
    v_or_b32_dpp v15, v39, v3 row_newbcast:9 row_mask:0xf bank_mask:0xc
    buffer_load_dwordx4 v15, s[32:35], 0 offen lds
    ds_read_b128 v[200:203], v9 offset:37888
    ds_read_b128 v[204:207], v10 offset:37888
    v_mfma_f32_16x16x32_bf16 v[92:95], v[176:179], v[232:235], 0
    v_mfma_f32_16x16x32_bf16 v[92:95], v[180:183], v[236:239], v[92:95]
    v_fmac_f32 v108, v84, v244
    v_fmac_f32 v109, v85, v245
    v_fmac_f32 v110, v86, v246
    v_fmac_f32 v111, v87, v247
    s_waitcnt vmcnt(6)
    ds_add_u32 v116, v117
    s_waitcnt lgkmcnt(1)
    s_add_u32 m0, s50, 37888
    v_or_b32_dpp v12, v52, v2 row_newbcast:4 row_mask:0xf bank_mask:0x3
    v_or_b32_dpp v12, v52, v2 row_newbcast:12 row_mask:0xf bank_mask:0xc
    buffer_load_dwordx4 v12, s[32:35], 0 offen lds
    s_add_u32 m0, s50, 38912
    v_or_b32_dpp v13, v52, v3 row_newbcast:5 row_mask:0xf bank_mask:0x3
    v_or_b32_dpp v13, v52, v3 row_newbcast:13 row_mask:0xf bank_mask:0xc
    buffer_load_dwordx4 v13, s[32:35], 0 offen lds
    s_mov_b64 exec, s[44:45]
    v_mov_b64 v[232:233], v[184:185]
    v_mov_b64 v[234:235], v[186:187]
    v_mov_b64 v[236:237], v[188:189]
    v_mov_b64 v[238:239], v[190:191]
    s_mov_b64 exec, -1
    v_mfma_f32_16x16x32_bf16 v[80:83], v[176:179], v[184:187], 0
    v_mfma_f32_16x16x32_bf16 v[80:83], v[180:183], v[188:191], v[80:83]
    v_fmac_f32 v108, v88, v64
    v_fmac_f32 v109, v89, v65
    v_fmac_f32 v110, v90, v66
    v_fmac_f32 v111, v91, v67
    v_add_f32 v112, v108, v109
    v_add_f32 v113, v110, v111
    v_add_f32 v112, v112, v113
    s_nop 1
    v_add_f32_dpp v112, v112, v112 row_shr:1 row_mask:0xf bank_mask:0xf
    s_nop 1
    v_add_f32_dpp v112, v112, v112 row_shr:2 row_mask:0xf bank_mask:0xf
    s_nop 1
    v_add_f32_dpp v112, v112, v112 row_shr:4 row_mask:0xf bank_mask:0xf
    s_nop 1
    v_add_f32_dpp v112, v112, v112 row_shr:8 row_mask:0xf bank_mask:0xf
    s_nop 1
    v_add_f32_dpp v112, v112, v112 row_bcast:15 row_mask:0xa bank_mask:0xf
    s_nop 1
    v_add_f32_dpp v112, v112, v112 row_bcast:31 row_mask:0xc bank_mask:0xf
    s_nop 0
    v_readlane_b32 s60, v112, 63
    s_add_u32 m0, s31, 67584
    v_or_b32_dpp v14, v43, v2 row_newbcast:1 row_mask:0xf bank_mask:0x3
    v_or_b32_dpp v14, v43, v2 row_newbcast:9 row_mask:0xf bank_mask:0xc
    buffer_load_dwordx4 v14, s[32:35], 0 offen lds
    v_mfma_f32_16x16x32_bf16 v[84:87], v[184:187], v[232:235], 0
    v_mfma_f32_16x16x32_bf16 v[84:87], v[188:191], v[236:239], v[84:87]
    v_mul_f32 v108, v92, v104
    v_mul_f32 v109, v93, v105
    v_mul_f32 v110, v94, v106
    v_mul_f32 v111, v95, v107
    s_add_u32 m0, s31, 68608
    v_or_b32_dpp v15, v47, v3 row_newbcast:1 row_mask:0xf bank_mask:0x3
    v_or_b32_dpp v15, v47, v3 row_newbcast:9 row_mask:0xf bank_mask:0xc
    buffer_load_dwordx4 v15, s[32:35], 0 offen lds
    ds_read_b128 v[192:195], v58 offset:32768
    ds_read_b128 v[196:199], v59 offset:32768
    v_mfma_f32_16x16x32_bf16 v[88:91], v[176:179], v[200:203], 0
    v_mfma_f32_16x16x32_bf16 v[88:91], v[180:183], v[204:207], v[88:91]
    v_fmac_f32 v108, v80, v120
    v_fmac_f32 v109, v81, v121
    v_fmac_f32 v110, v82, v122
    v_fmac_f32 v111, v83, v123
    s_waitcnt lgkmcnt(0)
    s_add_u32 m0, s50, 40448
    v_or_b32_dpp v12, v53, v2 row_newbcast:4 row_mask:0xf bank_mask:0x3
    v_or_b32_dpp v12, v53, v2 row_newbcast:12 row_mask:0xf bank_mask:0xc
    s_mov_b32 exec_hi, 0
    buffer_load_dwordx4 v12, s[32:35], 0 offen lds
    s_mov_b32 exec_hi, -1
    v_lshlrev_b32 v54, 7, v54
    ds_bpermute_b32 v54, v61, v54
    v_lshlrev_b32 v55, 7, v55
    ds_bpermute_b32 v55, v61, v55
    ds_read_b128 v[208:211], v9
    ds_read_b128 v[212:215], v10
    s_mov_b64 exec, s[44:45]
    v_mov_b64 v[232:233], v[200:201]
    v_mov_b64 v[234:235], v[202:203]
    v_mov_b64 v[236:237], v[204:205]
    v_mov_b64 v[238:239], v[206:207]
    s_mov_b64 exec, -1
    v_mfma_f32_16x16x32_bf16 v[92:95], v[184:187], v[200:203], 0
    v_mfma_f32_16x16x32_bf16 v[92:95], v[188:191], v[204:207], v[92:95]
    v_fmac_f32 v108, v84, v124
    v_fmac_f32 v109, v85, v125
    v_fmac_f32 v110, v86, v126
    v_fmac_f32 v111, v87, v127
    ds_read_b32 v119, v118 offset:16
    s_waitcnt lgkmcnt(1)
    s_add_u32 m0, s50, 0
    v_or_b32_dpp v13, v52, v2 row_newbcast:6 row_mask:0xf bank_mask:0x3
    v_or_b32_dpp v13, v52, v2 row_newbcast:14 row_mask:0xf bank_mask:0xc
    buffer_load_dwordx4 v13, s[32:35], 0 offen lds
    s_add_u32 m0, s50, 1024
    v_or_b32_dpp v14, v52, v3 row_newbcast:7 row_mask:0xf bank_mask:0x3
    v_or_b32_dpp v14, v52, v3 row_newbcast:15 row_mask:0xf bank_mask:0xc
    buffer_load_dwordx4 v14, s[32:35], 0 offen lds
    v_mfma_f32_16x16x32_bf16 v[80:83], v[200:203], v[232:235], 0
    v_mfma_f32_16x16x32_bf16 v[80:83], v[204:207], v[236:239], v[80:83]
    v_fmac_f32 v108, v88, v128
    v_fmac_f32 v109, v89, v129
    v_fmac_f32 v110, v90, v130
    v_fmac_f32 v111, v91, v131
    s_waitcnt lgkmcnt(0)
    v_cmp_gt_u32 vcc, 36, v119
    s_nop 0
    s_cbranch_vccnz L_rs37
L_rb37:
    s_add_u32 m0, s31, 0
    v_or_b32_dpp v15, v32, v2 row_newbcast:2 row_mask:0xf bank_mask:0x3
    v_or_b32_dpp v15, v32, v2 row_newbcast:10 row_mask:0xf bank_mask:0xc
    buffer_load_dwordx4 v15, s[32:35], 0 offen lds
    v_mfma_f32_16x16x32_bf16 v[84:87], v[192:195], v[192:195], 0
    v_mfma_f32_16x16x32_bf16 v[84:87], v[196:199], v[196:199], v[84:87]
    v_fmac_f32 v108, v92, v132
    v_fmac_f32 v109, v93, v133
    v_fmac_f32 v110, v94, v134
    v_fmac_f32 v111, v95, v135
    s_add_u32 m0, s31, 1024
    v_or_b32_dpp v12, v36, v3 row_newbcast:2 row_mask:0xf bank_mask:0x3
    v_or_b32_dpp v12, v36, v3 row_newbcast:10 row_mask:0xf bank_mask:0xc
    buffer_load_dwordx4 v12, s[32:35], 0 offen lds
    s_mov_b64 exec, s[44:45]
    v_mov_b64 v[232:233], v[208:209]
    v_mov_b64 v[234:235], v[210:211]
    v_mov_b64 v[236:237], v[212:213]
    v_mov_b64 v[238:239], v[214:215]
    s_mov_b64 exec, -1
    v_mfma_f32_16x16x32_bf16 v[88:91], v[176:179], v[208:211], 0
    v_mfma_f32_16x16x32_bf16 v[88:91], v[180:183], v[212:215], v[88:91]
    v_fmac_f32 v108, v80, v136
    v_fmac_f32 v109, v81, v137
    v_fmac_f32 v110, v82, v138
    v_fmac_f32 v111, v83, v139
    s_waitcnt vmcnt(5)
    ds_add_u32 v116, v117
    ds_read_b128 v[216:219], v9 offset:2560
    ds_read_b128 v[220:223], v10 offset:2560
    v_mfma_f32_16x16x32_bf16 v[92:95], v[208:211], v[232:235], 0
    v_mfma_f32_16x16x32_bf16 v[92:95], v[212:215], v[236:239], v[92:95]
    v_fmac_f32 v108, v84, v96
    v_fmac_f32 v109, v85, v97
    v_fmac_f32 v110, v86, v98
    v_fmac_f32 v111, v87, v99
    s_add_u32 m0, s31, 2048
    v_or_b32_dpp v13, v40, v2 row_newbcast:2 row_mask:0xf bank_mask:0x3
    v_or_b32_dpp v13, v40, v2 row_newbcast:10 row_mask:0xf bank_mask:0xc
    buffer_load_dwordx4 v13, s[32:35], 0 offen lds
    s_waitcnt lgkmcnt(0)
    s_add_u32 m0, s50, 2560
    v_or_b32_dpp v14, v53, v2 row_newbcast:0 row_mask:0xf bank_mask:0x3
    v_or_b32_dpp v14, v53, v2 row_newbcast:8 row_mask:0xf bank_mask:0xc
    buffer_load_dwordx4 v14, s[32:35], 0 offen lds
    s_add_u32 m0, s50, 3584
    v_or_b32_dpp v15, v53, v3 row_newbcast:1 row_mask:0xf bank_mask:0x3
    v_or_b32_dpp v15, v53, v3 row_newbcast:9 row_mask:0xf bank_mask:0xc
    buffer_load_dwordx4 v15, s[32:35], 0 offen lds
    buffer_load_dword v48, v11, s[36:39], s40 offen offset:1600
    buffer_load_dword v49, v11, s[36:39], s40 offen offset:1856
    v_mfma_f32_16x16x32_bf16 v[80:83], v[184:187], v[208:211], 0
    v_mfma_f32_16x16x32_bf16 v[80:83], v[188:191], v[212:215], v[80:83]
    v_fmac_f32 v108, v88, v140
    v_fmac_f32 v109, v89, v141
    v_fmac_f32 v110, v90, v142
    v_fmac_f32 v111, v91, v143
    s_add_u32 m0, s31, 3072
    v_or_b32_dpp v12, v44, v3 row_newbcast:2 row_mask:0xf bank_mask:0x3
    v_or_b32_dpp v12, v44, v3 row_newbcast:10 row_mask:0xf bank_mask:0xc
    buffer_load_dwordx4 v12, s[32:35], 0 offen lds
    v_mfma_f32_16x16x32_bf16 v[84:87], v[200:203], v[208:211], 0
    v_mfma_f32_16x16x32_bf16 v[84:87], v[204:207], v[212:215], v[84:87]
    v_fmac_f32 v108, v92, v144
    v_fmac_f32 v109, v93, v145
    v_fmac_f32 v110, v94, v146
    v_fmac_f32 v111, v95, v147
    ds_read_b32 v119, v118 offset:16
    s_mov_b64 exec, s[44:45]
    v_mov_b64 v[232:233], v[216:217]
    v_mov_b64 v[234:235], v[218:219]
    v_mov_b64 v[236:237], v[220:221]
    v_mov_b64 v[238:239], v[222:223]
    s_mov_b64 exec, -1
    v_mfma_f32_16x16x32_bf16 v[88:91], v[176:179], v[216:219], 0
    v_mfma_f32_16x16x32_bf16 v[88:91], v[180:183], v[220:223], v[88:91]
    v_fmac_f32 v108, v80, v148
    v_fmac_f32 v109, v81, v149
    v_fmac_f32 v110, v82, v150
    v_fmac_f32 v111, v83, v151
    s_waitcnt lgkmcnt(0)
    v_cmp_gt_u32 vcc, 37, v119
    s_nop 0
    s_cbranch_vccnz L_rs38
L_rb38:
    s_add_u32 m0, s31, 16384
    v_or_b32_dpp v13, v33, v2 row_newbcast:2 row_mask:0xf bank_mask:0x3
    v_or_b32_dpp v13, v33, v2 row_newbcast:10 row_mask:0xf bank_mask:0xc
    buffer_load_dwordx4 v13, s[32:35], 0 offen lds
    v_mfma_f32_16x16x32_bf16 v[92:95], v[216:219], v[232:235], 0
    v_mfma_f32_16x16x32_bf16 v[92:95], v[220:223], v[236:239], v[92:95]
    v_fmac_f32 v108, v84, v152
    v_fmac_f32 v109, v85, v153
    v_fmac_f32 v110, v86, v154
    v_fmac_f32 v111, v87, v155
    s_add_u32 m0, s31, 17408
    v_or_b32_dpp v14, v37, v3 row_newbcast:2 row_mask:0xf bank_mask:0x3
    v_or_b32_dpp v14, v37, v3 row_newbcast:10 row_mask:0xf bank_mask:0xc
    buffer_load_dwordx4 v14, s[32:35], 0 offen lds
    ds_read_b128 v[224:227], v9 offset:5120
    ds_read_b128 v[228:231], v10 offset:5120
    v_mfma_f32_16x16x32_bf16 v[80:83], v[184:187], v[216:219], 0
    v_mfma_f32_16x16x32_bf16 v[80:83], v[188:191], v[220:223], v[80:83]
    v_fmac_f32 v108, v88, v156
    v_fmac_f32 v109, v89, v157
    v_fmac_f32 v110, v90, v158
    v_fmac_f32 v111, v91, v159
    s_waitcnt vmcnt(2)
    ds_add_u32 v116, v117
    s_waitcnt lgkmcnt(1)
    s_add_u32 m0, s50, 5120
    v_or_b32_dpp v15, v53, v2 row_newbcast:2 row_mask:0xf bank_mask:0x3
    v_or_b32_dpp v15, v53, v2 row_newbcast:10 row_mask:0xf bank_mask:0xc
    buffer_load_dwordx4 v15, s[32:35], 0 offen lds
    s_add_u32 m0, s50, 6144
    v_or_b32_dpp v12, v53, v3 row_newbcast:3 row_mask:0xf bank_mask:0x3
    v_or_b32_dpp v12, v53, v3 row_newbcast:11 row_mask:0xf bank_mask:0xc
    buffer_load_dwordx4 v12, s[32:35], 0 offen lds
    v_mfma_f32_16x16x32_bf16 v[84:87], v[200:203], v[216:219], 0
    v_mfma_f32_16x16x32_bf16 v[84:87], v[204:207], v[220:223], v[84:87]
    v_fmac_f32 v108, v92, v160
    v_fmac_f32 v109, v93, v161
    v_fmac_f32 v110, v94, v162
    v_fmac_f32 v111, v95, v163
    s_add_u32 m0, s31, 18432
    v_or_b32_dpp v13, v41, v2 row_newbcast:2 row_mask:0xf bank_mask:0x3
    v_or_b32_dpp v13, v41, v2 row_newbcast:10 row_mask:0xf bank_mask:0xc
    buffer_load_dwordx4 v13, s[32:35], 0 offen lds
    v_mfma_f32_16x16x32_bf16 v[88:91], v[208:211], v[216:219], 0
    v_mfma_f32_16x16x32_bf16 v[88:91], v[212:215], v[220:223], v[88:91]
    v_fmac_f32 v108, v80, v164
    v_fmac_f32 v109, v81, v165
    v_fmac_f32 v110, v82, v166
    v_fmac_f32 v111, v83, v167
    s_add_u32 m0, s31, 19456
    v_or_b32_dpp v14, v45, v3 row_newbcast:2 row_mask:0xf bank_mask:0x3
    v_or_b32_dpp v14, v45, v3 row_newbcast:10 row_mask:0xf bank_mask:0xc
    buffer_load_dwordx4 v14, s[32:35], 0 offen lds
    ds_read_b128 v[192:195], v58
    ds_read_b128 v[196:199], v59
    s_mov_b64 exec, s[44:45]
    v_mov_b64 v[232:233], v[224:225]
    v_mov_b64 v[234:235], v[226:227]
    v_mov_b64 v[236:237], v[228:229]
    v_mov_b64 v[238:239], v[230:231]
    s_mov_b64 exec, -1
    v_mfma_f32_16x16x32_bf16 v[92:95], v[176:179], v[224:227], 0
    v_mfma_f32_16x16x32_bf16 v[92:95], v[180:183], v[228:231], v[92:95]
    v_fmac_f32 v108, v84, v168
    v_fmac_f32 v109, v85, v169
    v_fmac_f32 v110, v86, v170
    v_fmac_f32 v111, v87, v171
    v_mfma_f32_16x16x32_bf16 v[80:83], v[224:227], v[232:235], 0
    v_mfma_f32_16x16x32_bf16 v[80:83], v[228:231], v[236:239], v[80:83]
    v_fmac_f32 v108, v88, v68
    v_fmac_f32 v109, v89, v69
    v_fmac_f32 v110, v90, v70
    v_fmac_f32 v111, v91, v71
    ds_read_b32 v119, v118 offset:16
    s_mov_b64 exec, s[46:47]
    ds_read_b128 v[232:235], v7 offset:40448
    ds_read_b128 v[236:239], v8 offset:40448
    s_mov_b64 exec, -1
    v_mfma_f32_16x16x32_bf16 v[84:87], v[184:187], v[224:227], 0
    v_mfma_f32_16x16x32_bf16 v[84:87], v[188:191], v[228:231], v[84:87]
    v_fmac_f32 v108, v92, v72
    v_fmac_f32 v109, v93, v73
    v_fmac_f32 v110, v94, v74
    v_fmac_f32 v111, v95, v75
    s_waitcnt lgkmcnt(2)
    v_cmp_gt_u32 vcc, 38, v119
    s_nop 0
    s_cbranch_vccnz L_rs39
L_rb39:
    s_add_u32 m0, s31, 32768
    v_or_b32_dpp v15, v34, v2 row_newbcast:2 row_mask:0xf bank_mask:0x3
    v_or_b32_dpp v15, v34, v2 row_newbcast:10 row_mask:0xf bank_mask:0xc
    buffer_load_dwordx4 v15, s[32:35], 0 offen lds
    ds_read_b128 v[176:179], v7 offset:32768
    ds_read_b128 v[180:183], v8 offset:32768
    v_mfma_f32_16x16x32_bf16 v[88:91], v[192:195], v[192:195], 0
    v_mfma_f32_16x16x32_bf16 v[88:91], v[196:199], v[196:199], v[88:91]
    v_fmac_f32 v108, v80, v248
    v_fmac_f32 v109, v81, v249
    v_fmac_f32 v110, v82, v250
    v_fmac_f32 v111, v83, v251
    s_add_u32 m0, s31, 33792
    v_or_b32_dpp v12, v38, v3 row_newbcast:2 row_mask:0xf bank_mask:0x3
    v_or_b32_dpp v12, v38, v3 row_newbcast:10 row_mask:0xf bank_mask:0xc
    buffer_load_dwordx4 v12, s[32:35], 0 offen lds
    s_waitcnt lgkmcnt(0)
    s_add_u32 m0, s50, 33280
    v_or_b32_dpp v13, v54, v62 row_newbcast:0 row_mask:0xf bank_mask:0x3
    v_or_b32_dpp v13, v54, v62 row_newbcast:8 row_mask:0xf bank_mask:0xc
    buffer_load_dwordx4 v13, s[32:35], 0 offen lds
    s_add_u32 m0, s50, 34304
    v_or_b32_dpp v14, v54, v63 row_newbcast:1 row_mask:0xf bank_mask:0x3
    v_or_b32_dpp v14, v54, v63 row_newbcast:9 row_mask:0xf bank_mask:0xc
    buffer_load_dwordx4 v14, s[32:35], 0 offen lds
    v_mfma_f32_16x16x32_bf16 v[92:95], v[200:203], v[224:227], 0
    v_mfma_f32_16x16x32_bf16 v[92:95], v[204:207], v[228:231], v[92:95]
    v_fmac_f32 v108, v84, v252
    v_fmac_f32 v109, v85, v253
    v_fmac_f32 v110, v86, v254
    v_fmac_f32 v111, v87, v255
    s_waitcnt vmcnt(4)
    ds_add_u32 v116, v117
    ds_read_b128 v[184:187], v7 offset:35328
    ds_read_b128 v[188:191], v8 offset:35328
    v_mfma_f32_16x16x32_bf16 v[80:83], v[208:211], v[224:227], 0
    v_mfma_f32_16x16x32_bf16 v[80:83], v[212:215], v[228:231], v[80:83]
    v_fmac_f32 v108, v88, v100
    v_fmac_f32 v109, v89, v101
    v_fmac_f32 v110, v90, v102
    v_fmac_f32 v111, v91, v103
    s_add_u32 m0, s31, 34816
    v_or_b32_dpp v15, v42, v2 row_newbcast:2 row_mask:0xf bank_mask:0x3
    v_or_b32_dpp v15, v42, v2 row_newbcast:10 row_mask:0xf bank_mask:0xc
    buffer_load_dwordx4 v15, s[32:35], 0 offen lds
    s_waitcnt lgkmcnt(0)
    s_add_u32 m0, s50, 35840
    v_or_b32_dpp v12, v54, v62 row_newbcast:2 row_mask:0xf bank_mask:0x3
    v_or_b32_dpp v12, v54, v62 row_newbcast:10 row_mask:0xf bank_mask:0xc
    buffer_load_dwordx4 v12, s[32:35], 0 offen lds
    s_add_u32 m0, s50, 36864
    v_or_b32_dpp v13, v54, v63 row_newbcast:3 row_mask:0xf bank_mask:0x3
    v_or_b32_dpp v13, v54, v63 row_newbcast:11 row_mask:0xf bank_mask:0xc
    buffer_load_dwordx4 v13, s[32:35], 0 offen lds
    s_mov_b64 exec, s[44:45]
    v_mov_b64 v[232:233], v[176:177]
    v_mov_b64 v[234:235], v[178:179]
    v_mov_b64 v[236:237], v[180:181]
    v_mov_b64 v[238:239], v[182:183]
    s_mov_b64 exec, -1
    v_mfma_f32_16x16x32_bf16 v[84:87], v[216:219], v[224:227], 0
    v_mfma_f32_16x16x32_bf16 v[84:87], v[220:223], v[228:231], v[84:87]
    v_fmac_f32 v108, v92, v240
    v_fmac_f32 v109, v93, v241
    v_fmac_f32 v110, v94, v242
    v_fmac_f32 v111, v95, v243
    s_add_u32 m0, s31, 35840
    v_or_b32_dpp v14, v46, v3 row_newbcast:2 row_mask:0xf bank_mask:0x3
    v_or_b32_dpp v14, v46, v3 row_newbcast:10 row_mask:0xf bank_mask:0xc
    buffer_load_dwordx4 v14, s[32:35], 0 offen lds
    ds_read_b128 v[192:195], v7 offset:37888
    ds_read_b128 v[196:199], v8 offset:37888
    v_mfma_f32_16x16x32_bf16 v[88:91], v[176:179], v[232:235], 0
    v_mfma_f32_16x16x32_bf16 v[88:91], v[180:183], v[236:239], v[88:91]
    v_fmac_f32 v108, v80, v244
    v_fmac_f32 v109, v81, v245
    v_fmac_f32 v110, v82, v246
    v_fmac_f32 v111, v83, v247
    ds_read_b32 v119, v118 offset:16
    s_waitcnt lgkmcnt(1)
    s_add_u32 m0, s50, 38400
    v_or_b32_dpp v15, v54, v62 row_newbcast:4 row_mask:0xf bank_mask:0x3
    v_or_b32_dpp v15, v54, v62 row_newbcast:12 row_mask:0xf bank_mask:0xc
    buffer_load_dwordx4 v15, s[32:35], 0 offen lds
    s_add_u32 m0, s50, 39424
    v_or_b32_dpp v12, v54, v63 row_newbcast:5 row_mask:0xf bank_mask:0x3
    v_or_b32_dpp v12, v54, v63 row_newbcast:13 row_mask:0xf bank_mask:0xc
    buffer_load_dwordx4 v12, s[32:35], 0 offen lds
    s_mov_b64 exec, s[44:45]
    v_mov_b64 v[232:233], v[184:185]
    v_mov_b64 v[234:235], v[186:187]
    v_mov_b64 v[236:237], v[188:189]
    v_mov_b64 v[238:239], v[190:191]
    s_mov_b64 exec, -1
    v_mfma_f32_16x16x32_bf16 v[92:95], v[176:179], v[184:187], 0
    v_mfma_f32_16x16x32_bf16 v[92:95], v[180:183], v[188:191], v[92:95]
    v_fmac_f32 v108, v84, v64
    v_fmac_f32 v109, v85, v65
    v_fmac_f32 v110, v86, v66
    v_fmac_f32 v111, v87, v67
    v_add_f32 v112, v108, v109
    v_add_f32 v113, v110, v111
    v_add_f32 v112, v112, v113
    s_nop 1
    v_add_f32_dpp v112, v112, v112 row_shr:1 row_mask:0xf bank_mask:0xf
    s_nop 1
    v_add_f32_dpp v112, v112, v112 row_shr:2 row_mask:0xf bank_mask:0xf
    s_nop 1
    v_add_f32_dpp v112, v112, v112 row_shr:4 row_mask:0xf bank_mask:0xf
    s_nop 1
    v_add_f32_dpp v112, v112, v112 row_shr:8 row_mask:0xf bank_mask:0xf
    s_nop 1
    v_add_f32_dpp v112, v112, v112 row_bcast:15 row_mask:0xa bank_mask:0xf
    s_nop 1
    v_add_f32_dpp v112, v112, v112 row_bcast:31 row_mask:0xc bank_mask:0xf
    s_nop 0
    v_readlane_b32 s61, v112, 63
    s_waitcnt lgkmcnt(0)
    v_cmp_gt_u32 vcc, 39, v119
    s_nop 0
    s_cbranch_vccnz L_rs40
L_rb40:
    s_add_u32 m0, s31, 49152
    v_or_b32_dpp v13, v35, v2 row_newbcast:2 row_mask:0xf bank_mask:0x3
    v_or_b32_dpp v13, v35, v2 row_newbcast:10 row_mask:0xf bank_mask:0xc
    buffer_load_dwordx4 v13, s[32:35], 0 offen lds
    v_mfma_f32_16x16x32_bf16 v[80:83], v[184:187], v[232:235], 0
    v_mfma_f32_16x16x32_bf16 v[80:83], v[188:191], v[236:239], v[80:83]
    v_mul_f32 v108, v88, v104
    v_mul_f32 v109, v89, v105
    v_mul_f32 v110, v90, v106
    v_mul_f32 v111, v91, v107
    s_add_u32 m0, s31, 50176
    v_or_b32_dpp v14, v39, v3 row_newbcast:2 row_mask:0xf bank_mask:0x3
    v_or_b32_dpp v14, v39, v3 row_newbcast:10 row_mask:0xf bank_mask:0xc
    buffer_load_dwordx4 v14, s[32:35], 0 offen lds
    ds_read_b128 v[200:203], v56 offset:32768
    ds_read_b128 v[204:207], v57 offset:32768
    v_mfma_f32_16x16x32_bf16 v[84:87], v[176:179], v[192:195], 0
    v_mfma_f32_16x16x32_bf16 v[84:87], v[180:183], v[196:199], v[84:87]
    v_fmac_f32 v108, v92, v120
    v_fmac_f32 v109, v93, v121
    v_fmac_f32 v110, v94, v122
    v_fmac_f32 v111, v95, v123
    s_waitcnt vmcnt(4)
    ds_add_u32 v116, v117
    s_waitcnt lgkmcnt(1)
    s_add_u32 m0, s50, 39936
    v_or_b32_dpp v15, v55, v63 row_newbcast:5 row_mask:0xf bank_mask:0x3
    v_or_b32_dpp v15, v55, v63 row_newbcast:13 row_mask:0xf bank_mask:0xc
    s_mov_b32 exec_lo, 0
    buffer_load_dwordx4 v15, s[32:35], 0 offen lds
    s_mov_b32 exec_lo, -1
    v_lshlrev_b32 v48, 7, v48
    ds_bpermute_b32 v48, v4, v48
    v_lshlrev_b32 v49, 7, v49
    ds_bpermute_b32 v49, v4, v49
    ds_read_b128 v[208:211], v7
    ds_read_b128 v[212:215], v8
    s_mov_b64 exec, s[44:45]
    v_mov_b64 v[232:233], v[192:193]
    v_mov_b64 v[234:235], v[194:195]
    v_mov_b64 v[236:237], v[196:197]
    v_mov_b64 v[238:239], v[198:199]
    s_mov_b64 exec, -1
    v_mfma_f32_16x16x32_bf16 v[88:91], v[184:187], v[192:195], 0
    v_mfma_f32_16x16x32_bf16 v[88:91], v[188:191], v[196:199], v[88:91]
    v_fmac_f32 v108, v80, v124
    v_fmac_f32 v109, v81, v125
    v_fmac_f32 v110, v82, v126
    v_fmac_f32 v111, v83, v127
    s_add_u32 m0, s31, 51200
    v_or_b32_dpp v12, v43, v2 row_newbcast:2 row_mask:0xf bank_mask:0x3
    v_or_b32_dpp v12, v43, v2 row_newbcast:10 row_mask:0xf bank_mask:0xc
    buffer_load_dwordx4 v12, s[32:35], 0 offen lds
    s_waitcnt lgkmcnt(0)
    s_add_u32 m0, s50, 512
    v_or_b32_dpp v13, v54, v62 row_newbcast:6 row_mask:0xf bank_mask:0x3
    v_or_b32_dpp v13, v54, v62 row_newbcast:14 row_mask:0xf bank_mask:0xc
    buffer_load_dwordx4 v13, s[32:35], 0 offen lds
    s_add_u32 m0, s50, 1536
    v_or_b32_dpp v14, v54, v63 row_newbcast:7 row_mask:0xf bank_mask:0x3
    v_or_b32_dpp v14, v54, v63 row_newbcast:15 row_mask:0xf bank_mask:0xc
    buffer_load_dwordx4 v14, s[32:35], 0 offen lds
    v_mfma_f32_16x16x32_bf16 v[92:95], v[192:195], v[232:235], 0
    v_mfma_f32_16x16x32_bf16 v[92:95], v[196:199], v[236:239], v[92:95]
    v_fmac_f32 v108, v84, v128
    v_fmac_f32 v109, v85, v129
    v_fmac_f32 v110, v86, v130
    v_fmac_f32 v111, v87, v131
    s_add_u32 m0, s31, 52224
    v_or_b32_dpp v15, v47, v3 row_newbcast:2 row_mask:0xf bank_mask:0x3
    v_or_b32_dpp v15, v47, v3 row_newbcast:10 row_mask:0xf bank_mask:0xc
    buffer_load_dwordx4 v15, s[32:35], 0 offen lds
    v_mfma_f32_16x16x32_bf16 v[80:83], v[200:203], v[200:203], 0
    v_mfma_f32_16x16x32_bf16 v[80:83], v[204:207], v[204:207], v[80:83]
    v_fmac_f32 v108, v88, v132
    v_fmac_f32 v109, v89, v133
    v_fmac_f32 v110, v90, v134
    v_fmac_f32 v111, v91, v135
    s_mov_b64 exec, s[44:45]
    v_mov_b64 v[232:233], v[208:209]
    v_mov_b64 v[234:235], v[210:211]
    v_mov_b64 v[236:237], v[212:213]
    v_mov_b64 v[238:239], v[214:215]
    s_mov_b64 exec, -1
    v_mfma_f32_16x16x32_bf16 v[84:87], v[176:179], v[208:211], 0
    v_mfma_f32_16x16x32_bf16 v[84:87], v[180:183], v[212:215], v[84:87]
    v_fmac_f32 v108, v92, v136
    v_fmac_f32 v109, v93, v137
    v_fmac_f32 v110, v94, v138
    v_fmac_f32 v111, v95, v139
    ds_read_b32 v119, v118 offset:16
    ds_read_b128 v[216:219], v7 offset:2560
    ds_read_b128 v[220:223], v8 offset:2560
    v_mfma_f32_16x16x32_bf16 v[88:91], v[208:211], v[232:235], 0
    v_mfma_f32_16x16x32_bf16 v[88:91], v[212:215], v[236:239], v[88:91]
    v_fmac_f32 v108, v80, v96
    v_fmac_f32 v109, v81, v97
    v_fmac_f32 v110, v82, v98
    v_fmac_f32 v111, v83, v99
    s_waitcnt lgkmcnt(2)
    v_cmp_gt_u32 vcc, 40, v119
    s_nop 0
    s_cbranch_vccnz L_rs41
L_rb41:
    s_add_u32 m0, s31, 65536
    v_or_b32_dpp v12, v32, v2 row_newbcast:3 row_mask:0xf bank_mask:0x3
    v_or_b32_dpp v12, v32, v2 row_newbcast:11 row_mask:0xf bank_mask:0xc
    buffer_load_dwordx4 v12, s[32:35], 0 offen lds
    s_waitcnt lgkmcnt(0)
    s_add_u32 m0, s50, 3072
    v_or_b32_dpp v13, v55, v62 row_newbcast:0 row_mask:0xf bank_mask:0x3
    v_or_b32_dpp v13, v55, v62 row_newbcast:8 row_mask:0xf bank_mask:0xc
    buffer_load_dwordx4 v13, s[32:35], 0 offen lds
    s_add_u32 m0, s50, 4096
    v_or_b32_dpp v14, v55, v63 row_newbcast:1 row_mask:0xf bank_mask:0x3
    v_or_b32_dpp v14, v55, v63 row_newbcast:9 row_mask:0xf bank_mask:0xc
    buffer_load_dwordx4 v14, s[32:35], 0 offen lds
    buffer_load_dword v50, v11, s[36:39], s40 offen offset:2000
    buffer_load_dword v51, v11, s[36:39], s40 offen offset:2256
    v_mfma_f32_16x16x32_bf16 v[92:95], v[184:187], v[208:211], 0
    v_mfma_f32_16x16x32_bf16 v[92:95], v[188:191], v[212:215], v[92:95]
    v_fmac_f32 v108, v84, v140
    v_fmac_f32 v109, v85, v141
    v_fmac_f32 v110, v86, v142
    v_fmac_f32 v111, v87, v143
    s_add_u32 m0, s31, 66560
    v_or_b32_dpp v15, v36, v3 row_newbcast:3 row_mask:0xf bank_mask:0x3
    v_or_b32_dpp v15, v36, v3 row_newbcast:11 row_mask:0xf bank_mask:0xc
    buffer_load_dwordx4 v15, s[32:35], 0 offen lds
    v_mfma_f32_16x16x32_bf16 v[80:83], v[192:195], v[208:211], 0
    v_mfma_f32_16x16x32_bf16 v[80:83], v[196:199], v[212:215], v[80:83]
    v_fmac_f32 v108, v88, v144
    v_fmac_f32 v109, v89, v145
    v_fmac_f32 v110, v90, v146
    v_fmac_f32 v111, v91, v147
    s_waitcnt vmcnt(6)
    ds_add_u32 v116, v117
    s_mov_b64 exec, s[44:45]
    v_mov_b64 v[232:233], v[216:217]
    v_mov_b64 v[234:235], v[218:219]
    v_mov_b64 v[236:237], v[220:221]
    v_mov_b64 v[238:239], v[222:223]
    s_mov_b64 exec, -1
    v_mfma_f32_16x16x32_bf16 v[84:87], v[176:179], v[216:219], 0
    v_mfma_f32_16x16x32_bf16 v[84:87], v[180:183], v[220:223], v[84:87]
    v_fmac_f32 v108, v92, v148
    v_fmac_f32 v109, v93, v149
    v_fmac_f32 v110, v94, v150
    v_fmac_f32 v111, v95, v151
    s_add_u32 m0, s31, 67584
    v_or_b32_dpp v12, v40, v2 row_newbcast:3 row_mask:0xf bank_mask:0x3
    v_or_b32_dpp v12, v40, v2 row_newbcast:11 row_mask:0xf bank_mask:0xc
    buffer_load_dwordx4 v12, s[32:35], 0 offen lds
    v_mfma_f32_16x16x32_bf16 v[88:91], v[216:219], v[232:235], 0
    v_mfma_f32_16x16x32_bf16 v[88:91], v[220:223], v[236:239], v[88:91]
    v_fmac_f32 v108, v80, v152
    v_fmac_f32 v109, v81, v153
    v_fmac_f32 v110, v82, v154
    v_fmac_f32 v111, v83, v155
    s_add_u32 m0, s31, 68608
    v_or_b32_dpp v13, v44, v3 row_newbcast:3 row_mask:0xf bank_mask:0x3
    v_or_b32_dpp v13, v44, v3 row_newbcast:11 row_mask:0xf bank_mask:0xc
    buffer_load_dwordx4 v13, s[32:35], 0 offen lds
    ds_read_b128 v[224:227], v7 offset:5120
    ds_read_b128 v[228:231], v8 offset:5120
    v_mfma_f32_16x16x32_bf16 v[92:95], v[184:187], v[216:219], 0
    v_mfma_f32_16x16x32_bf16 v[92:95], v[188:191], v[220:223], v[92:95]
    v_fmac_f32 v108, v84, v156
    v_fmac_f32 v109, v85, v157
    v_fmac_f32 v110, v86, v158
    v_fmac_f32 v111, v87, v159
    s_waitcnt lgkmcnt(0)
    s_add_u32 m0, s50, 5632
    v_or_b32_dpp v14, v55, v62 row_newbcast:2 row_mask:0xf bank_mask:0x3
    v_or_b32_dpp v14, v55, v62 row_newbcast:10 row_mask:0xf bank_mask:0xc
    buffer_load_dwordx4 v14, s[32:35], 0 offen lds
    s_add_u32 m0, s50, 6656
    v_or_b32_dpp v15, v55, v63 row_newbcast:3 row_mask:0xf bank_mask:0x3
    v_or_b32_dpp v15, v55, v63 row_newbcast:11 row_mask:0xf bank_mask:0xc
    buffer_load_dwordx4 v15, s[32:35], 0 offen lds
    v_mfma_f32_16x16x32_bf16 v[80:83], v[192:195], v[216:219], 0
    v_mfma_f32_16x16x32_bf16 v[80:83], v[196:199], v[220:223], v[80:83]
    v_fmac_f32 v108, v88, v160
    v_fmac_f32 v109, v89, v161
    v_fmac_f32 v110, v90, v162
    v_fmac_f32 v111, v91, v163
    ds_read_b32 v119, v118 offset:16
    v_mfma_f32_16x16x32_bf16 v[84:87], v[208:211], v[216:219], 0
    v_mfma_f32_16x16x32_bf16 v[84:87], v[212:215], v[220:223], v[84:87]
    v_fmac_f32 v108, v92, v164
    v_fmac_f32 v109, v93, v165
    v_fmac_f32 v110, v94, v166
    v_fmac_f32 v111, v95, v167
    s_waitcnt lgkmcnt(0)
    v_cmp_gt_u32 vcc, 41, v119
    s_nop 0
    s_cbranch_vccnz L_rs42
L_rb42:
    s_add_u32 m0, s31, 0
    v_or_b32_dpp v12, v33, v2 row_newbcast:3 row_mask:0xf bank_mask:0x3
    v_or_b32_dpp v12, v33, v2 row_newbcast:11 row_mask:0xf bank_mask:0xc
    buffer_load_dwordx4 v12, s[32:35], 0 offen lds
    ds_read_b128 v[200:203], v56
    ds_read_b128 v[204:207], v57
    s_mov_b64 exec, s[44:45]
    v_mov_b64 v[232:233], v[224:225]
    v_mov_b64 v[234:235], v[226:227]
    v_mov_b64 v[236:237], v[228:229]
    v_mov_b64 v[238:239], v[230:231]
    s_mov_b64 exec, -1
    v_mfma_f32_16x16x32_bf16 v[88:91], v[176:179], v[224:227], 0
    v_mfma_f32_16x16x32_bf16 v[88:91], v[180:183], v[228:231], v[88:91]
    v_fmac_f32 v108, v80, v168
    v_fmac_f32 v109, v81, v169
    v_fmac_f32 v110, v82, v170
    v_fmac_f32 v111, v83, v171
    s_add_u32 m0, s31, 1024
    v_or_b32_dpp v13, v37, v3 row_newbcast:3 row_mask:0xf bank_mask:0x3
    v_or_b32_dpp v13, v37, v3 row_newbcast:11 row_mask:0xf bank_mask:0xc
    buffer_load_dwordx4 v13, s[32:35], 0 offen lds
    v_mfma_f32_16x16x32_bf16 v[92:95], v[224:227], v[232:235], 0
    v_mfma_f32_16x16x32_bf16 v[92:95], v[228:231], v[236:239], v[92:95]
    v_fmac_f32 v108, v84, v68
    v_fmac_f32 v109, v85, v69
    v_fmac_f32 v110, v86, v70
    v_fmac_f32 v111, v87, v71
    s_waitcnt vmcnt(4)
    ds_add_u32 v116, v117
    s_mov_b64 exec, s[46:47]
    ds_read_b128 v[232:235], v7 offset:40448
    ds_read_b128 v[236:239], v8 offset:40448
    s_mov_b64 exec, -1
    v_mfma_f32_16x16x32_bf16 v[80:83], v[184:187], v[224:227], 0
    v_mfma_f32_16x16x32_bf16 v[80:83], v[188:191], v[228:231], v[80:83]
    v_fmac_f32 v108, v88, v72
    v_fmac_f32 v109, v89, v73
    v_fmac_f32 v110, v90, v74
    v_fmac_f32 v111, v91, v75
    s_add_u32 m0, s31, 2048
    v_or_b32_dpp v14, v41, v2 row_newbcast:3 row_mask:0xf bank_mask:0x3
    v_or_b32_dpp v14, v41, v2 row_newbcast:11 row_mask:0xf bank_mask:0xc
    buffer_load_dwordx4 v14, s[32:35], 0 offen lds
    ds_read_b128 v[176:179], v9 offset:32768
    ds_read_b128 v[180:183], v10 offset:32768
    s_waitcnt lgkmcnt(6)
    v_mfma_f32_16x16x32_bf16 v[84:87], v[200:203], v[200:203], 0
    s_waitcnt lgkmcnt(5)
    v_mfma_f32_16x16x32_bf16 v[84:87], v[204:207], v[204:207], v[84:87]
    v_fmac_f32 v108, v92, v248
    v_fmac_f32 v109, v93, v249
    v_fmac_f32 v110, v94, v250
    v_fmac_f32 v111, v95, v251
    s_add_u32 m0, s31, 3072
    v_or_b32_dpp v15, v45, v3 row_newbcast:3 row_mask:0xf bank_mask:0x3
    v_or_b32_dpp v15, v45, v3 row_newbcast:11 row_mask:0xf bank_mask:0xc
    buffer_load_dwordx4 v15, s[32:35], 0 offen lds
    s_waitcnt lgkmcnt(0)
    s_add_u32 m0, s50, 32768
    v_or_b32_dpp v12, v48, v2 row_newbcast:0 row_mask:0xf bank_mask:0x3
    v_or_b32_dpp v12, v48, v2 row_newbcast:8 row_mask:0xf bank_mask:0xc
    buffer_load_dwordx4 v12, s[32:35], 0 offen lds
    s_add_u32 m0, s50, 33792
    v_or_b32_dpp v13, v48, v3 row_newbcast:1 row_mask:0xf bank_mask:0x3
    v_or_b32_dpp v13, v48, v3 row_newbcast:9 row_mask:0xf bank_mask:0xc
    buffer_load_dwordx4 v13, s[32:35], 0 offen lds
    v_mfma_f32_16x16x32_bf16 v[88:91], v[192:195], v[224:227], 0
    v_mfma_f32_16x16x32_bf16 v[88:91], v[196:199], v[228:231], v[88:91]
    v_fmac_f32 v108, v80, v252
    v_fmac_f32 v109, v81, v253
    v_fmac_f32 v110, v82, v254
    v_fmac_f32 v111, v83, v255
    ds_read_b32 v119, v118 offset:16
    ds_read_b128 v[184:187], v9 offset:35328
    ds_read_b128 v[188:191], v10 offset:35328
    v_mfma_f32_16x16x32_bf16 v[92:95], v[208:211], v[224:227], 0
    v_mfma_f32_16x16x32_bf16 v[92:95], v[212:215], v[228:231], v[92:95]
    v_fmac_f32 v108, v84, v100
    v_fmac_f32 v109, v85, v101
    v_fmac_f32 v110, v86, v102
    v_fmac_f32 v111, v87, v103
    s_waitcnt lgkmcnt(2)
    v_cmp_gt_u32 vcc, 42, v119
    s_nop 0
    s_cbranch_vccnz L_rs43
L_rb43:
    s_add_u32 m0, s31, 16384
    v_or_b32_dpp v14, v34, v2 row_newbcast:3 row_mask:0xf bank_mask:0x3
    v_or_b32_dpp v14, v34, v2 row_newbcast:11 row_mask:0xf bank_mask:0xc
    buffer_load_dwordx4 v14, s[32:35], 0 offen lds
    s_waitcnt lgkmcnt(0)
    s_add_u32 m0, s50, 35328
    v_or_b32_dpp v15, v48, v2 row_newbcast:2 row_mask:0xf bank_mask:0x3
    v_or_b32_dpp v15, v48, v2 row_newbcast:10 row_mask:0xf bank_mask:0xc
    buffer_load_dwordx4 v15, s[32:35], 0 offen lds
    s_add_u32 m0, s50, 36352
    v_or_b32_dpp v12, v48, v3 row_newbcast:3 row_mask:0xf bank_mask:0x3
    v_or_b32_dpp v12, v48, v3 row_newbcast:11 row_mask:0xf bank_mask:0xc
    buffer_load_dwordx4 v12, s[32:35], 0 offen lds
    s_mov_b64 exec, s[44:45]
    v_mov_b64 v[232:233], v[176:177]
    v_mov_b64 v[234:235], v[178:179]
    v_mov_b64 v[236:237], v[180:181]
    v_mov_b64 v[238:239], v[182:183]
    s_mov_b64 exec, -1
    v_mfma_f32_16x16x32_bf16 v[80:83], v[216:219], v[224:227], 0
    v_mfma_f32_16x16x32_bf16 v[80:83], v[220:223], v[228:231], v[80:83]
    v_fmac_f32 v108, v88, v240
    v_fmac_f32 v109, v89, v241
    v_fmac_f32 v110, v90, v242
    v_fmac_f32 v111, v91, v243
    s_add_u32 m0, s31, 17408
    v_or_b32_dpp v13, v38, v3 row_newbcast:3 row_mask:0xf bank_mask:0x3
    v_or_b32_dpp v13, v38, v3 row_newbcast:11 row_mask:0xf bank_mask:0xc
    buffer_load_dwordx4 v13, s[32:35], 0 offen lds
    ds_read_b128 v[200:203], v9 offset:37888
    ds_read_b128 v[204:207], v10 offset:37888
    v_mfma_f32_16x16x32_bf16 v[84:87], v[176:179], v[232:235], 0
    v_mfma_f32_16x16x32_bf16 v[84:87], v[180:183], v[236:239], v[84:87]
    v_fmac_f32 v108, v92, v244
    v_fmac_f32 v109, v93, v245
    v_fmac_f32 v110, v94, v246
    v_fmac_f32 v111, v95, v247
    s_waitcnt vmcnt(6)
    ds_add_u32 v116, v117
    s_waitcnt lgkmcnt(1)
    s_add_u32 m0, s50, 37888
    v_or_b32_dpp v14, v48, v2 row_newbcast:4 row_mask:0xf bank_mask:0x3
    v_or_b32_dpp v14, v48, v2 row_newbcast:12 row_mask:0xf bank_mask:0xc
    buffer_load_dwordx4 v14, s[32:35], 0 offen lds
    s_add_u32 m0, s50, 38912
    v_or_b32_dpp v15, v48, v3 row_newbcast:5 row_mask:0xf bank_mask:0x3
    v_or_b32_dpp v15, v48, v3 row_newbcast:13 row_mask:0xf bank_mask:0xc
    buffer_load_dwordx4 v15, s[32:35], 0 offen lds
    s_mov_b64 exec, s[44:45]
    v_mov_b64 v[232:233], v[184:185]
    v_mov_b64 v[234:235], v[186:187]
    v_mov_b64 v[236:237], v[188:189]
    v_mov_b64 v[238:239], v[190:191]
    s_mov_b64 exec, -1
    v_mfma_f32_16x16x32_bf16 v[88:91], v[176:179], v[184:187], 0
    v_mfma_f32_16x16x32_bf16 v[88:91], v[180:183], v[188:191], v[88:91]
    v_fmac_f32 v108, v80, v64
    v_fmac_f32 v109, v81, v65
    v_fmac_f32 v110, v82, v66
    v_fmac_f32 v111, v83, v67
    v_add_f32 v112, v108, v109
    v_add_f32 v113, v110, v111
    v_add_f32 v112, v112, v113
    s_nop 1
    v_add_f32_dpp v112, v112, v112 row_shr:1 row_mask:0xf bank_mask:0xf
    s_nop 1
    v_add_f32_dpp v112, v112, v112 row_shr:2 row_mask:0xf bank_mask:0xf
    s_nop 1
    v_add_f32_dpp v112, v112, v112 row_shr:4 row_mask:0xf bank_mask:0xf
    s_nop 1
    v_add_f32_dpp v112, v112, v112 row_shr:8 row_mask:0xf bank_mask:0xf
    s_nop 1
    v_add_f32_dpp v112, v112, v112 row_bcast:15 row_mask:0xa bank_mask:0xf
    s_nop 1
    v_add_f32_dpp v112, v112, v112 row_bcast:31 row_mask:0xc bank_mask:0xf
    s_nop 0
    v_readlane_b32 s62, v112, 63
    s_add_u32 m0, s31, 18432
    v_or_b32_dpp v12, v42, v2 row_newbcast:3 row_mask:0xf bank_mask:0x3
    v_or_b32_dpp v12, v42, v2 row_newbcast:11 row_mask:0xf bank_mask:0xc
    buffer_load_dwordx4 v12, s[32:35], 0 offen lds
    v_mfma_f32_16x16x32_bf16 v[92:95], v[184:187], v[232:235], 0
    v_mfma_f32_16x16x32_bf16 v[92:95], v[188:191], v[236:239], v[92:95]
    v_mul_f32 v108, v84, v104
    v_mul_f32 v109, v85, v105
    v_mul_f32 v110, v86, v106
    v_mul_f32 v111, v87, v107
    s_add_u32 m0, s31, 19456
    v_or_b32_dpp v13, v46, v3 row_newbcast:3 row_mask:0xf bank_mask:0x3
    v_or_b32_dpp v13, v46, v3 row_newbcast:11 row_mask:0xf bank_mask:0xc
    buffer_load_dwordx4 v13, s[32:35], 0 offen lds
    ds_read_b128 v[192:195], v58 offset:32768
    ds_read_b128 v[196:199], v59 offset:32768
    v_mfma_f32_16x16x32_bf16 v[80:83], v[176:179], v[200:203], 0
    v_mfma_f32_16x16x32_bf16 v[80:83], v[180:183], v[204:207], v[80:83]
    v_fmac_f32 v108, v88, v120
    v_fmac_f32 v109, v89, v121
    v_fmac_f32 v110, v90, v122
    v_fmac_f32 v111, v91, v123
    s_waitcnt lgkmcnt(0)
    s_add_u32 m0, s50, 40448
    v_or_b32_dpp v14, v49, v2 row_newbcast:4 row_mask:0xf bank_mask:0x3
    v_or_b32_dpp v14, v49, v2 row_newbcast:12 row_mask:0xf bank_mask:0xc
    s_mov_b32 exec_hi, 0
    buffer_load_dwordx4 v14, s[32:35], 0 offen lds
    s_mov_b32 exec_hi, -1
    v_lshlrev_b32 v50, 7, v50
    ds_bpermute_b32 v50, v61, v50
    v_lshlrev_b32 v51, 7, v51
    ds_bpermute_b32 v51, v61, v51
    ds_read_b128 v[208:211], v9
    ds_read_b128 v[212:215], v10
    s_mov_b64 exec, s[44:45]
    v_mov_b64 v[232:233], v[200:201]
    v_mov_b64 v[234:235], v[202:203]
    v_mov_b64 v[236:237], v[204:205]
    v_mov_b64 v[238:239], v[206:207]
    s_mov_b64 exec, -1
    v_mfma_f32_16x16x32_bf16 v[84:87], v[184:187], v[200:203], 0
    v_mfma_f32_16x16x32_bf16 v[84:87], v[188:191], v[204:207], v[84:87]
    v_fmac_f32 v108, v92, v124
    v_fmac_f32 v109, v93, v125
    v_fmac_f32 v110, v94, v126
    v_fmac_f32 v111, v95, v127
    ds_read_b32 v119, v118 offset:16
    s_waitcnt lgkmcnt(1)
    s_add_u32 m0, s50, 0
    v_or_b32_dpp v15, v48, v2 row_newbcast:6 row_mask:0xf bank_mask:0x3
    v_or_b32_dpp v15, v48, v2 row_newbcast:14 row_mask:0xf bank_mask:0xc
    buffer_load_dwordx4 v15, s[32:35], 0 offen lds
    s_add_u32 m0, s50, 1024
    v_or_b32_dpp v12, v48, v3 row_newbcast:7 row_mask:0xf bank_mask:0x3
    v_or_b32_dpp v12, v48, v3 row_newbcast:15 row_mask:0xf bank_mask:0xc
    buffer_load_dwordx4 v12, s[32:35], 0 offen lds
    v_mfma_f32_16x16x32_bf16 v[88:91], v[200:203], v[232:235], 0
    v_mfma_f32_16x16x32_bf16 v[88:91], v[204:207], v[236:239], v[88:91]
    v_fmac_f32 v108, v80, v128
    v_fmac_f32 v109, v81, v129
    v_fmac_f32 v110, v82, v130
    v_fmac_f32 v111, v83, v131
    s_waitcnt lgkmcnt(0)
    v_cmp_gt_u32 vcc, 43, v119
    s_nop 0
    s_cbranch_vccnz L_rs44
L_rb44:
    s_add_u32 m0, s31, 32768
    v_or_b32_dpp v13, v35, v2 row_newbcast:3 row_mask:0xf bank_mask:0x3
    v_or_b32_dpp v13, v35, v2 row_newbcast:11 row_mask:0xf bank_mask:0xc
    buffer_load_dwordx4 v13, s[32:35], 0 offen lds
    v_mfma_f32_16x16x32_bf16 v[92:95], v[192:195], v[192:195], 0
    v_mfma_f32_16x16x32_bf16 v[92:95], v[196:199], v[196:199], v[92:95]
    v_fmac_f32 v108, v84, v132
    v_fmac_f32 v109, v85, v133
    v_fmac_f32 v110, v86, v134
    v_fmac_f32 v111, v87, v135
    s_add_u32 m0, s31, 33792
    v_or_b32_dpp v14, v39, v3 row_newbcast:3 row_mask:0xf bank_mask:0x3
    v_or_b32_dpp v14, v39, v3 row_newbcast:11 row_mask:0xf bank_mask:0xc
    buffer_load_dwordx4 v14, s[32:35], 0 offen lds
    s_mov_b64 exec, s[44:45]
    v_mov_b64 v[232:233], v[208:209]
    v_mov_b64 v[234:235], v[210:211]
    v_mov_b64 v[236:237], v[212:213]
    v_mov_b64 v[238:239], v[214:215]
    s_mov_b64 exec, -1
    v_mfma_f32_16x16x32_bf16 v[80:83], v[176:179], v[208:211], 0
    v_mfma_f32_16x16x32_bf16 v[80:83], v[180:183], v[212:215], v[80:83]
    v_fmac_f32 v108, v88, v136
    v_fmac_f32 v109, v89, v137
    v_fmac_f32 v110, v90, v138
    v_fmac_f32 v111, v91, v139
    s_waitcnt vmcnt(5)
    ds_add_u32 v116, v117
    ds_read_b128 v[216:219], v9 offset:2560
    ds_read_b128 v[220:223], v10 offset:2560
    v_mfma_f32_16x16x32_bf16 v[84:87], v[208:211], v[232:235], 0
    v_mfma_f32_16x16x32_bf16 v[84:87], v[212:215], v[236:239], v[84:87]
    v_fmac_f32 v108, v92, v96
    v_fmac_f32 v109, v93, v97
    v_fmac_f32 v110, v94, v98
    v_fmac_f32 v111, v95, v99
    s_add_u32 m0, s31, 34816
    v_or_b32_dpp v15, v43, v2 row_newbcast:3 row_mask:0xf bank_mask:0x3
    v_or_b32_dpp v15, v43, v2 row_newbcast:11 row_mask:0xf bank_mask:0xc
    buffer_load_dwordx4 v15, s[32:35], 0 offen lds
    s_waitcnt lgkmcnt(0)
    s_add_u32 m0, s50, 2560
    v_or_b32_dpp v12, v49, v2 row_newbcast:0 row_mask:0xf bank_mask:0x3
    v_or_b32_dpp v12, v49, v2 row_newbcast:8 row_mask:0xf bank_mask:0xc
    buffer_load_dwordx4 v12, s[32:35], 0 offen lds
    s_add_u32 m0, s50, 3584
    v_or_b32_dpp v13, v49, v3 row_newbcast:1 row_mask:0xf bank_mask:0x3
    v_or_b32_dpp v13, v49, v3 row_newbcast:9 row_mask:0xf bank_mask:0xc
    buffer_load_dwordx4 v13, s[32:35], 0 offen lds
    buffer_load_dword v52, v11, s[36:39], s40 offen offset:2400
    buffer_load_dword v53, v11, s[36:39], s40 offen offset:2656
    v_mfma_f32_16x16x32_bf16 v[88:91], v[184:187], v[208:211], 0
    v_mfma_f32_16x16x32_bf16 v[88:91], v[188:191], v[212:215], v[88:91]
    v_fmac_f32 v108, v80, v140
    v_fmac_f32 v109, v81, v141
    v_fmac_f32 v110, v82, v142
    v_fmac_f32 v111, v83, v143
    s_add_u32 m0, s31, 35840
    v_or_b32_dpp v14, v47, v3 row_newbcast:3 row_mask:0xf bank_mask:0x3
    v_or_b32_dpp v14, v47, v3 row_newbcast:11 row_mask:0xf bank_mask:0xc
    buffer_load_dwordx4 v14, s[32:35], 0 offen lds
    v_mfma_f32_16x16x32_bf16 v[92:95], v[200:203], v[208:211], 0
    v_mfma_f32_16x16x32_bf16 v[92:95], v[204:207], v[212:215], v[92:95]
    v_fmac_f32 v108, v84, v144
    v_fmac_f32 v109, v85, v145
    v_fmac_f32 v110, v86, v146
    v_fmac_f32 v111, v87, v147
    ds_read_b32 v119, v118 offset:16
    s_mov_b64 exec, s[44:45]
    v_mov_b64 v[232:233], v[216:217]
    v_mov_b64 v[234:235], v[218:219]
    v_mov_b64 v[236:237], v[220:221]
    v_mov_b64 v[238:239], v[222:223]
    s_mov_b64 exec, -1
    v_mfma_f32_16x16x32_bf16 v[80:83], v[176:179], v[216:219], 0
    v_mfma_f32_16x16x32_bf16 v[80:83], v[180:183], v[220:223], v[80:83]
    v_fmac_f32 v108, v88, v148
    v_fmac_f32 v109, v89, v149
    v_fmac_f32 v110, v90, v150
    v_fmac_f32 v111, v91, v151
    s_waitcnt lgkmcnt(0)
    v_cmp_gt_u32 vcc, 44, v119
    s_nop 0
    s_cbranch_vccnz L_rs45
L_rb45:
    s_add_u32 m0, s31, 49152
    v_or_b32_dpp v15, v32, v2 row_newbcast:4 row_mask:0xf bank_mask:0x3
    v_or_b32_dpp v15, v32, v2 row_newbcast:12 row_mask:0xf bank_mask:0xc
    buffer_load_dwordx4 v15, s[32:35], 0 offen lds
    v_mfma_f32_16x16x32_bf16 v[84:87], v[216:219], v[232:235], 0
    v_mfma_f32_16x16x32_bf16 v[84:87], v[220:223], v[236:239], v[84:87]
    v_fmac_f32 v108, v92, v152
    v_fmac_f32 v109, v93, v153
    v_fmac_f32 v110, v94, v154
    v_fmac_f32 v111, v95, v155
    s_add_u32 m0, s31, 50176
    v_or_b32_dpp v12, v36, v3 row_newbcast:4 row_mask:0xf bank_mask:0x3
    v_or_b32_dpp v12, v36, v3 row_newbcast:12 row_mask:0xf bank_mask:0xc
    buffer_load_dwordx4 v12, s[32:35], 0 offen lds
    ds_read_b128 v[224:227], v9 offset:5120
    ds_read_b128 v[228:231], v10 offset:5120
    v_mfma_f32_16x16x32_bf16 v[88:91], v[184:187], v[216:219], 0
    v_mfma_f32_16x16x32_bf16 v[88:91], v[188:191], v[220:223], v[88:91]
    v_fmac_f32 v108, v80, v156
    v_fmac_f32 v109, v81, v157
    v_fmac_f32 v110, v82, v158
    v_fmac_f32 v111, v83, v159
    s_waitcnt vmcnt(2)
    ds_add_u32 v116, v117
    s_waitcnt lgkmcnt(1)
    s_add_u32 m0, s50, 5120
    v_or_b32_dpp v13, v49, v2 row_newbcast:2 row_mask:0xf bank_mask:0x3
    v_or_b32_dpp v13, v49, v2 row_newbcast:10 row_mask:0xf bank_mask:0xc
    buffer_load_dwordx4 v13, s[32:35], 0 offen lds
    s_add_u32 m0, s50, 6144
    v_or_b32_dpp v14, v49, v3 row_newbcast:3 row_mask:0xf bank_mask:0x3
    v_or_b32_dpp v14, v49, v3 row_newbcast:11 row_mask:0xf bank_mask:0xc
    buffer_load_dwordx4 v14, s[32:35], 0 offen lds
    v_mfma_f32_16x16x32_bf16 v[92:95], v[200:203], v[216:219], 0
    v_mfma_f32_16x16x32_bf16 v[92:95], v[204:207], v[220:223], v[92:95]
    v_fmac_f32 v108, v84, v160
    v_fmac_f32 v109, v85, v161
    v_fmac_f32 v110, v86, v162
    v_fmac_f32 v111, v87, v163
    s_add_u32 m0, s31, 51200
    v_or_b32_dpp v15, v40, v2 row_newbcast:4 row_mask:0xf bank_mask:0x3
    v_or_b32_dpp v15, v40, v2 row_newbcast:12 row_mask:0xf bank_mask:0xc
    buffer_load_dwordx4 v15, s[32:35], 0 offen lds
    v_mfma_f32_16x16x32_bf16 v[80:83], v[208:211], v[216:219], 0
    v_mfma_f32_16x16x32_bf16 v[80:83], v[212:215], v[220:223], v[80:83]
    v_fmac_f32 v108, v88, v164
    v_fmac_f32 v109, v89, v165
    v_fmac_f32 v110, v90, v166
    v_fmac_f32 v111, v91, v167
    s_add_u32 m0, s31, 52224
    v_or_b32_dpp v12, v44, v3 row_newbcast:4 row_mask:0xf bank_mask:0x3
    v_or_b32_dpp v12, v44, v3 row_newbcast:12 row_mask:0xf bank_mask:0xc
    buffer_load_dwordx4 v12, s[32:35], 0 offen lds
    ds_read_b128 v[192:195], v58
    ds_read_b128 v[196:199], v59
    s_mov_b64 exec, s[44:45]
    v_mov_b64 v[232:233], v[224:225]
    v_mov_b64 v[234:235], v[226:227]
    v_mov_b64 v[236:237], v[228:229]
    v_mov_b64 v[238:239], v[230:231]
    s_mov_b64 exec, -1
    v_mfma_f32_16x16x32_bf16 v[84:87], v[176:179], v[224:227], 0
    v_mfma_f32_16x16x32_bf16 v[84:87], v[180:183], v[228:231], v[84:87]
    v_fmac_f32 v108, v92, v168
    v_fmac_f32 v109, v93, v169
    v_fmac_f32 v110, v94, v170
    v_fmac_f32 v111, v95, v171
    v_mfma_f32_16x16x32_bf16 v[88:91], v[224:227], v[232:235], 0
    v_mfma_f32_16x16x32_bf16 v[88:91], v[228:231], v[236:239], v[88:91]
    v_fmac_f32 v108, v80, v68
    v_fmac_f32 v109, v81, v69
    v_fmac_f32 v110, v82, v70
    v_fmac_f32 v111, v83, v71
    ds_read_b32 v119, v118 offset:16
    s_mov_b64 exec, s[46:47]
    ds_read_b128 v[232:235], v7 offset:40448
    ds_read_b128 v[236:239], v8 offset:40448
    s_mov_b64 exec, -1
    v_mfma_f32_16x16x32_bf16 v[92:95], v[184:187], v[224:227], 0
    v_mfma_f32_16x16x32_bf16 v[92:95], v[188:191], v[228:231], v[92:95]
    v_fmac_f32 v108, v84, v72
    v_fmac_f32 v109, v85, v73
    v_fmac_f32 v110, v86, v74
    v_fmac_f32 v111, v87, v75
    s_waitcnt lgkmcnt(2)
    v_cmp_gt_u32 vcc, 45, v119
    s_nop 0
    s_cbranch_vccnz L_rs46
L_rb46:
    s_add_u32 m0, s31, 65536
    v_or_b32_dpp v13, v33, v2 row_newbcast:4 row_mask:0xf bank_mask:0x3
    v_or_b32_dpp v13, v33, v2 row_newbcast:12 row_mask:0xf bank_mask:0xc
    buffer_load_dwordx4 v13, s[32:35], 0 offen lds
    ds_read_b128 v[176:179], v7 offset:32768
    ds_read_b128 v[180:183], v8 offset:32768
    v_mfma_f32_16x16x32_bf16 v[80:83], v[192:195], v[192:195], 0
    v_mfma_f32_16x16x32_bf16 v[80:83], v[196:199], v[196:199], v[80:83]
    v_fmac_f32 v108, v88, v248
    v_fmac_f32 v109, v89, v249
    v_fmac_f32 v110, v90, v250
    v_fmac_f32 v111, v91, v251
    s_add_u32 m0, s31, 66560
    v_or_b32_dpp v14, v37, v3 row_newbcast:4 row_mask:0xf bank_mask:0x3
    v_or_b32_dpp v14, v37, v3 row_newbcast:12 row_mask:0xf bank_mask:0xc
    buffer_load_dwordx4 v14, s[32:35], 0 offen lds
    s_waitcnt lgkmcnt(0)
    s_add_u32 m0, s50, 33280
    v_or_b32_dpp v15, v50, v62 row_newbcast:0 row_mask:0xf bank_mask:0x3
    v_or_b32_dpp v15, v50, v62 row_newbcast:8 row_mask:0xf bank_mask:0xc
    buffer_load_dwordx4 v15, s[32:35], 0 offen lds
    s_add_u32 m0, s50, 34304
    v_or_b32_dpp v12, v50, v63 row_newbcast:1 row_mask:0xf bank_mask:0x3
    v_or_b32_dpp v12, v50, v63 row_newbcast:9 row_mask:0xf bank_mask:0xc
    buffer_load_dwordx4 v12, s[32:35], 0 offen lds
    v_mfma_f32_16x16x32_bf16 v[84:87], v[200:203], v[224:227], 0
    v_mfma_f32_16x16x32_bf16 v[84:87], v[204:207], v[228:231], v[84:87]
    v_fmac_f32 v108, v92, v252
    v_fmac_f32 v109, v93, v253
    v_fmac_f32 v110, v94, v254
    v_fmac_f32 v111, v95, v255
    s_waitcnt vmcnt(4)
    ds_add_u32 v116, v117
    ds_read_b128 v[184:187], v7 offset:35328
    ds_read_b128 v[188:191], v8 offset:35328
    v_mfma_f32_16x16x32_bf16 v[88:91], v[208:211], v[224:227], 0
    v_mfma_f32_16x16x32_bf16 v[88:91], v[212:215], v[228:231], v[88:91]
    v_fmac_f32 v108, v80, v100
    v_fmac_f32 v109, v81, v101
    v_fmac_f32 v110, v82, v102
    v_fmac_f32 v111, v83, v103
    s_add_u32 m0, s31, 67584
    v_or_b32_dpp v13, v41, v2 row_newbcast:4 row_mask:0xf bank_mask:0x3
    v_or_b32_dpp v13, v41, v2 row_newbcast:12 row_mask:0xf bank_mask:0xc
    buffer_load_dwordx4 v13, s[32:35], 0 offen lds
    s_waitcnt lgkmcnt(0)
    s_add_u32 m0, s50, 35840
    v_or_b32_dpp v14, v50, v62 row_newbcast:2 row_mask:0xf bank_mask:0x3
    v_or_b32_dpp v14, v50, v62 row_newbcast:10 row_mask:0xf bank_mask:0xc
    buffer_load_dwordx4 v14, s[32:35], 0 offen lds
    s_add_u32 m0, s50, 36864
    v_or_b32_dpp v15, v50, v63 row_newbcast:3 row_mask:0xf bank_mask:0x3
    v_or_b32_dpp v15, v50, v63 row_newbcast:11 row_mask:0xf bank_mask:0xc
    buffer_load_dwordx4 v15, s[32:35], 0 offen lds
    s_mov_b64 exec, s[44:45]
    v_mov_b64 v[232:233], v[176:177]
    v_mov_b64 v[234:235], v[178:179]
    v_mov_b64 v[236:237], v[180:181]
    v_mov_b64 v[238:239], v[182:183]
    s_mov_b64 exec, -1
    v_mfma_f32_16x16x32_bf16 v[92:95], v[216:219], v[224:227], 0
    v_mfma_f32_16x16x32_bf16 v[92:95], v[220:223], v[228:231], v[92:95]
    v_fmac_f32 v108, v84, v240
    v_fmac_f32 v109, v85, v241
    v_fmac_f32 v110, v86, v242
    v_fmac_f32 v111, v87, v243
    s_add_u32 m0, s31, 68608
    v_or_b32_dpp v12, v45, v3 row_newbcast:4 row_mask:0xf bank_mask:0x3
    v_or_b32_dpp v12, v45, v3 row_newbcast:12 row_mask:0xf bank_mask:0xc
    buffer_load_dwordx4 v12, s[32:35], 0 offen lds
    ds_read_b128 v[192:195], v7 offset:37888
    ds_read_b128 v[196:199], v8 offset:37888
    v_mfma_f32_16x16x32_bf16 v[80:83], v[176:179], v[232:235], 0
    v_mfma_f32_16x16x32_bf16 v[80:83], v[180:183], v[236:239], v[80:83]
    v_fmac_f32 v108, v88, v244
    v_fmac_f32 v109, v89, v245
    v_fmac_f32 v110, v90, v246
    v_fmac_f32 v111, v91, v247
    s_waitcnt lgkmcnt(0)
    s_add_u32 m0, s50, 38400
    v_or_b32_dpp v13, v50, v62 row_newbcast:4 row_mask:0xf bank_mask:0x3
    v_or_b32_dpp v13, v50, v62 row_newbcast:12 row_mask:0xf bank_mask:0xc
    buffer_load_dwordx4 v13, s[32:35], 0 offen lds
    s_add_u32 m0, s50, 39424
    v_or_b32_dpp v14, v50, v63 row_newbcast:5 row_mask:0xf bank_mask:0x3
    v_or_b32_dpp v14, v50, v63 row_newbcast:13 row_mask:0xf bank_mask:0xc
    buffer_load_dwordx4 v14, s[32:35], 0 offen lds
    s_mov_b64 exec, s[44:45]
    v_mov_b64 v[232:233], v[184:185]
    v_mov_b64 v[234:235], v[186:187]
    v_mov_b64 v[236:237], v[188:189]
    v_mov_b64 v[238:239], v[190:191]
    s_mov_b64 exec, -1
    v_mfma_f32_16x16x32_bf16 v[84:87], v[176:179], v[184:187], 0
    v_mfma_f32_16x16x32_bf16 v[84:87], v[180:183], v[188:191], v[84:87]
    v_fmac_f32 v108, v92, v64
    v_fmac_f32 v109, v93, v65
    v_fmac_f32 v110, v94, v66
    v_fmac_f32 v111, v95, v67
    v_add_f32 v112, v108, v109
    v_add_f32 v113, v110, v111
    v_add_f32 v112, v112, v113
    s_nop 1
    v_add_f32_dpp v112, v112, v112 row_shr:1 row_mask:0xf bank_mask:0xf
    s_nop 1
    v_add_f32_dpp v112, v112, v112 row_shr:2 row_mask:0xf bank_mask:0xf
    s_nop 1
    v_add_f32_dpp v112, v112, v112 row_shr:4 row_mask:0xf bank_mask:0xf
    s_nop 1
    v_add_f32_dpp v112, v112, v112 row_shr:8 row_mask:0xf bank_mask:0xf
    s_nop 1
    v_add_f32_dpp v112, v112, v112 row_bcast:15 row_mask:0xa bank_mask:0xf
    s_nop 1
    v_add_f32_dpp v112, v112, v112 row_bcast:31 row_mask:0xc bank_mask:0xf
    s_nop 0
    v_readlane_b32 s63, v112, 63
    v_mfma_f32_16x16x32_bf16 v[88:91], v[184:187], v[232:235], 0
    v_mfma_f32_16x16x32_bf16 v[88:91], v[188:191], v[236:239], v[88:91]
    v_mul_f32 v108, v80, v104
    v_mul_f32 v109, v81, v105
    v_mul_f32 v110, v82, v106
    v_mul_f32 v111, v83, v107
    ds_read_b128 v[200:203], v56 offset:32768
    ds_read_b128 v[204:207], v57 offset:32768
    v_mfma_f32_16x16x32_bf16 v[92:95], v[176:179], v[192:195], 0
    v_mfma_f32_16x16x32_bf16 v[92:95], v[180:183], v[196:199], v[92:95]
    v_fmac_f32 v108, v84, v120
    v_fmac_f32 v109, v85, v121
    v_fmac_f32 v110, v86, v122
    v_fmac_f32 v111, v87, v123
    s_waitcnt lgkmcnt(0)
    s_add_u32 m0, s50, 39936
    v_or_b32_dpp v15, v51, v63 row_newbcast:5 row_mask:0xf bank_mask:0x3
    v_or_b32_dpp v15, v51, v63 row_newbcast:13 row_mask:0xf bank_mask:0xc
    s_mov_b32 exec_lo, 0
    buffer_load_dwordx4 v15, s[32:35], 0 offen lds
    s_mov_b32 exec_lo, -1
    v_lshlrev_b32 v52, 7, v52
    ds_bpermute_b32 v52, v4, v52
    v_lshlrev_b32 v53, 7, v53
    ds_bpermute_b32 v53, v4, v53
    ds_read_b128 v[208:211], v7
    ds_read_b128 v[212:215], v8
    s_mov_b64 exec, s[44:45]
    v_mov_b64 v[232:233], v[192:193]
    v_mov_b64 v[234:235], v[194:195]
    v_mov_b64 v[236:237], v[196:197]
    v_mov_b64 v[238:239], v[198:199]
    s_mov_b64 exec, -1
    v_mfma_f32_16x16x32_bf16 v[80:83], v[184:187], v[192:195], 0
    v_mfma_f32_16x16x32_bf16 v[80:83], v[188:191], v[196:199], v[80:83]
    v_fmac_f32 v108, v88, v124
    v_fmac_f32 v109, v89, v125
    v_fmac_f32 v110, v90, v126
    v_fmac_f32 v111, v91, v127
    s_waitcnt lgkmcnt(0)
    s_add_u32 m0, s50, 512
    v_or_b32_dpp v12, v50, v62 row_newbcast:6 row_mask:0xf bank_mask:0x3
    v_or_b32_dpp v12, v50, v62 row_newbcast:14 row_mask:0xf bank_mask:0xc
    buffer_load_dwordx4 v12, s[32:35], 0 offen lds
    s_add_u32 m0, s50, 1536
    v_or_b32_dpp v13, v50, v63 row_newbcast:7 row_mask:0xf bank_mask:0x3
    v_or_b32_dpp v13, v50, v63 row_newbcast:15 row_mask:0xf bank_mask:0xc
    buffer_load_dwordx4 v13, s[32:35], 0 offen lds
    v_mfma_f32_16x16x32_bf16 v[84:87], v[192:195], v[232:235], 0
    v_mfma_f32_16x16x32_bf16 v[84:87], v[196:199], v[236:239], v[84:87]
    v_fmac_f32 v108, v92, v128
    v_fmac_f32 v109, v93, v129
    v_fmac_f32 v110, v94, v130
    v_fmac_f32 v111, v95, v131
    v_mfma_f32_16x16x32_bf16 v[88:91], v[200:203], v[200:203], 0
    v_mfma_f32_16x16x32_bf16 v[88:91], v[204:207], v[204:207], v[88:91]
    v_fmac_f32 v108, v80, v132
    v_fmac_f32 v109, v81, v133
    v_fmac_f32 v110, v82, v134
    v_fmac_f32 v111, v83, v135
    s_mov_b64 exec, s[44:45]
    v_mov_b64 v[232:233], v[208:209]
    v_mov_b64 v[234:235], v[210:211]
    v_mov_b64 v[236:237], v[212:213]
    v_mov_b64 v[238:239], v[214:215]
    s_mov_b64 exec, -1
    v_mfma_f32_16x16x32_bf16 v[92:95], v[176:179], v[208:211], 0
    v_mfma_f32_16x16x32_bf16 v[92:95], v[180:183], v[212:215], v[92:95]
    v_fmac_f32 v108, v84, v136
    v_fmac_f32 v109, v85, v137
    v_fmac_f32 v110, v86, v138
    v_fmac_f32 v111, v87, v139
    ds_read_b128 v[216:219], v7 offset:2560
    ds_read_b128 v[220:223], v8 offset:2560
    v_mfma_f32_16x16x32_bf16 v[80:83], v[208:211], v[232:235], 0
    v_mfma_f32_16x16x32_bf16 v[80:83], v[212:215], v[236:239], v[80:83]
    v_fmac_f32 v108, v88, v96
    v_fmac_f32 v109, v89, v97
    v_fmac_f32 v110, v90, v98
    v_fmac_f32 v111, v91, v99
    s_waitcnt vmcnt(5)
    ds_add_u32 v116, v117
    s_waitcnt lgkmcnt(1)
    s_add_u32 m0, s50, 3072
    v_or_b32_dpp v14, v51, v62 row_newbcast:0 row_mask:0xf bank_mask:0x3
    v_or_b32_dpp v14, v51, v62 row_newbcast:8 row_mask:0xf bank_mask:0xc
    buffer_load_dwordx4 v14, s[32:35], 0 offen lds
    s_add_u32 m0, s50, 4096
    v_or_b32_dpp v15, v51, v63 row_newbcast:1 row_mask:0xf bank_mask:0x3
    v_or_b32_dpp v15, v51, v63 row_newbcast:9 row_mask:0xf bank_mask:0xc
    buffer_load_dwordx4 v15, s[32:35], 0 offen lds
    buffer_load_dword v54, v11, s[36:39], s40 offen offset:2800
    buffer_load_dword v55, v11, s[36:39], s40 offen offset:3056
    v_mfma_f32_16x16x32_bf16 v[84:87], v[184:187], v[208:211], 0
    v_mfma_f32_16x16x32_bf16 v[84:87], v[188:191], v[212:215], v[84:87]
    v_fmac_f32 v108, v92, v140
    v_fmac_f32 v109, v93, v141
    v_fmac_f32 v110, v94, v142
    v_fmac_f32 v111, v95, v143
    v_mfma_f32_16x16x32_bf16 v[88:91], v[192:195], v[208:211], 0
    v_mfma_f32_16x16x32_bf16 v[88:91], v[196:199], v[212:215], v[88:91]
    v_fmac_f32 v108, v80, v144
    v_fmac_f32 v109, v81, v145
    v_fmac_f32 v110, v82, v146
    v_fmac_f32 v111, v83, v147
    s_mov_b64 exec, s[44:45]
    v_mov_b64 v[232:233], v[216:217]
    v_mov_b64 v[234:235], v[218:219]
    v_mov_b64 v[236:237], v[220:221]
    v_mov_b64 v[238:239], v[222:223]
    s_mov_b64 exec, -1
    v_mfma_f32_16x16x32_bf16 v[92:95], v[176:179], v[216:219], 0
    v_mfma_f32_16x16x32_bf16 v[92:95], v[180:183], v[220:223], v[92:95]
    v_fmac_f32 v108, v84, v148
    v_fmac_f32 v109, v85, v149
    v_fmac_f32 v110, v86, v150
    v_fmac_f32 v111, v87, v151
    v_mfma_f32_16x16x32_bf16 v[80:83], v[216:219], v[232:235], 0
    v_mfma_f32_16x16x32_bf16 v[80:83], v[220:223], v[236:239], v[80:83]
    v_fmac_f32 v108, v88, v152
    v_fmac_f32 v109, v89, v153
    v_fmac_f32 v110, v90, v154
    v_fmac_f32 v111, v91, v155
    ds_read_b128 v[224:227], v7 offset:5120
    ds_read_b128 v[228:231], v8 offset:5120
    v_mfma_f32_16x16x32_bf16 v[84:87], v[184:187], v[216:219], 0
    v_mfma_f32_16x16x32_bf16 v[84:87], v[188:191], v[220:223], v[84:87]
    v_fmac_f32 v108, v92, v156
    v_fmac_f32 v109, v93, v157
    v_fmac_f32 v110, v94, v158
    v_fmac_f32 v111, v95, v159
    s_waitcnt lgkmcnt(0)
    s_add_u32 m0, s50, 5632
    v_or_b32_dpp v12, v51, v62 row_newbcast:2 row_mask:0xf bank_mask:0x3
    v_or_b32_dpp v12, v51, v62 row_newbcast:10 row_mask:0xf bank_mask:0xc
    buffer_load_dwordx4 v12, s[32:35], 0 offen lds
    s_add_u32 m0, s50, 6656
    v_or_b32_dpp v13, v51, v63 row_newbcast:3 row_mask:0xf bank_mask:0x3
    v_or_b32_dpp v13, v51, v63 row_newbcast:11 row_mask:0xf bank_mask:0xc
    buffer_load_dwordx4 v13, s[32:35], 0 offen lds
    v_mfma_f32_16x16x32_bf16 v[88:91], v[192:195], v[216:219], 0
    v_mfma_f32_16x16x32_bf16 v[88:91], v[196:199], v[220:223], v[88:91]
    v_fmac_f32 v108, v80, v160
    v_fmac_f32 v109, v81, v161
    v_fmac_f32 v110, v82, v162
    v_fmac_f32 v111, v83, v163
    v_mfma_f32_16x16x32_bf16 v[92:95], v[208:211], v[216:219], 0
    v_mfma_f32_16x16x32_bf16 v[92:95], v[212:215], v[220:223], v[92:95]
    v_fmac_f32 v108, v84, v164
    v_fmac_f32 v109, v85, v165
    v_fmac_f32 v110, v86, v166
    v_fmac_f32 v111, v87, v167
    ds_read_b128 v[200:203], v56
    ds_read_b128 v[204:207], v57
    s_mov_b64 exec, s[44:45]
    v_mov_b64 v[232:233], v[224:225]
    v_mov_b64 v[234:235], v[226:227]
    v_mov_b64 v[236:237], v[228:229]
    v_mov_b64 v[238:239], v[230:231]
    s_mov_b64 exec, -1
    v_mfma_f32_16x16x32_bf16 v[80:83], v[176:179], v[224:227], 0
    v_mfma_f32_16x16x32_bf16 v[80:83], v[180:183], v[228:231], v[80:83]
    v_fmac_f32 v108, v88, v168
    v_fmac_f32 v109, v89, v169
    v_fmac_f32 v110, v90, v170
    v_fmac_f32 v111, v91, v171
    v_mfma_f32_16x16x32_bf16 v[84:87], v[224:227], v[232:235], 0
    v_mfma_f32_16x16x32_bf16 v[84:87], v[228:231], v[236:239], v[84:87]
    v_fmac_f32 v108, v92, v68
    v_fmac_f32 v109, v93, v69
    v_fmac_f32 v110, v94, v70
    v_fmac_f32 v111, v95, v71
    s_waitcnt vmcnt(8)
    s_mov_b64 exec, s[46:47]
    ds_read_b128 v[232:235], v7 offset:40448
    ds_read_b128 v[236:239], v8 offset:40448
    s_mov_b64 exec, -1
    v_mfma_f32_16x16x32_bf16 v[88:91], v[184:187], v[224:227], 0
    v_mfma_f32_16x16x32_bf16 v[88:91], v[188:191], v[228:231], v[88:91]
    v_fmac_f32 v108, v80, v72
    v_fmac_f32 v109, v81, v73
    v_fmac_f32 v110, v82, v74
    v_fmac_f32 v111, v83, v75
    ds_read_b128 v[176:179], v9 offset:32768
    ds_read_b128 v[180:183], v10 offset:32768
    s_waitcnt lgkmcnt(5)
    v_mfma_f32_16x16x32_bf16 v[92:95], v[200:203], v[200:203], 0
    s_waitcnt lgkmcnt(4)
    v_mfma_f32_16x16x32_bf16 v[92:95], v[204:207], v[204:207], v[92:95]
    v_fmac_f32 v108, v84, v248
    v_fmac_f32 v109, v85, v249
    v_fmac_f32 v110, v86, v250
    v_fmac_f32 v111, v87, v251
    s_waitcnt lgkmcnt(0)
    s_add_u32 m0, s50, 32768
    v_or_b32_dpp v14, v52, v2 row_newbcast:0 row_mask:0xf bank_mask:0x3
    v_or_b32_dpp v14, v52, v2 row_newbcast:8 row_mask:0xf bank_mask:0xc
    buffer_load_dwordx4 v14, s[32:35], 0 offen lds
    s_add_u32 m0, s50, 33792
    v_or_b32_dpp v15, v52, v3 row_newbcast:1 row_mask:0xf bank_mask:0x3
    v_or_b32_dpp v15, v52, v3 row_newbcast:9 row_mask:0xf bank_mask:0xc
    buffer_load_dwordx4 v15, s[32:35], 0 offen lds
    v_mfma_f32_16x16x32_bf16 v[80:83], v[192:195], v[224:227], 0
    v_mfma_f32_16x16x32_bf16 v[80:83], v[196:199], v[228:231], v[80:83]
    v_fmac_f32 v108, v88, v252
    v_fmac_f32 v109, v89, v253
    v_fmac_f32 v110, v90, v254
    v_fmac_f32 v111, v91, v255
    ds_read_b128 v[184:187], v9 offset:35328
    ds_read_b128 v[188:191], v10 offset:35328
    v_mfma_f32_16x16x32_bf16 v[84:87], v[208:211], v[224:227], 0
    v_mfma_f32_16x16x32_bf16 v[84:87], v[212:215], v[228:231], v[84:87]
    v_fmac_f32 v108, v92, v100
    v_fmac_f32 v109, v93, v101
    v_fmac_f32 v110, v94, v102
    v_fmac_f32 v111, v95, v103
    s_waitcnt lgkmcnt(0)
    s_add_u32 m0, s50, 35328
    v_or_b32_dpp v12, v52, v2 row_newbcast:2 row_mask:0xf bank_mask:0x3
    v_or_b32_dpp v12, v52, v2 row_newbcast:10 row_mask:0xf bank_mask:0xc
    buffer_load_dwordx4 v12, s[32:35], 0 offen lds
    s_add_u32 m0, s50, 36352
    v_or_b32_dpp v13, v52, v3 row_newbcast:3 row_mask:0xf bank_mask:0x3
    v_or_b32_dpp v13, v52, v3 row_newbcast:11 row_mask:0xf bank_mask:0xc
    buffer_load_dwordx4 v13, s[32:35], 0 offen lds
    s_mov_b64 exec, s[44:45]
    v_mov_b64 v[232:233], v[176:177]
    v_mov_b64 v[234:235], v[178:179]
    v_mov_b64 v[236:237], v[180:181]
    v_mov_b64 v[238:239], v[182:183]
    s_mov_b64 exec, -1
    v_mfma_f32_16x16x32_bf16 v[88:91], v[216:219], v[224:227], 0
    v_mfma_f32_16x16x32_bf16 v[88:91], v[220:223], v[228:231], v[88:91]
    v_fmac_f32 v108, v80, v240
    v_fmac_f32 v109, v81, v241
    v_fmac_f32 v110, v82, v242
    v_fmac_f32 v111, v83, v243
    ds_read_b128 v[200:203], v9 offset:37888
    ds_read_b128 v[204:207], v10 offset:37888
    v_mfma_f32_16x16x32_bf16 v[92:95], v[176:179], v[232:235], 0
    v_mfma_f32_16x16x32_bf16 v[92:95], v[180:183], v[236:239], v[92:95]
    v_fmac_f32 v108, v84, v244
    v_fmac_f32 v109, v85, v245
    v_fmac_f32 v110, v86, v246
    v_fmac_f32 v111, v87, v247
    s_waitcnt lgkmcnt(0)
    s_add_u32 m0, s50, 37888
    v_or_b32_dpp v14, v52, v2 row_newbcast:4 row_mask:0xf bank_mask:0x3
    v_or_b32_dpp v14, v52, v2 row_newbcast:12 row_mask:0xf bank_mask:0xc
    buffer_load_dwordx4 v14, s[32:35], 0 offen lds
    s_add_u32 m0, s50, 38912
    v_or_b32_dpp v15, v52, v3 row_newbcast:5 row_mask:0xf bank_mask:0x3
    v_or_b32_dpp v15, v52, v3 row_newbcast:13 row_mask:0xf bank_mask:0xc
    buffer_load_dwordx4 v15, s[32:35], 0 offen lds
    s_mov_b64 exec, s[44:45]
    v_mov_b64 v[232:233], v[184:185]
    v_mov_b64 v[234:235], v[186:187]
    v_mov_b64 v[236:237], v[188:189]
    v_mov_b64 v[238:239], v[190:191]
    s_mov_b64 exec, -1
    v_mfma_f32_16x16x32_bf16 v[80:83], v[176:179], v[184:187], 0
    v_mfma_f32_16x16x32_bf16 v[80:83], v[180:183], v[188:191], v[80:83]
    v_fmac_f32 v108, v88, v64
    v_fmac_f32 v109, v89, v65
    v_fmac_f32 v110, v90, v66
    v_fmac_f32 v111, v91, v67
    v_add_f32 v112, v108, v109
    v_add_f32 v113, v110, v111
    v_add_f32 v112, v112, v113
    s_nop 1
    v_add_f32_dpp v112, v112, v112 row_shr:1 row_mask:0xf bank_mask:0xf
    s_nop 1
    v_add_f32_dpp v112, v112, v112 row_shr:2 row_mask:0xf bank_mask:0xf
    s_nop 1
    v_add_f32_dpp v112, v112, v112 row_shr:4 row_mask:0xf bank_mask:0xf
    s_nop 1
    v_add_f32_dpp v112, v112, v112 row_shr:8 row_mask:0xf bank_mask:0xf
    s_nop 1
    v_add_f32_dpp v112, v112, v112 row_bcast:15 row_mask:0xa bank_mask:0xf
    s_nop 1
    v_add_f32_dpp v112, v112, v112 row_bcast:31 row_mask:0xc bank_mask:0xf
    s_nop 0
    v_readlane_b32 s64, v112, 63
    v_mfma_f32_16x16x32_bf16 v[84:87], v[184:187], v[232:235], 0
    v_mfma_f32_16x16x32_bf16 v[84:87], v[188:191], v[236:239], v[84:87]
    v_mul_f32 v108, v92, v104
    v_mul_f32 v109, v93, v105
    v_mul_f32 v110, v94, v106
    v_mul_f32 v111, v95, v107
    ds_read_b128 v[192:195], v58 offset:32768
    ds_read_b128 v[196:199], v59 offset:32768
    v_mfma_f32_16x16x32_bf16 v[88:91], v[176:179], v[200:203], 0
    v_mfma_f32_16x16x32_bf16 v[88:91], v[180:183], v[204:207], v[88:91]
    v_fmac_f32 v108, v80, v120
    v_fmac_f32 v109, v81, v121
    v_fmac_f32 v110, v82, v122
    v_fmac_f32 v111, v83, v123
    s_waitcnt lgkmcnt(0)
    s_add_u32 m0, s50, 40448
    v_or_b32_dpp v12, v53, v2 row_newbcast:4 row_mask:0xf bank_mask:0x3
    v_or_b32_dpp v12, v53, v2 row_newbcast:12 row_mask:0xf bank_mask:0xc
    s_mov_b32 exec_hi, 0
    buffer_load_dwordx4 v12, s[32:35], 0 offen lds
    s_mov_b32 exec_hi, -1
    s_waitcnt vmcnt(10)
    v_lshlrev_b32 v54, 7, v54
    ds_bpermute_b32 v54, v61, v54
    s_waitcnt vmcnt(9)
    v_lshlrev_b32 v55, 7, v55
    ds_bpermute_b32 v55, v61, v55
    ds_read_b128 v[208:211], v9
    ds_read_b128 v[212:215], v10
    s_mov_b64 exec, s[44:45]
    v_mov_b64 v[232:233], v[200:201]
    v_mov_b64 v[234:235], v[202:203]
    v_mov_b64 v[236:237], v[204:205]
    v_mov_b64 v[238:239], v[206:207]
    s_mov_b64 exec, -1
    v_mfma_f32_16x16x32_bf16 v[92:95], v[184:187], v[200:203], 0
    v_mfma_f32_16x16x32_bf16 v[92:95], v[188:191], v[204:207], v[92:95]
    v_fmac_f32 v108, v84, v124
    v_fmac_f32 v109, v85, v125
    v_fmac_f32 v110, v86, v126
    v_fmac_f32 v111, v87, v127
    s_waitcnt lgkmcnt(0)
    s_add_u32 m0, s50, 0
    v_or_b32_dpp v13, v52, v2 row_newbcast:6 row_mask:0xf bank_mask:0x3
    v_or_b32_dpp v13, v52, v2 row_newbcast:14 row_mask:0xf bank_mask:0xc
    buffer_load_dwordx4 v13, s[32:35], 0 offen lds
    s_add_u32 m0, s50, 1024
    v_or_b32_dpp v14, v52, v3 row_newbcast:7 row_mask:0xf bank_mask:0x3
    v_or_b32_dpp v14, v52, v3 row_newbcast:15 row_mask:0xf bank_mask:0xc
    buffer_load_dwordx4 v14, s[32:35], 0 offen lds
    v_mfma_f32_16x16x32_bf16 v[80:83], v[200:203], v[232:235], 0
    v_mfma_f32_16x16x32_bf16 v[80:83], v[204:207], v[236:239], v[80:83]
    v_fmac_f32 v108, v88, v128
    v_fmac_f32 v109, v89, v129
    v_fmac_f32 v110, v90, v130
    v_fmac_f32 v111, v91, v131
    v_mfma_f32_16x16x32_bf16 v[84:87], v[192:195], v[192:195], 0
    v_mfma_f32_16x16x32_bf16 v[84:87], v[196:199], v[196:199], v[84:87]
    v_fmac_f32 v108, v92, v132
    v_fmac_f32 v109, v93, v133
    v_fmac_f32 v110, v94, v134
    v_fmac_f32 v111, v95, v135
    s_mov_b64 exec, s[44:45]
    v_mov_b64 v[232:233], v[208:209]
    v_mov_b64 v[234:235], v[210:211]
    v_mov_b64 v[236:237], v[212:213]
    v_mov_b64 v[238:239], v[214:215]
    s_mov_b64 exec, -1
    v_mfma_f32_16x16x32_bf16 v[88:91], v[176:179], v[208:211], 0
    v_mfma_f32_16x16x32_bf16 v[88:91], v[180:183], v[212:215], v[88:91]
    v_fmac_f32 v108, v80, v136
    v_fmac_f32 v109, v81, v137
    v_fmac_f32 v110, v82, v138
    v_fmac_f32 v111, v83, v139
    ds_read_b128 v[216:219], v9 offset:2560
    ds_read_b128 v[220:223], v10 offset:2560
    v_mfma_f32_16x16x32_bf16 v[92:95], v[208:211], v[232:235], 0
    v_mfma_f32_16x16x32_bf16 v[92:95], v[212:215], v[236:239], v[92:95]
    v_fmac_f32 v108, v84, v96
    v_fmac_f32 v109, v85, v97
    v_fmac_f32 v110, v86, v98
    v_fmac_f32 v111, v87, v99
    s_waitcnt lgkmcnt(0)
    s_add_u32 m0, s50, 2560
    v_or_b32_dpp v15, v53, v2 row_newbcast:0 row_mask:0xf bank_mask:0x3
    v_or_b32_dpp v15, v53, v2 row_newbcast:8 row_mask:0xf bank_mask:0xc
    buffer_load_dwordx4 v15, s[32:35], 0 offen lds
    s_add_u32 m0, s50, 3584
    v_or_b32_dpp v12, v53, v3 row_newbcast:1 row_mask:0xf bank_mask:0x3
    v_or_b32_dpp v12, v53, v3 row_newbcast:9 row_mask:0xf bank_mask:0xc
    buffer_load_dwordx4 v12, s[32:35], 0 offen lds
    v_mfma_f32_16x16x32_bf16 v[80:83], v[184:187], v[208:211], 0
    v_mfma_f32_16x16x32_bf16 v[80:83], v[188:191], v[212:215], v[80:83]
    v_fmac_f32 v108, v88, v140
    v_fmac_f32 v109, v89, v141
    v_fmac_f32 v110, v90, v142
    v_fmac_f32 v111, v91, v143
    v_mfma_f32_16x16x32_bf16 v[84:87], v[200:203], v[208:211], 0
    v_mfma_f32_16x16x32_bf16 v[84:87], v[204:207], v[212:215], v[84:87]
    v_fmac_f32 v108, v92, v144
    v_fmac_f32 v109, v93, v145
    v_fmac_f32 v110, v94, v146
    v_fmac_f32 v111, v95, v147
    s_mov_b64 exec, s[44:45]
    v_mov_b64 v[232:233], v[216:217]
    v_mov_b64 v[234:235], v[218:219]
    v_mov_b64 v[236:237], v[220:221]
    v_mov_b64 v[238:239], v[222:223]
    s_mov_b64 exec, -1
    v_mfma_f32_16x16x32_bf16 v[88:91], v[176:179], v[216:219], 0
    v_mfma_f32_16x16x32_bf16 v[88:91], v[180:183], v[220:223], v[88:91]
    v_fmac_f32 v108, v80, v148
    v_fmac_f32 v109, v81, v149
    v_fmac_f32 v110, v82, v150
    v_fmac_f32 v111, v83, v151
    v_mfma_f32_16x16x32_bf16 v[92:95], v[216:219], v[232:235], 0
    v_mfma_f32_16x16x32_bf16 v[92:95], v[220:223], v[236:239], v[92:95]
    v_fmac_f32 v108, v84, v152
    v_fmac_f32 v109, v85, v153
    v_fmac_f32 v110, v86, v154
    v_fmac_f32 v111, v87, v155
    s_waitcnt vmcnt(11)
    ds_read_b128 v[224:227], v9 offset:5120
    ds_read_b128 v[228:231], v10 offset:5120
    v_mfma_f32_16x16x32_bf16 v[80:83], v[184:187], v[216:219], 0
    v_mfma_f32_16x16x32_bf16 v[80:83], v[188:191], v[220:223], v[80:83]
    v_fmac_f32 v108, v88, v156
    v_fmac_f32 v109, v89, v157
    v_fmac_f32 v110, v90, v158
    v_fmac_f32 v111, v91, v159
    s_waitcnt lgkmcnt(0)
    s_add_u32 m0, s50, 5120
    v_or_b32_dpp v13, v53, v2 row_newbcast:2 row_mask:0xf bank_mask:0x3
    v_or_b32_dpp v13, v53, v2 row_newbcast:10 row_mask:0xf bank_mask:0xc
    buffer_load_dwordx4 v13, s[32:35], 0 offen lds
    s_add_u32 m0, s50, 6144
    v_or_b32_dpp v14, v53, v3 row_newbcast:3 row_mask:0xf bank_mask:0x3
    v_or_b32_dpp v14, v53, v3 row_newbcast:11 row_mask:0xf bank_mask:0xc
    buffer_load_dwordx4 v14, s[32:35], 0 offen lds
    v_mfma_f32_16x16x32_bf16 v[84:87], v[200:203], v[216:219], 0
    v_mfma_f32_16x16x32_bf16 v[84:87], v[204:207], v[220:223], v[84:87]
    v_fmac_f32 v108, v92, v160
    v_fmac_f32 v109, v93, v161
    v_fmac_f32 v110, v94, v162
    v_fmac_f32 v111, v95, v163
    v_mfma_f32_16x16x32_bf16 v[88:91], v[208:211], v[216:219], 0
    v_mfma_f32_16x16x32_bf16 v[88:91], v[212:215], v[220:223], v[88:91]
    v_fmac_f32 v108, v80, v164
    v_fmac_f32 v109, v81, v165
    v_fmac_f32 v110, v82, v166
    v_fmac_f32 v111, v83, v167
    ds_read_b128 v[192:195], v58
    ds_read_b128 v[196:199], v59
    s_mov_b64 exec, s[44:45]
    v_mov_b64 v[232:233], v[224:225]
    v_mov_b64 v[234:235], v[226:227]
    v_mov_b64 v[236:237], v[228:229]
    v_mov_b64 v[238:239], v[230:231]
    s_mov_b64 exec, -1
    v_mfma_f32_16x16x32_bf16 v[92:95], v[176:179], v[224:227], 0
    v_mfma_f32_16x16x32_bf16 v[92:95], v[180:183], v[228:231], v[92:95]
    v_fmac_f32 v108, v84, v168
    v_fmac_f32 v109, v85, v169
    v_fmac_f32 v110, v86, v170
    v_fmac_f32 v111, v87, v171
    v_mfma_f32_16x16x32_bf16 v[80:83], v[224:227], v[232:235], 0
    v_mfma_f32_16x16x32_bf16 v[80:83], v[228:231], v[236:239], v[80:83]
    v_fmac_f32 v108, v88, v68
    v_fmac_f32 v109, v89, v69
    v_fmac_f32 v110, v90, v70
    v_fmac_f32 v111, v91, v71
    s_waitcnt vmcnt(6)
    s_mov_b64 exec, s[46:47]
    ds_read_b128 v[232:235], v7 offset:40448
    ds_read_b128 v[236:239], v8 offset:40448
    s_mov_b64 exec, -1
    v_mfma_f32_16x16x32_bf16 v[84:87], v[184:187], v[224:227], 0
    v_mfma_f32_16x16x32_bf16 v[84:87], v[188:191], v[228:231], v[84:87]
    v_fmac_f32 v108, v92, v72
    v_fmac_f32 v109, v93, v73
    v_fmac_f32 v110, v94, v74
    v_fmac_f32 v111, v95, v75
    ds_read_b128 v[176:179], v7 offset:32768
    ds_read_b128 v[180:183], v8 offset:32768
    s_waitcnt lgkmcnt(5)
    v_mfma_f32_16x16x32_bf16 v[88:91], v[192:195], v[192:195], 0
    s_waitcnt lgkmcnt(4)
    v_mfma_f32_16x16x32_bf16 v[88:91], v[196:199], v[196:199], v[88:91]
    v_fmac_f32 v108, v80, v248
    v_fmac_f32 v109, v81, v249
    v_fmac_f32 v110, v82, v250
    v_fmac_f32 v111, v83, v251
    s_waitcnt lgkmcnt(0)
    s_add_u32 m0, s50, 33280
    v_or_b32_dpp v15, v54, v62 row_newbcast:0 row_mask:0xf bank_mask:0x3
    v_or_b32_dpp v15, v54, v62 row_newbcast:8 row_mask:0xf bank_mask:0xc
    buffer_load_dwordx4 v15, s[32:35], 0 offen lds
    s_add_u32 m0, s50, 34304
    v_or_b32_dpp v12, v54, v63 row_newbcast:1 row_mask:0xf bank_mask:0x3
    v_or_b32_dpp v12, v54, v63 row_newbcast:9 row_mask:0xf bank_mask:0xc
    buffer_load_dwordx4 v12, s[32:35], 0 offen lds
    v_mfma_f32_16x16x32_bf16 v[92:95], v[200:203], v[224:227], 0
    v_mfma_f32_16x16x32_bf16 v[92:95], v[204:207], v[228:231], v[92:95]
    v_fmac_f32 v108, v84, v252
    v_fmac_f32 v109, v85, v253
    v_fmac_f32 v110, v86, v254
    v_fmac_f32 v111, v87, v255
    ds_read_b128 v[184:187], v7 offset:35328
    ds_read_b128 v[188:191], v8 offset:35328
    v_mfma_f32_16x16x32_bf16 v[80:83], v[208:211], v[224:227], 0
    v_mfma_f32_16x16x32_bf16 v[80:83], v[212:215], v[228:231], v[80:83]
    v_fmac_f32 v108, v88, v100
    v_fmac_f32 v109, v89, v101
    v_fmac_f32 v110, v90, v102
    v_fmac_f32 v111, v91, v103
    s_waitcnt lgkmcnt(0)
    s_add_u32 m0, s50, 35840
    v_or_b32_dpp v13, v54, v62 row_newbcast:2 row_mask:0xf bank_mask:0x3
    v_or_b32_dpp v13, v54, v62 row_newbcast:10 row_mask:0xf bank_mask:0xc
    buffer_load_dwordx4 v13, s[32:35], 0 offen lds
    s_add_u32 m0, s50, 36864
    v_or_b32_dpp v14, v54, v63 row_newbcast:3 row_mask:0xf bank_mask:0x3
    v_or_b32_dpp v14, v54, v63 row_newbcast:11 row_mask:0xf bank_mask:0xc
    buffer_load_dwordx4 v14, s[32:35], 0 offen lds
    s_mov_b64 exec, s[44:45]
    v_mov_b64 v[232:233], v[176:177]
    v_mov_b64 v[234:235], v[178:179]
    v_mov_b64 v[236:237], v[180:181]
    v_mov_b64 v[238:239], v[182:183]
    s_mov_b64 exec, -1
    v_mfma_f32_16x16x32_bf16 v[84:87], v[216:219], v[224:227], 0
    v_mfma_f32_16x16x32_bf16 v[84:87], v[220:223], v[228:231], v[84:87]
    v_fmac_f32 v108, v92, v240
    v_fmac_f32 v109, v93, v241
    v_fmac_f32 v110, v94, v242
    v_fmac_f32 v111, v95, v243
    ds_read_b128 v[192:195], v7 offset:37888
    ds_read_b128 v[196:199], v8 offset:37888
    v_mfma_f32_16x16x32_bf16 v[88:91], v[176:179], v[232:235], 0
    v_mfma_f32_16x16x32_bf16 v[88:91], v[180:183], v[236:239], v[88:91]
    v_fmac_f32 v108, v80, v244
    v_fmac_f32 v109, v81, v245
    v_fmac_f32 v110, v82, v246
    v_fmac_f32 v111, v83, v247
    s_waitcnt lgkmcnt(0)
    s_add_u32 m0, s50, 38400
    v_or_b32_dpp v15, v54, v62 row_newbcast:4 row_mask:0xf bank_mask:0x3
    v_or_b32_dpp v15, v54, v62 row_newbcast:12 row_mask:0xf bank_mask:0xc
    buffer_load_dwordx4 v15, s[32:35], 0 offen lds
    s_add_u32 m0, s50, 39424
    v_or_b32_dpp v12, v54, v63 row_newbcast:5 row_mask:0xf bank_mask:0x3
    v_or_b32_dpp v12, v54, v63 row_newbcast:13 row_mask:0xf bank_mask:0xc
    buffer_load_dwordx4 v12, s[32:35], 0 offen lds
    s_mov_b64 exec, s[44:45]
    v_mov_b64 v[232:233], v[184:185]
    v_mov_b64 v[234:235], v[186:187]
    v_mov_b64 v[236:237], v[188:189]
    v_mov_b64 v[238:239], v[190:191]
    s_mov_b64 exec, -1
    v_mfma_f32_16x16x32_bf16 v[92:95], v[176:179], v[184:187], 0
    v_mfma_f32_16x16x32_bf16 v[92:95], v[180:183], v[188:191], v[92:95]
    v_fmac_f32 v108, v84, v64
    v_fmac_f32 v109, v85, v65
    v_fmac_f32 v110, v86, v66
    v_fmac_f32 v111, v87, v67
    v_add_f32 v112, v108, v109
    v_add_f32 v113, v110, v111
    v_add_f32 v112, v112, v113
    s_nop 1
    v_add_f32_dpp v112, v112, v112 row_shr:1 row_mask:0xf bank_mask:0xf
    s_nop 1
    v_add_f32_dpp v112, v112, v112 row_shr:2 row_mask:0xf bank_mask:0xf
    s_nop 1
    v_add_f32_dpp v112, v112, v112 row_shr:4 row_mask:0xf bank_mask:0xf
    s_nop 1
    v_add_f32_dpp v112, v112, v112 row_shr:8 row_mask:0xf bank_mask:0xf
    s_nop 1
    v_add_f32_dpp v112, v112, v112 row_bcast:15 row_mask:0xa bank_mask:0xf
    s_nop 1
    v_add_f32_dpp v112, v112, v112 row_bcast:31 row_mask:0xc bank_mask:0xf
    s_nop 0
    v_readlane_b32 s65, v112, 63
    v_mfma_f32_16x16x32_bf16 v[80:83], v[184:187], v[232:235], 0
    v_mfma_f32_16x16x32_bf16 v[80:83], v[188:191], v[236:239], v[80:83]
    v_mul_f32 v108, v88, v104
    v_mul_f32 v109, v89, v105
    v_mul_f32 v110, v90, v106
    v_mul_f32 v111, v91, v107
    ds_read_b128 v[200:203], v56 offset:32768
    ds_read_b128 v[204:207], v57 offset:32768
    v_mfma_f32_16x16x32_bf16 v[84:87], v[176:179], v[192:195], 0
    v_mfma_f32_16x16x32_bf16 v[84:87], v[180:183], v[196:199], v[84:87]
    v_fmac_f32 v108, v92, v120
    v_fmac_f32 v109, v93, v121
    v_fmac_f32 v110, v94, v122
    v_fmac_f32 v111, v95, v123
    s_waitcnt lgkmcnt(0)
    s_add_u32 m0, s50, 39936
    v_or_b32_dpp v13, v55, v63 row_newbcast:5 row_mask:0xf bank_mask:0x3
    v_or_b32_dpp v13, v55, v63 row_newbcast:13 row_mask:0xf bank_mask:0xc
    s_mov_b32 exec_lo, 0
    buffer_load_dwordx4 v13, s[32:35], 0 offen lds
    s_mov_b32 exec_lo, -1
    s_waitcnt vmcnt(11)
    ds_read_b128 v[208:211], v7
    ds_read_b128 v[212:215], v8
    s_mov_b64 exec, s[44:45]
    v_mov_b64 v[232:233], v[192:193]
    v_mov_b64 v[234:235], v[194:195]
    v_mov_b64 v[236:237], v[196:197]
    v_mov_b64 v[238:239], v[198:199]
    s_mov_b64 exec, -1
    v_mfma_f32_16x16x32_bf16 v[88:91], v[184:187], v[192:195], 0
    v_mfma_f32_16x16x32_bf16 v[88:91], v[188:191], v[196:199], v[88:91]
    v_fmac_f32 v108, v80, v124
    v_fmac_f32 v109, v81, v125
    v_fmac_f32 v110, v82, v126
    v_fmac_f32 v111, v83, v127
    s_waitcnt lgkmcnt(0)
    s_add_u32 m0, s50, 512
    v_or_b32_dpp v14, v54, v62 row_newbcast:6 row_mask:0xf bank_mask:0x3
    v_or_b32_dpp v14, v54, v62 row_newbcast:14 row_mask:0xf bank_mask:0xc
    buffer_load_dwordx4 v14, s[32:35], 0 offen lds
    s_add_u32 m0, s50, 1536
    v_or_b32_dpp v15, v54, v63 row_newbcast:7 row_mask:0xf bank_mask:0x3
    v_or_b32_dpp v15, v54, v63 row_newbcast:15 row_mask:0xf bank_mask:0xc
    buffer_load_dwordx4 v15, s[32:35], 0 offen lds
    v_mfma_f32_16x16x32_bf16 v[92:95], v[192:195], v[232:235], 0
    v_mfma_f32_16x16x32_bf16 v[92:95], v[196:199], v[236:239], v[92:95]
    v_fmac_f32 v108, v84, v128
    v_fmac_f32 v109, v85, v129
    v_fmac_f32 v110, v86, v130
    v_fmac_f32 v111, v87, v131
    v_mfma_f32_16x16x32_bf16 v[80:83], v[200:203], v[200:203], 0
    v_mfma_f32_16x16x32_bf16 v[80:83], v[204:207], v[204:207], v[80:83]
    v_fmac_f32 v108, v88, v132
    v_fmac_f32 v109, v89, v133
    v_fmac_f32 v110, v90, v134
    v_fmac_f32 v111, v91, v135
    s_mov_b64 exec, s[44:45]
    v_mov_b64 v[232:233], v[208:209]
    v_mov_b64 v[234:235], v[210:211]
    v_mov_b64 v[236:237], v[212:213]
    v_mov_b64 v[238:239], v[214:215]
    s_mov_b64 exec, -1
    v_mfma_f32_16x16x32_bf16 v[84:87], v[176:179], v[208:211], 0
    v_mfma_f32_16x16x32_bf16 v[84:87], v[180:183], v[212:215], v[84:87]
    v_fmac_f32 v108, v92, v136
    v_fmac_f32 v109, v93, v137
    v_fmac_f32 v110, v94, v138
    v_fmac_f32 v111, v95, v139
    s_waitcnt vmcnt(11)
    ds_read_b128 v[216:219], v7 offset:2560
    ds_read_b128 v[220:223], v8 offset:2560
    v_mfma_f32_16x16x32_bf16 v[88:91], v[208:211], v[232:235], 0
    v_mfma_f32_16x16x32_bf16 v[88:91], v[212:215], v[236:239], v[88:91]
    v_fmac_f32 v108, v80, v96
    v_fmac_f32 v109, v81, v97
    v_fmac_f32 v110, v82, v98
    v_fmac_f32 v111, v83, v99
    s_waitcnt lgkmcnt(0)
    s_add_u32 m0, s50, 3072
    v_or_b32_dpp v12, v55, v62 row_newbcast:0 row_mask:0xf bank_mask:0x3
    v_or_b32_dpp v12, v55, v62 row_newbcast:8 row_mask:0xf bank_mask:0xc
    buffer_load_dwordx4 v12, s[32:35], 0 offen lds
    s_add_u32 m0, s50, 4096
    v_or_b32_dpp v13, v55, v63 row_newbcast:1 row_mask:0xf bank_mask:0x3
    v_or_b32_dpp v13, v55, v63 row_newbcast:9 row_mask:0xf bank_mask:0xc
    buffer_load_dwordx4 v13, s[32:35], 0 offen lds
    v_mfma_f32_16x16x32_bf16 v[92:95], v[184:187], v[208:211], 0
    v_mfma_f32_16x16x32_bf16 v[92:95], v[188:191], v[212:215], v[92:95]
    v_fmac_f32 v108, v84, v140
    v_fmac_f32 v109, v85, v141
    v_fmac_f32 v110, v86, v142
    v_fmac_f32 v111, v87, v143
    v_mfma_f32_16x16x32_bf16 v[80:83], v[192:195], v[208:211], 0
    v_mfma_f32_16x16x32_bf16 v[80:83], v[196:199], v[212:215], v[80:83]
    v_fmac_f32 v108, v88, v144
    v_fmac_f32 v109, v89, v145
    v_fmac_f32 v110, v90, v146
    v_fmac_f32 v111, v91, v147
    s_mov_b64 exec, s[44:45]
    v_mov_b64 v[232:233], v[216:217]
    v_mov_b64 v[234:235], v[218:219]
    v_mov_b64 v[236:237], v[220:221]
    v_mov_b64 v[238:239], v[222:223]
    s_mov_b64 exec, -1
    v_mfma_f32_16x16x32_bf16 v[84:87], v[176:179], v[216:219], 0
    v_mfma_f32_16x16x32_bf16 v[84:87], v[180:183], v[220:223], v[84:87]
    v_fmac_f32 v108, v92, v148
    v_fmac_f32 v109, v93, v149
    v_fmac_f32 v110, v94, v150
    v_fmac_f32 v111, v95, v151
    v_mfma_f32_16x16x32_bf16 v[88:91], v[216:219], v[232:235], 0
    v_mfma_f32_16x16x32_bf16 v[88:91], v[220:223], v[236:239], v[88:91]
    v_fmac_f32 v108, v80, v152
    v_fmac_f32 v109, v81, v153
    v_fmac_f32 v110, v82, v154
    v_fmac_f32 v111, v83, v155
    s_waitcnt vmcnt(11)
    ds_read_b128 v[224:227], v7 offset:5120
    ds_read_b128 v[228:231], v8 offset:5120
    v_mfma_f32_16x16x32_bf16 v[92:95], v[184:187], v[216:219], 0
    v_mfma_f32_16x16x32_bf16 v[92:95], v[188:191], v[220:223], v[92:95]
    v_fmac_f32 v108, v84, v156
    v_fmac_f32 v109, v85, v157
    v_fmac_f32 v110, v86, v158
    v_fmac_f32 v111, v87, v159
    s_waitcnt lgkmcnt(0)
    s_add_u32 m0, s50, 5632
    v_or_b32_dpp v14, v55, v62 row_newbcast:2 row_mask:0xf bank_mask:0x3
    v_or_b32_dpp v14, v55, v62 row_newbcast:10 row_mask:0xf bank_mask:0xc
    buffer_load_dwordx4 v14, s[32:35], 0 offen lds
    s_add_u32 m0, s50, 6656
    v_or_b32_dpp v15, v55, v63 row_newbcast:3 row_mask:0xf bank_mask:0x3
    v_or_b32_dpp v15, v55, v63 row_newbcast:11 row_mask:0xf bank_mask:0xc
    buffer_load_dwordx4 v15, s[32:35], 0 offen lds
    v_mfma_f32_16x16x32_bf16 v[80:83], v[192:195], v[216:219], 0
    v_mfma_f32_16x16x32_bf16 v[80:83], v[196:199], v[220:223], v[80:83]
    v_fmac_f32 v108, v88, v160
    v_fmac_f32 v109, v89, v161
    v_fmac_f32 v110, v90, v162
    v_fmac_f32 v111, v91, v163
    v_mfma_f32_16x16x32_bf16 v[84:87], v[208:211], v[216:219], 0
    v_mfma_f32_16x16x32_bf16 v[84:87], v[212:215], v[220:223], v[84:87]
    v_fmac_f32 v108, v92, v164
    v_fmac_f32 v109, v93, v165
    v_fmac_f32 v110, v94, v166
    v_fmac_f32 v111, v95, v167
    ds_read_b128 v[200:203], v56
    ds_read_b128 v[204:207], v57
    s_mov_b64 exec, s[44:45]
    v_mov_b64 v[232:233], v[224:225]
    v_mov_b64 v[234:235], v[226:227]
    v_mov_b64 v[236:237], v[228:229]
    v_mov_b64 v[238:239], v[230:231]
    s_mov_b64 exec, -1
    v_mfma_f32_16x16x32_bf16 v[88:91], v[176:179], v[224:227], 0
    v_mfma_f32_16x16x32_bf16 v[88:91], v[180:183], v[228:231], v[88:91]
    v_fmac_f32 v108, v80, v168
    v_fmac_f32 v109, v81, v169
    v_fmac_f32 v110, v82, v170
    v_fmac_f32 v111, v83, v171
    v_mfma_f32_16x16x32_bf16 v[92:95], v[224:227], v[232:235], 0
    v_mfma_f32_16x16x32_bf16 v[92:95], v[228:231], v[236:239], v[92:95]
    v_fmac_f32 v108, v84, v68
    v_fmac_f32 v109, v85, v69
    v_fmac_f32 v110, v86, v70
    v_fmac_f32 v111, v87, v71
    s_waitcnt vmcnt(6)
    s_mov_b64 exec, s[46:47]
    ds_read_b128 v[232:235], v7 offset:40448
    ds_read_b128 v[236:239], v8 offset:40448
    s_mov_b64 exec, -1
    v_mfma_f32_16x16x32_bf16 v[80:83], v[184:187], v[224:227], 0
    v_mfma_f32_16x16x32_bf16 v[80:83], v[188:191], v[228:231], v[80:83]
    v_fmac_f32 v108, v88, v72
    v_fmac_f32 v109, v89, v73
    v_fmac_f32 v110, v90, v74
    v_fmac_f32 v111, v91, v75
    ds_read_b128 v[176:179], v9 offset:32768
    ds_read_b128 v[180:183], v10 offset:32768
    s_waitcnt lgkmcnt(5)
    v_mfma_f32_16x16x32_bf16 v[84:87], v[200:203], v[200:203], 0
    s_waitcnt lgkmcnt(4)
    v_mfma_f32_16x16x32_bf16 v[84:87], v[204:207], v[204:207], v[84:87]
    v_fmac_f32 v108, v92, v248
    v_fmac_f32 v109, v93, v249
    v_fmac_f32 v110, v94, v250
    v_fmac_f32 v111, v95, v251
    v_mfma_f32_16x16x32_bf16 v[88:91], v[192:195], v[224:227], 0
    v_mfma_f32_16x16x32_bf16 v[88:91], v[196:199], v[228:231], v[88:91]
    v_fmac_f32 v108, v80, v252
    v_fmac_f32 v109, v81, v253
    v_fmac_f32 v110, v82, v254
    v_fmac_f32 v111, v83, v255
    ds_read_b128 v[184:187], v9 offset:35328
    ds_read_b128 v[188:191], v10 offset:35328
    v_mfma_f32_16x16x32_bf16 v[92:95], v[208:211], v[224:227], 0
    v_mfma_f32_16x16x32_bf16 v[92:95], v[212:215], v[228:231], v[92:95]
    v_fmac_f32 v108, v84, v100
    v_fmac_f32 v109, v85, v101
    v_fmac_f32 v110, v86, v102
    v_fmac_f32 v111, v87, v103
    s_waitcnt lgkmcnt(2)
    s_mov_b64 exec, s[44:45]
    v_mov_b64 v[232:233], v[176:177]
    v_mov_b64 v[234:235], v[178:179]
    v_mov_b64 v[236:237], v[180:181]
    v_mov_b64 v[238:239], v[182:183]
    s_mov_b64 exec, -1
    v_mfma_f32_16x16x32_bf16 v[80:83], v[216:219], v[224:227], 0
    v_mfma_f32_16x16x32_bf16 v[80:83], v[220:223], v[228:231], v[80:83]
    v_fmac_f32 v108, v88, v240
    v_fmac_f32 v109, v89, v241
    v_fmac_f32 v110, v90, v242
    v_fmac_f32 v111, v91, v243
    ds_read_b128 v[200:203], v9 offset:37888
    ds_read_b128 v[204:207], v10 offset:37888
    v_mfma_f32_16x16x32_bf16 v[84:87], v[176:179], v[232:235], 0
    v_mfma_f32_16x16x32_bf16 v[84:87], v[180:183], v[236:239], v[84:87]
    v_fmac_f32 v108, v92, v244
    v_fmac_f32 v109, v93, v245
    v_fmac_f32 v110, v94, v246
    v_fmac_f32 v111, v95, v247
    s_waitcnt lgkmcnt(2)
    s_mov_b64 exec, s[44:45]
    v_mov_b64 v[232:233], v[184:185]
    v_mov_b64 v[234:235], v[186:187]
    v_mov_b64 v[236:237], v[188:189]
    v_mov_b64 v[238:239], v[190:191]
    s_mov_b64 exec, -1
    v_mfma_f32_16x16x32_bf16 v[88:91], v[176:179], v[184:187], 0
    v_mfma_f32_16x16x32_bf16 v[88:91], v[180:183], v[188:191], v[88:91]
    v_fmac_f32 v108, v80, v64
    v_fmac_f32 v109, v81, v65
    v_fmac_f32 v110, v82, v66
    v_fmac_f32 v111, v83, v67
    v_add_f32 v112, v108, v109
    v_add_f32 v113, v110, v111
    v_add_f32 v112, v112, v113
    s_nop 1
    v_add_f32_dpp v112, v112, v112 row_shr:1 row_mask:0xf bank_mask:0xf
    s_nop 1
    v_add_f32_dpp v112, v112, v112 row_shr:2 row_mask:0xf bank_mask:0xf
    s_nop 1
    v_add_f32_dpp v112, v112, v112 row_shr:4 row_mask:0xf bank_mask:0xf
    s_nop 1
    v_add_f32_dpp v112, v112, v112 row_shr:8 row_mask:0xf bank_mask:0xf
    s_nop 1
    v_add_f32_dpp v112, v112, v112 row_bcast:15 row_mask:0xa bank_mask:0xf
    s_nop 1
    v_add_f32_dpp v112, v112, v112 row_bcast:31 row_mask:0xc bank_mask:0xf
    s_nop 0
    v_readlane_b32 s66, v112, 63
    v_mfma_f32_16x16x32_bf16 v[92:95], v[184:187], v[232:235], 0
    v_mfma_f32_16x16x32_bf16 v[92:95], v[188:191], v[236:239], v[92:95]
    v_mul_f32 v108, v84, v104
    v_mul_f32 v109, v85, v105
    v_mul_f32 v110, v86, v106
    v_mul_f32 v111, v87, v107
    ds_read_b128 v[192:195], v58 offset:32768
    ds_read_b128 v[196:199], v59 offset:32768
    s_waitcnt lgkmcnt(3)
    v_mfma_f32_16x16x32_bf16 v[80:83], v[176:179], v[200:203], 0
    s_waitcnt lgkmcnt(2)
    v_mfma_f32_16x16x32_bf16 v[80:83], v[180:183], v[204:207], v[80:83]
    v_fmac_f32 v108, v88, v120
    v_fmac_f32 v109, v89, v121
    v_fmac_f32 v110, v90, v122
    v_fmac_f32 v111, v91, v123
    s_waitcnt vmcnt(4)
    ds_read_b128 v[208:211], v9
    ds_read_b128 v[212:215], v10
    s_mov_b64 exec, s[44:45]
    v_mov_b64 v[232:233], v[200:201]
    v_mov_b64 v[234:235], v[202:203]
    v_mov_b64 v[236:237], v[204:205]
    v_mov_b64 v[238:239], v[206:207]
    s_mov_b64 exec, -1
    v_mfma_f32_16x16x32_bf16 v[84:87], v[184:187], v[200:203], 0
    v_mfma_f32_16x16x32_bf16 v[84:87], v[188:191], v[204:207], v[84:87]
    v_fmac_f32 v108, v92, v124
    v_fmac_f32 v109, v93, v125
    v_fmac_f32 v110, v94, v126
    v_fmac_f32 v111, v95, v127
    v_mfma_f32_16x16x32_bf16 v[88:91], v[200:203], v[232:235], 0
    v_mfma_f32_16x16x32_bf16 v[88:91], v[204:207], v[236:239], v[88:91]
    v_fmac_f32 v108, v80, v128
    v_fmac_f32 v109, v81, v129
    v_fmac_f32 v110, v82, v130
    v_fmac_f32 v111, v83, v131
    s_waitcnt lgkmcnt(3)
    v_mfma_f32_16x16x32_bf16 v[92:95], v[192:195], v[192:195], 0
    s_waitcnt lgkmcnt(2)
    v_mfma_f32_16x16x32_bf16 v[92:95], v[196:199], v[196:199], v[92:95]
    v_fmac_f32 v108, v84, v132
    v_fmac_f32 v109, v85, v133
    v_fmac_f32 v110, v86, v134
    v_fmac_f32 v111, v87, v135
    s_waitcnt lgkmcnt(0)
    s_mov_b64 exec, s[44:45]
    v_mov_b64 v[232:233], v[208:209]
    v_mov_b64 v[234:235], v[210:211]
    v_mov_b64 v[236:237], v[212:213]
    v_mov_b64 v[238:239], v[214:215]
    s_mov_b64 exec, -1
    v_mfma_f32_16x16x32_bf16 v[80:83], v[176:179], v[208:211], 0
    v_mfma_f32_16x16x32_bf16 v[80:83], v[180:183], v[212:215], v[80:83]
    v_fmac_f32 v108, v88, v136
    v_fmac_f32 v109, v89, v137
    v_fmac_f32 v110, v90, v138
    v_fmac_f32 v111, v91, v139
    s_waitcnt vmcnt(2)
    ds_read_b128 v[216:219], v9 offset:2560
    ds_read_b128 v[220:223], v10 offset:2560
    v_mfma_f32_16x16x32_bf16 v[84:87], v[208:211], v[232:235], 0
    v_mfma_f32_16x16x32_bf16 v[84:87], v[212:215], v[236:239], v[84:87]
    v_fmac_f32 v108, v92, v96
    v_fmac_f32 v109, v93, v97
    v_fmac_f32 v110, v94, v98
    v_fmac_f32 v111, v95, v99
    v_mfma_f32_16x16x32_bf16 v[88:91], v[184:187], v[208:211], 0
    v_mfma_f32_16x16x32_bf16 v[88:91], v[188:191], v[212:215], v[88:91]
    v_fmac_f32 v108, v80, v140
    v_fmac_f32 v109, v81, v141
    v_fmac_f32 v110, v82, v142
    v_fmac_f32 v111, v83, v143
    v_mfma_f32_16x16x32_bf16 v[92:95], v[200:203], v[208:211], 0
    v_mfma_f32_16x16x32_bf16 v[92:95], v[204:207], v[212:215], v[92:95]
    v_fmac_f32 v108, v84, v144
    v_fmac_f32 v109, v85, v145
    v_fmac_f32 v110, v86, v146
    v_fmac_f32 v111, v87, v147
    s_waitcnt lgkmcnt(0)
    s_mov_b64 exec, s[44:45]
    v_mov_b64 v[232:233], v[216:217]
    v_mov_b64 v[234:235], v[218:219]
    v_mov_b64 v[236:237], v[220:221]
    v_mov_b64 v[238:239], v[222:223]
    s_mov_b64 exec, -1
    v_mfma_f32_16x16x32_bf16 v[80:83], v[176:179], v[216:219], 0
    v_mfma_f32_16x16x32_bf16 v[80:83], v[180:183], v[220:223], v[80:83]
    v_fmac_f32 v108, v88, v148
    v_fmac_f32 v109, v89, v149
    v_fmac_f32 v110, v90, v150
    v_fmac_f32 v111, v91, v151
    v_mfma_f32_16x16x32_bf16 v[84:87], v[216:219], v[232:235], 0
    v_mfma_f32_16x16x32_bf16 v[84:87], v[220:223], v[236:239], v[84:87]
    v_fmac_f32 v108, v92, v152
    v_fmac_f32 v109, v93, v153
    v_fmac_f32 v110, v94, v154
    v_fmac_f32 v111, v95, v155
    s_waitcnt vmcnt(0)
    ds_read_b128 v[224:227], v9 offset:5120
    ds_read_b128 v[228:231], v10 offset:5120
    v_mfma_f32_16x16x32_bf16 v[88:91], v[184:187], v[216:219], 0
    v_mfma_f32_16x16x32_bf16 v[88:91], v[188:191], v[220:223], v[88:91]
    v_fmac_f32 v108, v80, v156
    v_fmac_f32 v109, v81, v157
    v_fmac_f32 v110, v82, v158
    v_fmac_f32 v111, v83, v159
    v_mfma_f32_16x16x32_bf16 v[92:95], v[200:203], v[216:219], 0
    v_mfma_f32_16x16x32_bf16 v[92:95], v[204:207], v[220:223], v[92:95]
    v_fmac_f32 v108, v84, v160
    v_fmac_f32 v109, v85, v161
    v_fmac_f32 v110, v86, v162
    v_fmac_f32 v111, v87, v163
    v_mfma_f32_16x16x32_bf16 v[80:83], v[208:211], v[216:219], 0
    v_mfma_f32_16x16x32_bf16 v[80:83], v[212:215], v[220:223], v[80:83]
    v_fmac_f32 v108, v88, v164
    v_fmac_f32 v109, v89, v165
    v_fmac_f32 v110, v90, v166
    v_fmac_f32 v111, v91, v167
    ds_read_b128 v[192:195], v58
    ds_read_b128 v[196:199], v59
    s_waitcnt lgkmcnt(2)
    s_mov_b64 exec, s[44:45]
    v_mov_b64 v[232:233], v[224:225]
    v_mov_b64 v[234:235], v[226:227]
    v_mov_b64 v[236:237], v[228:229]
    v_mov_b64 v[238:239], v[230:231]
    s_mov_b64 exec, -1
    v_mfma_f32_16x16x32_bf16 v[84:87], v[176:179], v[224:227], 0
    v_mfma_f32_16x16x32_bf16 v[84:87], v[180:183], v[228:231], v[84:87]
    v_fmac_f32 v108, v92, v168
    v_fmac_f32 v109, v93, v169
    v_fmac_f32 v110, v94, v170
    v_fmac_f32 v111, v95, v171
    v_mfma_f32_16x16x32_bf16 v[88:91], v[224:227], v[232:235], 0
    v_mfma_f32_16x16x32_bf16 v[88:91], v[228:231], v[236:239], v[88:91]
    v_fmac_f32 v108, v80, v68
    v_fmac_f32 v109, v81, v69
    v_fmac_f32 v110, v82, v70
    v_fmac_f32 v111, v83, v71
    v_mfma_f32_16x16x32_bf16 v[92:95], v[184:187], v[224:227], 0
    v_mfma_f32_16x16x32_bf16 v[92:95], v[188:191], v[228:231], v[92:95]
    v_fmac_f32 v108, v84, v72
    v_fmac_f32 v109, v85, v73
    v_fmac_f32 v110, v86, v74
    v_fmac_f32 v111, v87, v75
    s_waitcnt lgkmcnt(1)
    v_mfma_f32_16x16x32_bf16 v[80:83], v[192:195], v[192:195], 0
    s_waitcnt lgkmcnt(0)
    v_mfma_f32_16x16x32_bf16 v[80:83], v[196:199], v[196:199], v[80:83]
    v_fmac_f32 v108, v88, v248
    v_fmac_f32 v109, v89, v249
    v_fmac_f32 v110, v90, v250
    v_fmac_f32 v111, v91, v251
    v_mfma_f32_16x16x32_bf16 v[84:87], v[200:203], v[224:227], 0
    v_mfma_f32_16x16x32_bf16 v[84:87], v[204:207], v[228:231], v[84:87]
    v_fmac_f32 v108, v92, v252
    v_fmac_f32 v109, v93, v253
    v_fmac_f32 v110, v94, v254
    v_fmac_f32 v111, v95, v255
    v_mfma_f32_16x16x32_bf16 v[88:91], v[208:211], v[224:227], 0
    v_mfma_f32_16x16x32_bf16 v[88:91], v[212:215], v[228:231], v[88:91]
    v_fmac_f32 v108, v80, v100
    v_fmac_f32 v109, v81, v101
    v_fmac_f32 v110, v82, v102
    v_fmac_f32 v111, v83, v103
    v_mfma_f32_16x16x32_bf16 v[92:95], v[216:219], v[224:227], 0
    v_mfma_f32_16x16x32_bf16 v[92:95], v[220:223], v[228:231], v[92:95]
    v_fmac_f32 v108, v84, v240
    v_fmac_f32 v109, v85, v241
    v_fmac_f32 v110, v86, v242
    v_fmac_f32 v111, v87, v243
    v_fmac_f32 v108, v88, v244
    v_fmac_f32 v109, v89, v245
    v_fmac_f32 v110, v90, v246
    v_fmac_f32 v111, v91, v247
    v_fmac_f32 v108, v92, v64
    v_fmac_f32 v109, v93, v65
    v_fmac_f32 v110, v94, v66
    v_fmac_f32 v111, v95, v67
    v_add_f32 v112, v108, v109
    v_add_f32 v113, v110, v111
    v_add_f32 v112, v112, v113
    s_nop 1
    v_add_f32_dpp v112, v112, v112 row_shr:1 row_mask:0xf bank_mask:0xf
    s_nop 1
    v_add_f32_dpp v112, v112, v112 row_shr:2 row_mask:0xf bank_mask:0xf
    s_nop 1
    v_add_f32_dpp v112, v112, v112 row_shr:4 row_mask:0xf bank_mask:0xf
    s_nop 1
    v_add_f32_dpp v112, v112, v112 row_shr:8 row_mask:0xf bank_mask:0xf
    s_nop 1
    v_add_f32_dpp v112, v112, v112 row_bcast:15 row_mask:0xa bank_mask:0xf
    s_nop 1
    v_add_f32_dpp v112, v112, v112 row_bcast:31 row_mask:0xc bank_mask:0xf
    s_nop 0
    v_readlane_b32 s67, v112, 63
    v_mov_b32 v112, 0
    s_nop 0
    v_writelane_b32 v112, s52, 0
    s_nop 0
    v_writelane_b32 v112, s53, 1
    s_nop 0
    v_writelane_b32 v112, s54, 2
    s_nop 0
    v_writelane_b32 v112, s55, 3
    s_nop 0
    v_writelane_b32 v112, s56, 4
    s_nop 0
    v_writelane_b32 v112, s57, 5
    s_nop 0
    v_writelane_b32 v112, s58, 6
    s_nop 0
    v_writelane_b32 v112, s59, 7
    s_nop 0
    v_writelane_b32 v112, s60, 8
    s_nop 0
    v_writelane_b32 v112, s61, 9
    s_nop 0
    v_writelane_b32 v112, s62, 10
    s_nop 0
    v_writelane_b32 v112, s63, 11
    s_nop 0
    v_writelane_b32 v112, s64, 12
    s_nop 0
    v_writelane_b32 v112, s65, 13
    s_nop 0
    v_writelane_b32 v112, s66, 14
    s_nop 0
    v_writelane_b32 v112, s67, 15
    s_lshl_b32 s27, s3, 6
    s_add_u32 s27, s27, 96256
    v_lshl_add_u32 v6, v0, 2, s27
    s_mov_b64 exec, 0xffff
    ds_write_b32 v6, v112
    s_mov_b64 exec, -1
    s_waitcnt lgkmcnt(0)
    s_barrier
L_end:
    s_endpgm
L_rs0:
    ds_read_b32 v94, v118 offset:32
    s_waitcnt lgkmcnt(0)
    v_cmp_gt_u32 vcc, 2, v94
    s_sub_i32 s51, s51, 1
    s_cmp_lt_i32 s51, 0
    s_cbranch_scc1 L_rb0
    s_cbranch_vccnz L_rs0
    s_branch L_rb0
L_rs1:
    ds_read_b32 v94, v118 offset:16
    s_waitcnt lgkmcnt(0)
    v_cmp_gt_u32 vcc, 1, v94
    s_sub_i32 s51, s51, 1
    s_cmp_lt_i32 s51, 0
    s_cbranch_scc1 L_rb1
    s_cbranch_vccnz L_rs1
    s_branch L_rb1
L_rs2:
    ds_read_b32 v94, v118 offset:16
    s_waitcnt lgkmcnt(0)
    v_cmp_gt_u32 vcc, 2, v94
    s_sub_i32 s51, s51, 1
    s_cmp_lt_i32 s51, 0
    s_cbranch_scc1 L_rb2
    s_cbranch_vccnz L_rs2
    s_branch L_rb2
L_rs3:
    ds_read_b32 v94, v118 offset:80
    s_waitcnt lgkmcnt(0)
    v_cmp_gt_u32 vcc, 1, v94
    s_sub_i32 s51, s51, 1
    s_cmp_lt_i32 s51, 0
    s_cbranch_scc1 L_rb3
    s_cbranch_vccnz L_rs3
    s_branch L_rb3
L_rs4:
    ds_read_b32 v119, v118 offset:16
    s_waitcnt lgkmcnt(0)
    v_cmp_gt_u32 vcc, 3, v119
    s_sub_i32 s51, s51, 1
    s_cmp_lt_i32 s51, 0
    s_cbranch_scc1 L_rb4
    s_cbranch_vccnz L_rs4
    s_branch L_rb4
L_rs5:
    ds_read_b32 v119, v118 offset:16
    s_waitcnt lgkmcnt(0)
    v_cmp_gt_u32 vcc, 4, v119
    s_sub_i32 s51, s51, 1
    s_cmp_lt_i32 s51, 0
    s_cbranch_scc1 L_rb5
    s_cbranch_vccnz L_rs5
    s_branch L_rb5
L_rs6:
    ds_read_b32 v119, v118 offset:16
    s_waitcnt lgkmcnt(0)
    v_cmp_gt_u32 vcc, 5, v119
    s_sub_i32 s51, s51, 1
    s_cmp_lt_i32 s51, 0
    s_cbranch_scc1 L_rb6
    s_cbranch_vccnz L_rs6
    s_branch L_rb6
L_rs7:
    ds_read_b32 v119, v118 offset:16
    s_waitcnt lgkmcnt(0)
    v_cmp_gt_u32 vcc, 6, v119
    s_sub_i32 s51, s51, 1
    s_cmp_lt_i32 s51, 0
    s_cbranch_scc1 L_rb7
    s_cbranch_vccnz L_rs7
    s_branch L_rb7
L_rs8:
    ds_read_b32 v119, v118 offset:16
    s_waitcnt lgkmcnt(0)
    v_cmp_gt_u32 vcc, 7, v119
    s_sub_i32 s51, s51, 1
    s_cmp_lt_i32 s51, 0
    s_cbranch_scc1 L_rb8
    s_cbranch_vccnz L_rs8
    s_branch L_rb8
L_rs9:
    ds_read_b32 v119, v118 offset:16
    s_waitcnt lgkmcnt(0)
    v_cmp_gt_u32 vcc, 8, v119
    s_sub_i32 s51, s51, 1
    s_cmp_lt_i32 s51, 0
    s_cbranch_scc1 L_rb9
    s_cbranch_vccnz L_rs9
    s_branch L_rb9
L_rs10:
    ds_read_b32 v119, v118 offset:16
    s_waitcnt lgkmcnt(0)
    v_cmp_gt_u32 vcc, 9, v119
    s_sub_i32 s51, s51, 1
    s_cmp_lt_i32 s51, 0
    s_cbranch_scc1 L_rb10
    s_cbranch_vccnz L_rs10
    s_branch L_rb10
L_rs11:
    ds_read_b32 v119, v118 offset:16
    s_waitcnt lgkmcnt(0)
    v_cmp_gt_u32 vcc, 10, v119
    s_sub_i32 s51, s51, 1
    s_cmp_lt_i32 s51, 0
    s_cbranch_scc1 L_rb11
    s_cbranch_vccnz L_rs11
    s_branch L_rb11
L_rs12:
    ds_read_b32 v119, v118 offset:16
    s_waitcnt lgkmcnt(0)
    v_cmp_gt_u32 vcc, 11, v119
    s_sub_i32 s51, s51, 1
    s_cmp_lt_i32 s51, 0
    s_cbranch_scc1 L_rb12
    s_cbranch_vccnz L_rs12
    s_branch L_rb12
L_rs13:
    ds_read_b32 v119, v118 offset:16
    s_waitcnt lgkmcnt(0)
    v_cmp_gt_u32 vcc, 12, v119
    s_sub_i32 s51, s51, 1
    s_cmp_lt_i32 s51, 0
    s_cbranch_scc1 L_rb13
    s_cbranch_vccnz L_rs13
    s_branch L_rb13
L_rs14:
    ds_read_b32 v119, v118 offset:16
    s_waitcnt lgkmcnt(0)
    v_cmp_gt_u32 vcc, 13, v119
    s_sub_i32 s51, s51, 1
    s_cmp_lt_i32 s51, 0
    s_cbranch_scc1 L_rb14
    s_cbranch_vccnz L_rs14
    s_branch L_rb14
L_rs15:
    ds_read_b32 v119, v118 offset:16
    s_waitcnt lgkmcnt(0)
    v_cmp_gt_u32 vcc, 14, v119
    s_sub_i32 s51, s51, 1
    s_cmp_lt_i32 s51, 0
    s_cbranch_scc1 L_rb15
    s_cbranch_vccnz L_rs15
    s_branch L_rb15
L_rs16:
    ds_read_b32 v119, v118 offset:16
    s_waitcnt lgkmcnt(0)
    v_cmp_gt_u32 vcc, 15, v119
    s_sub_i32 s51, s51, 1
    s_cmp_lt_i32 s51, 0
    s_cbranch_scc1 L_rb16
    s_cbranch_vccnz L_rs16
    s_branch L_rb16
L_rs17:
    ds_read_b32 v119, v118 offset:16
    s_waitcnt lgkmcnt(0)
    v_cmp_gt_u32 vcc, 16, v119
    s_sub_i32 s51, s51, 1
    s_cmp_lt_i32 s51, 0
    s_cbranch_scc1 L_rb17
    s_cbranch_vccnz L_rs17
    s_branch L_rb17
L_rs18:
    ds_read_b32 v119, v118 offset:16
    s_waitcnt lgkmcnt(0)
    v_cmp_gt_u32 vcc, 17, v119
    s_sub_i32 s51, s51, 1
    s_cmp_lt_i32 s51, 0
    s_cbranch_scc1 L_rb18
    s_cbranch_vccnz L_rs18
    s_branch L_rb18
L_rs19:
    ds_read_b32 v119, v118 offset:16
    s_waitcnt lgkmcnt(0)
    v_cmp_gt_u32 vcc, 18, v119
    s_sub_i32 s51, s51, 1
    s_cmp_lt_i32 s51, 0
    s_cbranch_scc1 L_rb19
    s_cbranch_vccnz L_rs19
    s_branch L_rb19
L_rs20:
    ds_read_b32 v119, v118 offset:16
    s_waitcnt lgkmcnt(0)
    v_cmp_gt_u32 vcc, 19, v119
    s_sub_i32 s51, s51, 1
    s_cmp_lt_i32 s51, 0
    s_cbranch_scc1 L_rb20
    s_cbranch_vccnz L_rs20
    s_branch L_rb20
L_rs21:
    ds_read_b32 v119, v118 offset:16
    s_waitcnt lgkmcnt(0)
    v_cmp_gt_u32 vcc, 20, v119
    s_sub_i32 s51, s51, 1
    s_cmp_lt_i32 s51, 0
    s_cbranch_scc1 L_rb21
    s_cbranch_vccnz L_rs21
    s_branch L_rb21
L_rs22:
    ds_read_b32 v119, v118 offset:16
    s_waitcnt lgkmcnt(0)
    v_cmp_gt_u32 vcc, 21, v119
    s_sub_i32 s51, s51, 1
    s_cmp_lt_i32 s51, 0
    s_cbranch_scc1 L_rb22
    s_cbranch_vccnz L_rs22
    s_branch L_rb22
L_rs23:
    ds_read_b32 v119, v118 offset:16
    s_waitcnt lgkmcnt(0)
    v_cmp_gt_u32 vcc, 22, v119
    s_sub_i32 s51, s51, 1
    s_cmp_lt_i32 s51, 0
    s_cbranch_scc1 L_rb23
    s_cbranch_vccnz L_rs23
    s_branch L_rb23
L_rs24:
    ds_read_b32 v119, v118 offset:16
    s_waitcnt lgkmcnt(0)
    v_cmp_gt_u32 vcc, 23, v119
    s_sub_i32 s51, s51, 1
    s_cmp_lt_i32 s51, 0
    s_cbranch_scc1 L_rb24
    s_cbranch_vccnz L_rs24
    s_branch L_rb24
L_rs25:
    ds_read_b32 v119, v118 offset:16
    s_waitcnt lgkmcnt(0)
    v_cmp_gt_u32 vcc, 24, v119
    s_sub_i32 s51, s51, 1
    s_cmp_lt_i32 s51, 0
    s_cbranch_scc1 L_rb25
    s_cbranch_vccnz L_rs25
    s_branch L_rb25
L_rs26:
    ds_read_b32 v119, v118 offset:16
    s_waitcnt lgkmcnt(0)
    v_cmp_gt_u32 vcc, 25, v119
    s_sub_i32 s51, s51, 1
    s_cmp_lt_i32 s51, 0
    s_cbranch_scc1 L_rb26
    s_cbranch_vccnz L_rs26
    s_branch L_rb26
L_rs27:
    ds_read_b32 v119, v118 offset:16
    s_waitcnt lgkmcnt(0)
    v_cmp_gt_u32 vcc, 26, v119
    s_sub_i32 s51, s51, 1
    s_cmp_lt_i32 s51, 0
    s_cbranch_scc1 L_rb27
    s_cbranch_vccnz L_rs27
    s_branch L_rb27
L_rs28:
    ds_read_b32 v119, v118 offset:16
    s_waitcnt lgkmcnt(0)
    v_cmp_gt_u32 vcc, 27, v119
    s_sub_i32 s51, s51, 1
    s_cmp_lt_i32 s51, 0
    s_cbranch_scc1 L_rb28
    s_cbranch_vccnz L_rs28
    s_branch L_rb28
L_rs29:
    ds_read_b32 v119, v118 offset:16
    s_waitcnt lgkmcnt(0)
    v_cmp_gt_u32 vcc, 28, v119
    s_sub_i32 s51, s51, 1
    s_cmp_lt_i32 s51, 0
    s_cbranch_scc1 L_rb29
    s_cbranch_vccnz L_rs29
    s_branch L_rb29
L_rs30:
    ds_read_b32 v119, v118 offset:16
    s_waitcnt lgkmcnt(0)
    v_cmp_gt_u32 vcc, 29, v119
    s_sub_i32 s51, s51, 1
    s_cmp_lt_i32 s51, 0
    s_cbranch_scc1 L_rb30
    s_cbranch_vccnz L_rs30
    s_branch L_rb30
L_rs31:
    ds_read_b32 v119, v118 offset:16
    s_waitcnt lgkmcnt(0)
    v_cmp_gt_u32 vcc, 30, v119
    s_sub_i32 s51, s51, 1
    s_cmp_lt_i32 s51, 0
    s_cbranch_scc1 L_rb31
    s_cbranch_vccnz L_rs31
    s_branch L_rb31
L_rs32:
    ds_read_b32 v119, v118 offset:16
    s_waitcnt lgkmcnt(0)
    v_cmp_gt_u32 vcc, 31, v119
    s_sub_i32 s51, s51, 1
    s_cmp_lt_i32 s51, 0
    s_cbranch_scc1 L_rb32
    s_cbranch_vccnz L_rs32
    s_branch L_rb32
L_rs33:
    ds_read_b32 v119, v118 offset:16
    s_waitcnt lgkmcnt(0)
    v_cmp_gt_u32 vcc, 32, v119
    s_sub_i32 s51, s51, 1
    s_cmp_lt_i32 s51, 0
    s_cbranch_scc1 L_rb33
    s_cbranch_vccnz L_rs33
    s_branch L_rb33
L_rs34:
    ds_read_b32 v119, v118 offset:16
    s_waitcnt lgkmcnt(0)
    v_cmp_gt_u32 vcc, 33, v119
    s_sub_i32 s51, s51, 1
    s_cmp_lt_i32 s51, 0
    s_cbranch_scc1 L_rb34
    s_cbranch_vccnz L_rs34
    s_branch L_rb34
L_rs35:
    ds_read_b32 v119, v118 offset:16
    s_waitcnt lgkmcnt(0)
    v_cmp_gt_u32 vcc, 34, v119
    s_sub_i32 s51, s51, 1
    s_cmp_lt_i32 s51, 0
    s_cbranch_scc1 L_rb35
    s_cbranch_vccnz L_rs35
    s_branch L_rb35
L_rs36:
    ds_read_b32 v119, v118 offset:16
    s_waitcnt lgkmcnt(0)
    v_cmp_gt_u32 vcc, 35, v119
    s_sub_i32 s51, s51, 1
    s_cmp_lt_i32 s51, 0
    s_cbranch_scc1 L_rb36
    s_cbranch_vccnz L_rs36
    s_branch L_rb36
L_rs37:
    ds_read_b32 v119, v118 offset:16
    s_waitcnt lgkmcnt(0)
    v_cmp_gt_u32 vcc, 36, v119
    s_sub_i32 s51, s51, 1
    s_cmp_lt_i32 s51, 0
    s_cbranch_scc1 L_rb37
    s_cbranch_vccnz L_rs37
    s_branch L_rb37
L_rs38:
    ds_read_b32 v119, v118 offset:16
    s_waitcnt lgkmcnt(0)
    v_cmp_gt_u32 vcc, 37, v119
    s_sub_i32 s51, s51, 1
    s_cmp_lt_i32 s51, 0
    s_cbranch_scc1 L_rb38
    s_cbranch_vccnz L_rs38
    s_branch L_rb38
L_rs39:
    ds_read_b32 v119, v118 offset:16
    s_waitcnt lgkmcnt(0)
    v_cmp_gt_u32 vcc, 38, v119
    s_sub_i32 s51, s51, 1
    s_cmp_lt_i32 s51, 0
    s_cbranch_scc1 L_rb39
    s_cbranch_vccnz L_rs39
    s_branch L_rb39
L_rs40:
    ds_read_b32 v119, v118 offset:16
    s_waitcnt lgkmcnt(0)
    v_cmp_gt_u32 vcc, 39, v119
    s_sub_i32 s51, s51, 1
    s_cmp_lt_i32 s51, 0
    s_cbranch_scc1 L_rb40
    s_cbranch_vccnz L_rs40
    s_branch L_rb40
L_rs41:
    ds_read_b32 v119, v118 offset:16
    s_waitcnt lgkmcnt(0)
    v_cmp_gt_u32 vcc, 40, v119
    s_sub_i32 s51, s51, 1
    s_cmp_lt_i32 s51, 0
    s_cbranch_scc1 L_rb41
    s_cbranch_vccnz L_rs41
    s_branch L_rb41
L_rs42:
    ds_read_b32 v119, v118 offset:16
    s_waitcnt lgkmcnt(0)
    v_cmp_gt_u32 vcc, 41, v119
    s_sub_i32 s51, s51, 1
    s_cmp_lt_i32 s51, 0
    s_cbranch_scc1 L_rb42
    s_cbranch_vccnz L_rs42
    s_branch L_rb42
L_rs43:
    ds_read_b32 v119, v118 offset:16
    s_waitcnt lgkmcnt(0)
    v_cmp_gt_u32 vcc, 42, v119
    s_sub_i32 s51, s51, 1
    s_cmp_lt_i32 s51, 0
    s_cbranch_scc1 L_rb43
    s_cbranch_vccnz L_rs43
    s_branch L_rb43
L_rs44:
    ds_read_b32 v119, v118 offset:16
    s_waitcnt lgkmcnt(0)
    v_cmp_gt_u32 vcc, 43, v119
    s_sub_i32 s51, s51, 1
    s_cmp_lt_i32 s51, 0
    s_cbranch_scc1 L_rb44
    s_cbranch_vccnz L_rs44
    s_branch L_rb44
L_rs45:
    ds_read_b32 v119, v118 offset:16
    s_waitcnt lgkmcnt(0)
    v_cmp_gt_u32 vcc, 44, v119
    s_sub_i32 s51, s51, 1
    s_cmp_lt_i32 s51, 0
    s_cbranch_scc1 L_rb45
    s_cbranch_vccnz L_rs45
    s_branch L_rb45
L_rs46:
    ds_read_b32 v119, v118 offset:16
    s_waitcnt lgkmcnt(0)
    v_cmp_gt_u32 vcc, 45, v119
    s_sub_i32 s51, s51, 1
    s_cmp_lt_i32 s51, 0
    s_cbranch_scc1 L_rb46
    s_cbranch_vccnz L_rs46
    s_branch L_rb46
L_gwave:
    s_setprio 3
    v_mov_b32 v131, 0
    s_lshl_b32 s27, s3, 8
    s_add_u32 s29, s27, 81920
    v_lshl_add_u32 v129, v0, 2, s29
    ds_write_b32 v129, v131
    s_mul_i32 s49, s25, 1638400
    s_mov_b32 s76, s10
    s_mov_b32 s77, s11
    s_mov_b32 s78, 3276800
    s_mov_b32 s79, 0x00020000
    v_and_b32 v132, 15, v0
    v_lshrrev_b32 v133, 4, v0
    s_lshl_b32 s27, s3, 7
    v_lshl_add_u32 v128, v132, 3, s27
    v_lshl_add_u32 v6, v133, 12, v128
    s_mov_b32 s32, s8
    s_mov_b32 s33, s9
    s_mov_b32 s34, 20000
    s_mov_b32 s35, 0x00020000
    s_mul_i32 s30, s3, 5120
    v_lshl_add_u32 v130, v0, 4, s30
    s_waitcnt lgkmcnt(0)
    s_barrier
    s_add_u32 m0, s30, 98304
    s_nop 0
    buffer_load_dwordx4 v130, s[32:35], 0 offen lds
    buffer_load_dwordx4 v130, s[32:35], 0 offen offset:1024 lds
    buffer_load_dwordx4 v130, s[32:35], 0 offen offset:2048 lds
    buffer_load_dwordx4 v130, s[32:35], 0 offen offset:3072 lds
    s_add_u32 m0, s30, 102400
    s_mov_b32 s48, 4096
    buffer_load_dwordx4 v130, s[32:35], s48 offen lds
    s_add_u32 s48, s49, 0
    buffer_load_dwordx2 v[16:17], v6, s[76:79], s48 offen
    buffer_load_dwordx2 v[18:19], v6, s[76:79], s48 offen offset:512
    buffer_load_dwordx2 v[20:21], v6, s[76:79], s48 offen offset:1024
    buffer_load_dwordx2 v[22:23], v6, s[76:79], s48 offen offset:1536
    buffer_load_dwordx2 v[24:25], v6, s[76:79], s48 offen offset:2048
    buffer_load_dwordx2 v[26:27], v6, s[76:79], s48 offen offset:2560
    buffer_load_dwordx2 v[28:29], v6, s[76:79], s48 offen offset:3072
    buffer_load_dwordx2 v[30:31], v6, s[76:79], s48 offen offset:3584
    s_add_u32 s48, s49, 16384
    buffer_load_dwordx2 v[32:33], v6, s[76:79], s48 offen
    buffer_load_dwordx2 v[34:35], v6, s[76:79], s48 offen offset:512
    buffer_load_dwordx2 v[36:37], v6, s[76:79], s48 offen offset:1024
    buffer_load_dwordx2 v[38:39], v6, s[76:79], s48 offen offset:1536
    buffer_load_dwordx2 v[40:41], v6, s[76:79], s48 offen offset:2048
    buffer_load_dwordx2 v[42:43], v6, s[76:79], s48 offen offset:2560
    buffer_load_dwordx2 v[44:45], v6, s[76:79], s48 offen offset:3072
    buffer_load_dwordx2 v[46:47], v6, s[76:79], s48 offen offset:3584
    s_add_u32 s48, s49, 32768
    buffer_load_dwordx2 v[48:49], v6, s[76:79], s48 offen
    buffer_load_dwordx2 v[50:51], v6, s[76:79], s48 offen offset:512
    buffer_load_dwordx2 v[52:53], v6, s[76:79], s48 offen offset:1024
    buffer_load_dwordx2 v[54:55], v6, s[76:79], s48 offen offset:1536
    buffer_load_dwordx2 v[56:57], v6, s[76:79], s48 offen offset:2048
    buffer_load_dwordx2 v[58:59], v6, s[76:79], s48 offen offset:2560
    buffer_load_dwordx2 v[60:61], v6, s[76:79], s48 offen offset:3072
    buffer_load_dwordx2 v[62:63], v6, s[76:79], s48 offen offset:3584
    s_mov_b32 s68, 0x05040100
    s_mov_b32 s69, 0x07060302
    s_mov_b32 s80, s22
    s_mov_b32 s81, s23
    s_mov_b32 s82, 24248320
    s_mov_b32 s83, 0x00020000
    v_lshrrev_b32 v129, 1, v132
    v_xor_b32 v129, v129, v133
    v_lshlrev_b32 v130, 7, v132
    v_lshl_add_u32 v2, v129, 4, v130
    v_xor_b32 v3, 64, v2
    v_add_u32 v4, 0x10000, v2
    v_add_u32 v5, 0x10000, v3
    s_lshl_b32 s27, s3, 2
    s_add_u32 s27, s27, 81920
    v_lshlrev_b32 v7, 2, v0
    v_add_u32 v7, 82176, v7
    s_nop 0
    v_writelane_b32 v7, s27, 0
    v_mov_b32 v8, 1
    s_mov_b32 s51, 1048576
    v_and_b32 v128, 3, v0
    v_lshlrev_b32 v128, 2, v128
    v_add_u32 v9, 81920, v128
    s_add_u32 s27, s31, 20971520
    v_lshl_add_u32 v1, v0, 4, s27
    v_lshlrev_b32 v131, 2, v133
    v_add_u32 v131, s3, v131
    v_mul_u32_u24 v129, 200, v131
    v_lshl_add_u32 v134, v132, 1, v129
    v_add_u32 v134, 98304, v134
    v_mul_u32_u24 v129, 200, v132
    v_lshl_add_u32 v135, v131, 1, v129
    v_add_u32 v135, 98304, v135
    v_cmp_gt_u32 vcc, 4, v132
    v_add_u32 v137, 192, v134
    v_add_u32 v138, 19200, v135
    v_mov_b32 v139, 32
    v_mov_b32 v140, 3200
    v_cndmask_b32 v137, v134, v137, vcc
    v_cndmask_b32 v138, v135, v138, vcc
    v_cndmask_b32 v139, v139, 0, vcc
    v_cndmask_b32 v140, v140, 0, vcc
    s_mul_i32 s27, s3, 200
    s_add_u32 s27, s27, 98304
    v_and_b32 v129, 3, v132
    v_lshl_add_u32 v129, v129, 1, s27
    v_mul_u32_u24 v141, 3232, v133
    v_add_u32 v141, v141, v129
    v_mad_u32_u24 v194, v139, 0, v137
    v_mad_u32_u24 v195, v140, 0, v138
    v_mad_u32_u24 v196, v139, 1, v137
    v_mad_u32_u24 v197, v140, 1, v138
    v_mad_u32_u24 v198, v139, 2, v137
    v_mad_u32_u24 v199, v140, 2, v138
    v_mad_u32_u24 v200, v139, 3, v137
    v_mad_u32_u24 v201, v140, 3, v138
    v_mad_u32_u24 v202, v139, 4, v137
    v_mad_u32_u24 v203, v140, 4, v138
    v_mad_u32_u24 v204, v139, 5, v137
    v_mad_u32_u24 v205, v140, 5, v138
    s_lshl_b32 s27, s3, 2
    s_add_u32 s27, s27, 82944
    v_lshl_add_u32 v136, v0, 4, s27
    s_mov_b32 s44, 0x000fffff
    s_mov_b32 s45, 0x000f000f
    s_mov_b32 s46, 0x00f0000f
    s_mov_b32 s47, 0x00000f00
    s_waitcnt vmcnt(24)
    ds_add_u32 v7, v8 offset:32
    ds_read_b32 v10, v9 offset:32
    s_waitcnt lgkmcnt(0)
    v_cmp_gt_u32 vcc, 1, v10
    s_nop 1
    s_cbranch_vccnz L_gs0
L_gb0:
    ds_read_u16 v144, v141 offset:0
    ds_read_u16 v148, v141 offset:9696
    ds_read_u16 v152, v194 offset:0
    ds_read_u16 v153, v195 offset:0
    ds_read_u16 v154, v134 offset:32
    ds_read_u16 v155, v135 offset:3200
    ds_read_u16 v156, v196 offset:3200
    ds_read_u16 v157, v197 offset:32
    ds_read_u16 v158, v134 offset:64
    ds_read_u16 v159, v135 offset:6400
    ds_read_u16 v160, v134 offset:3264
    ds_read_u16 v161, v135 offset:6432
    ds_read_u16 v162, v198 offset:6400
    ds_read_u16 v163, v199 offset:64
    ds_read_u16 v164, v134 offset:96
    ds_read_u16 v165, v135 offset:9600
    ds_read_u16 v166, v200 offset:9600
    ds_read_u16 v167, v201 offset:96
    ds_read_u16 v168, v134 offset:3296
    ds_read_u16 v169, v135 offset:9632
    ds_read_u16 v170, v134 offset:6496
    ds_read_u16 v171, v135 offset:9664
    ds_read_u16 v172, v134 offset:128
    ds_read_u16 v173, v135 offset:12800
    ds_read_u16 v174, v202 offset:12800
    ds_read_u16 v175, v203 offset:128
    ds_read_u16 v176, v134 offset:3328
    ds_read_u16 v177, v135 offset:12832
    ds_read_u16 v178, v134 offset:6528
    ds_read_u16 v179, v135 offset:12864
    ds_read_u16 v180, v134 offset:9728
    ds_read_u16 v181, v135 offset:12896
    ds_read_u16 v182, v134 offset:160
    ds_read_u16 v183, v135 offset:16000
    ds_read_u16 v184, v204 offset:16000
    ds_read_u16 v185, v205 offset:160
    ds_read_u16 v186, v134 offset:3360
    ds_read_u16 v187, v135 offset:16032
    ds_read_u16 v188, v134 offset:6560
    ds_read_u16 v189, v135 offset:16064
    ds_read_u16 v190, v134 offset:9760
    ds_read_u16 v191, v135 offset:16096
    ds_read_u16 v192, v134 offset:12960
    ds_read_u16 v193, v135 offset:16128
    s_mov_b32 vcc_lo, 0
    s_mov_b32 vcc_hi, 0xf0000000
    s_waitcnt lgkmcnt(15)
    v_lshlrev_b32 v144, 16, v144
    v_lshlrev_b32 v148, 16, v148
    v_cndmask_b32 v146, 0, v144, s[46:47]
    v_cndmask_b32 v149, 0, v148, s[46:47]
    v_cndmask_b32 v145, v146, v148, vcc
    v_cndmask_b32 v150, v149, v148, vcc
    ds_write_b32 v136, v145 offset:0
    ds_write_b32 v136, v149 offset:2048
    v_lshlrev_b32 v152, 16, v152
    v_lshlrev_b32 v153, 16, v153
    v_cndmask_b32 v153, 0, v153, s[44:45]
    v_add_f32 v152, v152, v153
    ds_write_b32 v136, v152 offset:4096
    v_lshlrev_b32 v154, 16, v154
    v_lshlrev_b32 v155, 16, v155
    v_add_f32 v154, v154, v155
    ds_write_b32 v136, v154 offset:5120
    v_lshlrev_b32 v156, 16, v156
    v_lshlrev_b32 v157, 16, v157
    v_cndmask_b32 v157, 0, v157, s[44:45]
    v_add_f32 v156, v156, v157
    ds_write_b32 v136, v156 offset:6144
    v_lshlrev_b32 v158, 16, v158
    v_lshlrev_b32 v159, 16, v159
    v_add_f32 v158, v158, v159
    ds_write_b32 v136, v158 offset:7168
    v_lshlrev_b32 v160, 16, v160
    v_lshlrev_b32 v161, 16, v161
    v_add_f32 v160, v160, v161
    ds_write_b32 v136, v160 offset:8192
    v_lshlrev_b32 v162, 16, v162
    v_lshlrev_b32 v163, 16, v163
    v_cndmask_b32 v163, 0, v163, s[44:45]
    v_add_f32 v162, v162, v163
    ds_write_b32 v136, v162 offset:9216
    v_lshlrev_b32 v164, 16, v164
    v_lshlrev_b32 v165, 16, v165
    v_add_f32 v164, v164, v165
    ds_write_b32 v136, v164 offset:10240
    v_lshlrev_b32 v166, 16, v166
    v_lshlrev_b32 v167, 16, v167
    v_cndmask_b32 v167, 0, v167, s[44:45]
    v_add_f32 v166, v166, v167
    ds_write_b32 v136, v166 offset:11264
    v_lshlrev_b32 v168, 16, v168
    v_lshlrev_b32 v169, 16, v169
    v_add_f32 v168, v168, v169
    ds_write_b32 v136, v168 offset:12288
    v_lshlrev_b32 v170, 16, v170
    v_lshlrev_b32 v171, 16, v171
    v_add_f32 v170, v170, v171
    ds_write_b32 v136, v170 offset:13312
    v_lshlrev_b32 v172, 16, v172
    v_lshlrev_b32 v173, 16, v173
    v_add_f32 v172, v172, v173
    ds_write_b32 v136, v172 offset:14336
    v_lshlrev_b32 v174, 16, v174
    v_lshlrev_b32 v175, 16, v175
    v_cndmask_b32 v175, 0, v175, s[44:45]
    v_add_f32 v174, v174, v175
    ds_write_b32 v136, v174 offset:35840
    v_lshlrev_b32 v176, 16, v176
    v_lshlrev_b32 v177, 16, v177
    v_add_f32 v176, v176, v177
    ds_write_b32 v136, v176 offset:36864
    v_lshlrev_b32 v178, 16, v178
    s_waitcnt lgkmcnt(15)
    v_lshlrev_b32 v179, 16, v179
    v_add_f32 v178, v178, v179
    ds_write_b32 v136, v178 offset:37888
    v_lshlrev_b32 v180, 16, v180
    v_lshlrev_b32 v181, 16, v181
    v_add_f32 v180, v180, v181
    ds_write_b32 v136, v180 offset:38912
    v_lshlrev_b32 v182, 16, v182
    v_lshlrev_b32 v183, 16, v183
    v_add_f32 v182, v182, v183
    ds_write_b32 v136, v182 offset:39936
    v_lshlrev_b32 v184, 16, v184
    v_lshlrev_b32 v185, 16, v185
    v_cndmask_b32 v185, 0, v185, s[44:45]
    v_add_f32 v184, v184, v185
    ds_write_b32 v136, v184 offset:40960
    v_lshlrev_b32 v186, 16, v186
    v_lshlrev_b32 v187, 16, v187
    v_add_f32 v186, v186, v187
    ds_write_b32 v136, v186 offset:41984
    v_lshlrev_b32 v188, 16, v188
    v_lshlrev_b32 v189, 16, v189
    v_add_f32 v188, v188, v189
    ds_write_b32 v136, v188 offset:43008
    v_lshlrev_b32 v190, 16, v190
    v_lshlrev_b32 v191, 16, v191
    v_add_f32 v190, v190, v191
    ds_write_b32 v136, v190 offset:44032
    v_lshlrev_b32 v192, 16, v192
    v_lshlrev_b32 v193, 16, v193
    v_add_f32 v192, v192, v193
    ds_write_b32 v136, v192 offset:45056
    ds_add_u32 v7, v8 offset:32
    s_waitcnt vmcnt(22)
    v_perm_b32 v64, v18, v16, s68
    v_perm_b32 v68, v18, v16, s69
    v_perm_b32 v72, v19, v17, s68
    v_perm_b32 v76, v19, v17, s69
    s_waitcnt vmcnt(20)
    v_perm_b32 v65, v22, v20, s68
    v_perm_b32 v69, v22, v20, s69
    v_perm_b32 v73, v23, v21, s68
    v_perm_b32 v77, v23, v21, s69
    s_waitcnt vmcnt(18)
    v_perm_b32 v66, v26, v24, s68
    v_perm_b32 v70, v26, v24, s69
    v_perm_b32 v74, v27, v25, s68
    v_perm_b32 v78, v27, v25, s69
    s_waitcnt vmcnt(16)
    v_perm_b32 v67, v30, v28, s68
    v_perm_b32 v71, v30, v28, s69
    v_perm_b32 v75, v31, v29, s68
    v_perm_b32 v79, v31, v29, s69
    s_add_u32 s48, s49, 49152
    buffer_load_dwordx2 v[16:17], v6, s[76:79], s48 offen
    buffer_load_dwordx2 v[18:19], v6, s[76:79], s48 offen offset:512
    buffer_load_dwordx2 v[20:21], v6, s[76:79], s48 offen offset:1024
    buffer_load_dwordx2 v[22:23], v6, s[76:79], s48 offen offset:1536
    buffer_load_dwordx2 v[24:25], v6, s[76:79], s48 offen offset:2048
    buffer_load_dwordx2 v[26:27], v6, s[76:79], s48 offen offset:2560
    buffer_load_dwordx2 v[28:29], v6, s[76:79], s48 offen offset:3072
    buffer_load_dwordx2 v[30:31], v6, s[76:79], s48 offen offset:3584
    ds_read_b32 v10, v9
    s_waitcnt lgkmcnt(0)
    v_cmp_gt_u32 vcc, 1, v10
    s_nop 1
    s_cbranch_vccnz L_gs1
L_gb1:
    ds_read_b128 v[96:99], v2 offset:0
    ds_read_b128 v[100:103], v2 offset:2048
    ds_read_b128 v[104:107], v2 offset:4096
    ds_read_b128 v[108:111], v2 offset:6144
    ds_read_b128 v[112:115], v2 offset:8192
    ds_read_b128 v[116:119], v2 offset:10240
    ds_read_b128 v[120:123], v2 offset:12288
    ds_read_b128 v[124:127], v2 offset:14336
    s_waitcnt lgkmcnt(7)
    v_mfma_f32_16x16x32_bf16 v[128:131], v[64:67], v[96:99], 0
    s_waitcnt vmcnt(22)
    v_perm_b32 v80, v34, v32, s68
    v_mfma_f32_16x16x32_bf16 v[132:135], v[68:71], v[96:99], 0
    v_perm_b32 v84, v34, v32, s69
    v_mfma_f32_16x16x32_bf16 v[136:139], v[72:75], v[96:99], 0
    v_perm_b32 v88, v35, v33, s68
    v_mfma_f32_16x16x32_bf16 v[140:143], v[76:79], v[96:99], 0
    ds_read_b128 v[96:99], v3 offset:0
    v_perm_b32 v92, v35, v33, s69
    s_waitcnt lgkmcnt(7)
    v_mfma_f32_16x16x32_bf16 v[156:159], v[76:79], v[100:103], 0
    v_mfma_f32_16x16x32_bf16 v[152:155], v[72:75], v[100:103], 0
    s_add_u32 s48, s49, 65536
    buffer_load_dwordx2 v[32:33], v6, s[76:79], s48 offen
    v_mfma_f32_16x16x32_bf16 v[148:151], v[68:71], v[100:103], 0
    buffer_load_dwordx2 v[34:35], v6, s[76:79], s48 offen offset:512
    v_mfma_f32_16x16x32_bf16 v[144:147], v[64:67], v[100:103], 0
    ds_read_b128 v[100:103], v3 offset:2048
    s_waitcnt vmcnt(22)
    v_perm_b32 v81, v38, v36, s68
    s_waitcnt lgkmcnt(7)
    v_mfma_f32_16x16x32_bf16 v[160:163], v[64:67], v[104:107], 0
    v_perm_b32 v85, v38, v36, s69
    v_mfma_f32_16x16x32_bf16 v[164:167], v[68:71], v[104:107], 0
    v_mfma_f32_16x16x32_bf16 v[168:171], v[72:75], v[104:107], 0
    v_perm_b32 v89, v39, v37, s68
    v_mfma_f32_16x16x32_bf16 v[172:175], v[76:79], v[104:107], 0
    ds_read_b128 v[104:107], v3 offset:4096
    v_perm_b32 v93, v39, v37, s69
    s_waitcnt lgkmcnt(7)
    v_mfma_f32_16x16x32_bf16 v[188:191], v[76:79], v[108:111], 0
    buffer_load_dwordx2 v[36:37], v6, s[76:79], s48 offen offset:1024
    v_mfma_f32_16x16x32_bf16 v[184:187], v[72:75], v[108:111], 0
    buffer_load_dwordx2 v[38:39], v6, s[76:79], s48 offen offset:1536
    v_mfma_f32_16x16x32_bf16 v[180:183], v[68:71], v[108:111], 0
    v_mfma_f32_16x16x32_bf16 v[176:179], v[64:67], v[108:111], 0
    ds_read_b128 v[108:111], v3 offset:6144
    s_waitcnt vmcnt(22)
    v_perm_b32 v82, v42, v40, s68
    s_waitcnt lgkmcnt(7)
    v_mfma_f32_16x16x32_bf16 v[192:195], v[64:67], v[112:115], 0
    v_perm_b32 v86, v42, v40, s69
    v_mfma_f32_16x16x32_bf16 v[196:199], v[68:71], v[112:115], 0
    v_perm_b32 v90, v43, v41, s68
    v_mfma_f32_16x16x32_bf16 v[200:203], v[72:75], v[112:115], 0
    v_perm_b32 v94, v43, v41, s69
    v_mfma_f32_16x16x32_bf16 v[204:207], v[76:79], v[112:115], 0
    ds_read_b128 v[112:115], v3 offset:8192
    ds_read_b32 v10, v9
    s_waitcnt lgkmcnt(8)
    v_mfma_f32_16x16x32_bf16 v[220:223], v[76:79], v[116:119], 0
    buffer_load_dwordx2 v[40:41], v6, s[76:79], s48 offen offset:2048
    v_mfma_f32_16x16x32_bf16 v[216:219], v[72:75], v[116:119], 0
    buffer_load_dwordx2 v[42:43], v6, s[76:79], s48 offen offset:2560
    v_mfma_f32_16x16x32_bf16 v[212:215], v[68:71], v[116:119], 0
    s_waitcnt vmcnt(22)
    v_perm_b32 v83, v46, v44, s68
    v_mfma_f32_16x16x32_bf16 v[208:211], v[64:67], v[116:119], 0
    ds_read_b128 v[116:119], v3 offset:10240
    v_perm_b32 v87, v46, v44, s69
    s_waitcnt lgkmcnt(8)
    v_mfma_f32_16x16x32_bf16 v[224:227], v[64:67], v[120:123], 0
    v_mfma_f32_16x16x32_bf16 v[228:231], v[68:71], v[120:123], 0
    v_perm_b32 v91, v47, v45, s68
    v_mfma_f32_16x16x32_bf16 v[232:235], v[72:75], v[120:123], 0
    v_perm_b32 v95, v47, v45, s69
    v_mfma_f32_16x16x32_bf16 v[236:239], v[76:79], v[120:123], 0
    ds_read_b128 v[120:123], v3 offset:12288
    buffer_load_dwordx2 v[44:45], v6, s[76:79], s48 offen offset:3072
    s_waitcnt lgkmcnt(8)
    v_mfma_f32_16x16x32_bf16 v[252:255], v[76:79], v[124:127], 0
    buffer_load_dwordx2 v[46:47], v6, s[76:79], s48 offen offset:3584
    v_mfma_f32_16x16x32_bf16 v[248:251], v[72:75], v[124:127], 0
    v_mfma_f32_16x16x32_bf16 v[244:247], v[68:71], v[124:127], 0
    v_mfma_f32_16x16x32_bf16 v[240:243], v[64:67], v[124:127], 0
    ds_read_b128 v[124:127], v3 offset:14336
    ds_add_u32 v7, v8 offset:16
    s_waitcnt lgkmcnt(9)
    v_mfma_f32_16x16x32_bf16 v[128:131], v[80:83], v[96:99], v[128:131]
    s_waitcnt vmcnt(22)
    v_perm_b32 v64, v50, v48, s68
    v_mfma_f32_16x16x32_bf16 v[132:135], v[84:87], v[96:99], v[132:135]
    s_waitcnt lgkmcnt(4)
    v_cmp_gt_u32 vcc, 2, v10
    v_perm_b32 v68, v50, v48, s69
    v_mfma_f32_16x16x32_bf16 v[136:139], v[88:91], v[96:99], v[136:139]
    s_cbranch_vccnz L_gs2
L_gb2:
    v_perm_b32 v72, v51, v49, s68
    v_mfma_f32_16x16x32_bf16 v[140:143], v[92:95], v[96:99], v[140:143]
    ds_read_b128 v[96:99], v2 offset:16384
    v_perm_b32 v76, v51, v49, s69
    v_mfma_f32_16x16x32_bf16 v[156:159], v[92:95], v[100:103], v[156:159]
    v_mfma_f32_16x16x32_bf16 v[152:155], v[88:91], v[100:103], v[152:155]
    s_add_u32 s48, s49, 81920
    buffer_load_dwordx2 v[48:49], v6, s[76:79], s48 offen
    v_mfma_f32_16x16x32_bf16 v[148:151], v[84:87], v[100:103], v[148:151]
    buffer_load_dwordx2 v[50:51], v6, s[76:79], s48 offen offset:512
    v_mfma_f32_16x16x32_bf16 v[144:147], v[80:83], v[100:103], v[144:147]
    ds_read_b128 v[100:103], v2 offset:18432
    s_waitcnt vmcnt(22)
    v_perm_b32 v65, v54, v52, s68
    v_mfma_f32_16x16x32_bf16 v[160:163], v[80:83], v[104:107], v[160:163]
    v_perm_b32 v69, v54, v52, s69
    v_mfma_f32_16x16x32_bf16 v[164:167], v[84:87], v[104:107], v[164:167]
    v_mfma_f32_16x16x32_bf16 v[168:171], v[88:91], v[104:107], v[168:171]
    v_perm_b32 v73, v55, v53, s68
    v_mfma_f32_16x16x32_bf16 v[172:175], v[92:95], v[104:107], v[172:175]
    ds_read_b128 v[104:107], v2 offset:20480
    v_perm_b32 v77, v55, v53, s69
    v_mfma_f32_16x16x32_bf16 v[188:191], v[92:95], v[108:111], v[188:191]
    buffer_load_dwordx2 v[52:53], v6, s[76:79], s48 offen offset:1024
    v_mfma_f32_16x16x32_bf16 v[184:187], v[88:91], v[108:111], v[184:187]
    buffer_load_dwordx2 v[54:55], v6, s[76:79], s48 offen offset:1536
    v_mfma_f32_16x16x32_bf16 v[180:183], v[84:87], v[108:111], v[180:183]
    v_mfma_f32_16x16x32_bf16 v[176:179], v[80:83], v[108:111], v[176:179]
    ds_read_b128 v[108:111], v2 offset:22528
    s_waitcnt vmcnt(22)
    v_perm_b32 v66, v58, v56, s68
    v_mfma_f32_16x16x32_bf16 v[192:195], v[80:83], v[112:115], v[192:195]
    v_perm_b32 v70, v58, v56, s69
    v_mfma_f32_16x16x32_bf16 v[196:199], v[84:87], v[112:115], v[196:199]
    v_perm_b32 v74, v59, v57, s68
    v_mfma_f32_16x16x32_bf16 v[200:203], v[88:91], v[112:115], v[200:203]
    v_perm_b32 v78, v59, v57, s69
    v_mfma_f32_16x16x32_bf16 v[204:207], v[92:95], v[112:115], v[204:207]
    ds_read_b128 v[112:115], v2 offset:24576
    s_waitcnt lgkmcnt(8)
    v_mfma_f32_16x16x32_bf16 v[220:223], v[92:95], v[116:119], v[220:223]
    buffer_load_dwordx2 v[56:57], v6, s[76:79], s48 offen offset:2048
    v_mfma_f32_16x16x32_bf16 v[216:219], v[88:91], v[116:119], v[216:219]
    buffer_load_dwordx2 v[58:59], v6, s[76:79], s48 offen offset:2560
    v_mfma_f32_16x16x32_bf16 v[212:215], v[84:87], v[116:119], v[212:215]
    s_waitcnt vmcnt(22)
    v_perm_b32 v67, v62, v60, s68
    v_mfma_f32_16x16x32_bf16 v[208:211], v[80:83], v[116:119], v[208:211]
    ds_read_b128 v[116:119], v2 offset:26624
    v_perm_b32 v71, v62, v60, s69
    s_waitcnt lgkmcnt(8)
    v_mfma_f32_16x16x32_bf16 v[224:227], v[80:83], v[120:123], v[224:227]
    v_mfma_f32_16x16x32_bf16 v[228:231], v[84:87], v[120:123], v[228:231]
    v_perm_b32 v75, v63, v61, s68
    v_mfma_f32_16x16x32_bf16 v[232:235], v[88:91], v[120:123], v[232:235]
    v_perm_b32 v79, v63, v61, s69
    v_mfma_f32_16x16x32_bf16 v[236:239], v[92:95], v[120:123], v[236:239]
    ds_read_b128 v[120:123], v2 offset:28672
    buffer_load_dwordx2 v[60:61], v6, s[76:79], s48 offen offset:3072
    s_waitcnt lgkmcnt(8)
    v_mfma_f32_16x16x32_bf16 v[252:255], v[92:95], v[124:127], v[252:255]
    buffer_load_dwordx2 v[62:63], v6, s[76:79], s48 offen offset:3584
    v_mfma_f32_16x16x32_bf16 v[248:251], v[88:91], v[124:127], v[248:251]
    v_mfma_f32_16x16x32_bf16 v[244:247], v[84:87], v[124:127], v[244:247]
    v_mfma_f32_16x16x32_bf16 v[240:243], v[80:83], v[124:127], v[240:243]
    ds_read_b128 v[124:127], v2 offset:30720
    s_waitcnt lgkmcnt(7)
    v_mfma_f32_16x16x32_bf16 v[128:131], v[64:67], v[96:99], v[128:131]
    s_waitcnt vmcnt(22)
    v_perm_b32 v80, v18, v16, s68
    v_mfma_f32_16x16x32_bf16 v[132:135], v[68:71], v[96:99], v[132:135]
    v_perm_b32 v84, v18, v16, s69
    v_mfma_f32_16x16x32_bf16 v[136:139], v[72:75], v[96:99], v[136:139]
    v_perm_b32 v88, v19, v17, s68
    v_mfma_f32_16x16x32_bf16 v[140:143], v[76:79], v[96:99], v[140:143]
    ds_read_b128 v[96:99], v3 offset:16384
    v_perm_b32 v92, v19, v17, s69
    s_waitcnt lgkmcnt(7)
    v_mfma_f32_16x16x32_bf16 v[156:159], v[76:79], v[100:103], v[156:159]
    v_mfma_f32_16x16x32_bf16 v[152:155], v[72:75], v[100:103], v[152:155]
    s_add_u32 s48, s49, 98304
    buffer_load_dwordx2 v[16:17], v6, s[76:79], s48 offen
    v_mfma_f32_16x16x32_bf16 v[148:151], v[68:71], v[100:103], v[148:151]
    buffer_load_dwordx2 v[18:19], v6, s[76:79], s48 offen offset:512
    v_mfma_f32_16x16x32_bf16 v[144:147], v[64:67], v[100:103], v[144:147]
    ds_read_b128 v[100:103], v3 offset:18432
    s_waitcnt vmcnt(22)
    v_perm_b32 v81, v22, v20, s68
    s_waitcnt lgkmcnt(7)
    v_mfma_f32_16x16x32_bf16 v[160:163], v[64:67], v[104:107], v[160:163]
    v_perm_b32 v85, v22, v20, s69
    v_mfma_f32_16x16x32_bf16 v[164:167], v[68:71], v[104:107], v[164:167]
    v_mfma_f32_16x16x32_bf16 v[168:171], v[72:75], v[104:107], v[168:171]
    v_perm_b32 v89, v23, v21, s68
    v_mfma_f32_16x16x32_bf16 v[172:175], v[76:79], v[104:107], v[172:175]
    ds_read_b128 v[104:107], v3 offset:20480
    v_perm_b32 v93, v23, v21, s69
    s_waitcnt lgkmcnt(7)
    v_mfma_f32_16x16x32_bf16 v[188:191], v[76:79], v[108:111], v[188:191]
    buffer_load_dwordx2 v[20:21], v6, s[76:79], s48 offen offset:1024
    v_mfma_f32_16x16x32_bf16 v[184:187], v[72:75], v[108:111], v[184:187]
    buffer_load_dwordx2 v[22:23], v6, s[76:79], s48 offen offset:1536
    v_mfma_f32_16x16x32_bf16 v[180:183], v[68:71], v[108:111], v[180:183]
    v_mfma_f32_16x16x32_bf16 v[176:179], v[64:67], v[108:111], v[176:179]
    ds_read_b128 v[108:111], v3 offset:22528
    s_waitcnt vmcnt(22)
    v_perm_b32 v82, v26, v24, s68
    s_waitcnt lgkmcnt(7)
    v_mfma_f32_16x16x32_bf16 v[192:195], v[64:67], v[112:115], v[192:195]
    v_perm_b32 v86, v26, v24, s69
    v_mfma_f32_16x16x32_bf16 v[196:199], v[68:71], v[112:115], v[196:199]
    v_perm_b32 v90, v27, v25, s68
    v_mfma_f32_16x16x32_bf16 v[200:203], v[72:75], v[112:115], v[200:203]
    v_perm_b32 v94, v27, v25, s69
    v_mfma_f32_16x16x32_bf16 v[204:207], v[76:79], v[112:115], v[204:207]
    ds_read_b128 v[112:115], v3 offset:24576
    ds_read_b32 v10, v9
    s_waitcnt lgkmcnt(8)
    v_mfma_f32_16x16x32_bf16 v[220:223], v[76:79], v[116:119], v[220:223]
    buffer_load_dwordx2 v[24:25], v6, s[76:79], s48 offen offset:2048
    v_mfma_f32_16x16x32_bf16 v[216:219], v[72:75], v[116:119], v[216:219]
    buffer_load_dwordx2 v[26:27], v6, s[76:79], s48 offen offset:2560
    v_mfma_f32_16x16x32_bf16 v[212:215], v[68:71], v[116:119], v[212:215]
    s_waitcnt vmcnt(22)
    v_perm_b32 v83, v30, v28, s68
    v_mfma_f32_16x16x32_bf16 v[208:211], v[64:67], v[116:119], v[208:211]
    ds_read_b128 v[116:119], v3 offset:26624
    v_perm_b32 v87, v30, v28, s69
    s_waitcnt lgkmcnt(8)
    v_mfma_f32_16x16x32_bf16 v[224:227], v[64:67], v[120:123], v[224:227]
    v_mfma_f32_16x16x32_bf16 v[228:231], v[68:71], v[120:123], v[228:231]
    v_perm_b32 v91, v31, v29, s68
    v_mfma_f32_16x16x32_bf16 v[232:235], v[72:75], v[120:123], v[232:235]
    v_perm_b32 v95, v31, v29, s69
    v_mfma_f32_16x16x32_bf16 v[236:239], v[76:79], v[120:123], v[236:239]
    ds_read_b128 v[120:123], v3 offset:28672
    buffer_load_dwordx2 v[28:29], v6, s[76:79], s48 offen offset:3072
    s_waitcnt lgkmcnt(8)
    v_mfma_f32_16x16x32_bf16 v[252:255], v[76:79], v[124:127], v[252:255]
    buffer_load_dwordx2 v[30:31], v6, s[76:79], s48 offen offset:3584
    v_mfma_f32_16x16x32_bf16 v[248:251], v[72:75], v[124:127], v[248:251]
    v_mfma_f32_16x16x32_bf16 v[244:247], v[68:71], v[124:127], v[244:247]
    v_mfma_f32_16x16x32_bf16 v[240:243], v[64:67], v[124:127], v[240:243]
    ds_read_b128 v[124:127], v3 offset:30720
    ds_add_u32 v7, v8 offset:16
    s_waitcnt lgkmcnt(9)
    v_mfma_f32_16x16x32_bf16 v[128:131], v[80:83], v[96:99], v[128:131]
    s_waitcnt vmcnt(22)
    v_perm_b32 v64, v34, v32, s68
    v_mfma_f32_16x16x32_bf16 v[132:135], v[84:87], v[96:99], v[132:135]
    s_waitcnt lgkmcnt(4)
    v_cmp_gt_u32 vcc, 3, v10
    v_perm_b32 v68, v34, v32, s69
    v_mfma_f32_16x16x32_bf16 v[136:139], v[88:91], v[96:99], v[136:139]
    s_cbranch_vccnz L_gs3
L_gb3:
    v_perm_b32 v72, v35, v33, s68
    v_mfma_f32_16x16x32_bf16 v[140:143], v[92:95], v[96:99], v[140:143]
    ds_read_b128 v[96:99], v2 offset:32768
    v_perm_b32 v76, v35, v33, s69
    v_mfma_f32_16x16x32_bf16 v[156:159], v[92:95], v[100:103], v[156:159]
    v_mfma_f32_16x16x32_bf16 v[152:155], v[88:91], v[100:103], v[152:155]
    s_add_u32 s48, s49, 114688
    buffer_load_dwordx2 v[32:33], v6, s[76:79], s48 offen
    v_mfma_f32_16x16x32_bf16 v[148:151], v[84:87], v[100:103], v[148:151]
    buffer_load_dwordx2 v[34:35], v6, s[76:79], s48 offen offset:512
    v_mfma_f32_16x16x32_bf16 v[144:147], v[80:83], v[100:103], v[144:147]
    ds_read_b128 v[100:103], v2 offset:34816
    s_waitcnt vmcnt(22)
    v_perm_b32 v65, v38, v36, s68
    v_mfma_f32_16x16x32_bf16 v[160:163], v[80:83], v[104:107], v[160:163]
    v_perm_b32 v69, v38, v36, s69
    v_mfma_f32_16x16x32_bf16 v[164:167], v[84:87], v[104:107], v[164:167]
    v_mfma_f32_16x16x32_bf16 v[168:171], v[88:91], v[104:107], v[168:171]
    v_perm_b32 v73, v39, v37, s68
    v_mfma_f32_16x16x32_bf16 v[172:175], v[92:95], v[104:107], v[172:175]
    ds_read_b128 v[104:107], v2 offset:36864
    v_perm_b32 v77, v39, v37, s69
    v_mfma_f32_16x16x32_bf16 v[188:191], v[92:95], v[108:111], v[188:191]
    buffer_load_dwordx2 v[36:37], v6, s[76:79], s48 offen offset:1024
    v_mfma_f32_16x16x32_bf16 v[184:187], v[88:91], v[108:111], v[184:187]
    buffer_load_dwordx2 v[38:39], v6, s[76:79], s48 offen offset:1536
    v_mfma_f32_16x16x32_bf16 v[180:183], v[84:87], v[108:111], v[180:183]
    v_mfma_f32_16x16x32_bf16 v[176:179], v[80:83], v[108:111], v[176:179]
    ds_read_b128 v[108:111], v2 offset:38912
    s_waitcnt vmcnt(22)
    v_perm_b32 v66, v42, v40, s68
    v_mfma_f32_16x16x32_bf16 v[192:195], v[80:83], v[112:115], v[192:195]
    v_perm_b32 v70, v42, v40, s69
    v_mfma_f32_16x16x32_bf16 v[196:199], v[84:87], v[112:115], v[196:199]
    v_perm_b32 v74, v43, v41, s68
    v_mfma_f32_16x16x32_bf16 v[200:203], v[88:91], v[112:115], v[200:203]
    v_perm_b32 v78, v43, v41, s69
    v_mfma_f32_16x16x32_bf16 v[204:207], v[92:95], v[112:115], v[204:207]
    ds_read_b128 v[112:115], v2 offset:40960
    s_waitcnt lgkmcnt(8)
    v_mfma_f32_16x16x32_bf16 v[220:223], v[92:95], v[116:119], v[220:223]
    buffer_load_dwordx2 v[40:41], v6, s[76:79], s48 offen offset:2048
    v_mfma_f32_16x16x32_bf16 v[216:219], v[88:91], v[116:119], v[216:219]
    buffer_load_dwordx2 v[42:43], v6, s[76:79], s48 offen offset:2560
    v_mfma_f32_16x16x32_bf16 v[212:215], v[84:87], v[116:119], v[212:215]
    s_waitcnt vmcnt(22)
    v_perm_b32 v67, v46, v44, s68
    v_mfma_f32_16x16x32_bf16 v[208:211], v[80:83], v[116:119], v[208:211]
    ds_read_b128 v[116:119], v2 offset:43008
    v_perm_b32 v71, v46, v44, s69
    s_waitcnt lgkmcnt(8)
    v_mfma_f32_16x16x32_bf16 v[224:227], v[80:83], v[120:123], v[224:227]
    v_mfma_f32_16x16x32_bf16 v[228:231], v[84:87], v[120:123], v[228:231]
    v_perm_b32 v75, v47, v45, s68
    v_mfma_f32_16x16x32_bf16 v[232:235], v[88:91], v[120:123], v[232:235]
    v_perm_b32 v79, v47, v45, s69
    v_mfma_f32_16x16x32_bf16 v[236:239], v[92:95], v[120:123], v[236:239]
    ds_read_b128 v[120:123], v2 offset:45056
    buffer_load_dwordx2 v[44:45], v6, s[76:79], s48 offen offset:3072
    s_waitcnt lgkmcnt(8)
    v_mfma_f32_16x16x32_bf16 v[252:255], v[92:95], v[124:127], v[252:255]
    buffer_load_dwordx2 v[46:47], v6, s[76:79], s48 offen offset:3584
    v_mfma_f32_16x16x32_bf16 v[248:251], v[88:91], v[124:127], v[248:251]
    v_mfma_f32_16x16x32_bf16 v[244:247], v[84:87], v[124:127], v[244:247]
    v_mfma_f32_16x16x32_bf16 v[240:243], v[80:83], v[124:127], v[240:243]
    ds_read_b128 v[124:127], v2 offset:47104
    s_waitcnt lgkmcnt(7)
    v_mfma_f32_16x16x32_bf16 v[128:131], v[64:67], v[96:99], v[128:131]
    s_waitcnt vmcnt(22)
    v_perm_b32 v80, v50, v48, s68
    v_mfma_f32_16x16x32_bf16 v[132:135], v[68:71], v[96:99], v[132:135]
    v_perm_b32 v84, v50, v48, s69
    v_mfma_f32_16x16x32_bf16 v[136:139], v[72:75], v[96:99], v[136:139]
    v_perm_b32 v88, v51, v49, s68
    v_mfma_f32_16x16x32_bf16 v[140:143], v[76:79], v[96:99], v[140:143]
    ds_read_b128 v[96:99], v3 offset:32768
    v_perm_b32 v92, v51, v49, s69
    s_waitcnt lgkmcnt(7)
    v_mfma_f32_16x16x32_bf16 v[156:159], v[76:79], v[100:103], v[156:159]
    v_mfma_f32_16x16x32_bf16 v[152:155], v[72:75], v[100:103], v[152:155]
    s_add_u32 s48, s49, 131072
    buffer_load_dwordx2 v[48:49], v6, s[76:79], s48 offen
    v_mfma_f32_16x16x32_bf16 v[148:151], v[68:71], v[100:103], v[148:151]
    buffer_load_dwordx2 v[50:51], v6, s[76:79], s48 offen offset:512
    v_mfma_f32_16x16x32_bf16 v[144:147], v[64:67], v[100:103], v[144:147]
    ds_read_b128 v[100:103], v3 offset:34816
    s_waitcnt vmcnt(22)
    v_perm_b32 v81, v54, v52, s68
    s_waitcnt lgkmcnt(7)
    v_mfma_f32_16x16x32_bf16 v[160:163], v[64:67], v[104:107], v[160:163]
    v_perm_b32 v85, v54, v52, s69
    v_mfma_f32_16x16x32_bf16 v[164:167], v[68:71], v[104:107], v[164:167]
    v_mfma_f32_16x16x32_bf16 v[168:171], v[72:75], v[104:107], v[168:171]
    v_perm_b32 v89, v55, v53, s68
    v_mfma_f32_16x16x32_bf16 v[172:175], v[76:79], v[104:107], v[172:175]
    ds_read_b128 v[104:107], v3 offset:36864
    v_perm_b32 v93, v55, v53, s69
    s_waitcnt lgkmcnt(7)
    v_mfma_f32_16x16x32_bf16 v[188:191], v[76:79], v[108:111], v[188:191]
    buffer_load_dwordx2 v[52:53], v6, s[76:79], s48 offen offset:1024
    v_mfma_f32_16x16x32_bf16 v[184:187], v[72:75], v[108:111], v[184:187]
    buffer_load_dwordx2 v[54:55], v6, s[76:79], s48 offen offset:1536
    v_mfma_f32_16x16x32_bf16 v[180:183], v[68:71], v[108:111], v[180:183]
    v_mfma_f32_16x16x32_bf16 v[176:179], v[64:67], v[108:111], v[176:179]
    ds_read_b128 v[108:111], v3 offset:38912
    s_waitcnt vmcnt(22)
    v_perm_b32 v82, v58, v56, s68
    s_waitcnt lgkmcnt(7)
    v_mfma_f32_16x16x32_bf16 v[192:195], v[64:67], v[112:115], v[192:195]
    v_perm_b32 v86, v58, v56, s69
    v_mfma_f32_16x16x32_bf16 v[196:199], v[68:71], v[112:115], v[196:199]
    v_perm_b32 v90, v59, v57, s68
    v_mfma_f32_16x16x32_bf16 v[200:203], v[72:75], v[112:115], v[200:203]
    v_perm_b32 v94, v59, v57, s69
    v_mfma_f32_16x16x32_bf16 v[204:207], v[76:79], v[112:115], v[204:207]
    ds_read_b128 v[112:115], v3 offset:40960
    ds_read_b32 v10, v9
    s_waitcnt lgkmcnt(8)
    v_mfma_f32_16x16x32_bf16 v[220:223], v[76:79], v[116:119], v[220:223]
    buffer_load_dwordx2 v[56:57], v6, s[76:79], s48 offen offset:2048
    v_mfma_f32_16x16x32_bf16 v[216:219], v[72:75], v[116:119], v[216:219]
    buffer_load_dwordx2 v[58:59], v6, s[76:79], s48 offen offset:2560
    v_mfma_f32_16x16x32_bf16 v[212:215], v[68:71], v[116:119], v[212:215]
    s_waitcnt vmcnt(22)
    v_perm_b32 v83, v62, v60, s68
    v_mfma_f32_16x16x32_bf16 v[208:211], v[64:67], v[116:119], v[208:211]
    ds_read_b128 v[116:119], v3 offset:43008
    v_perm_b32 v87, v62, v60, s69
    s_waitcnt lgkmcnt(8)
    v_mfma_f32_16x16x32_bf16 v[224:227], v[64:67], v[120:123], v[224:227]
    v_mfma_f32_16x16x32_bf16 v[228:231], v[68:71], v[120:123], v[228:231]
    v_perm_b32 v91, v63, v61, s68
    v_mfma_f32_16x16x32_bf16 v[232:235], v[72:75], v[120:123], v[232:235]
    v_perm_b32 v95, v63, v61, s69
    v_mfma_f32_16x16x32_bf16 v[236:239], v[76:79], v[120:123], v[236:239]
    ds_read_b128 v[120:123], v3 offset:45056
    buffer_load_dwordx2 v[60:61], v6, s[76:79], s48 offen offset:3072
    s_waitcnt lgkmcnt(8)
    v_mfma_f32_16x16x32_bf16 v[252:255], v[76:79], v[124:127], v[252:255]
    buffer_load_dwordx2 v[62:63], v6, s[76:79], s48 offen offset:3584
    v_mfma_f32_16x16x32_bf16 v[248:251], v[72:75], v[124:127], v[248:251]
    v_mfma_f32_16x16x32_bf16 v[244:247], v[68:71], v[124:127], v[244:247]
    v_mfma_f32_16x16x32_bf16 v[240:243], v[64:67], v[124:127], v[240:243]
    ds_read_b128 v[124:127], v3 offset:47104
    ds_add_u32 v7, v8 offset:16
    s_waitcnt lgkmcnt(9)
    v_mfma_f32_16x16x32_bf16 v[128:131], v[80:83], v[96:99], v[128:131]
    s_waitcnt vmcnt(22)
    v_perm_b32 v64, v18, v16, s68
    v_mfma_f32_16x16x32_bf16 v[132:135], v[84:87], v[96:99], v[132:135]
    s_waitcnt lgkmcnt(4)
    v_cmp_gt_u32 vcc, 4, v10
    v_perm_b32 v68, v18, v16, s69
    v_mfma_f32_16x16x32_bf16 v[136:139], v[88:91], v[96:99], v[136:139]
    s_cbranch_vccnz L_gs4
L_gb4:
    v_perm_b32 v72, v19, v17, s68
    v_mfma_f32_16x16x32_bf16 v[140:143], v[92:95], v[96:99], v[140:143]
    ds_read_b128 v[96:99], v2 offset:49152
    v_perm_b32 v76, v19, v17, s69
    v_mfma_f32_16x16x32_bf16 v[156:159], v[92:95], v[100:103], v[156:159]
    v_mfma_f32_16x16x32_bf16 v[152:155], v[88:91], v[100:103], v[152:155]
    s_add_u32 s48, s49, 147456
    buffer_load_dwordx2 v[16:17], v6, s[76:79], s48 offen
    v_mfma_f32_16x16x32_bf16 v[148:151], v[84:87], v[100:103], v[148:151]
    buffer_load_dwordx2 v[18:19], v6, s[76:79], s48 offen offset:512
    v_mfma_f32_16x16x32_bf16 v[144:147], v[80:83], v[100:103], v[144:147]
    ds_read_b128 v[100:103], v2 offset:51200
    s_waitcnt vmcnt(22)
    v_perm_b32 v65, v22, v20, s68
    v_mfma_f32_16x16x32_bf16 v[160:163], v[80:83], v[104:107], v[160:163]
    v_perm_b32 v69, v22, v20, s69
    v_mfma_f32_16x16x32_bf16 v[164:167], v[84:87], v[104:107], v[164:167]
    v_mfma_f32_16x16x32_bf16 v[168:171], v[88:91], v[104:107], v[168:171]
    v_perm_b32 v73, v23, v21, s68
    v_mfma_f32_16x16x32_bf16 v[172:175], v[92:95], v[104:107], v[172:175]
    ds_read_b128 v[104:107], v2 offset:53248
    v_perm_b32 v77, v23, v21, s69
    v_mfma_f32_16x16x32_bf16 v[188:191], v[92:95], v[108:111], v[188:191]
    buffer_load_dwordx2 v[20:21], v6, s[76:79], s48 offen offset:1024
    v_mfma_f32_16x16x32_bf16 v[184:187], v[88:91], v[108:111], v[184:187]
    buffer_load_dwordx2 v[22:23], v6, s[76:79], s48 offen offset:1536
    v_mfma_f32_16x16x32_bf16 v[180:183], v[84:87], v[108:111], v[180:183]
    v_mfma_f32_16x16x32_bf16 v[176:179], v[80:83], v[108:111], v[176:179]
    ds_read_b128 v[108:111], v2 offset:55296
    s_waitcnt vmcnt(22)
    v_perm_b32 v66, v26, v24, s68
    v_mfma_f32_16x16x32_bf16 v[192:195], v[80:83], v[112:115], v[192:195]
    v_perm_b32 v70, v26, v24, s69
    v_mfma_f32_16x16x32_bf16 v[196:199], v[84:87], v[112:115], v[196:199]
    v_perm_b32 v74, v27, v25, s68
    v_mfma_f32_16x16x32_bf16 v[200:203], v[88:91], v[112:115], v[200:203]
    v_perm_b32 v78, v27, v25, s69
    v_mfma_f32_16x16x32_bf16 v[204:207], v[92:95], v[112:115], v[204:207]
    ds_read_b128 v[112:115], v2 offset:57344
    s_waitcnt lgkmcnt(8)
    v_mfma_f32_16x16x32_bf16 v[220:223], v[92:95], v[116:119], v[220:223]
    buffer_load_dwordx2 v[24:25], v6, s[76:79], s48 offen offset:2048
    v_mfma_f32_16x16x32_bf16 v[216:219], v[88:91], v[116:119], v[216:219]
    buffer_load_dwordx2 v[26:27], v6, s[76:79], s48 offen offset:2560
    v_mfma_f32_16x16x32_bf16 v[212:215], v[84:87], v[116:119], v[212:215]
    s_waitcnt vmcnt(22)
    v_perm_b32 v67, v30, v28, s68
    v_mfma_f32_16x16x32_bf16 v[208:211], v[80:83], v[116:119], v[208:211]
    ds_read_b128 v[116:119], v2 offset:59392
    v_perm_b32 v71, v30, v28, s69
    s_waitcnt lgkmcnt(8)
    v_mfma_f32_16x16x32_bf16 v[224:227], v[80:83], v[120:123], v[224:227]
    v_mfma_f32_16x16x32_bf16 v[228:231], v[84:87], v[120:123], v[228:231]
    v_perm_b32 v75, v31, v29, s68
    v_mfma_f32_16x16x32_bf16 v[232:235], v[88:91], v[120:123], v[232:235]
    v_perm_b32 v79, v31, v29, s69
    v_mfma_f32_16x16x32_bf16 v[236:239], v[92:95], v[120:123], v[236:239]
    ds_read_b128 v[120:123], v2 offset:61440
    buffer_load_dwordx2 v[28:29], v6, s[76:79], s48 offen offset:3072
    s_waitcnt lgkmcnt(8)
    v_mfma_f32_16x16x32_bf16 v[252:255], v[92:95], v[124:127], v[252:255]
    buffer_load_dwordx2 v[30:31], v6, s[76:79], s48 offen offset:3584
    v_mfma_f32_16x16x32_bf16 v[248:251], v[88:91], v[124:127], v[248:251]
    v_mfma_f32_16x16x32_bf16 v[244:247], v[84:87], v[124:127], v[244:247]
    v_mfma_f32_16x16x32_bf16 v[240:243], v[80:83], v[124:127], v[240:243]
    ds_read_b128 v[124:127], v2 offset:63488
    s_waitcnt lgkmcnt(7)
    v_mfma_f32_16x16x32_bf16 v[128:131], v[64:67], v[96:99], v[128:131]
    s_waitcnt vmcnt(22)
    v_perm_b32 v80, v34, v32, s68
    v_mfma_f32_16x16x32_bf16 v[132:135], v[68:71], v[96:99], v[132:135]
    v_perm_b32 v84, v34, v32, s69
    v_mfma_f32_16x16x32_bf16 v[136:139], v[72:75], v[96:99], v[136:139]
    v_perm_b32 v88, v35, v33, s68
    v_mfma_f32_16x16x32_bf16 v[140:143], v[76:79], v[96:99], v[140:143]
    ds_read_b128 v[96:99], v3 offset:49152
    v_perm_b32 v92, v35, v33, s69
    s_waitcnt lgkmcnt(7)
    v_mfma_f32_16x16x32_bf16 v[156:159], v[76:79], v[100:103], v[156:159]
    v_mfma_f32_16x16x32_bf16 v[152:155], v[72:75], v[100:103], v[152:155]
    s_add_u32 s48, s49, 163840
    buffer_load_dwordx2 v[32:33], v6, s[76:79], s48 offen
    v_mfma_f32_16x16x32_bf16 v[148:151], v[68:71], v[100:103], v[148:151]
    buffer_load_dwordx2 v[34:35], v6, s[76:79], s48 offen offset:512
    v_mfma_f32_16x16x32_bf16 v[144:147], v[64:67], v[100:103], v[144:147]
    ds_read_b128 v[100:103], v3 offset:51200
    s_waitcnt vmcnt(22)
    v_perm_b32 v81, v38, v36, s68
    s_waitcnt lgkmcnt(7)
    v_mfma_f32_16x16x32_bf16 v[160:163], v[64:67], v[104:107], v[160:163]
    v_perm_b32 v85, v38, v36, s69
    v_mfma_f32_16x16x32_bf16 v[164:167], v[68:71], v[104:107], v[164:167]
    v_mfma_f32_16x16x32_bf16 v[168:171], v[72:75], v[104:107], v[168:171]
    v_perm_b32 v89, v39, v37, s68
    v_mfma_f32_16x16x32_bf16 v[172:175], v[76:79], v[104:107], v[172:175]
    ds_read_b128 v[104:107], v3 offset:53248
    v_perm_b32 v93, v39, v37, s69
    s_waitcnt lgkmcnt(7)
    v_mfma_f32_16x16x32_bf16 v[188:191], v[76:79], v[108:111], v[188:191]
    buffer_load_dwordx2 v[36:37], v6, s[76:79], s48 offen offset:1024
    v_mfma_f32_16x16x32_bf16 v[184:187], v[72:75], v[108:111], v[184:187]
    buffer_load_dwordx2 v[38:39], v6, s[76:79], s48 offen offset:1536
    v_mfma_f32_16x16x32_bf16 v[180:183], v[68:71], v[108:111], v[180:183]
    v_mfma_f32_16x16x32_bf16 v[176:179], v[64:67], v[108:111], v[176:179]
    ds_read_b128 v[108:111], v3 offset:55296
    s_waitcnt vmcnt(22)
    v_perm_b32 v82, v42, v40, s68
    s_waitcnt lgkmcnt(7)
    v_mfma_f32_16x16x32_bf16 v[192:195], v[64:67], v[112:115], v[192:195]
    v_perm_b32 v86, v42, v40, s69
    v_mfma_f32_16x16x32_bf16 v[196:199], v[68:71], v[112:115], v[196:199]
    v_perm_b32 v90, v43, v41, s68
    v_mfma_f32_16x16x32_bf16 v[200:203], v[72:75], v[112:115], v[200:203]
    v_perm_b32 v94, v43, v41, s69
    v_mfma_f32_16x16x32_bf16 v[204:207], v[76:79], v[112:115], v[204:207]
    ds_read_b128 v[112:115], v3 offset:57344
    ds_read_b32 v10, v9
    s_waitcnt lgkmcnt(8)
    v_mfma_f32_16x16x32_bf16 v[220:223], v[76:79], v[116:119], v[220:223]
    buffer_load_dwordx2 v[40:41], v6, s[76:79], s48 offen offset:2048
    v_mfma_f32_16x16x32_bf16 v[216:219], v[72:75], v[116:119], v[216:219]
    buffer_load_dwordx2 v[42:43], v6, s[76:79], s48 offen offset:2560
    v_mfma_f32_16x16x32_bf16 v[212:215], v[68:71], v[116:119], v[212:215]
    s_waitcnt vmcnt(22)
    v_perm_b32 v83, v46, v44, s68
    v_mfma_f32_16x16x32_bf16 v[208:211], v[64:67], v[116:119], v[208:211]
    ds_read_b128 v[116:119], v3 offset:59392
    v_perm_b32 v87, v46, v44, s69
    s_waitcnt lgkmcnt(8)
    v_mfma_f32_16x16x32_bf16 v[224:227], v[64:67], v[120:123], v[224:227]
    v_mfma_f32_16x16x32_bf16 v[228:231], v[68:71], v[120:123], v[228:231]
    v_perm_b32 v91, v47, v45, s68
    v_mfma_f32_16x16x32_bf16 v[232:235], v[72:75], v[120:123], v[232:235]
    v_perm_b32 v95, v47, v45, s69
    v_mfma_f32_16x16x32_bf16 v[236:239], v[76:79], v[120:123], v[236:239]
    ds_read_b128 v[120:123], v3 offset:61440
    buffer_load_dwordx2 v[44:45], v6, s[76:79], s48 offen offset:3072
    s_waitcnt lgkmcnt(8)
    v_mfma_f32_16x16x32_bf16 v[252:255], v[76:79], v[124:127], v[252:255]
    buffer_load_dwordx2 v[46:47], v6, s[76:79], s48 offen offset:3584
    v_mfma_f32_16x16x32_bf16 v[248:251], v[72:75], v[124:127], v[248:251]
    v_mfma_f32_16x16x32_bf16 v[244:247], v[68:71], v[124:127], v[244:247]
    v_mfma_f32_16x16x32_bf16 v[240:243], v[64:67], v[124:127], v[240:243]
    ds_read_b128 v[124:127], v3 offset:63488
    ds_add_u32 v7, v8 offset:16
    s_waitcnt lgkmcnt(9)
    v_mfma_f32_16x16x32_bf16 v[128:131], v[80:83], v[96:99], v[128:131]
    s_waitcnt vmcnt(22)
    v_perm_b32 v64, v50, v48, s68
    v_mfma_f32_16x16x32_bf16 v[132:135], v[84:87], v[96:99], v[132:135]
    s_waitcnt lgkmcnt(4)
    v_cmp_gt_u32 vcc, 5, v10
    v_perm_b32 v68, v50, v48, s69
    v_mfma_f32_16x16x32_bf16 v[136:139], v[88:91], v[96:99], v[136:139]
    s_cbranch_vccnz L_gs5
L_gb5:
    v_perm_b32 v72, v51, v49, s68
    v_mfma_f32_16x16x32_bf16 v[140:143], v[92:95], v[96:99], v[140:143]
    ds_read_b128 v[96:99], v4 offset:0
    v_perm_b32 v76, v51, v49, s69
    v_mfma_f32_16x16x32_bf16 v[156:159], v[92:95], v[100:103], v[156:159]
    v_mfma_f32_16x16x32_bf16 v[152:155], v[88:91], v[100:103], v[152:155]
    s_add_u32 s48, s49, 180224
    buffer_load_dwordx2 v[48:49], v6, s[76:79], s48 offen
    v_mfma_f32_16x16x32_bf16 v[148:151], v[84:87], v[100:103], v[148:151]
    buffer_load_dwordx2 v[50:51], v6, s[76:79], s48 offen offset:512
    v_mfma_f32_16x16x32_bf16 v[144:147], v[80:83], v[100:103], v[144:147]
    ds_read_b128 v[100:103], v4 offset:2048
    s_waitcnt vmcnt(22)
    v_perm_b32 v65, v54, v52, s68
    v_mfma_f32_16x16x32_bf16 v[160:163], v[80:83], v[104:107], v[160:163]
    v_perm_b32 v69, v54, v52, s69
    v_mfma_f32_16x16x32_bf16 v[164:167], v[84:87], v[104:107], v[164:167]
    v_mfma_f32_16x16x32_bf16 v[168:171], v[88:91], v[104:107], v[168:171]
    v_perm_b32 v73, v55, v53, s68
    v_mfma_f32_16x16x32_bf16 v[172:175], v[92:95], v[104:107], v[172:175]
    ds_read_b128 v[104:107], v4 offset:4096
    v_perm_b32 v77, v55, v53, s69
    v_mfma_f32_16x16x32_bf16 v[188:191], v[92:95], v[108:111], v[188:191]
    buffer_load_dwordx2 v[52:53], v6, s[76:79], s48 offen offset:1024
    v_mfma_f32_16x16x32_bf16 v[184:187], v[88:91], v[108:111], v[184:187]
    buffer_load_dwordx2 v[54:55], v6, s[76:79], s48 offen offset:1536
    v_mfma_f32_16x16x32_bf16 v[180:183], v[84:87], v[108:111], v[180:183]
    v_mfma_f32_16x16x32_bf16 v[176:179], v[80:83], v[108:111], v[176:179]
    ds_read_b128 v[108:111], v4 offset:6144
    s_waitcnt vmcnt(22)
    v_perm_b32 v66, v58, v56, s68
    v_mfma_f32_16x16x32_bf16 v[192:195], v[80:83], v[112:115], v[192:195]
    v_perm_b32 v70, v58, v56, s69
    v_mfma_f32_16x16x32_bf16 v[196:199], v[84:87], v[112:115], v[196:199]
    v_perm_b32 v74, v59, v57, s68
    v_mfma_f32_16x16x32_bf16 v[200:203], v[88:91], v[112:115], v[200:203]
    v_perm_b32 v78, v59, v57, s69
    v_mfma_f32_16x16x32_bf16 v[204:207], v[92:95], v[112:115], v[204:207]
    ds_read_b128 v[112:115], v4 offset:8192
    s_waitcnt lgkmcnt(8)
    v_mfma_f32_16x16x32_bf16 v[220:223], v[92:95], v[116:119], v[220:223]
    buffer_load_dwordx2 v[56:57], v6, s[76:79], s48 offen offset:2048
    v_mfma_f32_16x16x32_bf16 v[216:219], v[88:91], v[116:119], v[216:219]
    buffer_load_dwordx2 v[58:59], v6, s[76:79], s48 offen offset:2560
    v_mfma_f32_16x16x32_bf16 v[212:215], v[84:87], v[116:119], v[212:215]
    s_waitcnt vmcnt(22)
    v_perm_b32 v67, v62, v60, s68
    v_mfma_f32_16x16x32_bf16 v[208:211], v[80:83], v[116:119], v[208:211]
    ds_read_b128 v[116:119], v4 offset:10240
    v_perm_b32 v71, v62, v60, s69
    s_waitcnt lgkmcnt(8)
    v_mfma_f32_16x16x32_bf16 v[224:227], v[80:83], v[120:123], v[224:227]
    v_mfma_f32_16x16x32_bf16 v[228:231], v[84:87], v[120:123], v[228:231]
    v_perm_b32 v75, v63, v61, s68
    v_mfma_f32_16x16x32_bf16 v[232:235], v[88:91], v[120:123], v[232:235]
    v_perm_b32 v79, v63, v61, s69
    v_mfma_f32_16x16x32_bf16 v[236:239], v[92:95], v[120:123], v[236:239]
    ds_read_b128 v[120:123], v4 offset:12288
    buffer_load_dwordx2 v[60:61], v6, s[76:79], s48 offen offset:3072
    s_waitcnt lgkmcnt(8)
    v_mfma_f32_16x16x32_bf16 v[252:255], v[92:95], v[124:127], v[252:255]
    buffer_load_dwordx2 v[62:63], v6, s[76:79], s48 offen offset:3584
    v_mfma_f32_16x16x32_bf16 v[248:251], v[88:91], v[124:127], v[248:251]
    v_mfma_f32_16x16x32_bf16 v[244:247], v[84:87], v[124:127], v[244:247]
    v_mfma_f32_16x16x32_bf16 v[240:243], v[80:83], v[124:127], v[240:243]
    ds_read_b128 v[124:127], v4 offset:14336
    s_waitcnt lgkmcnt(7)
    v_mfma_f32_16x16x32_bf16 v[128:131], v[64:67], v[96:99], v[128:131]
    s_waitcnt vmcnt(22)
    v_perm_b32 v80, v18, v16, s68
    v_mfma_f32_16x16x32_bf16 v[132:135], v[68:71], v[96:99], v[132:135]
    v_perm_b32 v84, v18, v16, s69
    v_mfma_f32_16x16x32_bf16 v[136:139], v[72:75], v[96:99], v[136:139]
    v_perm_b32 v88, v19, v17, s68
    v_mfma_f32_16x16x32_bf16 v[140:143], v[76:79], v[96:99], v[140:143]
    ds_read_b128 v[96:99], v5 offset:0
    v_perm_b32 v92, v19, v17, s69
    s_waitcnt lgkmcnt(7)
    v_mfma_f32_16x16x32_bf16 v[156:159], v[76:79], v[100:103], v[156:159]
    v_mfma_f32_16x16x32_bf16 v[152:155], v[72:75], v[100:103], v[152:155]
    s_add_u32 s48, s49, 196608
    buffer_load_dwordx2 v[16:17], v6, s[76:79], s48 offen
    v_mfma_f32_16x16x32_bf16 v[148:151], v[68:71], v[100:103], v[148:151]
    buffer_load_dwordx2 v[18:19], v6, s[76:79], s48 offen offset:512
    v_mfma_f32_16x16x32_bf16 v[144:147], v[64:67], v[100:103], v[144:147]
    ds_read_b128 v[100:103], v5 offset:2048
    s_waitcnt vmcnt(22)
    v_perm_b32 v81, v22, v20, s68
    s_waitcnt lgkmcnt(7)
    v_mfma_f32_16x16x32_bf16 v[160:163], v[64:67], v[104:107], v[160:163]
    v_perm_b32 v85, v22, v20, s69
    v_mfma_f32_16x16x32_bf16 v[164:167], v[68:71], v[104:107], v[164:167]
    v_mfma_f32_16x16x32_bf16 v[168:171], v[72:75], v[104:107], v[168:171]
    v_perm_b32 v89, v23, v21, s68
    v_mfma_f32_16x16x32_bf16 v[172:175], v[76:79], v[104:107], v[172:175]
    ds_read_b128 v[104:107], v5 offset:4096
    v_perm_b32 v93, v23, v21, s69
    s_waitcnt lgkmcnt(7)
    v_mfma_f32_16x16x32_bf16 v[188:191], v[76:79], v[108:111], v[188:191]
    buffer_load_dwordx2 v[20:21], v6, s[76:79], s48 offen offset:1024
    v_mfma_f32_16x16x32_bf16 v[184:187], v[72:75], v[108:111], v[184:187]
    buffer_load_dwordx2 v[22:23], v6, s[76:79], s48 offen offset:1536
    v_mfma_f32_16x16x32_bf16 v[180:183], v[68:71], v[108:111], v[180:183]
    v_mfma_f32_16x16x32_bf16 v[176:179], v[64:67], v[108:111], v[176:179]
    ds_read_b128 v[108:111], v5 offset:6144
    s_waitcnt vmcnt(22)
    v_perm_b32 v82, v26, v24, s68
    s_waitcnt lgkmcnt(7)
    v_mfma_f32_16x16x32_bf16 v[192:195], v[64:67], v[112:115], v[192:195]
    v_perm_b32 v86, v26, v24, s69
    v_mfma_f32_16x16x32_bf16 v[196:199], v[68:71], v[112:115], v[196:199]
    v_perm_b32 v90, v27, v25, s68
    v_mfma_f32_16x16x32_bf16 v[200:203], v[72:75], v[112:115], v[200:203]
    v_perm_b32 v94, v27, v25, s69
    v_mfma_f32_16x16x32_bf16 v[204:207], v[76:79], v[112:115], v[204:207]
    ds_read_b128 v[112:115], v5 offset:8192
    ds_read_b32 v10, v9
    s_waitcnt lgkmcnt(8)
    v_mfma_f32_16x16x32_bf16 v[220:223], v[76:79], v[116:119], v[220:223]
    buffer_load_dwordx2 v[24:25], v6, s[76:79], s48 offen offset:2048
    v_mfma_f32_16x16x32_bf16 v[216:219], v[72:75], v[116:119], v[216:219]
    buffer_load_dwordx2 v[26:27], v6, s[76:79], s48 offen offset:2560
    v_mfma_f32_16x16x32_bf16 v[212:215], v[68:71], v[116:119], v[212:215]
    s_waitcnt vmcnt(22)
    v_perm_b32 v83, v30, v28, s68
    v_mfma_f32_16x16x32_bf16 v[208:211], v[64:67], v[116:119], v[208:211]
    ds_read_b128 v[116:119], v5 offset:10240
    v_perm_b32 v87, v30, v28, s69
    s_waitcnt lgkmcnt(8)
    v_mfma_f32_16x16x32_bf16 v[224:227], v[64:67], v[120:123], v[224:227]
    v_mfma_f32_16x16x32_bf16 v[228:231], v[68:71], v[120:123], v[228:231]
    v_perm_b32 v91, v31, v29, s68
    v_mfma_f32_16x16x32_bf16 v[232:235], v[72:75], v[120:123], v[232:235]
    v_perm_b32 v95, v31, v29, s69
    v_mfma_f32_16x16x32_bf16 v[236:239], v[76:79], v[120:123], v[236:239]
    ds_read_b128 v[120:123], v5 offset:12288
    buffer_load_dwordx2 v[28:29], v6, s[76:79], s48 offen offset:3072
    s_waitcnt lgkmcnt(8)
    v_mfma_f32_16x16x32_bf16 v[252:255], v[76:79], v[124:127], v[252:255]
    buffer_load_dwordx2 v[30:31], v6, s[76:79], s48 offen offset:3584
    v_mfma_f32_16x16x32_bf16 v[248:251], v[72:75], v[124:127], v[248:251]
    v_mfma_f32_16x16x32_bf16 v[244:247], v[68:71], v[124:127], v[244:247]
    v_mfma_f32_16x16x32_bf16 v[240:243], v[64:67], v[124:127], v[240:243]
    ds_read_b128 v[124:127], v5 offset:14336
    ds_add_u32 v7, v8 offset:16
    s_waitcnt lgkmcnt(9)
    v_mfma_f32_16x16x32_bf16 v[128:131], v[80:83], v[96:99], v[128:131]
    s_waitcnt vmcnt(22)
    v_perm_b32 v64, v34, v32, s68
    v_mfma_f32_16x16x32_bf16 v[132:135], v[84:87], v[96:99], v[132:135]
    s_waitcnt lgkmcnt(4)
    v_cmp_gt_u32 vcc, 6, v10
    v_perm_b32 v68, v34, v32, s69
    v_mfma_f32_16x16x32_bf16 v[136:139], v[88:91], v[96:99], v[136:139]
    s_cbranch_vccnz L_gs6
L_gb6:
    v_perm_b32 v72, v35, v33, s68
    v_mfma_f32_16x16x32_bf16 v[140:143], v[92:95], v[96:99], v[140:143]
    ds_read_b128 v[96:99], v2 offset:0
    v_perm_b32 v76, v35, v33, s69
    v_mfma_f32_16x16x32_bf16 v[156:159], v[92:95], v[100:103], v[156:159]
    v_mfma_f32_16x16x32_bf16 v[152:155], v[88:91], v[100:103], v[152:155]
    s_add_u32 s48, s49, 212992
    buffer_load_dwordx2 v[32:33], v6, s[76:79], s48 offen
    v_mfma_f32_16x16x32_bf16 v[148:151], v[84:87], v[100:103], v[148:151]
    buffer_load_dwordx2 v[34:35], v6, s[76:79], s48 offen offset:512
    v_mfma_f32_16x16x32_bf16 v[144:147], v[80:83], v[100:103], v[144:147]
    ds_read_b128 v[100:103], v2 offset:2048
    s_waitcnt vmcnt(22)
    v_perm_b32 v65, v38, v36, s68
    v_mfma_f32_16x16x32_bf16 v[160:163], v[80:83], v[104:107], v[160:163]
    v_perm_b32 v69, v38, v36, s69
    v_mfma_f32_16x16x32_bf16 v[164:167], v[84:87], v[104:107], v[164:167]
    v_mfma_f32_16x16x32_bf16 v[168:171], v[88:91], v[104:107], v[168:171]
    v_perm_b32 v73, v39, v37, s68
    v_mfma_f32_16x16x32_bf16 v[172:175], v[92:95], v[104:107], v[172:175]
    ds_read_b128 v[104:107], v2 offset:4096
    v_perm_b32 v77, v39, v37, s69
    v_mfma_f32_16x16x32_bf16 v[188:191], v[92:95], v[108:111], v[188:191]
    buffer_load_dwordx2 v[36:37], v6, s[76:79], s48 offen offset:1024
    v_mfma_f32_16x16x32_bf16 v[184:187], v[88:91], v[108:111], v[184:187]
    buffer_load_dwordx2 v[38:39], v6, s[76:79], s48 offen offset:1536
    v_mfma_f32_16x16x32_bf16 v[180:183], v[84:87], v[108:111], v[180:183]
    v_mfma_f32_16x16x32_bf16 v[176:179], v[80:83], v[108:111], v[176:179]
    ds_read_b128 v[108:111], v2 offset:6144
    s_waitcnt vmcnt(22)
    v_perm_b32 v66, v42, v40, s68
    v_mfma_f32_16x16x32_bf16 v[192:195], v[80:83], v[112:115], v[192:195]
    v_perm_b32 v70, v42, v40, s69
    v_mfma_f32_16x16x32_bf16 v[196:199], v[84:87], v[112:115], v[196:199]
    v_perm_b32 v74, v43, v41, s68
    v_mfma_f32_16x16x32_bf16 v[200:203], v[88:91], v[112:115], v[200:203]
    v_perm_b32 v78, v43, v41, s69
    v_mfma_f32_16x16x32_bf16 v[204:207], v[92:95], v[112:115], v[204:207]
    ds_read_b128 v[112:115], v2 offset:8192
    s_waitcnt lgkmcnt(8)
    v_mfma_f32_16x16x32_bf16 v[220:223], v[92:95], v[116:119], v[220:223]
    buffer_load_dwordx2 v[40:41], v6, s[76:79], s48 offen offset:2048
    v_mfma_f32_16x16x32_bf16 v[216:219], v[88:91], v[116:119], v[216:219]
    buffer_load_dwordx2 v[42:43], v6, s[76:79], s48 offen offset:2560
    v_mfma_f32_16x16x32_bf16 v[212:215], v[84:87], v[116:119], v[212:215]
    s_waitcnt vmcnt(22)
    v_perm_b32 v67, v46, v44, s68
    v_mfma_f32_16x16x32_bf16 v[208:211], v[80:83], v[116:119], v[208:211]
    ds_read_b128 v[116:119], v2 offset:10240
    v_perm_b32 v71, v46, v44, s69
    s_waitcnt lgkmcnt(8)
    v_mfma_f32_16x16x32_bf16 v[224:227], v[80:83], v[120:123], v[224:227]
    v_mfma_f32_16x16x32_bf16 v[228:231], v[84:87], v[120:123], v[228:231]
    v_perm_b32 v75, v47, v45, s68
    v_mfma_f32_16x16x32_bf16 v[232:235], v[88:91], v[120:123], v[232:235]
    v_perm_b32 v79, v47, v45, s69
    v_mfma_f32_16x16x32_bf16 v[236:239], v[92:95], v[120:123], v[236:239]
    ds_read_b128 v[120:123], v2 offset:12288
    buffer_load_dwordx2 v[44:45], v6, s[76:79], s48 offen offset:3072
    s_waitcnt lgkmcnt(8)
    v_mfma_f32_16x16x32_bf16 v[252:255], v[92:95], v[124:127], v[252:255]
    buffer_load_dwordx2 v[46:47], v6, s[76:79], s48 offen offset:3584
    v_mfma_f32_16x16x32_bf16 v[248:251], v[88:91], v[124:127], v[248:251]
    v_mfma_f32_16x16x32_bf16 v[244:247], v[84:87], v[124:127], v[244:247]
    v_mfma_f32_16x16x32_bf16 v[240:243], v[80:83], v[124:127], v[240:243]
    ds_read_b128 v[124:127], v2 offset:14336
    s_setprio 0
    s_waitcnt lgkmcnt(7)
    v_mfma_f32_16x16x32_bf16 v[128:131], v[64:67], v[96:99], v[128:131]
    s_waitcnt vmcnt(22)
    v_perm_b32 v80, v50, v48, s68
    v_mfma_f32_16x16x32_bf16 v[132:135], v[68:71], v[96:99], v[132:135]
    v_perm_b32 v84, v50, v48, s69
    v_mfma_f32_16x16x32_bf16 v[136:139], v[72:75], v[96:99], v[136:139]
    v_perm_b32 v88, v51, v49, s68
    v_mfma_f32_16x16x32_bf16 v[140:143], v[76:79], v[96:99], v[140:143]
    ds_read_b128 v[96:99], v3 offset:0
    v_perm_b32 v92, v51, v49, s69
    s_waitcnt lgkmcnt(7)
    v_mfma_f32_16x16x32_bf16 v[156:159], v[76:79], v[100:103], v[156:159]
    v_mfma_f32_16x16x32_bf16 v[152:155], v[72:75], v[100:103], v[152:155]
    v_mfma_f32_16x16x32_bf16 v[148:151], v[68:71], v[100:103], v[148:151]
    v_mfma_f32_16x16x32_bf16 v[144:147], v[64:67], v[100:103], v[144:147]
    ds_read_b128 v[100:103], v3 offset:2048
    s_waitcnt vmcnt(20)
    v_perm_b32 v81, v54, v52, s68
    s_waitcnt lgkmcnt(7)
    v_mfma_f32_16x16x32_bf16 v[160:163], v[64:67], v[104:107], v[160:163]
    v_perm_b32 v85, v54, v52, s69
    v_mfma_f32_16x16x32_bf16 v[164:167], v[68:71], v[104:107], v[164:167]
    v_mfma_f32_16x16x32_bf16 v[168:171], v[72:75], v[104:107], v[168:171]
    v_perm_b32 v89, v55, v53, s68
    v_mfma_f32_16x16x32_bf16 v[172:175], v[76:79], v[104:107], v[172:175]
    ds_read_b128 v[104:107], v3 offset:4096
    v_perm_b32 v93, v55, v53, s69
    s_waitcnt lgkmcnt(7)
    v_mfma_f32_16x16x32_bf16 v[188:191], v[76:79], v[108:111], v[188:191]
    v_mfma_f32_16x16x32_bf16 v[184:187], v[72:75], v[108:111], v[184:187]
    v_mfma_f32_16x16x32_bf16 v[180:183], v[68:71], v[108:111], v[180:183]
    v_mfma_f32_16x16x32_bf16 v[176:179], v[64:67], v[108:111], v[176:179]
    ds_read_b128 v[108:111], v3 offset:6144
    s_waitcnt vmcnt(18)
    v_perm_b32 v82, v58, v56, s68
    s_waitcnt lgkmcnt(7)
    v_mfma_f32_16x16x32_bf16 v[192:195], v[64:67], v[112:115], v[192:195]
    v_perm_b32 v86, v58, v56, s69
    v_mfma_f32_16x16x32_bf16 v[196:199], v[68:71], v[112:115], v[196:199]
    v_perm_b32 v90, v59, v57, s68
    v_mfma_f32_16x16x32_bf16 v[200:203], v[72:75], v[112:115], v[200:203]
    v_perm_b32 v94, v59, v57, s69
    v_mfma_f32_16x16x32_bf16 v[204:207], v[76:79], v[112:115], v[204:207]
    ds_read_b128 v[112:115], v3 offset:8192
    ds_read_b32 v10, v9
    s_waitcnt lgkmcnt(8)
    v_mfma_f32_16x16x32_bf16 v[220:223], v[76:79], v[116:119], v[220:223]
    v_mfma_f32_16x16x32_bf16 v[216:219], v[72:75], v[116:119], v[216:219]
    v_mfma_f32_16x16x32_bf16 v[212:215], v[68:71], v[116:119], v[212:215]
    s_waitcnt vmcnt(16)
    v_perm_b32 v83, v62, v60, s68
    v_mfma_f32_16x16x32_bf16 v[208:211], v[64:67], v[116:119], v[208:211]
    ds_read_b128 v[116:119], v3 offset:10240
    v_perm_b32 v87, v62, v60, s69
    s_waitcnt lgkmcnt(8)
    v_mfma_f32_16x16x32_bf16 v[224:227], v[64:67], v[120:123], v[224:227]
    v_mfma_f32_16x16x32_bf16 v[228:231], v[68:71], v[120:123], v[228:231]
    v_perm_b32 v91, v63, v61, s68
    v_mfma_f32_16x16x32_bf16 v[232:235], v[72:75], v[120:123], v[232:235]
    v_perm_b32 v95, v63, v61, s69
    v_mfma_f32_16x16x32_bf16 v[236:239], v[76:79], v[120:123], v[236:239]
    ds_read_b128 v[120:123], v3 offset:12288
    s_waitcnt lgkmcnt(8)
    v_mfma_f32_16x16x32_bf16 v[252:255], v[76:79], v[124:127], v[252:255]
    v_mfma_f32_16x16x32_bf16 v[248:251], v[72:75], v[124:127], v[248:251]
    v_mfma_f32_16x16x32_bf16 v[244:247], v[68:71], v[124:127], v[244:247]
    v_mfma_f32_16x16x32_bf16 v[240:243], v[64:67], v[124:127], v[240:243]
    ds_read_b128 v[124:127], v3 offset:14336
    ds_add_u32 v7, v8 offset:16
    ds_read_b32 v15, v9 offset:64
    s_waitcnt lgkmcnt(0)
    v_cmp_gt_u32 vcc, 1, v15
    s_nop 1
    s_cbranch_vccnz L_gs7
L_gb7:
    v_mfma_f32_16x16x32_bf16 v[128:131], v[80:83], v[96:99], v[128:131]
    s_waitcnt vmcnt(14)
    v_perm_b32 v64, v18, v16, s68
    s_add_u32 s48, s49, 229376
    buffer_load_dwordx4 v[48:51], v1, s[80:83], s48 offen sc1
    v_mfma_f32_16x16x32_bf16 v[132:135], v[84:87], v[96:99], v[132:135]
    v_cmp_gt_u32 vcc, 7, v10
    v_perm_b32 v68, v18, v16, s69
    v_mfma_f32_16x16x32_bf16 v[136:139], v[88:91], v[96:99], v[136:139]
    s_cbranch_vccnz L_gs8
L_gb8:
    v_perm_b32 v72, v19, v17, s68
    buffer_load_dwordx4 v[52:55], v1, s[80:83], s48 offen offset:1024 sc1
    v_mfma_f32_16x16x32_bf16 v[140:143], v[92:95], v[96:99], v[140:143]
    ds_read_b128 v[96:99], v2 offset:16384
    v_perm_b32 v76, v19, v17, s69
    v_mfma_f32_16x16x32_bf16 v[156:159], v[92:95], v[100:103], v[156:159]
    buffer_load_dwordx4 v[56:59], v1, s[80:83], s48 offen offset:2048 sc1
    v_mfma_f32_16x16x32_bf16 v[152:155], v[88:91], v[100:103], v[152:155]
    v_mfma_f32_16x16x32_bf16 v[148:151], v[84:87], v[100:103], v[148:151]
    buffer_load_dwordx4 v[60:63], v1, s[80:83], s48 offen offset:3072 sc1
    v_mfma_f32_16x16x32_bf16 v[144:147], v[80:83], v[100:103], v[144:147]
    ds_read_b128 v[100:103], v2 offset:18432
    s_waitcnt vmcnt(16)
    v_perm_b32 v65, v22, v20, s68
    v_mfma_f32_16x16x32_bf16 v[160:163], v[80:83], v[104:107], v[160:163]
    v_perm_b32 v69, v22, v20, s69
    v_mfma_f32_16x16x32_bf16 v[164:167], v[84:87], v[104:107], v[164:167]
    v_mfma_f32_16x16x32_bf16 v[168:171], v[88:91], v[104:107], v[168:171]
    v_perm_b32 v73, v23, v21, s68
    v_mfma_f32_16x16x32_bf16 v[172:175], v[92:95], v[104:107], v[172:175]
    ds_read_b128 v[104:107], v2 offset:20480
    v_perm_b32 v77, v23, v21, s69
    v_mfma_f32_16x16x32_bf16 v[188:191], v[92:95], v[108:111], v[188:191]
    v_mfma_f32_16x16x32_bf16 v[184:187], v[88:91], v[108:111], v[184:187]
    v_mfma_f32_16x16x32_bf16 v[180:183], v[84:87], v[108:111], v[180:183]
    v_mfma_f32_16x16x32_bf16 v[176:179], v[80:83], v[108:111], v[176:179]
    ds_read_b128 v[108:111], v2 offset:22528
    s_waitcnt vmcnt(14)
    v_perm_b32 v66, v26, v24, s68
    v_mfma_f32_16x16x32_bf16 v[192:195], v[80:83], v[112:115], v[192:195]
    v_perm_b32 v70, v26, v24, s69
    v_mfma_f32_16x16x32_bf16 v[196:199], v[84:87], v[112:115], v[196:199]
    v_perm_b32 v74, v27, v25, s68
    v_mfma_f32_16x16x32_bf16 v[200:203], v[88:91], v[112:115], v[200:203]
    v_perm_b32 v78, v27, v25, s69
    v_mfma_f32_16x16x32_bf16 v[204:207], v[92:95], v[112:115], v[204:207]
    ds_read_b128 v[112:115], v2 offset:24576
    v_mfma_f32_16x16x32_bf16 v[220:223], v[92:95], v[116:119], v[220:223]
    v_mfma_f32_16x16x32_bf16 v[216:219], v[88:91], v[116:119], v[216:219]
    v_mfma_f32_16x16x32_bf16 v[212:215], v[84:87], v[116:119], v[212:215]
    s_waitcnt vmcnt(12)
    v_perm_b32 v67, v30, v28, s68
    v_mfma_f32_16x16x32_bf16 v[208:211], v[80:83], v[116:119], v[208:211]
    ds_read_b128 v[116:119], v2 offset:26624
    v_perm_b32 v71, v30, v28, s69
    v_mfma_f32_16x16x32_bf16 v[224:227], v[80:83], v[120:123], v[224:227]
    v_mfma_f32_16x16x32_bf16 v[228:231], v[84:87], v[120:123], v[228:231]
    v_perm_b32 v75, v31, v29, s68
    v_mfma_f32_16x16x32_bf16 v[232:235], v[88:91], v[120:123], v[232:235]
    v_perm_b32 v79, v31, v29, s69
    v_mfma_f32_16x16x32_bf16 v[236:239], v[92:95], v[120:123], v[236:239]
    ds_read_b128 v[120:123], v2 offset:28672
    v_mfma_f32_16x16x32_bf16 v[252:255], v[92:95], v[124:127], v[252:255]
    v_mfma_f32_16x16x32_bf16 v[248:251], v[88:91], v[124:127], v[248:251]
    v_mfma_f32_16x16x32_bf16 v[244:247], v[84:87], v[124:127], v[244:247]
    v_mfma_f32_16x16x32_bf16 v[240:243], v[80:83], v[124:127], v[240:243]
    ds_read_b128 v[124:127], v2 offset:30720
    s_waitcnt lgkmcnt(7)
    v_mfma_f32_16x16x32_bf16 v[128:131], v[64:67], v[96:99], v[128:131]
    s_waitcnt vmcnt(10)
    v_perm_b32 v80, v34, v32, s68
    s_add_u32 s48, s49, 245760
    buffer_load_dwordx4 v[16:19], v1, s[80:83], s48 offen sc1
    v_mfma_f32_16x16x32_bf16 v[132:135], v[68:71], v[96:99], v[132:135]
    v_perm_b32 v84, v34, v32, s69
    v_mfma_f32_16x16x32_bf16 v[136:139], v[72:75], v[96:99], v[136:139]
    v_perm_b32 v88, v35, v33, s68
    buffer_load_dwordx4 v[20:23], v1, s[80:83], s48 offen offset:1024 sc1
    v_mfma_f32_16x16x32_bf16 v[140:143], v[76:79], v[96:99], v[140:143]
    ds_read_b128 v[96:99], v3 offset:16384
    v_perm_b32 v92, v35, v33, s69
    s_waitcnt lgkmcnt(7)
    v_mfma_f32_16x16x32_bf16 v[156:159], v[76:79], v[100:103], v[156:159]
    buffer_load_dwordx4 v[24:27], v1, s[80:83], s48 offen offset:2048 sc1
    v_mfma_f32_16x16x32_bf16 v[152:155], v[72:75], v[100:103], v[152:155]
    v_mfma_f32_16x16x32_bf16 v[148:151], v[68:71], v[100:103], v[148:151]
    buffer_load_dwordx4 v[28:31], v1, s[80:83], s48 offen offset:3072 sc1
    v_mfma_f32_16x16x32_bf16 v[144:147], v[64:67], v[100:103], v[144:147]
    ds_read_b128 v[100:103], v3 offset:18432
    s_waitcnt vmcnt(12)
    v_perm_b32 v81, v38, v36, s68
    s_waitcnt lgkmcnt(7)
    v_mfma_f32_16x16x32_bf16 v[160:163], v[64:67], v[104:107], v[160:163]
    v_perm_b32 v85, v38, v36, s69
    v_mfma_f32_16x16x32_bf16 v[164:167], v[68:71], v[104:107], v[164:167]
    v_mfma_f32_16x16x32_bf16 v[168:171], v[72:75], v[104:107], v[168:171]
    v_perm_b32 v89, v39, v37, s68
    v_mfma_f32_16x16x32_bf16 v[172:175], v[76:79], v[104:107], v[172:175]
    ds_read_b128 v[104:107], v3 offset:20480
    v_perm_b32 v93, v39, v37, s69
    s_waitcnt lgkmcnt(7)
    v_mfma_f32_16x16x32_bf16 v[188:191], v[76:79], v[108:111], v[188:191]
    v_mfma_f32_16x16x32_bf16 v[184:187], v[72:75], v[108:111], v[184:187]
    v_mfma_f32_16x16x32_bf16 v[180:183], v[68:71], v[108:111], v[180:183]
    v_mfma_f32_16x16x32_bf16 v[176:179], v[64:67], v[108:111], v[176:179]
    ds_read_b128 v[108:111], v3 offset:22528
    s_waitcnt vmcnt(10)
    v_perm_b32 v82, v42, v40, s68
    s_waitcnt lgkmcnt(7)
    v_mfma_f32_16x16x32_bf16 v[192:195], v[64:67], v[112:115], v[192:195]
    v_perm_b32 v86, v42, v40, s69
    v_mfma_f32_16x16x32_bf16 v[196:199], v[68:71], v[112:115], v[196:199]
    v_perm_b32 v90, v43, v41, s68
    v_mfma_f32_16x16x32_bf16 v[200:203], v[72:75], v[112:115], v[200:203]
    v_perm_b32 v94, v43, v41, s69
    v_mfma_f32_16x16x32_bf16 v[204:207], v[76:79], v[112:115], v[204:207]
    ds_read_b128 v[112:115], v3 offset:24576
    ds_read_b32 v10, v9
    s_waitcnt lgkmcnt(8)
    v_mfma_f32_16x16x32_bf16 v[220:223], v[76:79], v[116:119], v[220:223]
    v_mfma_f32_16x16x32_bf16 v[216:219], v[72:75], v[116:119], v[216:219]
    v_mfma_f32_16x16x32_bf16 v[212:215], v[68:71], v[116:119], v[212:215]
    s_waitcnt vmcnt(8)
    v_perm_b32 v83, v46, v44, s68
    v_mfma_f32_16x16x32_bf16 v[208:211], v[64:67], v[116:119], v[208:211]
    ds_read_b128 v[116:119], v3 offset:26624
    v_perm_b32 v87, v46, v44, s69
    s_waitcnt lgkmcnt(8)
    v_mfma_f32_16x16x32_bf16 v[224:227], v[64:67], v[120:123], v[224:227]
    v_mfma_f32_16x16x32_bf16 v[228:231], v[68:71], v[120:123], v[228:231]
    v_perm_b32 v91, v47, v45, s68
    v_mfma_f32_16x16x32_bf16 v[232:235], v[72:75], v[120:123], v[232:235]
    v_perm_b32 v95, v47, v45, s69
    v_mfma_f32_16x16x32_bf16 v[236:239], v[76:79], v[120:123], v[236:239]
    ds_read_b128 v[120:123], v3 offset:28672
    s_waitcnt lgkmcnt(8)
    v_mfma_f32_16x16x32_bf16 v[252:255], v[76:79], v[124:127], v[252:255]
    v_mfma_f32_16x16x32_bf16 v[248:251], v[72:75], v[124:127], v[248:251]
    v_mfma_f32_16x16x32_bf16 v[244:247], v[68:71], v[124:127], v[244:247]
    v_mfma_f32_16x16x32_bf16 v[240:243], v[64:67], v[124:127], v[240:243]
    ds_read_b128 v[124:127], v3 offset:30720
    ds_add_u32 v7, v8 offset:16
    s_waitcnt lgkmcnt(9)
    v_mfma_f32_16x16x32_bf16 v[128:131], v[80:83], v[96:99], v[128:131]
    s_add_u32 s48, s49, 262144
    buffer_load_dwordx4 v[32:35], v1, s[80:83], s48 offen sc1
    v_mfma_f32_16x16x32_bf16 v[132:135], v[84:87], v[96:99], v[132:135]
    s_waitcnt lgkmcnt(4)
    v_cmp_gt_u32 vcc, 8, v10
    v_mfma_f32_16x16x32_bf16 v[136:139], v[88:91], v[96:99], v[136:139]
    s_cbranch_vccnz L_gs9
L_gb9:
    buffer_load_dwordx4 v[36:39], v1, s[80:83], s48 offen offset:1024 sc1
    v_mfma_f32_16x16x32_bf16 v[140:143], v[92:95], v[96:99], v[140:143]
    ds_read_b128 v[96:99], v2 offset:32768
    v_mfma_f32_16x16x32_bf16 v[156:159], v[92:95], v[100:103], v[156:159]
    buffer_load_dwordx4 v[40:43], v1, s[80:83], s48 offen offset:2048 sc1
    v_mfma_f32_16x16x32_bf16 v[152:155], v[88:91], v[100:103], v[152:155]
    v_mfma_f32_16x16x32_bf16 v[148:151], v[84:87], v[100:103], v[148:151]
    buffer_load_dwordx4 v[44:47], v1, s[80:83], s48 offen offset:3072 sc1
    v_mfma_f32_16x16x32_bf16 v[144:147], v[80:83], v[100:103], v[144:147]
    ds_read_b128 v[100:103], v2 offset:34816
    v_mfma_f32_16x16x32_bf16 v[160:163], v[80:83], v[104:107], v[160:163]
    s_add_u32 s48, s49, 278528
    buffer_load_dwordx4 v[64:67], v1, s[80:83], s48 offen sc1
    v_mfma_f32_16x16x32_bf16 v[164:167], v[84:87], v[104:107], v[164:167]
    v_mfma_f32_16x16x32_bf16 v[168:171], v[88:91], v[104:107], v[168:171]
    buffer_load_dwordx4 v[68:71], v1, s[80:83], s48 offen offset:1024 sc1
    v_mfma_f32_16x16x32_bf16 v[172:175], v[92:95], v[104:107], v[172:175]
    ds_read_b128 v[104:107], v2 offset:36864
    v_mfma_f32_16x16x32_bf16 v[188:191], v[92:95], v[108:111], v[188:191]
    buffer_load_dwordx4 v[72:75], v1, s[80:83], s48 offen offset:2048 sc1
    v_mfma_f32_16x16x32_bf16 v[184:187], v[88:91], v[108:111], v[184:187]
    v_mfma_f32_16x16x32_bf16 v[180:183], v[84:87], v[108:111], v[180:183]
    buffer_load_dwordx4 v[76:79], v1, s[80:83], s48 offen offset:3072 sc1
    v_mfma_f32_16x16x32_bf16 v[176:179], v[80:83], v[108:111], v[176:179]
    ds_read_b128 v[108:111], v2 offset:38912
    v_mfma_f32_16x16x32_bf16 v[192:195], v[80:83], v[112:115], v[192:195]
    v_mfma_f32_16x16x32_bf16 v[196:199], v[84:87], v[112:115], v[196:199]
    v_mfma_f32_16x16x32_bf16 v[200:203], v[88:91], v[112:115], v[200:203]
    v_mfma_f32_16x16x32_bf16 v[204:207], v[92:95], v[112:115], v[204:207]
    ds_read_b128 v[112:115], v2 offset:40960
    s_waitcnt lgkmcnt(8)
    v_mfma_f32_16x16x32_bf16 v[220:223], v[92:95], v[116:119], v[220:223]
    v_mfma_f32_16x16x32_bf16 v[216:219], v[88:91], v[116:119], v[216:219]
    v_mfma_f32_16x16x32_bf16 v[212:215], v[84:87], v[116:119], v[212:215]
    v_mfma_f32_16x16x32_bf16 v[208:211], v[80:83], v[116:119], v[208:211]
    ds_read_b128 v[116:119], v2 offset:43008
    s_waitcnt lgkmcnt(8)
    v_mfma_f32_16x16x32_bf16 v[224:227], v[80:83], v[120:123], v[224:227]
    v_mfma_f32_16x16x32_bf16 v[228:231], v[84:87], v[120:123], v[228:231]
    v_mfma_f32_16x16x32_bf16 v[232:235], v[88:91], v[120:123], v[232:235]
    v_mfma_f32_16x16x32_bf16 v[236:239], v[92:95], v[120:123], v[236:239]
    ds_read_b128 v[120:123], v2 offset:45056
    s_waitcnt lgkmcnt(8)
    v_mfma_f32_16x16x32_bf16 v[252:255], v[92:95], v[124:127], v[252:255]
    v_mfma_f32_16x16x32_bf16 v[248:251], v[88:91], v[124:127], v[248:251]
    v_mfma_f32_16x16x32_bf16 v[244:247], v[84:87], v[124:127], v[244:247]
    v_mfma_f32_16x16x32_bf16 v[240:243], v[80:83], v[124:127], v[240:243]
    ds_read_b128 v[124:127], v2 offset:47104
    s_waitcnt vmcnt(15) lgkmcnt(7)
    v_mfma_f32_16x16x32_bf16 v[128:131], v[48:51], v[96:99], v[128:131]
    s_add_u32 s48, s49, 294912
    buffer_load_dwordx4 v[80:83], v1, s[80:83], s48 offen sc1
    s_waitcnt vmcnt(15)
    v_mfma_f32_16x16x32_bf16 v[132:135], v[52:55], v[96:99], v[132:135]
    s_waitcnt vmcnt(14)
    v_mfma_f32_16x16x32_bf16 v[136:139], v[56:59], v[96:99], v[136:139]
    buffer_load_dwordx4 v[84:87], v1, s[80:83], s48 offen offset:1024 sc1
    s_waitcnt vmcnt(14)
    v_mfma_f32_16x16x32_bf16 v[140:143], v[60:63], v[96:99], v[140:143]
    ds_read_b128 v[96:99], v3 offset:32768
    s_waitcnt lgkmcnt(7)
    v_mfma_f32_16x16x32_bf16 v[156:159], v[60:63], v[100:103], v[156:159]
    buffer_load_dwordx4 v[88:91], v1, s[80:83], s48 offen offset:2048 sc1
    v_mfma_f32_16x16x32_bf16 v[152:155], v[56:59], v[100:103], v[152:155]
    v_mfma_f32_16x16x32_bf16 v[148:151], v[52:55], v[100:103], v[148:151]
    buffer_load_dwordx4 v[92:95], v1, s[80:83], s48 offen offset:3072 sc1
    v_mfma_f32_16x16x32_bf16 v[144:147], v[48:51], v[100:103], v[144:147]
    ds_read_b128 v[100:103], v3 offset:34816
    s_waitcnt lgkmcnt(7)
    v_mfma_f32_16x16x32_bf16 v[160:163], v[48:51], v[104:107], v[160:163]
    v_mfma_f32_16x16x32_bf16 v[164:167], v[52:55], v[104:107], v[164:167]
    v_mfma_f32_16x16x32_bf16 v[168:171], v[56:59], v[104:107], v[168:171]
    v_mfma_f32_16x16x32_bf16 v[172:175], v[60:63], v[104:107], v[172:175]
    ds_read_b128 v[104:107], v3 offset:36864
    s_waitcnt lgkmcnt(7)
    v_mfma_f32_16x16x32_bf16 v[188:191], v[60:63], v[108:111], v[188:191]
    v_mfma_f32_16x16x32_bf16 v[184:187], v[56:59], v[108:111], v[184:187]
    v_mfma_f32_16x16x32_bf16 v[180:183], v[52:55], v[108:111], v[180:183]
    v_mfma_f32_16x16x32_bf16 v[176:179], v[48:51], v[108:111], v[176:179]
    ds_read_b128 v[108:111], v3 offset:38912
    s_waitcnt lgkmcnt(7)
    v_mfma_f32_16x16x32_bf16 v[192:195], v[48:51], v[112:115], v[192:195]
    v_mfma_f32_16x16x32_bf16 v[196:199], v[52:55], v[112:115], v[196:199]
    v_mfma_f32_16x16x32_bf16 v[200:203], v[56:59], v[112:115], v[200:203]
    v_mfma_f32_16x16x32_bf16 v[204:207], v[60:63], v[112:115], v[204:207]
    ds_read_b128 v[112:115], v3 offset:40960
    ds_read_b32 v10, v9
    s_waitcnt lgkmcnt(8)
    v_mfma_f32_16x16x32_bf16 v[220:223], v[60:63], v[116:119], v[220:223]
    v_mfma_f32_16x16x32_bf16 v[216:219], v[56:59], v[116:119], v[216:219]
    v_mfma_f32_16x16x32_bf16 v[212:215], v[52:55], v[116:119], v[212:215]
    v_mfma_f32_16x16x32_bf16 v[208:211], v[48:51], v[116:119], v[208:211]
    ds_read_b128 v[116:119], v3 offset:43008
    s_waitcnt lgkmcnt(8)
    v_mfma_f32_16x16x32_bf16 v[224:227], v[48:51], v[120:123], v[224:227]
    v_mfma_f32_16x16x32_bf16 v[228:231], v[52:55], v[120:123], v[228:231]
    v_mfma_f32_16x16x32_bf16 v[232:235], v[56:59], v[120:123], v[232:235]
    v_mfma_f32_16x16x32_bf16 v[236:239], v[60:63], v[120:123], v[236:239]
    ds_read_b128 v[120:123], v3 offset:45056
    s_waitcnt lgkmcnt(8)
    v_mfma_f32_16x16x32_bf16 v[252:255], v[60:63], v[124:127], v[252:255]
    v_mfma_f32_16x16x32_bf16 v[248:251], v[56:59], v[124:127], v[248:251]
    v_mfma_f32_16x16x32_bf16 v[244:247], v[52:55], v[124:127], v[244:247]
    v_mfma_f32_16x16x32_bf16 v[240:243], v[48:51], v[124:127], v[240:243]
    ds_read_b128 v[124:127], v3 offset:47104
    ds_add_u32 v7, v8 offset:16
    s_waitcnt vmcnt(15) lgkmcnt(9)
    v_mfma_f32_16x16x32_bf16 v[128:131], v[16:19], v[96:99], v[128:131]
    s_add_u32 s48, s49, 311296
    buffer_load_dwordx4 v[48:51], v1, s[80:83], s48 offen sc1
    s_waitcnt vmcnt(15)
    v_mfma_f32_16x16x32_bf16 v[132:135], v[20:23], v[96:99], v[132:135]
    s_waitcnt lgkmcnt(4)
    v_cmp_gt_u32 vcc, 9, v10
    s_waitcnt vmcnt(14)
    v_mfma_f32_16x16x32_bf16 v[136:139], v[24:27], v[96:99], v[136:139]
    s_cbranch_vccnz L_gs10
L_gb10:
    buffer_load_dwordx4 v[52:55], v1, s[80:83], s48 offen offset:1024 sc1
    s_waitcnt vmcnt(14)
    v_mfma_f32_16x16x32_bf16 v[140:143], v[28:31], v[96:99], v[140:143]
    ds_read_b128 v[96:99], v2 offset:49152
    v_mfma_f32_16x16x32_bf16 v[156:159], v[28:31], v[100:103], v[156:159]
    buffer_load_dwordx4 v[56:59], v1, s[80:83], s48 offen offset:2048 sc1
    v_mfma_f32_16x16x32_bf16 v[152:155], v[24:27], v[100:103], v[152:155]
    v_mfma_f32_16x16x32_bf16 v[148:151], v[20:23], v[100:103], v[148:151]
    buffer_load_dwordx4 v[60:63], v1, s[80:83], s48 offen offset:3072 sc1
    v_mfma_f32_16x16x32_bf16 v[144:147], v[16:19], v[100:103], v[144:147]
    ds_read_b128 v[100:103], v2 offset:51200
    v_mfma_f32_16x16x32_bf16 v[160:163], v[16:19], v[104:107], v[160:163]
    v_mfma_f32_16x16x32_bf16 v[164:167], v[20:23], v[104:107], v[164:167]
    v_mfma_f32_16x16x32_bf16 v[168:171], v[24:27], v[104:107], v[168:171]
    v_mfma_f32_16x16x32_bf16 v[172:175], v[28:31], v[104:107], v[172:175]
    ds_read_b128 v[104:107], v2 offset:53248
    v_mfma_f32_16x16x32_bf16 v[188:191], v[28:31], v[108:111], v[188:191]
    v_mfma_f32_16x16x32_bf16 v[184:187], v[24:27], v[108:111], v[184:187]
    v_mfma_f32_16x16x32_bf16 v[180:183], v[20:23], v[108:111], v[180:183]
    v_mfma_f32_16x16x32_bf16 v[176:179], v[16:19], v[108:111], v[176:179]
    ds_read_b128 v[108:111], v2 offset:55296
    v_mfma_f32_16x16x32_bf16 v[192:195], v[16:19], v[112:115], v[192:195]
    v_mfma_f32_16x16x32_bf16 v[196:199], v[20:23], v[112:115], v[196:199]
    v_mfma_f32_16x16x32_bf16 v[200:203], v[24:27], v[112:115], v[200:203]
    v_mfma_f32_16x16x32_bf16 v[204:207], v[28:31], v[112:115], v[204:207]
    ds_read_b128 v[112:115], v2 offset:57344
    s_waitcnt lgkmcnt(8)
    v_mfma_f32_16x16x32_bf16 v[220:223], v[28:31], v[116:119], v[220:223]
    v_mfma_f32_16x16x32_bf16 v[216:219], v[24:27], v[116:119], v[216:219]
    v_mfma_f32_16x16x32_bf16 v[212:215], v[20:23], v[116:119], v[212:215]
    v_mfma_f32_16x16x32_bf16 v[208:211], v[16:19], v[116:119], v[208:211]
    ds_read_b128 v[116:119], v2 offset:59392
    s_waitcnt lgkmcnt(8)
    v_mfma_f32_16x16x32_bf16 v[224:227], v[16:19], v[120:123], v[224:227]
    v_mfma_f32_16x16x32_bf16 v[228:231], v[20:23], v[120:123], v[228:231]
    v_mfma_f32_16x16x32_bf16 v[232:235], v[24:27], v[120:123], v[232:235]
    v_mfma_f32_16x16x32_bf16 v[236:239], v[28:31], v[120:123], v[236:239]
    ds_read_b128 v[120:123], v2 offset:61440
    s_waitcnt lgkmcnt(8)
    v_mfma_f32_16x16x32_bf16 v[252:255], v[28:31], v[124:127], v[252:255]
    v_mfma_f32_16x16x32_bf16 v[248:251], v[24:27], v[124:127], v[248:251]
    v_mfma_f32_16x16x32_bf16 v[244:247], v[20:23], v[124:127], v[244:247]
    v_mfma_f32_16x16x32_bf16 v[240:243], v[16:19], v[124:127], v[240:243]
    ds_read_b128 v[124:127], v2 offset:63488
    s_waitcnt vmcnt(15) lgkmcnt(7)
    v_mfma_f32_16x16x32_bf16 v[128:131], v[32:35], v[96:99], v[128:131]
    s_add_u32 s48, s49, 327680
    buffer_load_dwordx4 v[16:19], v1, s[80:83], s48 offen sc1
    s_waitcnt vmcnt(15)
    v_mfma_f32_16x16x32_bf16 v[132:135], v[36:39], v[96:99], v[132:135]
    s_waitcnt vmcnt(14)
    v_mfma_f32_16x16x32_bf16 v[136:139], v[40:43], v[96:99], v[136:139]
    buffer_load_dwordx4 v[20:23], v1, s[80:83], s48 offen offset:1024 sc1
    s_waitcnt vmcnt(14)
    v_mfma_f32_16x16x32_bf16 v[140:143], v[44:47], v[96:99], v[140:143]
    ds_read_b128 v[96:99], v3 offset:49152
    s_waitcnt lgkmcnt(7)
    v_mfma_f32_16x16x32_bf16 v[156:159], v[44:47], v[100:103], v[156:159]
    buffer_load_dwordx4 v[24:27], v1, s[80:83], s48 offen offset:2048 sc1
    v_mfma_f32_16x16x32_bf16 v[152:155], v[40:43], v[100:103], v[152:155]
    v_mfma_f32_16x16x32_bf16 v[148:151], v[36:39], v[100:103], v[148:151]
    buffer_load_dwordx4 v[28:31], v1, s[80:83], s48 offen offset:3072 sc1
    v_mfma_f32_16x16x32_bf16 v[144:147], v[32:35], v[100:103], v[144:147]
    ds_read_b128 v[100:103], v3 offset:51200
    s_waitcnt lgkmcnt(7)
    v_mfma_f32_16x16x32_bf16 v[160:163], v[32:35], v[104:107], v[160:163]
    v_mfma_f32_16x16x32_bf16 v[164:167], v[36:39], v[104:107], v[164:167]
    v_mfma_f32_16x16x32_bf16 v[168:171], v[40:43], v[104:107], v[168:171]
    v_mfma_f32_16x16x32_bf16 v[172:175], v[44:47], v[104:107], v[172:175]
    ds_read_b128 v[104:107], v3 offset:53248
    s_waitcnt lgkmcnt(7)
    v_mfma_f32_16x16x32_bf16 v[188:191], v[44:47], v[108:111], v[188:191]
    v_mfma_f32_16x16x32_bf16 v[184:187], v[40:43], v[108:111], v[184:187]
    v_mfma_f32_16x16x32_bf16 v[180:183], v[36:39], v[108:111], v[180:183]
    v_mfma_f32_16x16x32_bf16 v[176:179], v[32:35], v[108:111], v[176:179]
    ds_read_b128 v[108:111], v3 offset:55296
    s_waitcnt lgkmcnt(7)
    v_mfma_f32_16x16x32_bf16 v[192:195], v[32:35], v[112:115], v[192:195]
    v_mfma_f32_16x16x32_bf16 v[196:199], v[36:39], v[112:115], v[196:199]
    v_mfma_f32_16x16x32_bf16 v[200:203], v[40:43], v[112:115], v[200:203]
    v_mfma_f32_16x16x32_bf16 v[204:207], v[44:47], v[112:115], v[204:207]
    ds_read_b128 v[112:115], v3 offset:57344
    ds_read_b32 v10, v9
    s_waitcnt lgkmcnt(8)
    v_mfma_f32_16x16x32_bf16 v[220:223], v[44:47], v[116:119], v[220:223]
    v_mfma_f32_16x16x32_bf16 v[216:219], v[40:43], v[116:119], v[216:219]
    v_mfma_f32_16x16x32_bf16 v[212:215], v[36:39], v[116:119], v[212:215]
    v_mfma_f32_16x16x32_bf16 v[208:211], v[32:35], v[116:119], v[208:211]
    ds_read_b128 v[116:119], v3 offset:59392
    s_waitcnt lgkmcnt(8)
    v_mfma_f32_16x16x32_bf16 v[224:227], v[32:35], v[120:123], v[224:227]
    v_mfma_f32_16x16x32_bf16 v[228:231], v[36:39], v[120:123], v[228:231]
    v_mfma_f32_16x16x32_bf16 v[232:235], v[40:43], v[120:123], v[232:235]
    v_mfma_f32_16x16x32_bf16 v[236:239], v[44:47], v[120:123], v[236:239]
    ds_read_b128 v[120:123], v3 offset:61440
    s_waitcnt lgkmcnt(8)
    v_mfma_f32_16x16x32_bf16 v[252:255], v[44:47], v[124:127], v[252:255]
    v_mfma_f32_16x16x32_bf16 v[248:251], v[40:43], v[124:127], v[248:251]
    v_mfma_f32_16x16x32_bf16 v[244:247], v[36:39], v[124:127], v[244:247]
    v_mfma_f32_16x16x32_bf16 v[240:243], v[32:35], v[124:127], v[240:243]
    ds_read_b128 v[124:127], v3 offset:63488
    ds_add_u32 v7, v8 offset:16
    s_waitcnt vmcnt(15) lgkmcnt(9)
    v_mfma_f32_16x16x32_bf16 v[128:131], v[64:67], v[96:99], v[128:131]
    s_add_u32 s48, s49, 344064
    buffer_load_dwordx4 v[32:35], v1, s[80:83], s48 offen sc1
    s_waitcnt vmcnt(15)
    v_mfma_f32_16x16x32_bf16 v[132:135], v[68:71], v[96:99], v[132:135]
    s_waitcnt lgkmcnt(4)
    v_cmp_gt_u32 vcc, 10, v10
    s_waitcnt vmcnt(14)
    v_mfma_f32_16x16x32_bf16 v[136:139], v[72:75], v[96:99], v[136:139]
    s_cbranch_vccnz L_gs11
L_gb11:
    buffer_load_dwordx4 v[36:39], v1, s[80:83], s48 offen offset:1024 sc1
    s_waitcnt vmcnt(14)
    v_mfma_f32_16x16x32_bf16 v[140:143], v[76:79], v[96:99], v[140:143]
    ds_read_b128 v[96:99], v4 offset:0
    v_mfma_f32_16x16x32_bf16 v[156:159], v[76:79], v[100:103], v[156:159]
    buffer_load_dwordx4 v[40:43], v1, s[80:83], s48 offen offset:2048 sc1
    v_mfma_f32_16x16x32_bf16 v[152:155], v[72:75], v[100:103], v[152:155]
    v_mfma_f32_16x16x32_bf16 v[148:151], v[68:71], v[100:103], v[148:151]
    buffer_load_dwordx4 v[44:47], v1, s[80:83], s48 offen offset:3072 sc1
    v_mfma_f32_16x16x32_bf16 v[144:147], v[64:67], v[100:103], v[144:147]
    ds_read_b128 v[100:103], v4 offset:2048
    v_mfma_f32_16x16x32_bf16 v[160:163], v[64:67], v[104:107], v[160:163]
    v_mfma_f32_16x16x32_bf16 v[164:167], v[68:71], v[104:107], v[164:167]
    v_mfma_f32_16x16x32_bf16 v[168:171], v[72:75], v[104:107], v[168:171]
    v_mfma_f32_16x16x32_bf16 v[172:175], v[76:79], v[104:107], v[172:175]
    ds_read_b128 v[104:107], v4 offset:4096
    v_mfma_f32_16x16x32_bf16 v[188:191], v[76:79], v[108:111], v[188:191]
    v_mfma_f32_16x16x32_bf16 v[184:187], v[72:75], v[108:111], v[184:187]
    v_mfma_f32_16x16x32_bf16 v[180:183], v[68:71], v[108:111], v[180:183]
    v_mfma_f32_16x16x32_bf16 v[176:179], v[64:67], v[108:111], v[176:179]
    ds_read_b128 v[108:111], v4 offset:6144
    v_mfma_f32_16x16x32_bf16 v[192:195], v[64:67], v[112:115], v[192:195]
    v_mfma_f32_16x16x32_bf16 v[196:199], v[68:71], v[112:115], v[196:199]
    v_mfma_f32_16x16x32_bf16 v[200:203], v[72:75], v[112:115], v[200:203]
    v_mfma_f32_16x16x32_bf16 v[204:207], v[76:79], v[112:115], v[204:207]
    ds_read_b128 v[112:115], v4 offset:8192
    s_waitcnt lgkmcnt(8)
    v_mfma_f32_16x16x32_bf16 v[220:223], v[76:79], v[116:119], v[220:223]
    v_mfma_f32_16x16x32_bf16 v[216:219], v[72:75], v[116:119], v[216:219]
    v_mfma_f32_16x16x32_bf16 v[212:215], v[68:71], v[116:119], v[212:215]
    v_mfma_f32_16x16x32_bf16 v[208:211], v[64:67], v[116:119], v[208:211]
    ds_read_b128 v[116:119], v4 offset:10240
    s_waitcnt lgkmcnt(8)
    v_mfma_f32_16x16x32_bf16 v[224:227], v[64:67], v[120:123], v[224:227]
    v_mfma_f32_16x16x32_bf16 v[228:231], v[68:71], v[120:123], v[228:231]
    v_mfma_f32_16x16x32_bf16 v[232:235], v[72:75], v[120:123], v[232:235]
    v_mfma_f32_16x16x32_bf16 v[236:239], v[76:79], v[120:123], v[236:239]
    ds_read_b128 v[120:123], v4 offset:12288
    s_waitcnt lgkmcnt(8)
    v_mfma_f32_16x16x32_bf16 v[252:255], v[76:79], v[124:127], v[252:255]
    v_mfma_f32_16x16x32_bf16 v[248:251], v[72:75], v[124:127], v[248:251]
    v_mfma_f32_16x16x32_bf16 v[244:247], v[68:71], v[124:127], v[244:247]
    v_mfma_f32_16x16x32_bf16 v[240:243], v[64:67], v[124:127], v[240:243]
    ds_read_b128 v[124:127], v4 offset:14336
    s_waitcnt vmcnt(15) lgkmcnt(7)
    v_mfma_f32_16x16x32_bf16 v[128:131], v[80:83], v[96:99], v[128:131]
    s_add_u32 s48, s49, 360448
    buffer_load_dwordx4 v[64:67], v1, s[80:83], s48 offen sc1
    s_waitcnt vmcnt(15)
    v_mfma_f32_16x16x32_bf16 v[132:135], v[84:87], v[96:99], v[132:135]
    s_waitcnt vmcnt(14)
    v_mfma_f32_16x16x32_bf16 v[136:139], v[88:91], v[96:99], v[136:139]
    buffer_load_dwordx4 v[68:71], v1, s[80:83], s48 offen offset:1024 sc1
    s_waitcnt vmcnt(14)
    v_mfma_f32_16x16x32_bf16 v[140:143], v[92:95], v[96:99], v[140:143]
    ds_read_b128 v[96:99], v5 offset:0
    s_waitcnt lgkmcnt(7)
    v_mfma_f32_16x16x32_bf16 v[156:159], v[92:95], v[100:103], v[156:159]
    buffer_load_dwordx4 v[72:75], v1, s[80:83], s48 offen offset:2048 sc1
    v_mfma_f32_16x16x32_bf16 v[152:155], v[88:91], v[100:103], v[152:155]
    v_mfma_f32_16x16x32_bf16 v[148:151], v[84:87], v[100:103], v[148:151]
    buffer_load_dwordx4 v[76:79], v1, s[80:83], s48 offen offset:3072 sc1
    v_mfma_f32_16x16x32_bf16 v[144:147], v[80:83], v[100:103], v[144:147]
    ds_read_b128 v[100:103], v5 offset:2048
    s_waitcnt lgkmcnt(7)
    v_mfma_f32_16x16x32_bf16 v[160:163], v[80:83], v[104:107], v[160:163]
    v_mfma_f32_16x16x32_bf16 v[164:167], v[84:87], v[104:107], v[164:167]
    v_mfma_f32_16x16x32_bf16 v[168:171], v[88:91], v[104:107], v[168:171]
    v_mfma_f32_16x16x32_bf16 v[172:175], v[92:95], v[104:107], v[172:175]
    ds_read_b128 v[104:107], v5 offset:4096
    s_waitcnt lgkmcnt(7)
    v_mfma_f32_16x16x32_bf16 v[188:191], v[92:95], v[108:111], v[188:191]
    v_mfma_f32_16x16x32_bf16 v[184:187], v[88:91], v[108:111], v[184:187]
    v_mfma_f32_16x16x32_bf16 v[180:183], v[84:87], v[108:111], v[180:183]
    v_mfma_f32_16x16x32_bf16 v[176:179], v[80:83], v[108:111], v[176:179]
    ds_read_b128 v[108:111], v5 offset:6144
    s_waitcnt lgkmcnt(7)
    v_mfma_f32_16x16x32_bf16 v[192:195], v[80:83], v[112:115], v[192:195]
    v_mfma_f32_16x16x32_bf16 v[196:199], v[84:87], v[112:115], v[196:199]
    v_mfma_f32_16x16x32_bf16 v[200:203], v[88:91], v[112:115], v[200:203]
    v_mfma_f32_16x16x32_bf16 v[204:207], v[92:95], v[112:115], v[204:207]
    ds_read_b128 v[112:115], v5 offset:8192
    ds_read_b32 v10, v9
    s_waitcnt lgkmcnt(8)
    v_mfma_f32_16x16x32_bf16 v[220:223], v[92:95], v[116:119], v[220:223]
    v_mfma_f32_16x16x32_bf16 v[216:219], v[88:91], v[116:119], v[216:219]
    v_mfma_f32_16x16x32_bf16 v[212:215], v[84:87], v[116:119], v[212:215]
    v_mfma_f32_16x16x32_bf16 v[208:211], v[80:83], v[116:119], v[208:211]
    ds_read_b128 v[116:119], v5 offset:10240
    s_waitcnt lgkmcnt(8)
    v_mfma_f32_16x16x32_bf16 v[224:227], v[80:83], v[120:123], v[224:227]
    v_mfma_f32_16x16x32_bf16 v[228:231], v[84:87], v[120:123], v[228:231]
    v_mfma_f32_16x16x32_bf16 v[232:235], v[88:91], v[120:123], v[232:235]
    v_mfma_f32_16x16x32_bf16 v[236:239], v[92:95], v[120:123], v[236:239]
    ds_read_b128 v[120:123], v5 offset:12288
    s_waitcnt lgkmcnt(8)
    v_mfma_f32_16x16x32_bf16 v[252:255], v[92:95], v[124:127], v[252:255]
    v_mfma_f32_16x16x32_bf16 v[248:251], v[88:91], v[124:127], v[248:251]
    v_mfma_f32_16x16x32_bf16 v[244:247], v[84:87], v[124:127], v[244:247]
    v_mfma_f32_16x16x32_bf16 v[240:243], v[80:83], v[124:127], v[240:243]
    ds_read_b128 v[124:127], v5 offset:14336
    ds_add_u32 v7, v8 offset:16
    s_waitcnt vmcnt(15) lgkmcnt(9)
    v_mfma_f32_16x16x32_bf16 v[128:131], v[48:51], v[96:99], v[128:131]
    s_add_u32 s48, s49, 376832
    buffer_load_dwordx4 v[80:83], v1, s[80:83], s48 offen sc1
    s_waitcnt vmcnt(15)
    v_mfma_f32_16x16x32_bf16 v[132:135], v[52:55], v[96:99], v[132:135]
    s_waitcnt lgkmcnt(4)
    v_cmp_gt_u32 vcc, 11, v10
    s_waitcnt vmcnt(14)
    v_mfma_f32_16x16x32_bf16 v[136:139], v[56:59], v[96:99], v[136:139]
    s_cbranch_vccnz L_gs12
L_gb12:
    buffer_load_dwordx4 v[84:87], v1, s[80:83], s48 offen offset:1024 sc1
    s_waitcnt vmcnt(14)
    v_mfma_f32_16x16x32_bf16 v[140:143], v[60:63], v[96:99], v[140:143]
    ds_read_b128 v[96:99], v2 offset:0
    v_mfma_f32_16x16x32_bf16 v[156:159], v[60:63], v[100:103], v[156:159]
    buffer_load_dwordx4 v[88:91], v1, s[80:83], s48 offen offset:2048 sc1
    v_mfma_f32_16x16x32_bf16 v[152:155], v[56:59], v[100:103], v[152:155]
    v_mfma_f32_16x16x32_bf16 v[148:151], v[52:55], v[100:103], v[148:151]
    buffer_load_dwordx4 v[92:95], v1, s[80:83], s48 offen offset:3072 sc1
    v_mfma_f32_16x16x32_bf16 v[144:147], v[48:51], v[100:103], v[144:147]
    ds_read_b128 v[100:103], v2 offset:2048
    v_mfma_f32_16x16x32_bf16 v[160:163], v[48:51], v[104:107], v[160:163]
    v_mfma_f32_16x16x32_bf16 v[164:167], v[52:55], v[104:107], v[164:167]
    v_mfma_f32_16x16x32_bf16 v[168:171], v[56:59], v[104:107], v[168:171]
    v_mfma_f32_16x16x32_bf16 v[172:175], v[60:63], v[104:107], v[172:175]
    ds_read_b128 v[104:107], v2 offset:4096
    v_mfma_f32_16x16x32_bf16 v[188:191], v[60:63], v[108:111], v[188:191]
    v_mfma_f32_16x16x32_bf16 v[184:187], v[56:59], v[108:111], v[184:187]
    v_mfma_f32_16x16x32_bf16 v[180:183], v[52:55], v[108:111], v[180:183]
    v_mfma_f32_16x16x32_bf16 v[176:179], v[48:51], v[108:111], v[176:179]
    ds_read_b128 v[108:111], v2 offset:6144
    v_mfma_f32_16x16x32_bf16 v[192:195], v[48:51], v[112:115], v[192:195]
    v_mfma_f32_16x16x32_bf16 v[196:199], v[52:55], v[112:115], v[196:199]
    v_mfma_f32_16x16x32_bf16 v[200:203], v[56:59], v[112:115], v[200:203]
    v_mfma_f32_16x16x32_bf16 v[204:207], v[60:63], v[112:115], v[204:207]
    ds_read_b128 v[112:115], v2 offset:8192
    s_waitcnt lgkmcnt(8)
    v_mfma_f32_16x16x32_bf16 v[220:223], v[60:63], v[116:119], v[220:223]
    v_mfma_f32_16x16x32_bf16 v[216:219], v[56:59], v[116:119], v[216:219]
    v_mfma_f32_16x16x32_bf16 v[212:215], v[52:55], v[116:119], v[212:215]
    v_mfma_f32_16x16x32_bf16 v[208:211], v[48:51], v[116:119], v[208:211]
    ds_read_b128 v[116:119], v2 offset:10240
    s_waitcnt lgkmcnt(8)
    v_mfma_f32_16x16x32_bf16 v[224:227], v[48:51], v[120:123], v[224:227]
    v_mfma_f32_16x16x32_bf16 v[228:231], v[52:55], v[120:123], v[228:231]
    v_mfma_f32_16x16x32_bf16 v[232:235], v[56:59], v[120:123], v[232:235]
    v_mfma_f32_16x16x32_bf16 v[236:239], v[60:63], v[120:123], v[236:239]
    ds_read_b128 v[120:123], v2 offset:12288
    s_waitcnt lgkmcnt(8)
    v_mfma_f32_16x16x32_bf16 v[252:255], v[60:63], v[124:127], v[252:255]
    v_mfma_f32_16x16x32_bf16 v[248:251], v[56:59], v[124:127], v[248:251]
    v_mfma_f32_16x16x32_bf16 v[244:247], v[52:55], v[124:127], v[244:247]
    v_mfma_f32_16x16x32_bf16 v[240:243], v[48:51], v[124:127], v[240:243]
    ds_read_b128 v[124:127], v2 offset:14336
    s_waitcnt vmcnt(15) lgkmcnt(7)
    v_mfma_f32_16x16x32_bf16 v[128:131], v[16:19], v[96:99], v[128:131]
    s_add_u32 s48, s49, 393216
    buffer_load_dwordx4 v[48:51], v1, s[80:83], s48 offen sc1
    s_waitcnt vmcnt(15)
    v_mfma_f32_16x16x32_bf16 v[132:135], v[20:23], v[96:99], v[132:135]
    s_waitcnt vmcnt(14)
    v_mfma_f32_16x16x32_bf16 v[136:139], v[24:27], v[96:99], v[136:139]
    buffer_load_dwordx4 v[52:55], v1, s[80:83], s48 offen offset:1024 sc1
    s_waitcnt vmcnt(14)
    v_mfma_f32_16x16x32_bf16 v[140:143], v[28:31], v[96:99], v[140:143]
    ds_read_b128 v[96:99], v3 offset:0
    s_waitcnt lgkmcnt(7)
    v_mfma_f32_16x16x32_bf16 v[156:159], v[28:31], v[100:103], v[156:159]
    buffer_load_dwordx4 v[56:59], v1, s[80:83], s48 offen offset:2048 sc1
    v_mfma_f32_16x16x32_bf16 v[152:155], v[24:27], v[100:103], v[152:155]
    v_mfma_f32_16x16x32_bf16 v[148:151], v[20:23], v[100:103], v[148:151]
    buffer_load_dwordx4 v[60:63], v1, s[80:83], s48 offen offset:3072 sc1
    v_mfma_f32_16x16x32_bf16 v[144:147], v[16:19], v[100:103], v[144:147]
    ds_read_b128 v[100:103], v3 offset:2048
    s_waitcnt lgkmcnt(7)
    v_mfma_f32_16x16x32_bf16 v[160:163], v[16:19], v[104:107], v[160:163]
    v_mfma_f32_16x16x32_bf16 v[164:167], v[20:23], v[104:107], v[164:167]
    v_mfma_f32_16x16x32_bf16 v[168:171], v[24:27], v[104:107], v[168:171]
    v_mfma_f32_16x16x32_bf16 v[172:175], v[28:31], v[104:107], v[172:175]
    ds_read_b128 v[104:107], v3 offset:4096
    s_waitcnt lgkmcnt(7)
    v_mfma_f32_16x16x32_bf16 v[188:191], v[28:31], v[108:111], v[188:191]
    v_mfma_f32_16x16x32_bf16 v[184:187], v[24:27], v[108:111], v[184:187]
    v_mfma_f32_16x16x32_bf16 v[180:183], v[20:23], v[108:111], v[180:183]
    v_mfma_f32_16x16x32_bf16 v[176:179], v[16:19], v[108:111], v[176:179]
    ds_read_b128 v[108:111], v3 offset:6144
    s_waitcnt lgkmcnt(7)
    v_mfma_f32_16x16x32_bf16 v[192:195], v[16:19], v[112:115], v[192:195]
    v_mfma_f32_16x16x32_bf16 v[196:199], v[20:23], v[112:115], v[196:199]
    v_mfma_f32_16x16x32_bf16 v[200:203], v[24:27], v[112:115], v[200:203]
    v_mfma_f32_16x16x32_bf16 v[204:207], v[28:31], v[112:115], v[204:207]
    ds_read_b128 v[112:115], v3 offset:8192
    ds_read_b32 v10, v9
    s_waitcnt lgkmcnt(8)
    v_mfma_f32_16x16x32_bf16 v[220:223], v[28:31], v[116:119], v[220:223]
    v_mfma_f32_16x16x32_bf16 v[216:219], v[24:27], v[116:119], v[216:219]
    v_mfma_f32_16x16x32_bf16 v[212:215], v[20:23], v[116:119], v[212:215]
    v_mfma_f32_16x16x32_bf16 v[208:211], v[16:19], v[116:119], v[208:211]
    ds_read_b128 v[116:119], v3 offset:10240
    s_waitcnt lgkmcnt(8)
    v_mfma_f32_16x16x32_bf16 v[224:227], v[16:19], v[120:123], v[224:227]
    v_mfma_f32_16x16x32_bf16 v[228:231], v[20:23], v[120:123], v[228:231]
    v_mfma_f32_16x16x32_bf16 v[232:235], v[24:27], v[120:123], v[232:235]
    v_mfma_f32_16x16x32_bf16 v[236:239], v[28:31], v[120:123], v[236:239]
    ds_read_b128 v[120:123], v3 offset:12288
    s_waitcnt lgkmcnt(8)
    v_mfma_f32_16x16x32_bf16 v[252:255], v[28:31], v[124:127], v[252:255]
    v_mfma_f32_16x16x32_bf16 v[248:251], v[24:27], v[124:127], v[248:251]
    v_mfma_f32_16x16x32_bf16 v[244:247], v[20:23], v[124:127], v[244:247]
    v_mfma_f32_16x16x32_bf16 v[240:243], v[16:19], v[124:127], v[240:243]
    ds_read_b128 v[124:127], v3 offset:14336
    ds_add_u32 v7, v8 offset:16
    s_waitcnt vmcnt(15) lgkmcnt(9)
    v_mfma_f32_16x16x32_bf16 v[128:131], v[32:35], v[96:99], v[128:131]
    s_add_u32 s48, s49, 409600
    buffer_load_dwordx4 v[16:19], v1, s[80:83], s48 offen sc1
    s_waitcnt vmcnt(15)
    v_mfma_f32_16x16x32_bf16 v[132:135], v[36:39], v[96:99], v[132:135]
    s_waitcnt lgkmcnt(4)
    v_cmp_gt_u32 vcc, 12, v10
    s_waitcnt vmcnt(14)
    v_mfma_f32_16x16x32_bf16 v[136:139], v[40:43], v[96:99], v[136:139]
    s_cbranch_vccnz L_gs13
L_gb13:
    buffer_load_dwordx4 v[20:23], v1, s[80:83], s48 offen offset:1024 sc1
    s_waitcnt vmcnt(14)
    v_mfma_f32_16x16x32_bf16 v[140:143], v[44:47], v[96:99], v[140:143]
    ds_read_b128 v[96:99], v2 offset:16384
    v_mfma_f32_16x16x32_bf16 v[156:159], v[44:47], v[100:103], v[156:159]
    buffer_load_dwordx4 v[24:27], v1, s[80:83], s48 offen offset:2048 sc1
    v_mfma_f32_16x16x32_bf16 v[152:155], v[40:43], v[100:103], v[152:155]
    v_mfma_f32_16x16x32_bf16 v[148:151], v[36:39], v[100:103], v[148:151]
    buffer_load_dwordx4 v[28:31], v1, s[80:83], s48 offen offset:3072 sc1
    v_mfma_f32_16x16x32_bf16 v[144:147], v[32:35], v[100:103], v[144:147]
    ds_read_b128 v[100:103], v2 offset:18432
    v_mfma_f32_16x16x32_bf16 v[160:163], v[32:35], v[104:107], v[160:163]
    v_mfma_f32_16x16x32_bf16 v[164:167], v[36:39], v[104:107], v[164:167]
    v_mfma_f32_16x16x32_bf16 v[168:171], v[40:43], v[104:107], v[168:171]
    v_mfma_f32_16x16x32_bf16 v[172:175], v[44:47], v[104:107], v[172:175]
    ds_read_b128 v[104:107], v2 offset:20480
    v_mfma_f32_16x16x32_bf16 v[188:191], v[44:47], v[108:111], v[188:191]
    v_mfma_f32_16x16x32_bf16 v[184:187], v[40:43], v[108:111], v[184:187]
    v_mfma_f32_16x16x32_bf16 v[180:183], v[36:39], v[108:111], v[180:183]
    v_mfma_f32_16x16x32_bf16 v[176:179], v[32:35], v[108:111], v[176:179]
    ds_read_b128 v[108:111], v2 offset:22528
    v_mfma_f32_16x16x32_bf16 v[192:195], v[32:35], v[112:115], v[192:195]
    v_mfma_f32_16x16x32_bf16 v[196:199], v[36:39], v[112:115], v[196:199]
    v_mfma_f32_16x16x32_bf16 v[200:203], v[40:43], v[112:115], v[200:203]
    v_mfma_f32_16x16x32_bf16 v[204:207], v[44:47], v[112:115], v[204:207]
    ds_read_b128 v[112:115], v2 offset:24576
    s_waitcnt lgkmcnt(8)
    v_mfma_f32_16x16x32_bf16 v[220:223], v[44:47], v[116:119], v[220:223]
    v_mfma_f32_16x16x32_bf16 v[216:219], v[40:43], v[116:119], v[216:219]
    v_mfma_f32_16x16x32_bf16 v[212:215], v[36:39], v[116:119], v[212:215]
    v_mfma_f32_16x16x32_bf16 v[208:211], v[32:35], v[116:119], v[208:211]
    ds_read_b128 v[116:119], v2 offset:26624
    s_waitcnt lgkmcnt(8)
    v_mfma_f32_16x16x32_bf16 v[224:227], v[32:35], v[120:123], v[224:227]
    v_mfma_f32_16x16x32_bf16 v[228:231], v[36:39], v[120:123], v[228:231]
    v_mfma_f32_16x16x32_bf16 v[232:235], v[40:43], v[120:123], v[232:235]
    v_mfma_f32_16x16x32_bf16 v[236:239], v[44:47], v[120:123], v[236:239]
    ds_read_b128 v[120:123], v2 offset:28672
    s_waitcnt lgkmcnt(8)
    v_mfma_f32_16x16x32_bf16 v[252:255], v[44:47], v[124:127], v[252:255]
    v_mfma_f32_16x16x32_bf16 v[248:251], v[40:43], v[124:127], v[248:251]
    v_mfma_f32_16x16x32_bf16 v[244:247], v[36:39], v[124:127], v[244:247]
    v_mfma_f32_16x16x32_bf16 v[240:243], v[32:35], v[124:127], v[240:243]
    ds_read_b128 v[124:127], v2 offset:30720
    s_waitcnt vmcnt(15) lgkmcnt(7)
    v_mfma_f32_16x16x32_bf16 v[128:131], v[64:67], v[96:99], v[128:131]
    s_add_u32 s48, s49, 425984
    buffer_load_dwordx4 v[32:35], v1, s[80:83], s48 offen sc1
    s_waitcnt vmcnt(15)
    v_mfma_f32_16x16x32_bf16 v[132:135], v[68:71], v[96:99], v[132:135]
    s_waitcnt vmcnt(14)
    v_mfma_f32_16x16x32_bf16 v[136:139], v[72:75], v[96:99], v[136:139]
    buffer_load_dwordx4 v[36:39], v1, s[80:83], s48 offen offset:1024 sc1
    s_waitcnt vmcnt(14)
    v_mfma_f32_16x16x32_bf16 v[140:143], v[76:79], v[96:99], v[140:143]
    ds_read_b128 v[96:99], v3 offset:16384
    s_waitcnt lgkmcnt(7)
    v_mfma_f32_16x16x32_bf16 v[156:159], v[76:79], v[100:103], v[156:159]
    buffer_load_dwordx4 v[40:43], v1, s[80:83], s48 offen offset:2048 sc1
    v_mfma_f32_16x16x32_bf16 v[152:155], v[72:75], v[100:103], v[152:155]
    v_mfma_f32_16x16x32_bf16 v[148:151], v[68:71], v[100:103], v[148:151]
    buffer_load_dwordx4 v[44:47], v1, s[80:83], s48 offen offset:3072 sc1
    v_mfma_f32_16x16x32_bf16 v[144:147], v[64:67], v[100:103], v[144:147]
    ds_read_b128 v[100:103], v3 offset:18432
    s_waitcnt lgkmcnt(7)
    v_mfma_f32_16x16x32_bf16 v[160:163], v[64:67], v[104:107], v[160:163]
    v_mfma_f32_16x16x32_bf16 v[164:167], v[68:71], v[104:107], v[164:167]
    v_mfma_f32_16x16x32_bf16 v[168:171], v[72:75], v[104:107], v[168:171]
    v_mfma_f32_16x16x32_bf16 v[172:175], v[76:79], v[104:107], v[172:175]
    ds_read_b128 v[104:107], v3 offset:20480
    s_waitcnt lgkmcnt(7)
    v_mfma_f32_16x16x32_bf16 v[188:191], v[76:79], v[108:111], v[188:191]
    v_mfma_f32_16x16x32_bf16 v[184:187], v[72:75], v[108:111], v[184:187]
    v_mfma_f32_16x16x32_bf16 v[180:183], v[68:71], v[108:111], v[180:183]
    v_mfma_f32_16x16x32_bf16 v[176:179], v[64:67], v[108:111], v[176:179]
    ds_read_b128 v[108:111], v3 offset:22528
    s_waitcnt lgkmcnt(7)
    v_mfma_f32_16x16x32_bf16 v[192:195], v[64:67], v[112:115], v[192:195]
    v_mfma_f32_16x16x32_bf16 v[196:199], v[68:71], v[112:115], v[196:199]
    v_mfma_f32_16x16x32_bf16 v[200:203], v[72:75], v[112:115], v[200:203]
    v_mfma_f32_16x16x32_bf16 v[204:207], v[76:79], v[112:115], v[204:207]
    ds_read_b128 v[112:115], v3 offset:24576
    ds_read_b32 v10, v9
    s_waitcnt lgkmcnt(8)
    v_mfma_f32_16x16x32_bf16 v[220:223], v[76:79], v[116:119], v[220:223]
    v_mfma_f32_16x16x32_bf16 v[216:219], v[72:75], v[116:119], v[216:219]
    v_mfma_f32_16x16x32_bf16 v[212:215], v[68:71], v[116:119], v[212:215]
    v_mfma_f32_16x16x32_bf16 v[208:211], v[64:67], v[116:119], v[208:211]
    ds_read_b128 v[116:119], v3 offset:26624
    s_waitcnt lgkmcnt(8)
    v_mfma_f32_16x16x32_bf16 v[224:227], v[64:67], v[120:123], v[224:227]
    v_mfma_f32_16x16x32_bf16 v[228:231], v[68:71], v[120:123], v[228:231]
    v_mfma_f32_16x16x32_bf16 v[232:235], v[72:75], v[120:123], v[232:235]
    v_mfma_f32_16x16x32_bf16 v[236:239], v[76:79], v[120:123], v[236:239]
    ds_read_b128 v[120:123], v3 offset:28672
    s_waitcnt lgkmcnt(8)
    v_mfma_f32_16x16x32_bf16 v[252:255], v[76:79], v[124:127], v[252:255]
    v_mfma_f32_16x16x32_bf16 v[248:251], v[72:75], v[124:127], v[248:251]
    v_mfma_f32_16x16x32_bf16 v[244:247], v[68:71], v[124:127], v[244:247]
    v_mfma_f32_16x16x32_bf16 v[240:243], v[64:67], v[124:127], v[240:243]
    ds_read_b128 v[124:127], v3 offset:30720
    ds_add_u32 v7, v8 offset:16
    s_waitcnt vmcnt(15) lgkmcnt(9)
    v_mfma_f32_16x16x32_bf16 v[128:131], v[80:83], v[96:99], v[128:131]
    s_add_u32 s48, s49, 442368
    buffer_load_dwordx4 v[64:67], v1, s[80:83], s48 offen sc1
    s_waitcnt vmcnt(15)
    v_mfma_f32_16x16x32_bf16 v[132:135], v[84:87], v[96:99], v[132:135]
    s_waitcnt lgkmcnt(4)
    v_cmp_gt_u32 vcc, 13, v10
    s_waitcnt vmcnt(14)
    v_mfma_f32_16x16x32_bf16 v[136:139], v[88:91], v[96:99], v[136:139]
    s_cbranch_vccnz L_gs14
L_gb14:
    buffer_load_dwordx4 v[68:71], v1, s[80:83], s48 offen offset:1024 sc1
    s_waitcnt vmcnt(14)
    v_mfma_f32_16x16x32_bf16 v[140:143], v[92:95], v[96:99], v[140:143]
    ds_read_b128 v[96:99], v2 offset:32768
    v_mfma_f32_16x16x32_bf16 v[156:159], v[92:95], v[100:103], v[156:159]
    buffer_load_dwordx4 v[72:75], v1, s[80:83], s48 offen offset:2048 sc1
    v_mfma_f32_16x16x32_bf16 v[152:155], v[88:91], v[100:103], v[152:155]
    v_mfma_f32_16x16x32_bf16 v[148:151], v[84:87], v[100:103], v[148:151]
    buffer_load_dwordx4 v[76:79], v1, s[80:83], s48 offen offset:3072 sc1
    v_mfma_f32_16x16x32_bf16 v[144:147], v[80:83], v[100:103], v[144:147]
    ds_read_b128 v[100:103], v2 offset:34816
    v_mfma_f32_16x16x32_bf16 v[160:163], v[80:83], v[104:107], v[160:163]
    v_mfma_f32_16x16x32_bf16 v[164:167], v[84:87], v[104:107], v[164:167]
    v_mfma_f32_16x16x32_bf16 v[168:171], v[88:91], v[104:107], v[168:171]
    v_mfma_f32_16x16x32_bf16 v[172:175], v[92:95], v[104:107], v[172:175]
    ds_read_b128 v[104:107], v2 offset:36864
    v_mfma_f32_16x16x32_bf16 v[188:191], v[92:95], v[108:111], v[188:191]
    v_mfma_f32_16x16x32_bf16 v[184:187], v[88:91], v[108:111], v[184:187]
    v_mfma_f32_16x16x32_bf16 v[180:183], v[84:87], v[108:111], v[180:183]
    v_mfma_f32_16x16x32_bf16 v[176:179], v[80:83], v[108:111], v[176:179]
    ds_read_b128 v[108:111], v2 offset:38912
    v_mfma_f32_16x16x32_bf16 v[192:195], v[80:83], v[112:115], v[192:195]
    v_mfma_f32_16x16x32_bf16 v[196:199], v[84:87], v[112:115], v[196:199]
    v_mfma_f32_16x16x32_bf16 v[200:203], v[88:91], v[112:115], v[200:203]
    v_mfma_f32_16x16x32_bf16 v[204:207], v[92:95], v[112:115], v[204:207]
    ds_read_b128 v[112:115], v2 offset:40960
    s_waitcnt lgkmcnt(8)
    v_mfma_f32_16x16x32_bf16 v[220:223], v[92:95], v[116:119], v[220:223]
    v_mfma_f32_16x16x32_bf16 v[216:219], v[88:91], v[116:119], v[216:219]
    v_mfma_f32_16x16x32_bf16 v[212:215], v[84:87], v[116:119], v[212:215]
    v_mfma_f32_16x16x32_bf16 v[208:211], v[80:83], v[116:119], v[208:211]
    ds_read_b128 v[116:119], v2 offset:43008
    s_waitcnt lgkmcnt(8)
    v_mfma_f32_16x16x32_bf16 v[224:227], v[80:83], v[120:123], v[224:227]
    v_mfma_f32_16x16x32_bf16 v[228:231], v[84:87], v[120:123], v[228:231]
    v_mfma_f32_16x16x32_bf16 v[232:235], v[88:91], v[120:123], v[232:235]
    v_mfma_f32_16x16x32_bf16 v[236:239], v[92:95], v[120:123], v[236:239]
    ds_read_b128 v[120:123], v2 offset:45056
    s_waitcnt lgkmcnt(8)
    v_mfma_f32_16x16x32_bf16 v[252:255], v[92:95], v[124:127], v[252:255]
    v_mfma_f32_16x16x32_bf16 v[248:251], v[88:91], v[124:127], v[248:251]
    v_mfma_f32_16x16x32_bf16 v[244:247], v[84:87], v[124:127], v[244:247]
    v_mfma_f32_16x16x32_bf16 v[240:243], v[80:83], v[124:127], v[240:243]
    ds_read_b128 v[124:127], v2 offset:47104
    s_waitcnt vmcnt(15) lgkmcnt(7)
    v_mfma_f32_16x16x32_bf16 v[128:131], v[48:51], v[96:99], v[128:131]
    s_add_u32 s48, s49, 458752
    buffer_load_dwordx4 v[80:83], v1, s[80:83], s48 offen sc1
    s_waitcnt vmcnt(15)
    v_mfma_f32_16x16x32_bf16 v[132:135], v[52:55], v[96:99], v[132:135]
    s_waitcnt vmcnt(14)
    v_mfma_f32_16x16x32_bf16 v[136:139], v[56:59], v[96:99], v[136:139]
    buffer_load_dwordx4 v[84:87], v1, s[80:83], s48 offen offset:1024 sc1
    s_waitcnt vmcnt(14)
    v_mfma_f32_16x16x32_bf16 v[140:143], v[60:63], v[96:99], v[140:143]
    ds_read_b128 v[96:99], v3 offset:32768
    s_waitcnt lgkmcnt(7)
    v_mfma_f32_16x16x32_bf16 v[156:159], v[60:63], v[100:103], v[156:159]
    buffer_load_dwordx4 v[88:91], v1, s[80:83], s48 offen offset:2048 sc1
    v_mfma_f32_16x16x32_bf16 v[152:155], v[56:59], v[100:103], v[152:155]
    v_mfma_f32_16x16x32_bf16 v[148:151], v[52:55], v[100:103], v[148:151]
    buffer_load_dwordx4 v[92:95], v1, s[80:83], s48 offen offset:3072 sc1
    v_mfma_f32_16x16x32_bf16 v[144:147], v[48:51], v[100:103], v[144:147]
    ds_read_b128 v[100:103], v3 offset:34816
    s_waitcnt lgkmcnt(7)
    v_mfma_f32_16x16x32_bf16 v[160:163], v[48:51], v[104:107], v[160:163]
    v_mfma_f32_16x16x32_bf16 v[164:167], v[52:55], v[104:107], v[164:167]
    v_mfma_f32_16x16x32_bf16 v[168:171], v[56:59], v[104:107], v[168:171]
    v_mfma_f32_16x16x32_bf16 v[172:175], v[60:63], v[104:107], v[172:175]
    ds_read_b128 v[104:107], v3 offset:36864
    s_waitcnt lgkmcnt(7)
    v_mfma_f32_16x16x32_bf16 v[188:191], v[60:63], v[108:111], v[188:191]
    v_mfma_f32_16x16x32_bf16 v[184:187], v[56:59], v[108:111], v[184:187]
    v_mfma_f32_16x16x32_bf16 v[180:183], v[52:55], v[108:111], v[180:183]
    v_mfma_f32_16x16x32_bf16 v[176:179], v[48:51], v[108:111], v[176:179]
    ds_read_b128 v[108:111], v3 offset:38912
    s_waitcnt lgkmcnt(7)
    v_mfma_f32_16x16x32_bf16 v[192:195], v[48:51], v[112:115], v[192:195]
    v_mfma_f32_16x16x32_bf16 v[196:199], v[52:55], v[112:115], v[196:199]
    v_mfma_f32_16x16x32_bf16 v[200:203], v[56:59], v[112:115], v[200:203]
    v_mfma_f32_16x16x32_bf16 v[204:207], v[60:63], v[112:115], v[204:207]
    ds_read_b128 v[112:115], v3 offset:40960
    ds_read_b32 v10, v9
    s_waitcnt lgkmcnt(8)
    v_mfma_f32_16x16x32_bf16 v[220:223], v[60:63], v[116:119], v[220:223]
    v_mfma_f32_16x16x32_bf16 v[216:219], v[56:59], v[116:119], v[216:219]
    v_mfma_f32_16x16x32_bf16 v[212:215], v[52:55], v[116:119], v[212:215]
    v_mfma_f32_16x16x32_bf16 v[208:211], v[48:51], v[116:119], v[208:211]
    ds_read_b128 v[116:119], v3 offset:43008
    s_waitcnt lgkmcnt(8)
    v_mfma_f32_16x16x32_bf16 v[224:227], v[48:51], v[120:123], v[224:227]
    v_mfma_f32_16x16x32_bf16 v[228:231], v[52:55], v[120:123], v[228:231]
    v_mfma_f32_16x16x32_bf16 v[232:235], v[56:59], v[120:123], v[232:235]
    v_mfma_f32_16x16x32_bf16 v[236:239], v[60:63], v[120:123], v[236:239]
    ds_read_b128 v[120:123], v3 offset:45056
    s_waitcnt lgkmcnt(8)
    v_mfma_f32_16x16x32_bf16 v[252:255], v[60:63], v[124:127], v[252:255]
    v_mfma_f32_16x16x32_bf16 v[248:251], v[56:59], v[124:127], v[248:251]
    v_mfma_f32_16x16x32_bf16 v[244:247], v[52:55], v[124:127], v[244:247]
    v_mfma_f32_16x16x32_bf16 v[240:243], v[48:51], v[124:127], v[240:243]
    ds_read_b128 v[124:127], v3 offset:47104
    ds_add_u32 v7, v8 offset:16
    s_waitcnt vmcnt(15) lgkmcnt(9)
    v_mfma_f32_16x16x32_bf16 v[128:131], v[16:19], v[96:99], v[128:131]
    s_add_u32 s48, s49, 475136
    buffer_load_dwordx4 v[48:51], v1, s[80:83], s48 offen sc1
    s_waitcnt vmcnt(15)
    v_mfma_f32_16x16x32_bf16 v[132:135], v[20:23], v[96:99], v[132:135]
    s_waitcnt lgkmcnt(4)
    v_cmp_gt_u32 vcc, 14, v10
    s_waitcnt vmcnt(14)
    v_mfma_f32_16x16x32_bf16 v[136:139], v[24:27], v[96:99], v[136:139]
    s_cbranch_vccnz L_gs15
L_gb15:
    buffer_load_dwordx4 v[52:55], v1, s[80:83], s48 offen offset:1024 sc1
    s_waitcnt vmcnt(14)
    v_mfma_f32_16x16x32_bf16 v[140:143], v[28:31], v[96:99], v[140:143]
    ds_read_b128 v[96:99], v2 offset:49152
    v_mfma_f32_16x16x32_bf16 v[156:159], v[28:31], v[100:103], v[156:159]
    buffer_load_dwordx4 v[56:59], v1, s[80:83], s48 offen offset:2048 sc1
    v_mfma_f32_16x16x32_bf16 v[152:155], v[24:27], v[100:103], v[152:155]
    v_mfma_f32_16x16x32_bf16 v[148:151], v[20:23], v[100:103], v[148:151]
    buffer_load_dwordx4 v[60:63], v1, s[80:83], s48 offen offset:3072 sc1
    v_mfma_f32_16x16x32_bf16 v[144:147], v[16:19], v[100:103], v[144:147]
    ds_read_b128 v[100:103], v2 offset:51200
    v_mfma_f32_16x16x32_bf16 v[160:163], v[16:19], v[104:107], v[160:163]
    v_mfma_f32_16x16x32_bf16 v[164:167], v[20:23], v[104:107], v[164:167]
    v_mfma_f32_16x16x32_bf16 v[168:171], v[24:27], v[104:107], v[168:171]
    v_mfma_f32_16x16x32_bf16 v[172:175], v[28:31], v[104:107], v[172:175]
    ds_read_b128 v[104:107], v2 offset:53248
    v_mfma_f32_16x16x32_bf16 v[188:191], v[28:31], v[108:111], v[188:191]
    v_mfma_f32_16x16x32_bf16 v[184:187], v[24:27], v[108:111], v[184:187]
    v_mfma_f32_16x16x32_bf16 v[180:183], v[20:23], v[108:111], v[180:183]
    v_mfma_f32_16x16x32_bf16 v[176:179], v[16:19], v[108:111], v[176:179]
    ds_read_b128 v[108:111], v2 offset:55296
    v_mfma_f32_16x16x32_bf16 v[192:195], v[16:19], v[112:115], v[192:195]
    v_mfma_f32_16x16x32_bf16 v[196:199], v[20:23], v[112:115], v[196:199]
    v_mfma_f32_16x16x32_bf16 v[200:203], v[24:27], v[112:115], v[200:203]
    v_mfma_f32_16x16x32_bf16 v[204:207], v[28:31], v[112:115], v[204:207]
    ds_read_b128 v[112:115], v2 offset:57344
    s_waitcnt lgkmcnt(8)
    v_mfma_f32_16x16x32_bf16 v[220:223], v[28:31], v[116:119], v[220:223]
    v_mfma_f32_16x16x32_bf16 v[216:219], v[24:27], v[116:119], v[216:219]
    v_mfma_f32_16x16x32_bf16 v[212:215], v[20:23], v[116:119], v[212:215]
    v_mfma_f32_16x16x32_bf16 v[208:211], v[16:19], v[116:119], v[208:211]
    ds_read_b128 v[116:119], v2 offset:59392
    s_waitcnt lgkmcnt(8)
    v_mfma_f32_16x16x32_bf16 v[224:227], v[16:19], v[120:123], v[224:227]
    v_mfma_f32_16x16x32_bf16 v[228:231], v[20:23], v[120:123], v[228:231]
    v_mfma_f32_16x16x32_bf16 v[232:235], v[24:27], v[120:123], v[232:235]
    v_mfma_f32_16x16x32_bf16 v[236:239], v[28:31], v[120:123], v[236:239]
    ds_read_b128 v[120:123], v2 offset:61440
    s_waitcnt lgkmcnt(8)
    v_mfma_f32_16x16x32_bf16 v[252:255], v[28:31], v[124:127], v[252:255]
    v_mfma_f32_16x16x32_bf16 v[248:251], v[24:27], v[124:127], v[248:251]
    v_mfma_f32_16x16x32_bf16 v[244:247], v[20:23], v[124:127], v[244:247]
    v_mfma_f32_16x16x32_bf16 v[240:243], v[16:19], v[124:127], v[240:243]
    ds_read_b128 v[124:127], v2 offset:63488
    s_waitcnt vmcnt(15) lgkmcnt(7)
    v_mfma_f32_16x16x32_bf16 v[128:131], v[32:35], v[96:99], v[128:131]
    s_add_u32 s48, s49, 491520
    buffer_load_dwordx4 v[16:19], v1, s[80:83], s48 offen sc1
    s_waitcnt vmcnt(15)
    v_mfma_f32_16x16x32_bf16 v[132:135], v[36:39], v[96:99], v[132:135]
    s_waitcnt vmcnt(14)
    v_mfma_f32_16x16x32_bf16 v[136:139], v[40:43], v[96:99], v[136:139]
    buffer_load_dwordx4 v[20:23], v1, s[80:83], s48 offen offset:1024 sc1
    s_waitcnt vmcnt(14)
    v_mfma_f32_16x16x32_bf16 v[140:143], v[44:47], v[96:99], v[140:143]
    ds_read_b128 v[96:99], v3 offset:49152
    s_waitcnt lgkmcnt(7)
    v_mfma_f32_16x16x32_bf16 v[156:159], v[44:47], v[100:103], v[156:159]
    buffer_load_dwordx4 v[24:27], v1, s[80:83], s48 offen offset:2048 sc1
    v_mfma_f32_16x16x32_bf16 v[152:155], v[40:43], v[100:103], v[152:155]
    v_mfma_f32_16x16x32_bf16 v[148:151], v[36:39], v[100:103], v[148:151]
    buffer_load_dwordx4 v[28:31], v1, s[80:83], s48 offen offset:3072 sc1
    v_mfma_f32_16x16x32_bf16 v[144:147], v[32:35], v[100:103], v[144:147]
    ds_read_b128 v[100:103], v3 offset:51200
    s_waitcnt lgkmcnt(7)
    v_mfma_f32_16x16x32_bf16 v[160:163], v[32:35], v[104:107], v[160:163]
    v_mfma_f32_16x16x32_bf16 v[164:167], v[36:39], v[104:107], v[164:167]
    v_mfma_f32_16x16x32_bf16 v[168:171], v[40:43], v[104:107], v[168:171]
    v_mfma_f32_16x16x32_bf16 v[172:175], v[44:47], v[104:107], v[172:175]
    ds_read_b128 v[104:107], v3 offset:53248
    s_waitcnt lgkmcnt(7)
    v_mfma_f32_16x16x32_bf16 v[188:191], v[44:47], v[108:111], v[188:191]
    v_mfma_f32_16x16x32_bf16 v[184:187], v[40:43], v[108:111], v[184:187]
    v_mfma_f32_16x16x32_bf16 v[180:183], v[36:39], v[108:111], v[180:183]
    v_mfma_f32_16x16x32_bf16 v[176:179], v[32:35], v[108:111], v[176:179]
    ds_read_b128 v[108:111], v3 offset:55296
    s_waitcnt lgkmcnt(7)
    v_mfma_f32_16x16x32_bf16 v[192:195], v[32:35], v[112:115], v[192:195]
    v_mfma_f32_16x16x32_bf16 v[196:199], v[36:39], v[112:115], v[196:199]
    v_mfma_f32_16x16x32_bf16 v[200:203], v[40:43], v[112:115], v[200:203]
    v_mfma_f32_16x16x32_bf16 v[204:207], v[44:47], v[112:115], v[204:207]
    ds_read_b128 v[112:115], v3 offset:57344
    ds_read_b32 v10, v9
    s_waitcnt lgkmcnt(8)
    v_mfma_f32_16x16x32_bf16 v[220:223], v[44:47], v[116:119], v[220:223]
    v_mfma_f32_16x16x32_bf16 v[216:219], v[40:43], v[116:119], v[216:219]
    v_mfma_f32_16x16x32_bf16 v[212:215], v[36:39], v[116:119], v[212:215]
    v_mfma_f32_16x16x32_bf16 v[208:211], v[32:35], v[116:119], v[208:211]
    ds_read_b128 v[116:119], v3 offset:59392
    s_waitcnt lgkmcnt(8)
    v_mfma_f32_16x16x32_bf16 v[224:227], v[32:35], v[120:123], v[224:227]
    v_mfma_f32_16x16x32_bf16 v[228:231], v[36:39], v[120:123], v[228:231]
    v_mfma_f32_16x16x32_bf16 v[232:235], v[40:43], v[120:123], v[232:235]
    v_mfma_f32_16x16x32_bf16 v[236:239], v[44:47], v[120:123], v[236:239]
    ds_read_b128 v[120:123], v3 offset:61440
    s_waitcnt lgkmcnt(8)
    v_mfma_f32_16x16x32_bf16 v[252:255], v[44:47], v[124:127], v[252:255]
    v_mfma_f32_16x16x32_bf16 v[248:251], v[40:43], v[124:127], v[248:251]
    v_mfma_f32_16x16x32_bf16 v[244:247], v[36:39], v[124:127], v[244:247]
    v_mfma_f32_16x16x32_bf16 v[240:243], v[32:35], v[124:127], v[240:243]
    ds_read_b128 v[124:127], v3 offset:63488
    ds_add_u32 v7, v8 offset:16
    s_waitcnt vmcnt(15) lgkmcnt(9)
    v_mfma_f32_16x16x32_bf16 v[128:131], v[64:67], v[96:99], v[128:131]
    s_add_u32 s48, s49, 507904
    buffer_load_dwordx4 v[32:35], v1, s[80:83], s48 offen sc1
    s_waitcnt vmcnt(15)
    v_mfma_f32_16x16x32_bf16 v[132:135], v[68:71], v[96:99], v[132:135]
    s_waitcnt lgkmcnt(4)
    v_cmp_gt_u32 vcc, 15, v10
    s_waitcnt vmcnt(14)
    v_mfma_f32_16x16x32_bf16 v[136:139], v[72:75], v[96:99], v[136:139]
    s_cbranch_vccnz L_gs16
L_gb16:
    buffer_load_dwordx4 v[36:39], v1, s[80:83], s48 offen offset:1024 sc1
    s_waitcnt vmcnt(14)
    v_mfma_f32_16x16x32_bf16 v[140:143], v[76:79], v[96:99], v[140:143]
    ds_read_b128 v[96:99], v4 offset:0
    v_mfma_f32_16x16x32_bf16 v[156:159], v[76:79], v[100:103], v[156:159]
    buffer_load_dwordx4 v[40:43], v1, s[80:83], s48 offen offset:2048 sc1
    v_mfma_f32_16x16x32_bf16 v[152:155], v[72:75], v[100:103], v[152:155]
    v_mfma_f32_16x16x32_bf16 v[148:151], v[68:71], v[100:103], v[148:151]
    buffer_load_dwordx4 v[44:47], v1, s[80:83], s48 offen offset:3072 sc1
    v_mfma_f32_16x16x32_bf16 v[144:147], v[64:67], v[100:103], v[144:147]
    ds_read_b128 v[100:103], v4 offset:2048
    v_mfma_f32_16x16x32_bf16 v[160:163], v[64:67], v[104:107], v[160:163]
    v_mfma_f32_16x16x32_bf16 v[164:167], v[68:71], v[104:107], v[164:167]
    v_mfma_f32_16x16x32_bf16 v[168:171], v[72:75], v[104:107], v[168:171]
    v_mfma_f32_16x16x32_bf16 v[172:175], v[76:79], v[104:107], v[172:175]
    ds_read_b128 v[104:107], v4 offset:4096
    v_mfma_f32_16x16x32_bf16 v[188:191], v[76:79], v[108:111], v[188:191]
    v_mfma_f32_16x16x32_bf16 v[184:187], v[72:75], v[108:111], v[184:187]
    v_mfma_f32_16x16x32_bf16 v[180:183], v[68:71], v[108:111], v[180:183]
    v_mfma_f32_16x16x32_bf16 v[176:179], v[64:67], v[108:111], v[176:179]
    ds_read_b128 v[108:111], v4 offset:6144
    v_mfma_f32_16x16x32_bf16 v[192:195], v[64:67], v[112:115], v[192:195]
    v_mfma_f32_16x16x32_bf16 v[196:199], v[68:71], v[112:115], v[196:199]
    v_mfma_f32_16x16x32_bf16 v[200:203], v[72:75], v[112:115], v[200:203]
    v_mfma_f32_16x16x32_bf16 v[204:207], v[76:79], v[112:115], v[204:207]
    ds_read_b128 v[112:115], v4 offset:8192
    s_waitcnt lgkmcnt(8)
    v_mfma_f32_16x16x32_bf16 v[220:223], v[76:79], v[116:119], v[220:223]
    v_mfma_f32_16x16x32_bf16 v[216:219], v[72:75], v[116:119], v[216:219]
    v_mfma_f32_16x16x32_bf16 v[212:215], v[68:71], v[116:119], v[212:215]
    v_mfma_f32_16x16x32_bf16 v[208:211], v[64:67], v[116:119], v[208:211]
    ds_read_b128 v[116:119], v4 offset:10240
    s_waitcnt lgkmcnt(8)
    v_mfma_f32_16x16x32_bf16 v[224:227], v[64:67], v[120:123], v[224:227]
    v_mfma_f32_16x16x32_bf16 v[228:231], v[68:71], v[120:123], v[228:231]
    v_mfma_f32_16x16x32_bf16 v[232:235], v[72:75], v[120:123], v[232:235]
    v_mfma_f32_16x16x32_bf16 v[236:239], v[76:79], v[120:123], v[236:239]
    ds_read_b128 v[120:123], v4 offset:12288
    s_waitcnt lgkmcnt(8)
    v_mfma_f32_16x16x32_bf16 v[252:255], v[76:79], v[124:127], v[252:255]
    v_mfma_f32_16x16x32_bf16 v[248:251], v[72:75], v[124:127], v[248:251]
    v_mfma_f32_16x16x32_bf16 v[244:247], v[68:71], v[124:127], v[244:247]
    v_mfma_f32_16x16x32_bf16 v[240:243], v[64:67], v[124:127], v[240:243]
    ds_read_b128 v[124:127], v4 offset:14336
    s_waitcnt vmcnt(15) lgkmcnt(7)
    v_mfma_f32_16x16x32_bf16 v[128:131], v[80:83], v[96:99], v[128:131]
    s_add_u32 s48, s49, 524288
    buffer_load_dwordx4 v[64:67], v1, s[80:83], s48 offen sc1
    s_waitcnt vmcnt(15)
    v_mfma_f32_16x16x32_bf16 v[132:135], v[84:87], v[96:99], v[132:135]
    s_waitcnt vmcnt(14)
    v_mfma_f32_16x16x32_bf16 v[136:139], v[88:91], v[96:99], v[136:139]
    buffer_load_dwordx4 v[68:71], v1, s[80:83], s48 offen offset:1024 sc1
    s_waitcnt vmcnt(14)
    v_mfma_f32_16x16x32_bf16 v[140:143], v[92:95], v[96:99], v[140:143]
    ds_read_b128 v[96:99], v5 offset:0
    s_waitcnt lgkmcnt(7)
    v_mfma_f32_16x16x32_bf16 v[156:159], v[92:95], v[100:103], v[156:159]
    buffer_load_dwordx4 v[72:75], v1, s[80:83], s48 offen offset:2048 sc1
    v_mfma_f32_16x16x32_bf16 v[152:155], v[88:91], v[100:103], v[152:155]
    v_mfma_f32_16x16x32_bf16 v[148:151], v[84:87], v[100:103], v[148:151]
    buffer_load_dwordx4 v[76:79], v1, s[80:83], s48 offen offset:3072 sc1
    v_mfma_f32_16x16x32_bf16 v[144:147], v[80:83], v[100:103], v[144:147]
    ds_read_b128 v[100:103], v5 offset:2048
    s_waitcnt lgkmcnt(7)
    v_mfma_f32_16x16x32_bf16 v[160:163], v[80:83], v[104:107], v[160:163]
    v_mfma_f32_16x16x32_bf16 v[164:167], v[84:87], v[104:107], v[164:167]
    v_mfma_f32_16x16x32_bf16 v[168:171], v[88:91], v[104:107], v[168:171]
    v_mfma_f32_16x16x32_bf16 v[172:175], v[92:95], v[104:107], v[172:175]
    ds_read_b128 v[104:107], v5 offset:4096
    s_waitcnt lgkmcnt(7)
    v_mfma_f32_16x16x32_bf16 v[188:191], v[92:95], v[108:111], v[188:191]
    v_mfma_f32_16x16x32_bf16 v[184:187], v[88:91], v[108:111], v[184:187]
    v_mfma_f32_16x16x32_bf16 v[180:183], v[84:87], v[108:111], v[180:183]
    v_mfma_f32_16x16x32_bf16 v[176:179], v[80:83], v[108:111], v[176:179]
    ds_read_b128 v[108:111], v5 offset:6144
    s_waitcnt lgkmcnt(7)
    v_mfma_f32_16x16x32_bf16 v[192:195], v[80:83], v[112:115], v[192:195]
    v_mfma_f32_16x16x32_bf16 v[196:199], v[84:87], v[112:115], v[196:199]
    v_mfma_f32_16x16x32_bf16 v[200:203], v[88:91], v[112:115], v[200:203]
    v_mfma_f32_16x16x32_bf16 v[204:207], v[92:95], v[112:115], v[204:207]
    ds_read_b128 v[112:115], v5 offset:8192
    ds_read_b32 v10, v9
    s_waitcnt lgkmcnt(8)
    v_mfma_f32_16x16x32_bf16 v[220:223], v[92:95], v[116:119], v[220:223]
    v_mfma_f32_16x16x32_bf16 v[216:219], v[88:91], v[116:119], v[216:219]
    v_mfma_f32_16x16x32_bf16 v[212:215], v[84:87], v[116:119], v[212:215]
    v_mfma_f32_16x16x32_bf16 v[208:211], v[80:83], v[116:119], v[208:211]
    ds_read_b128 v[116:119], v5 offset:10240
    s_waitcnt lgkmcnt(8)
    v_mfma_f32_16x16x32_bf16 v[224:227], v[80:83], v[120:123], v[224:227]
    v_mfma_f32_16x16x32_bf16 v[228:231], v[84:87], v[120:123], v[228:231]
    v_mfma_f32_16x16x32_bf16 v[232:235], v[88:91], v[120:123], v[232:235]
    v_mfma_f32_16x16x32_bf16 v[236:239], v[92:95], v[120:123], v[236:239]
    ds_read_b128 v[120:123], v5 offset:12288
    s_waitcnt lgkmcnt(8)
    v_mfma_f32_16x16x32_bf16 v[252:255], v[92:95], v[124:127], v[252:255]
    v_mfma_f32_16x16x32_bf16 v[248:251], v[88:91], v[124:127], v[248:251]
    v_mfma_f32_16x16x32_bf16 v[244:247], v[84:87], v[124:127], v[244:247]
    v_mfma_f32_16x16x32_bf16 v[240:243], v[80:83], v[124:127], v[240:243]
    ds_read_b128 v[124:127], v5 offset:14336
    ds_add_u32 v7, v8 offset:16
    s_waitcnt vmcnt(15) lgkmcnt(9)
    v_mfma_f32_16x16x32_bf16 v[128:131], v[48:51], v[96:99], v[128:131]
    s_add_u32 s48, s49, 540672
    buffer_load_dwordx4 v[80:83], v1, s[80:83], s48 offen sc1
    s_waitcnt vmcnt(15)
    v_mfma_f32_16x16x32_bf16 v[132:135], v[52:55], v[96:99], v[132:135]
    s_waitcnt lgkmcnt(4)
    v_cmp_gt_u32 vcc, 16, v10
    s_waitcnt vmcnt(14)
    v_mfma_f32_16x16x32_bf16 v[136:139], v[56:59], v[96:99], v[136:139]
    s_cbranch_vccnz L_gs17
L_gb17:
    buffer_load_dwordx4 v[84:87], v1, s[80:83], s48 offen offset:1024 sc1
    s_waitcnt vmcnt(14)
    v_mfma_f32_16x16x32_bf16 v[140:143], v[60:63], v[96:99], v[140:143]
    ds_read_b128 v[96:99], v2 offset:0
    v_mfma_f32_16x16x32_bf16 v[156:159], v[60:63], v[100:103], v[156:159]
    buffer_load_dwordx4 v[88:91], v1, s[80:83], s48 offen offset:2048 sc1
    v_mfma_f32_16x16x32_bf16 v[152:155], v[56:59], v[100:103], v[152:155]
    v_mfma_f32_16x16x32_bf16 v[148:151], v[52:55], v[100:103], v[148:151]
    buffer_load_dwordx4 v[92:95], v1, s[80:83], s48 offen offset:3072 sc1
    v_mfma_f32_16x16x32_bf16 v[144:147], v[48:51], v[100:103], v[144:147]
    ds_read_b128 v[100:103], v2 offset:2048
    v_mfma_f32_16x16x32_bf16 v[160:163], v[48:51], v[104:107], v[160:163]
    v_mfma_f32_16x16x32_bf16 v[164:167], v[52:55], v[104:107], v[164:167]
    v_mfma_f32_16x16x32_bf16 v[168:171], v[56:59], v[104:107], v[168:171]
    v_mfma_f32_16x16x32_bf16 v[172:175], v[60:63], v[104:107], v[172:175]
    ds_read_b128 v[104:107], v2 offset:4096
    v_mfma_f32_16x16x32_bf16 v[188:191], v[60:63], v[108:111], v[188:191]
    v_mfma_f32_16x16x32_bf16 v[184:187], v[56:59], v[108:111], v[184:187]
    v_mfma_f32_16x16x32_bf16 v[180:183], v[52:55], v[108:111], v[180:183]
    v_mfma_f32_16x16x32_bf16 v[176:179], v[48:51], v[108:111], v[176:179]
    ds_read_b128 v[108:111], v2 offset:6144
    v_mfma_f32_16x16x32_bf16 v[192:195], v[48:51], v[112:115], v[192:195]
    v_mfma_f32_16x16x32_bf16 v[196:199], v[52:55], v[112:115], v[196:199]
    v_mfma_f32_16x16x32_bf16 v[200:203], v[56:59], v[112:115], v[200:203]
    v_mfma_f32_16x16x32_bf16 v[204:207], v[60:63], v[112:115], v[204:207]
    ds_read_b128 v[112:115], v2 offset:8192
    s_waitcnt lgkmcnt(8)
    v_mfma_f32_16x16x32_bf16 v[220:223], v[60:63], v[116:119], v[220:223]
    v_mfma_f32_16x16x32_bf16 v[216:219], v[56:59], v[116:119], v[216:219]
    v_mfma_f32_16x16x32_bf16 v[212:215], v[52:55], v[116:119], v[212:215]
    v_mfma_f32_16x16x32_bf16 v[208:211], v[48:51], v[116:119], v[208:211]
    ds_read_b128 v[116:119], v2 offset:10240
    s_waitcnt lgkmcnt(8)
    v_mfma_f32_16x16x32_bf16 v[224:227], v[48:51], v[120:123], v[224:227]
    v_mfma_f32_16x16x32_bf16 v[228:231], v[52:55], v[120:123], v[228:231]
    v_mfma_f32_16x16x32_bf16 v[232:235], v[56:59], v[120:123], v[232:235]
    v_mfma_f32_16x16x32_bf16 v[236:239], v[60:63], v[120:123], v[236:239]
    ds_read_b128 v[120:123], v2 offset:12288
    s_waitcnt lgkmcnt(8)
    v_mfma_f32_16x16x32_bf16 v[252:255], v[60:63], v[124:127], v[252:255]
    v_mfma_f32_16x16x32_bf16 v[248:251], v[56:59], v[124:127], v[248:251]
    v_mfma_f32_16x16x32_bf16 v[244:247], v[52:55], v[124:127], v[244:247]
    v_mfma_f32_16x16x32_bf16 v[240:243], v[48:51], v[124:127], v[240:243]
    ds_read_b128 v[124:127], v2 offset:14336
    s_waitcnt vmcnt(15) lgkmcnt(7)
    v_mfma_f32_16x16x32_bf16 v[128:131], v[16:19], v[96:99], v[128:131]
    s_add_u32 s48, s49, 557056
    buffer_load_dwordx4 v[48:51], v1, s[80:83], s48 offen sc1
    s_waitcnt vmcnt(15)
    v_mfma_f32_16x16x32_bf16 v[132:135], v[20:23], v[96:99], v[132:135]
    s_waitcnt vmcnt(14)
    v_mfma_f32_16x16x32_bf16 v[136:139], v[24:27], v[96:99], v[136:139]
    buffer_load_dwordx4 v[52:55], v1, s[80:83], s48 offen offset:1024 sc1
    s_waitcnt vmcnt(14)
    v_mfma_f32_16x16x32_bf16 v[140:143], v[28:31], v[96:99], v[140:143]
    ds_read_b128 v[96:99], v3 offset:0
    s_waitcnt lgkmcnt(7)
    v_mfma_f32_16x16x32_bf16 v[156:159], v[28:31], v[100:103], v[156:159]
    buffer_load_dwordx4 v[56:59], v1, s[80:83], s48 offen offset:2048 sc1
    v_mfma_f32_16x16x32_bf16 v[152:155], v[24:27], v[100:103], v[152:155]
    v_mfma_f32_16x16x32_bf16 v[148:151], v[20:23], v[100:103], v[148:151]
    buffer_load_dwordx4 v[60:63], v1, s[80:83], s48 offen offset:3072 sc1
    v_mfma_f32_16x16x32_bf16 v[144:147], v[16:19], v[100:103], v[144:147]
    ds_read_b128 v[100:103], v3 offset:2048
    s_waitcnt lgkmcnt(7)
    v_mfma_f32_16x16x32_bf16 v[160:163], v[16:19], v[104:107], v[160:163]
    v_mfma_f32_16x16x32_bf16 v[164:167], v[20:23], v[104:107], v[164:167]
    v_mfma_f32_16x16x32_bf16 v[168:171], v[24:27], v[104:107], v[168:171]
    v_mfma_f32_16x16x32_bf16 v[172:175], v[28:31], v[104:107], v[172:175]
    ds_read_b128 v[104:107], v3 offset:4096
    s_waitcnt lgkmcnt(7)
    v_mfma_f32_16x16x32_bf16 v[188:191], v[28:31], v[108:111], v[188:191]
    v_mfma_f32_16x16x32_bf16 v[184:187], v[24:27], v[108:111], v[184:187]
    v_mfma_f32_16x16x32_bf16 v[180:183], v[20:23], v[108:111], v[180:183]
    v_mfma_f32_16x16x32_bf16 v[176:179], v[16:19], v[108:111], v[176:179]
    ds_read_b128 v[108:111], v3 offset:6144
    s_waitcnt lgkmcnt(7)
    v_mfma_f32_16x16x32_bf16 v[192:195], v[16:19], v[112:115], v[192:195]
    v_mfma_f32_16x16x32_bf16 v[196:199], v[20:23], v[112:115], v[196:199]
    v_mfma_f32_16x16x32_bf16 v[200:203], v[24:27], v[112:115], v[200:203]
    v_mfma_f32_16x16x32_bf16 v[204:207], v[28:31], v[112:115], v[204:207]
    ds_read_b128 v[112:115], v3 offset:8192
    ds_read_b32 v10, v9
    s_waitcnt lgkmcnt(8)
    v_mfma_f32_16x16x32_bf16 v[220:223], v[28:31], v[116:119], v[220:223]
    v_mfma_f32_16x16x32_bf16 v[216:219], v[24:27], v[116:119], v[216:219]
    v_mfma_f32_16x16x32_bf16 v[212:215], v[20:23], v[116:119], v[212:215]
    v_mfma_f32_16x16x32_bf16 v[208:211], v[16:19], v[116:119], v[208:211]
    ds_read_b128 v[116:119], v3 offset:10240
    s_waitcnt lgkmcnt(8)
    v_mfma_f32_16x16x32_bf16 v[224:227], v[16:19], v[120:123], v[224:227]
    v_mfma_f32_16x16x32_bf16 v[228:231], v[20:23], v[120:123], v[228:231]
    v_mfma_f32_16x16x32_bf16 v[232:235], v[24:27], v[120:123], v[232:235]
    v_mfma_f32_16x16x32_bf16 v[236:239], v[28:31], v[120:123], v[236:239]
    ds_read_b128 v[120:123], v3 offset:12288
    s_waitcnt lgkmcnt(8)
    v_mfma_f32_16x16x32_bf16 v[252:255], v[28:31], v[124:127], v[252:255]
    v_mfma_f32_16x16x32_bf16 v[248:251], v[24:27], v[124:127], v[248:251]
    v_mfma_f32_16x16x32_bf16 v[244:247], v[20:23], v[124:127], v[244:247]
    v_mfma_f32_16x16x32_bf16 v[240:243], v[16:19], v[124:127], v[240:243]
    ds_read_b128 v[124:127], v3 offset:14336
    ds_add_u32 v7, v8 offset:16
    s_waitcnt vmcnt(15) lgkmcnt(9)
    v_mfma_f32_16x16x32_bf16 v[128:131], v[32:35], v[96:99], v[128:131]
    s_add_u32 s48, s49, 573440
    buffer_load_dwordx4 v[16:19], v1, s[80:83], s48 offen sc1
    s_waitcnt vmcnt(15)
    v_mfma_f32_16x16x32_bf16 v[132:135], v[36:39], v[96:99], v[132:135]
    s_waitcnt lgkmcnt(4)
    v_cmp_gt_u32 vcc, 17, v10
    s_waitcnt vmcnt(14)
    v_mfma_f32_16x16x32_bf16 v[136:139], v[40:43], v[96:99], v[136:139]
    s_cbranch_vccnz L_gs18
L_gb18:
    buffer_load_dwordx4 v[20:23], v1, s[80:83], s48 offen offset:1024 sc1
    s_waitcnt vmcnt(14)
    v_mfma_f32_16x16x32_bf16 v[140:143], v[44:47], v[96:99], v[140:143]
    ds_read_b128 v[96:99], v2 offset:16384
    v_mfma_f32_16x16x32_bf16 v[156:159], v[44:47], v[100:103], v[156:159]
    buffer_load_dwordx4 v[24:27], v1, s[80:83], s48 offen offset:2048 sc1
    v_mfma_f32_16x16x32_bf16 v[152:155], v[40:43], v[100:103], v[152:155]
    v_mfma_f32_16x16x32_bf16 v[148:151], v[36:39], v[100:103], v[148:151]
    buffer_load_dwordx4 v[28:31], v1, s[80:83], s48 offen offset:3072 sc1
    v_mfma_f32_16x16x32_bf16 v[144:147], v[32:35], v[100:103], v[144:147]
    ds_read_b128 v[100:103], v2 offset:18432
    v_mfma_f32_16x16x32_bf16 v[160:163], v[32:35], v[104:107], v[160:163]
    v_mfma_f32_16x16x32_bf16 v[164:167], v[36:39], v[104:107], v[164:167]
    v_mfma_f32_16x16x32_bf16 v[168:171], v[40:43], v[104:107], v[168:171]
    v_mfma_f32_16x16x32_bf16 v[172:175], v[44:47], v[104:107], v[172:175]
    ds_read_b128 v[104:107], v2 offset:20480
    v_mfma_f32_16x16x32_bf16 v[188:191], v[44:47], v[108:111], v[188:191]
    v_mfma_f32_16x16x32_bf16 v[184:187], v[40:43], v[108:111], v[184:187]
    v_mfma_f32_16x16x32_bf16 v[180:183], v[36:39], v[108:111], v[180:183]
    v_mfma_f32_16x16x32_bf16 v[176:179], v[32:35], v[108:111], v[176:179]
    ds_read_b128 v[108:111], v2 offset:22528
    v_mfma_f32_16x16x32_bf16 v[192:195], v[32:35], v[112:115], v[192:195]
    v_mfma_f32_16x16x32_bf16 v[196:199], v[36:39], v[112:115], v[196:199]
    v_mfma_f32_16x16x32_bf16 v[200:203], v[40:43], v[112:115], v[200:203]
    v_mfma_f32_16x16x32_bf16 v[204:207], v[44:47], v[112:115], v[204:207]
    ds_read_b128 v[112:115], v2 offset:24576
    s_waitcnt lgkmcnt(8)
    v_mfma_f32_16x16x32_bf16 v[220:223], v[44:47], v[116:119], v[220:223]
    v_mfma_f32_16x16x32_bf16 v[216:219], v[40:43], v[116:119], v[216:219]
    v_mfma_f32_16x16x32_bf16 v[212:215], v[36:39], v[116:119], v[212:215]
    v_mfma_f32_16x16x32_bf16 v[208:211], v[32:35], v[116:119], v[208:211]
    ds_read_b128 v[116:119], v2 offset:26624
    s_waitcnt lgkmcnt(8)
    v_mfma_f32_16x16x32_bf16 v[224:227], v[32:35], v[120:123], v[224:227]
    v_mfma_f32_16x16x32_bf16 v[228:231], v[36:39], v[120:123], v[228:231]
    v_mfma_f32_16x16x32_bf16 v[232:235], v[40:43], v[120:123], v[232:235]
    v_mfma_f32_16x16x32_bf16 v[236:239], v[44:47], v[120:123], v[236:239]
    ds_read_b128 v[120:123], v2 offset:28672
    s_waitcnt lgkmcnt(8)
    v_mfma_f32_16x16x32_bf16 v[252:255], v[44:47], v[124:127], v[252:255]
    v_mfma_f32_16x16x32_bf16 v[248:251], v[40:43], v[124:127], v[248:251]
    v_mfma_f32_16x16x32_bf16 v[244:247], v[36:39], v[124:127], v[244:247]
    v_mfma_f32_16x16x32_bf16 v[240:243], v[32:35], v[124:127], v[240:243]
    ds_read_b128 v[124:127], v2 offset:30720
    s_waitcnt vmcnt(15) lgkmcnt(7)
    v_mfma_f32_16x16x32_bf16 v[128:131], v[64:67], v[96:99], v[128:131]
    s_add_u32 s48, s49, 589824
    buffer_load_dwordx4 v[32:35], v1, s[80:83], s48 offen sc1
    s_waitcnt vmcnt(15)
    v_mfma_f32_16x16x32_bf16 v[132:135], v[68:71], v[96:99], v[132:135]
    s_waitcnt vmcnt(14)
    v_mfma_f32_16x16x32_bf16 v[136:139], v[72:75], v[96:99], v[136:139]
    buffer_load_dwordx4 v[36:39], v1, s[80:83], s48 offen offset:1024 sc1
    s_waitcnt vmcnt(14)
    v_mfma_f32_16x16x32_bf16 v[140:143], v[76:79], v[96:99], v[140:143]
    ds_read_b128 v[96:99], v3 offset:16384
    s_waitcnt lgkmcnt(7)
    v_mfma_f32_16x16x32_bf16 v[156:159], v[76:79], v[100:103], v[156:159]
    buffer_load_dwordx4 v[40:43], v1, s[80:83], s48 offen offset:2048 sc1
    v_mfma_f32_16x16x32_bf16 v[152:155], v[72:75], v[100:103], v[152:155]
    v_mfma_f32_16x16x32_bf16 v[148:151], v[68:71], v[100:103], v[148:151]
    buffer_load_dwordx4 v[44:47], v1, s[80:83], s48 offen offset:3072 sc1
    v_mfma_f32_16x16x32_bf16 v[144:147], v[64:67], v[100:103], v[144:147]
    ds_read_b128 v[100:103], v3 offset:18432
    s_waitcnt lgkmcnt(7)
    v_mfma_f32_16x16x32_bf16 v[160:163], v[64:67], v[104:107], v[160:163]
    v_mfma_f32_16x16x32_bf16 v[164:167], v[68:71], v[104:107], v[164:167]
    v_mfma_f32_16x16x32_bf16 v[168:171], v[72:75], v[104:107], v[168:171]
    v_mfma_f32_16x16x32_bf16 v[172:175], v[76:79], v[104:107], v[172:175]
    ds_read_b128 v[104:107], v3 offset:20480
    s_waitcnt lgkmcnt(7)
    v_mfma_f32_16x16x32_bf16 v[188:191], v[76:79], v[108:111], v[188:191]
    v_mfma_f32_16x16x32_bf16 v[184:187], v[72:75], v[108:111], v[184:187]
    v_mfma_f32_16x16x32_bf16 v[180:183], v[68:71], v[108:111], v[180:183]
    v_mfma_f32_16x16x32_bf16 v[176:179], v[64:67], v[108:111], v[176:179]
    ds_read_b128 v[108:111], v3 offset:22528
    s_waitcnt lgkmcnt(7)
    v_mfma_f32_16x16x32_bf16 v[192:195], v[64:67], v[112:115], v[192:195]
    v_mfma_f32_16x16x32_bf16 v[196:199], v[68:71], v[112:115], v[196:199]
    v_mfma_f32_16x16x32_bf16 v[200:203], v[72:75], v[112:115], v[200:203]
    v_mfma_f32_16x16x32_bf16 v[204:207], v[76:79], v[112:115], v[204:207]
    ds_read_b128 v[112:115], v3 offset:24576
    ds_read_b32 v10, v9
    s_waitcnt lgkmcnt(8)
    v_mfma_f32_16x16x32_bf16 v[220:223], v[76:79], v[116:119], v[220:223]
    v_mfma_f32_16x16x32_bf16 v[216:219], v[72:75], v[116:119], v[216:219]
    v_mfma_f32_16x16x32_bf16 v[212:215], v[68:71], v[116:119], v[212:215]
    v_mfma_f32_16x16x32_bf16 v[208:211], v[64:67], v[116:119], v[208:211]
    ds_read_b128 v[116:119], v3 offset:26624
    s_waitcnt lgkmcnt(8)
    v_mfma_f32_16x16x32_bf16 v[224:227], v[64:67], v[120:123], v[224:227]
    v_mfma_f32_16x16x32_bf16 v[228:231], v[68:71], v[120:123], v[228:231]
    v_mfma_f32_16x16x32_bf16 v[232:235], v[72:75], v[120:123], v[232:235]
    v_mfma_f32_16x16x32_bf16 v[236:239], v[76:79], v[120:123], v[236:239]
    ds_read_b128 v[120:123], v3 offset:28672
    s_waitcnt lgkmcnt(8)
    v_mfma_f32_16x16x32_bf16 v[252:255], v[76:79], v[124:127], v[252:255]
    v_mfma_f32_16x16x32_bf16 v[248:251], v[72:75], v[124:127], v[248:251]
    v_mfma_f32_16x16x32_bf16 v[244:247], v[68:71], v[124:127], v[244:247]
    v_mfma_f32_16x16x32_bf16 v[240:243], v[64:67], v[124:127], v[240:243]
    ds_read_b128 v[124:127], v3 offset:30720
    ds_add_u32 v7, v8 offset:16
    s_waitcnt vmcnt(15) lgkmcnt(9)
    v_mfma_f32_16x16x32_bf16 v[128:131], v[80:83], v[96:99], v[128:131]
    s_add_u32 s48, s49, 606208
    buffer_load_dwordx4 v[64:67], v1, s[80:83], s48 offen sc1
    s_waitcnt vmcnt(15)
    v_mfma_f32_16x16x32_bf16 v[132:135], v[84:87], v[96:99], v[132:135]
    s_waitcnt lgkmcnt(4)
    v_cmp_gt_u32 vcc, 18, v10
    s_waitcnt vmcnt(14)
    v_mfma_f32_16x16x32_bf16 v[136:139], v[88:91], v[96:99], v[136:139]
    s_cbranch_vccnz L_gs19
L_gb19:
    buffer_load_dwordx4 v[68:71], v1, s[80:83], s48 offen offset:1024 sc1
    s_waitcnt vmcnt(14)
    v_mfma_f32_16x16x32_bf16 v[140:143], v[92:95], v[96:99], v[140:143]
    ds_read_b128 v[96:99], v2 offset:32768
    v_mfma_f32_16x16x32_bf16 v[156:159], v[92:95], v[100:103], v[156:159]
    buffer_load_dwordx4 v[72:75], v1, s[80:83], s48 offen offset:2048 sc1
    v_mfma_f32_16x16x32_bf16 v[152:155], v[88:91], v[100:103], v[152:155]
    v_mfma_f32_16x16x32_bf16 v[148:151], v[84:87], v[100:103], v[148:151]
    buffer_load_dwordx4 v[76:79], v1, s[80:83], s48 offen offset:3072 sc1
    v_mfma_f32_16x16x32_bf16 v[144:147], v[80:83], v[100:103], v[144:147]
    ds_read_b128 v[100:103], v2 offset:34816
    v_mfma_f32_16x16x32_bf16 v[160:163], v[80:83], v[104:107], v[160:163]
    v_mfma_f32_16x16x32_bf16 v[164:167], v[84:87], v[104:107], v[164:167]
    v_mfma_f32_16x16x32_bf16 v[168:171], v[88:91], v[104:107], v[168:171]
    v_mfma_f32_16x16x32_bf16 v[172:175], v[92:95], v[104:107], v[172:175]
    ds_read_b128 v[104:107], v2 offset:36864
    v_mfma_f32_16x16x32_bf16 v[188:191], v[92:95], v[108:111], v[188:191]
    v_mfma_f32_16x16x32_bf16 v[184:187], v[88:91], v[108:111], v[184:187]
    v_mfma_f32_16x16x32_bf16 v[180:183], v[84:87], v[108:111], v[180:183]
    v_mfma_f32_16x16x32_bf16 v[176:179], v[80:83], v[108:111], v[176:179]
    ds_read_b128 v[108:111], v2 offset:38912
    v_mfma_f32_16x16x32_bf16 v[192:195], v[80:83], v[112:115], v[192:195]
    v_mfma_f32_16x16x32_bf16 v[196:199], v[84:87], v[112:115], v[196:199]
    v_mfma_f32_16x16x32_bf16 v[200:203], v[88:91], v[112:115], v[200:203]
    v_mfma_f32_16x16x32_bf16 v[204:207], v[92:95], v[112:115], v[204:207]
    ds_read_b128 v[112:115], v2 offset:40960
    s_waitcnt lgkmcnt(8)
    v_mfma_f32_16x16x32_bf16 v[220:223], v[92:95], v[116:119], v[220:223]
    v_mfma_f32_16x16x32_bf16 v[216:219], v[88:91], v[116:119], v[216:219]
    v_mfma_f32_16x16x32_bf16 v[212:215], v[84:87], v[116:119], v[212:215]
    v_mfma_f32_16x16x32_bf16 v[208:211], v[80:83], v[116:119], v[208:211]
    ds_read_b128 v[116:119], v2 offset:43008
    s_waitcnt lgkmcnt(8)
    v_mfma_f32_16x16x32_bf16 v[224:227], v[80:83], v[120:123], v[224:227]
    v_mfma_f32_16x16x32_bf16 v[228:231], v[84:87], v[120:123], v[228:231]
    v_mfma_f32_16x16x32_bf16 v[232:235], v[88:91], v[120:123], v[232:235]
    v_mfma_f32_16x16x32_bf16 v[236:239], v[92:95], v[120:123], v[236:239]
    ds_read_b128 v[120:123], v2 offset:45056
    s_waitcnt lgkmcnt(8)
    v_mfma_f32_16x16x32_bf16 v[252:255], v[92:95], v[124:127], v[252:255]
    v_mfma_f32_16x16x32_bf16 v[248:251], v[88:91], v[124:127], v[248:251]
    v_mfma_f32_16x16x32_bf16 v[244:247], v[84:87], v[124:127], v[244:247]
    v_mfma_f32_16x16x32_bf16 v[240:243], v[80:83], v[124:127], v[240:243]
    ds_read_b128 v[124:127], v2 offset:47104
    s_waitcnt vmcnt(15) lgkmcnt(7)
    v_mfma_f32_16x16x32_bf16 v[128:131], v[48:51], v[96:99], v[128:131]
    s_add_u32 s48, s49, 622592
    buffer_load_dwordx4 v[80:83], v1, s[80:83], s48 offen sc1
    s_waitcnt vmcnt(15)
    v_mfma_f32_16x16x32_bf16 v[132:135], v[52:55], v[96:99], v[132:135]
    s_waitcnt vmcnt(14)
    v_mfma_f32_16x16x32_bf16 v[136:139], v[56:59], v[96:99], v[136:139]
    buffer_load_dwordx4 v[84:87], v1, s[80:83], s48 offen offset:1024 sc1
    s_waitcnt vmcnt(14)
    v_mfma_f32_16x16x32_bf16 v[140:143], v[60:63], v[96:99], v[140:143]
    ds_read_b128 v[96:99], v3 offset:32768
    s_waitcnt lgkmcnt(7)
    v_mfma_f32_16x16x32_bf16 v[156:159], v[60:63], v[100:103], v[156:159]
    buffer_load_dwordx4 v[88:91], v1, s[80:83], s48 offen offset:2048 sc1
    v_mfma_f32_16x16x32_bf16 v[152:155], v[56:59], v[100:103], v[152:155]
    v_mfma_f32_16x16x32_bf16 v[148:151], v[52:55], v[100:103], v[148:151]
    buffer_load_dwordx4 v[92:95], v1, s[80:83], s48 offen offset:3072 sc1
    v_mfma_f32_16x16x32_bf16 v[144:147], v[48:51], v[100:103], v[144:147]
    ds_read_b128 v[100:103], v3 offset:34816
    s_waitcnt lgkmcnt(7)
    v_mfma_f32_16x16x32_bf16 v[160:163], v[48:51], v[104:107], v[160:163]
    v_mfma_f32_16x16x32_bf16 v[164:167], v[52:55], v[104:107], v[164:167]
    v_mfma_f32_16x16x32_bf16 v[168:171], v[56:59], v[104:107], v[168:171]
    v_mfma_f32_16x16x32_bf16 v[172:175], v[60:63], v[104:107], v[172:175]
    ds_read_b128 v[104:107], v3 offset:36864
    s_waitcnt lgkmcnt(7)
    v_mfma_f32_16x16x32_bf16 v[188:191], v[60:63], v[108:111], v[188:191]
    v_mfma_f32_16x16x32_bf16 v[184:187], v[56:59], v[108:111], v[184:187]
    v_mfma_f32_16x16x32_bf16 v[180:183], v[52:55], v[108:111], v[180:183]
    v_mfma_f32_16x16x32_bf16 v[176:179], v[48:51], v[108:111], v[176:179]
    ds_read_b128 v[108:111], v3 offset:38912
    s_waitcnt lgkmcnt(7)
    v_mfma_f32_16x16x32_bf16 v[192:195], v[48:51], v[112:115], v[192:195]
    v_mfma_f32_16x16x32_bf16 v[196:199], v[52:55], v[112:115], v[196:199]
    v_mfma_f32_16x16x32_bf16 v[200:203], v[56:59], v[112:115], v[200:203]
    v_mfma_f32_16x16x32_bf16 v[204:207], v[60:63], v[112:115], v[204:207]
    ds_read_b128 v[112:115], v3 offset:40960
    ds_read_b32 v10, v9
    s_waitcnt lgkmcnt(8)
    v_mfma_f32_16x16x32_bf16 v[220:223], v[60:63], v[116:119], v[220:223]
    v_mfma_f32_16x16x32_bf16 v[216:219], v[56:59], v[116:119], v[216:219]
    v_mfma_f32_16x16x32_bf16 v[212:215], v[52:55], v[116:119], v[212:215]
    v_mfma_f32_16x16x32_bf16 v[208:211], v[48:51], v[116:119], v[208:211]
    ds_read_b128 v[116:119], v3 offset:43008
    s_waitcnt lgkmcnt(8)
    v_mfma_f32_16x16x32_bf16 v[224:227], v[48:51], v[120:123], v[224:227]
    v_mfma_f32_16x16x32_bf16 v[228:231], v[52:55], v[120:123], v[228:231]
    v_mfma_f32_16x16x32_bf16 v[232:235], v[56:59], v[120:123], v[232:235]
    v_mfma_f32_16x16x32_bf16 v[236:239], v[60:63], v[120:123], v[236:239]
    ds_read_b128 v[120:123], v3 offset:45056
    s_waitcnt lgkmcnt(8)
    v_mfma_f32_16x16x32_bf16 v[252:255], v[60:63], v[124:127], v[252:255]
    v_mfma_f32_16x16x32_bf16 v[248:251], v[56:59], v[124:127], v[248:251]
    v_mfma_f32_16x16x32_bf16 v[244:247], v[52:55], v[124:127], v[244:247]
    v_mfma_f32_16x16x32_bf16 v[240:243], v[48:51], v[124:127], v[240:243]
    ds_read_b128 v[124:127], v3 offset:47104
    ds_add_u32 v7, v8 offset:16
    s_waitcnt vmcnt(15) lgkmcnt(9)
    v_mfma_f32_16x16x32_bf16 v[128:131], v[16:19], v[96:99], v[128:131]
    s_add_u32 s48, s49, 638976
    buffer_load_dwordx4 v[48:51], v1, s[80:83], s48 offen sc1
    s_waitcnt vmcnt(15)
    v_mfma_f32_16x16x32_bf16 v[132:135], v[20:23], v[96:99], v[132:135]
    s_waitcnt lgkmcnt(4)
    v_cmp_gt_u32 vcc, 19, v10
    s_waitcnt vmcnt(14)
    v_mfma_f32_16x16x32_bf16 v[136:139], v[24:27], v[96:99], v[136:139]
    s_cbranch_vccnz L_gs20
L_gb20:
    buffer_load_dwordx4 v[52:55], v1, s[80:83], s48 offen offset:1024 sc1
    s_waitcnt vmcnt(14)
    v_mfma_f32_16x16x32_bf16 v[140:143], v[28:31], v[96:99], v[140:143]
    ds_read_b128 v[96:99], v2 offset:49152
    v_mfma_f32_16x16x32_bf16 v[156:159], v[28:31], v[100:103], v[156:159]
    buffer_load_dwordx4 v[56:59], v1, s[80:83], s48 offen offset:2048 sc1
    v_mfma_f32_16x16x32_bf16 v[152:155], v[24:27], v[100:103], v[152:155]
    v_mfma_f32_16x16x32_bf16 v[148:151], v[20:23], v[100:103], v[148:151]
    buffer_load_dwordx4 v[60:63], v1, s[80:83], s48 offen offset:3072 sc1
    v_mfma_f32_16x16x32_bf16 v[144:147], v[16:19], v[100:103], v[144:147]
    ds_read_b128 v[100:103], v2 offset:51200
    v_mfma_f32_16x16x32_bf16 v[160:163], v[16:19], v[104:107], v[160:163]
    v_mfma_f32_16x16x32_bf16 v[164:167], v[20:23], v[104:107], v[164:167]
    v_mfma_f32_16x16x32_bf16 v[168:171], v[24:27], v[104:107], v[168:171]
    v_mfma_f32_16x16x32_bf16 v[172:175], v[28:31], v[104:107], v[172:175]
    ds_read_b128 v[104:107], v2 offset:53248
    v_mfma_f32_16x16x32_bf16 v[188:191], v[28:31], v[108:111], v[188:191]
    v_mfma_f32_16x16x32_bf16 v[184:187], v[24:27], v[108:111], v[184:187]
    v_mfma_f32_16x16x32_bf16 v[180:183], v[20:23], v[108:111], v[180:183]
    v_mfma_f32_16x16x32_bf16 v[176:179], v[16:19], v[108:111], v[176:179]
    ds_read_b128 v[108:111], v2 offset:55296
    v_mfma_f32_16x16x32_bf16 v[192:195], v[16:19], v[112:115], v[192:195]
    v_mfma_f32_16x16x32_bf16 v[196:199], v[20:23], v[112:115], v[196:199]
    v_mfma_f32_16x16x32_bf16 v[200:203], v[24:27], v[112:115], v[200:203]
    v_mfma_f32_16x16x32_bf16 v[204:207], v[28:31], v[112:115], v[204:207]
    ds_read_b128 v[112:115], v2 offset:57344
    s_waitcnt lgkmcnt(8)
    v_mfma_f32_16x16x32_bf16 v[220:223], v[28:31], v[116:119], v[220:223]
    v_mfma_f32_16x16x32_bf16 v[216:219], v[24:27], v[116:119], v[216:219]
    v_mfma_f32_16x16x32_bf16 v[212:215], v[20:23], v[116:119], v[212:215]
    v_mfma_f32_16x16x32_bf16 v[208:211], v[16:19], v[116:119], v[208:211]
    ds_read_b128 v[116:119], v2 offset:59392
    s_waitcnt lgkmcnt(8)
    v_mfma_f32_16x16x32_bf16 v[224:227], v[16:19], v[120:123], v[224:227]
    v_mfma_f32_16x16x32_bf16 v[228:231], v[20:23], v[120:123], v[228:231]
    v_mfma_f32_16x16x32_bf16 v[232:235], v[24:27], v[120:123], v[232:235]
    v_mfma_f32_16x16x32_bf16 v[236:239], v[28:31], v[120:123], v[236:239]
    ds_read_b128 v[120:123], v2 offset:61440
    s_waitcnt lgkmcnt(8)
    v_mfma_f32_16x16x32_bf16 v[252:255], v[28:31], v[124:127], v[252:255]
    v_mfma_f32_16x16x32_bf16 v[248:251], v[24:27], v[124:127], v[248:251]
    v_mfma_f32_16x16x32_bf16 v[244:247], v[20:23], v[124:127], v[244:247]
    v_mfma_f32_16x16x32_bf16 v[240:243], v[16:19], v[124:127], v[240:243]
    ds_read_b128 v[124:127], v2 offset:63488
    s_waitcnt vmcnt(15) lgkmcnt(7)
    v_mfma_f32_16x16x32_bf16 v[128:131], v[32:35], v[96:99], v[128:131]
    s_add_u32 s48, s49, 655360
    buffer_load_dwordx4 v[16:19], v1, s[80:83], s48 offen sc1
    s_waitcnt vmcnt(15)
    v_mfma_f32_16x16x32_bf16 v[132:135], v[36:39], v[96:99], v[132:135]
    s_waitcnt vmcnt(14)
    v_mfma_f32_16x16x32_bf16 v[136:139], v[40:43], v[96:99], v[136:139]
    buffer_load_dwordx4 v[20:23], v1, s[80:83], s48 offen offset:1024 sc1
    s_waitcnt vmcnt(14)
    v_mfma_f32_16x16x32_bf16 v[140:143], v[44:47], v[96:99], v[140:143]
    ds_read_b128 v[96:99], v3 offset:49152
    s_waitcnt lgkmcnt(7)
    v_mfma_f32_16x16x32_bf16 v[156:159], v[44:47], v[100:103], v[156:159]
    buffer_load_dwordx4 v[24:27], v1, s[80:83], s48 offen offset:2048 sc1
    v_mfma_f32_16x16x32_bf16 v[152:155], v[40:43], v[100:103], v[152:155]
    v_mfma_f32_16x16x32_bf16 v[148:151], v[36:39], v[100:103], v[148:151]
    buffer_load_dwordx4 v[28:31], v1, s[80:83], s48 offen offset:3072 sc1
    v_mfma_f32_16x16x32_bf16 v[144:147], v[32:35], v[100:103], v[144:147]
    ds_read_b128 v[100:103], v3 offset:51200
    s_waitcnt lgkmcnt(7)
    v_mfma_f32_16x16x32_bf16 v[160:163], v[32:35], v[104:107], v[160:163]
    v_mfma_f32_16x16x32_bf16 v[164:167], v[36:39], v[104:107], v[164:167]
    v_mfma_f32_16x16x32_bf16 v[168:171], v[40:43], v[104:107], v[168:171]
    v_mfma_f32_16x16x32_bf16 v[172:175], v[44:47], v[104:107], v[172:175]
    ds_read_b128 v[104:107], v3 offset:53248
    s_waitcnt lgkmcnt(7)
    v_mfma_f32_16x16x32_bf16 v[188:191], v[44:47], v[108:111], v[188:191]
    v_mfma_f32_16x16x32_bf16 v[184:187], v[40:43], v[108:111], v[184:187]
    v_mfma_f32_16x16x32_bf16 v[180:183], v[36:39], v[108:111], v[180:183]
    v_mfma_f32_16x16x32_bf16 v[176:179], v[32:35], v[108:111], v[176:179]
    ds_read_b128 v[108:111], v3 offset:55296
    s_waitcnt lgkmcnt(7)
    v_mfma_f32_16x16x32_bf16 v[192:195], v[32:35], v[112:115], v[192:195]
    v_mfma_f32_16x16x32_bf16 v[196:199], v[36:39], v[112:115], v[196:199]
    v_mfma_f32_16x16x32_bf16 v[200:203], v[40:43], v[112:115], v[200:203]
    v_mfma_f32_16x16x32_bf16 v[204:207], v[44:47], v[112:115], v[204:207]
    ds_read_b128 v[112:115], v3 offset:57344
    ds_read_b32 v10, v9
    s_waitcnt lgkmcnt(8)
    v_mfma_f32_16x16x32_bf16 v[220:223], v[44:47], v[116:119], v[220:223]
    v_mfma_f32_16x16x32_bf16 v[216:219], v[40:43], v[116:119], v[216:219]
    v_mfma_f32_16x16x32_bf16 v[212:215], v[36:39], v[116:119], v[212:215]
    v_mfma_f32_16x16x32_bf16 v[208:211], v[32:35], v[116:119], v[208:211]
    ds_read_b128 v[116:119], v3 offset:59392
    s_waitcnt lgkmcnt(8)
    v_mfma_f32_16x16x32_bf16 v[224:227], v[32:35], v[120:123], v[224:227]
    v_mfma_f32_16x16x32_bf16 v[228:231], v[36:39], v[120:123], v[228:231]
    v_mfma_f32_16x16x32_bf16 v[232:235], v[40:43], v[120:123], v[232:235]
    v_mfma_f32_16x16x32_bf16 v[236:239], v[44:47], v[120:123], v[236:239]
    ds_read_b128 v[120:123], v3 offset:61440
    s_waitcnt lgkmcnt(8)
    v_mfma_f32_16x16x32_bf16 v[252:255], v[44:47], v[124:127], v[252:255]
    v_mfma_f32_16x16x32_bf16 v[248:251], v[40:43], v[124:127], v[248:251]
    v_mfma_f32_16x16x32_bf16 v[244:247], v[36:39], v[124:127], v[244:247]
    v_mfma_f32_16x16x32_bf16 v[240:243], v[32:35], v[124:127], v[240:243]
    ds_read_b128 v[124:127], v3 offset:63488
    ds_add_u32 v7, v8 offset:16
    s_waitcnt vmcnt(15) lgkmcnt(9)
    v_mfma_f32_16x16x32_bf16 v[128:131], v[64:67], v[96:99], v[128:131]
    s_add_u32 s48, s49, 671744
    buffer_load_dwordx4 v[32:35], v1, s[80:83], s48 offen sc1
    s_waitcnt vmcnt(15)
    v_mfma_f32_16x16x32_bf16 v[132:135], v[68:71], v[96:99], v[132:135]
    s_waitcnt lgkmcnt(4)
    v_cmp_gt_u32 vcc, 20, v10
    s_waitcnt vmcnt(14)
    v_mfma_f32_16x16x32_bf16 v[136:139], v[72:75], v[96:99], v[136:139]
    s_cbranch_vccnz L_gs21
L_gb21:
    buffer_load_dwordx4 v[36:39], v1, s[80:83], s48 offen offset:1024 sc1
    s_waitcnt vmcnt(14)
    v_mfma_f32_16x16x32_bf16 v[140:143], v[76:79], v[96:99], v[140:143]
    ds_read_b128 v[96:99], v4 offset:0
    v_mfma_f32_16x16x32_bf16 v[156:159], v[76:79], v[100:103], v[156:159]
    buffer_load_dwordx4 v[40:43], v1, s[80:83], s48 offen offset:2048 sc1
    v_mfma_f32_16x16x32_bf16 v[152:155], v[72:75], v[100:103], v[152:155]
    v_mfma_f32_16x16x32_bf16 v[148:151], v[68:71], v[100:103], v[148:151]
    buffer_load_dwordx4 v[44:47], v1, s[80:83], s48 offen offset:3072 sc1
    v_mfma_f32_16x16x32_bf16 v[144:147], v[64:67], v[100:103], v[144:147]
    ds_read_b128 v[100:103], v4 offset:2048
    v_mfma_f32_16x16x32_bf16 v[160:163], v[64:67], v[104:107], v[160:163]
    v_mfma_f32_16x16x32_bf16 v[164:167], v[68:71], v[104:107], v[164:167]
    v_mfma_f32_16x16x32_bf16 v[168:171], v[72:75], v[104:107], v[168:171]
    v_mfma_f32_16x16x32_bf16 v[172:175], v[76:79], v[104:107], v[172:175]
    ds_read_b128 v[104:107], v4 offset:4096
    v_mfma_f32_16x16x32_bf16 v[188:191], v[76:79], v[108:111], v[188:191]
    v_mfma_f32_16x16x32_bf16 v[184:187], v[72:75], v[108:111], v[184:187]
    v_mfma_f32_16x16x32_bf16 v[180:183], v[68:71], v[108:111], v[180:183]
    v_mfma_f32_16x16x32_bf16 v[176:179], v[64:67], v[108:111], v[176:179]
    ds_read_b128 v[108:111], v4 offset:6144
    v_mfma_f32_16x16x32_bf16 v[192:195], v[64:67], v[112:115], v[192:195]
    v_mfma_f32_16x16x32_bf16 v[196:199], v[68:71], v[112:115], v[196:199]
    v_mfma_f32_16x16x32_bf16 v[200:203], v[72:75], v[112:115], v[200:203]
    v_mfma_f32_16x16x32_bf16 v[204:207], v[76:79], v[112:115], v[204:207]
    ds_read_b128 v[112:115], v4 offset:8192
    s_waitcnt lgkmcnt(8)
    v_mfma_f32_16x16x32_bf16 v[220:223], v[76:79], v[116:119], v[220:223]
    v_mfma_f32_16x16x32_bf16 v[216:219], v[72:75], v[116:119], v[216:219]
    v_mfma_f32_16x16x32_bf16 v[212:215], v[68:71], v[116:119], v[212:215]
    v_mfma_f32_16x16x32_bf16 v[208:211], v[64:67], v[116:119], v[208:211]
    ds_read_b128 v[116:119], v4 offset:10240
    s_waitcnt lgkmcnt(8)
    v_mfma_f32_16x16x32_bf16 v[224:227], v[64:67], v[120:123], v[224:227]
    v_mfma_f32_16x16x32_bf16 v[228:231], v[68:71], v[120:123], v[228:231]
    v_mfma_f32_16x16x32_bf16 v[232:235], v[72:75], v[120:123], v[232:235]
    v_mfma_f32_16x16x32_bf16 v[236:239], v[76:79], v[120:123], v[236:239]
    ds_read_b128 v[120:123], v4 offset:12288
    s_waitcnt lgkmcnt(8)
    v_mfma_f32_16x16x32_bf16 v[252:255], v[76:79], v[124:127], v[252:255]
    v_mfma_f32_16x16x32_bf16 v[248:251], v[72:75], v[124:127], v[248:251]
    v_mfma_f32_16x16x32_bf16 v[244:247], v[68:71], v[124:127], v[244:247]
    v_mfma_f32_16x16x32_bf16 v[240:243], v[64:67], v[124:127], v[240:243]
    ds_read_b128 v[124:127], v4 offset:14336
    s_waitcnt vmcnt(15) lgkmcnt(7)
    v_mfma_f32_16x16x32_bf16 v[128:131], v[80:83], v[96:99], v[128:131]
    s_add_u32 s48, s49, 688128
    buffer_load_dwordx4 v[64:67], v1, s[80:83], s48 offen sc1
    s_waitcnt vmcnt(15)
    v_mfma_f32_16x16x32_bf16 v[132:135], v[84:87], v[96:99], v[132:135]
    s_waitcnt vmcnt(14)
    v_mfma_f32_16x16x32_bf16 v[136:139], v[88:91], v[96:99], v[136:139]
    buffer_load_dwordx4 v[68:71], v1, s[80:83], s48 offen offset:1024 sc1
    s_waitcnt vmcnt(14)
    v_mfma_f32_16x16x32_bf16 v[140:143], v[92:95], v[96:99], v[140:143]
    ds_read_b128 v[96:99], v5 offset:0
    s_waitcnt lgkmcnt(7)
    v_mfma_f32_16x16x32_bf16 v[156:159], v[92:95], v[100:103], v[156:159]
    buffer_load_dwordx4 v[72:75], v1, s[80:83], s48 offen offset:2048 sc1
    v_mfma_f32_16x16x32_bf16 v[152:155], v[88:91], v[100:103], v[152:155]
    v_mfma_f32_16x16x32_bf16 v[148:151], v[84:87], v[100:103], v[148:151]
    buffer_load_dwordx4 v[76:79], v1, s[80:83], s48 offen offset:3072 sc1
    v_mfma_f32_16x16x32_bf16 v[144:147], v[80:83], v[100:103], v[144:147]
    ds_read_b128 v[100:103], v5 offset:2048
    s_waitcnt lgkmcnt(7)
    v_mfma_f32_16x16x32_bf16 v[160:163], v[80:83], v[104:107], v[160:163]
    v_mfma_f32_16x16x32_bf16 v[164:167], v[84:87], v[104:107], v[164:167]
    v_mfma_f32_16x16x32_bf16 v[168:171], v[88:91], v[104:107], v[168:171]
    v_mfma_f32_16x16x32_bf16 v[172:175], v[92:95], v[104:107], v[172:175]
    ds_read_b128 v[104:107], v5 offset:4096
    s_waitcnt lgkmcnt(7)
    v_mfma_f32_16x16x32_bf16 v[188:191], v[92:95], v[108:111], v[188:191]
    v_mfma_f32_16x16x32_bf16 v[184:187], v[88:91], v[108:111], v[184:187]
    v_mfma_f32_16x16x32_bf16 v[180:183], v[84:87], v[108:111], v[180:183]
    v_mfma_f32_16x16x32_bf16 v[176:179], v[80:83], v[108:111], v[176:179]
    ds_read_b128 v[108:111], v5 offset:6144
    s_waitcnt lgkmcnt(7)
    v_mfma_f32_16x16x32_bf16 v[192:195], v[80:83], v[112:115], v[192:195]
    v_mfma_f32_16x16x32_bf16 v[196:199], v[84:87], v[112:115], v[196:199]
    v_mfma_f32_16x16x32_bf16 v[200:203], v[88:91], v[112:115], v[200:203]
    v_mfma_f32_16x16x32_bf16 v[204:207], v[92:95], v[112:115], v[204:207]
    ds_read_b128 v[112:115], v5 offset:8192
    ds_read_b32 v10, v9
    s_waitcnt lgkmcnt(8)
    v_mfma_f32_16x16x32_bf16 v[220:223], v[92:95], v[116:119], v[220:223]
    v_mfma_f32_16x16x32_bf16 v[216:219], v[88:91], v[116:119], v[216:219]
    v_mfma_f32_16x16x32_bf16 v[212:215], v[84:87], v[116:119], v[212:215]
    v_mfma_f32_16x16x32_bf16 v[208:211], v[80:83], v[116:119], v[208:211]
    ds_read_b128 v[116:119], v5 offset:10240
    s_waitcnt lgkmcnt(8)
    v_mfma_f32_16x16x32_bf16 v[224:227], v[80:83], v[120:123], v[224:227]
    v_mfma_f32_16x16x32_bf16 v[228:231], v[84:87], v[120:123], v[228:231]
    v_mfma_f32_16x16x32_bf16 v[232:235], v[88:91], v[120:123], v[232:235]
    v_mfma_f32_16x16x32_bf16 v[236:239], v[92:95], v[120:123], v[236:239]
    ds_read_b128 v[120:123], v5 offset:12288
    s_waitcnt lgkmcnt(8)
    v_mfma_f32_16x16x32_bf16 v[252:255], v[92:95], v[124:127], v[252:255]
    v_mfma_f32_16x16x32_bf16 v[248:251], v[88:91], v[124:127], v[248:251]
    v_mfma_f32_16x16x32_bf16 v[244:247], v[84:87], v[124:127], v[244:247]
    v_mfma_f32_16x16x32_bf16 v[240:243], v[80:83], v[124:127], v[240:243]
    ds_read_b128 v[124:127], v5 offset:14336
    ds_add_u32 v7, v8 offset:16
    s_waitcnt vmcnt(15) lgkmcnt(9)
    v_mfma_f32_16x16x32_bf16 v[128:131], v[48:51], v[96:99], v[128:131]
    s_add_u32 s48, s49, 704512
    buffer_load_dwordx4 v[80:83], v1, s[80:83], s48 offen sc1
    s_waitcnt vmcnt(15)
    v_mfma_f32_16x16x32_bf16 v[132:135], v[52:55], v[96:99], v[132:135]
    s_waitcnt lgkmcnt(4)
    v_cmp_gt_u32 vcc, 21, v10
    s_waitcnt vmcnt(14)
    v_mfma_f32_16x16x32_bf16 v[136:139], v[56:59], v[96:99], v[136:139]
    s_cbranch_vccnz L_gs22
L_gb22:
    buffer_load_dwordx4 v[84:87], v1, s[80:83], s48 offen offset:1024 sc1
    s_waitcnt vmcnt(14)
    v_mfma_f32_16x16x32_bf16 v[140:143], v[60:63], v[96:99], v[140:143]
    ds_read_b128 v[96:99], v2 offset:0
    v_mfma_f32_16x16x32_bf16 v[156:159], v[60:63], v[100:103], v[156:159]
    buffer_load_dwordx4 v[88:91], v1, s[80:83], s48 offen offset:2048 sc1
    v_mfma_f32_16x16x32_bf16 v[152:155], v[56:59], v[100:103], v[152:155]
    v_mfma_f32_16x16x32_bf16 v[148:151], v[52:55], v[100:103], v[148:151]
    buffer_load_dwordx4 v[92:95], v1, s[80:83], s48 offen offset:3072 sc1
    v_mfma_f32_16x16x32_bf16 v[144:147], v[48:51], v[100:103], v[144:147]
    ds_read_b128 v[100:103], v2 offset:2048
    v_mfma_f32_16x16x32_bf16 v[160:163], v[48:51], v[104:107], v[160:163]
    v_mfma_f32_16x16x32_bf16 v[164:167], v[52:55], v[104:107], v[164:167]
    v_mfma_f32_16x16x32_bf16 v[168:171], v[56:59], v[104:107], v[168:171]
    v_mfma_f32_16x16x32_bf16 v[172:175], v[60:63], v[104:107], v[172:175]
    ds_read_b128 v[104:107], v2 offset:4096
    v_mfma_f32_16x16x32_bf16 v[188:191], v[60:63], v[108:111], v[188:191]
    v_mfma_f32_16x16x32_bf16 v[184:187], v[56:59], v[108:111], v[184:187]
    v_mfma_f32_16x16x32_bf16 v[180:183], v[52:55], v[108:111], v[180:183]
    v_mfma_f32_16x16x32_bf16 v[176:179], v[48:51], v[108:111], v[176:179]
    ds_read_b128 v[108:111], v2 offset:6144
    v_mfma_f32_16x16x32_bf16 v[192:195], v[48:51], v[112:115], v[192:195]
    v_mfma_f32_16x16x32_bf16 v[196:199], v[52:55], v[112:115], v[196:199]
    v_mfma_f32_16x16x32_bf16 v[200:203], v[56:59], v[112:115], v[200:203]
    v_mfma_f32_16x16x32_bf16 v[204:207], v[60:63], v[112:115], v[204:207]
    ds_read_b128 v[112:115], v2 offset:8192
    s_waitcnt lgkmcnt(8)
    v_mfma_f32_16x16x32_bf16 v[220:223], v[60:63], v[116:119], v[220:223]
    v_mfma_f32_16x16x32_bf16 v[216:219], v[56:59], v[116:119], v[216:219]
    v_mfma_f32_16x16x32_bf16 v[212:215], v[52:55], v[116:119], v[212:215]
    v_mfma_f32_16x16x32_bf16 v[208:211], v[48:51], v[116:119], v[208:211]
    ds_read_b128 v[116:119], v2 offset:10240
    s_waitcnt lgkmcnt(8)
    v_mfma_f32_16x16x32_bf16 v[224:227], v[48:51], v[120:123], v[224:227]
    v_mfma_f32_16x16x32_bf16 v[228:231], v[52:55], v[120:123], v[228:231]
    v_mfma_f32_16x16x32_bf16 v[232:235], v[56:59], v[120:123], v[232:235]
    v_mfma_f32_16x16x32_bf16 v[236:239], v[60:63], v[120:123], v[236:239]
    ds_read_b128 v[120:123], v2 offset:12288
    s_waitcnt lgkmcnt(8)
    v_mfma_f32_16x16x32_bf16 v[252:255], v[60:63], v[124:127], v[252:255]
    v_mfma_f32_16x16x32_bf16 v[248:251], v[56:59], v[124:127], v[248:251]
    v_mfma_f32_16x16x32_bf16 v[244:247], v[52:55], v[124:127], v[244:247]
    v_mfma_f32_16x16x32_bf16 v[240:243], v[48:51], v[124:127], v[240:243]
    ds_read_b128 v[124:127], v2 offset:14336
    s_waitcnt vmcnt(15) lgkmcnt(7)
    v_mfma_f32_16x16x32_bf16 v[128:131], v[16:19], v[96:99], v[128:131]
    s_add_u32 s48, s49, 720896
    buffer_load_dwordx4 v[48:51], v1, s[80:83], s48 offen sc1
    s_waitcnt vmcnt(15)
    v_mfma_f32_16x16x32_bf16 v[132:135], v[20:23], v[96:99], v[132:135]
    s_waitcnt vmcnt(14)
    v_mfma_f32_16x16x32_bf16 v[136:139], v[24:27], v[96:99], v[136:139]
    buffer_load_dwordx4 v[52:55], v1, s[80:83], s48 offen offset:1024 sc1
    s_waitcnt vmcnt(14)
    v_mfma_f32_16x16x32_bf16 v[140:143], v[28:31], v[96:99], v[140:143]
    ds_read_b128 v[96:99], v3 offset:0
    s_waitcnt lgkmcnt(7)
    v_mfma_f32_16x16x32_bf16 v[156:159], v[28:31], v[100:103], v[156:159]
    buffer_load_dwordx4 v[56:59], v1, s[80:83], s48 offen offset:2048 sc1
    v_mfma_f32_16x16x32_bf16 v[152:155], v[24:27], v[100:103], v[152:155]
    v_mfma_f32_16x16x32_bf16 v[148:151], v[20:23], v[100:103], v[148:151]
    buffer_load_dwordx4 v[60:63], v1, s[80:83], s48 offen offset:3072 sc1
    v_mfma_f32_16x16x32_bf16 v[144:147], v[16:19], v[100:103], v[144:147]
    ds_read_b128 v[100:103], v3 offset:2048
    s_waitcnt lgkmcnt(7)
    v_mfma_f32_16x16x32_bf16 v[160:163], v[16:19], v[104:107], v[160:163]
    v_mfma_f32_16x16x32_bf16 v[164:167], v[20:23], v[104:107], v[164:167]
    v_mfma_f32_16x16x32_bf16 v[168:171], v[24:27], v[104:107], v[168:171]
    v_mfma_f32_16x16x32_bf16 v[172:175], v[28:31], v[104:107], v[172:175]
    ds_read_b128 v[104:107], v3 offset:4096
    s_waitcnt lgkmcnt(7)
    v_mfma_f32_16x16x32_bf16 v[188:191], v[28:31], v[108:111], v[188:191]
    v_mfma_f32_16x16x32_bf16 v[184:187], v[24:27], v[108:111], v[184:187]
    v_mfma_f32_16x16x32_bf16 v[180:183], v[20:23], v[108:111], v[180:183]
    v_mfma_f32_16x16x32_bf16 v[176:179], v[16:19], v[108:111], v[176:179]
    ds_read_b128 v[108:111], v3 offset:6144
    s_waitcnt lgkmcnt(7)
    v_mfma_f32_16x16x32_bf16 v[192:195], v[16:19], v[112:115], v[192:195]
    v_mfma_f32_16x16x32_bf16 v[196:199], v[20:23], v[112:115], v[196:199]
    v_mfma_f32_16x16x32_bf16 v[200:203], v[24:27], v[112:115], v[200:203]
    v_mfma_f32_16x16x32_bf16 v[204:207], v[28:31], v[112:115], v[204:207]
    ds_read_b128 v[112:115], v3 offset:8192
    ds_read_b32 v10, v9
    s_waitcnt lgkmcnt(8)
    v_mfma_f32_16x16x32_bf16 v[220:223], v[28:31], v[116:119], v[220:223]
    v_mfma_f32_16x16x32_bf16 v[216:219], v[24:27], v[116:119], v[216:219]
    v_mfma_f32_16x16x32_bf16 v[212:215], v[20:23], v[116:119], v[212:215]
    v_mfma_f32_16x16x32_bf16 v[208:211], v[16:19], v[116:119], v[208:211]
    ds_read_b128 v[116:119], v3 offset:10240
    s_waitcnt lgkmcnt(8)
    v_mfma_f32_16x16x32_bf16 v[224:227], v[16:19], v[120:123], v[224:227]
    v_mfma_f32_16x16x32_bf16 v[228:231], v[20:23], v[120:123], v[228:231]
    v_mfma_f32_16x16x32_bf16 v[232:235], v[24:27], v[120:123], v[232:235]
    v_mfma_f32_16x16x32_bf16 v[236:239], v[28:31], v[120:123], v[236:239]
    ds_read_b128 v[120:123], v3 offset:12288
    s_waitcnt lgkmcnt(8)
    v_mfma_f32_16x16x32_bf16 v[252:255], v[28:31], v[124:127], v[252:255]
    v_mfma_f32_16x16x32_bf16 v[248:251], v[24:27], v[124:127], v[248:251]
    v_mfma_f32_16x16x32_bf16 v[244:247], v[20:23], v[124:127], v[244:247]
    v_mfma_f32_16x16x32_bf16 v[240:243], v[16:19], v[124:127], v[240:243]
    ds_read_b128 v[124:127], v3 offset:14336
    ds_add_u32 v7, v8 offset:16
    s_waitcnt vmcnt(15) lgkmcnt(9)
    v_mfma_f32_16x16x32_bf16 v[128:131], v[32:35], v[96:99], v[128:131]
    s_add_u32 s48, s49, 737280
    buffer_load_dwordx4 v[16:19], v1, s[80:83], s48 offen sc1
    s_waitcnt vmcnt(15)
    v_mfma_f32_16x16x32_bf16 v[132:135], v[36:39], v[96:99], v[132:135]
    s_waitcnt lgkmcnt(4)
    v_cmp_gt_u32 vcc, 22, v10
    s_waitcnt vmcnt(14)
    v_mfma_f32_16x16x32_bf16 v[136:139], v[40:43], v[96:99], v[136:139]
    s_cbranch_vccnz L_gs23
L_gb23:
    buffer_load_dwordx4 v[20:23], v1, s[80:83], s48 offen offset:1024 sc1
    s_waitcnt vmcnt(14)
    v_mfma_f32_16x16x32_bf16 v[140:143], v[44:47], v[96:99], v[140:143]
    ds_read_b128 v[96:99], v2 offset:16384
    v_mfma_f32_16x16x32_bf16 v[156:159], v[44:47], v[100:103], v[156:159]
    buffer_load_dwordx4 v[24:27], v1, s[80:83], s48 offen offset:2048 sc1
    v_mfma_f32_16x16x32_bf16 v[152:155], v[40:43], v[100:103], v[152:155]
    v_mfma_f32_16x16x32_bf16 v[148:151], v[36:39], v[100:103], v[148:151]
    buffer_load_dwordx4 v[28:31], v1, s[80:83], s48 offen offset:3072 sc1
    v_mfma_f32_16x16x32_bf16 v[144:147], v[32:35], v[100:103], v[144:147]
    ds_read_b128 v[100:103], v2 offset:18432
    v_mfma_f32_16x16x32_bf16 v[160:163], v[32:35], v[104:107], v[160:163]
    v_mfma_f32_16x16x32_bf16 v[164:167], v[36:39], v[104:107], v[164:167]
    v_mfma_f32_16x16x32_bf16 v[168:171], v[40:43], v[104:107], v[168:171]
    v_mfma_f32_16x16x32_bf16 v[172:175], v[44:47], v[104:107], v[172:175]
    ds_read_b128 v[104:107], v2 offset:20480
    v_mfma_f32_16x16x32_bf16 v[188:191], v[44:47], v[108:111], v[188:191]
    v_mfma_f32_16x16x32_bf16 v[184:187], v[40:43], v[108:111], v[184:187]
    v_mfma_f32_16x16x32_bf16 v[180:183], v[36:39], v[108:111], v[180:183]
    v_mfma_f32_16x16x32_bf16 v[176:179], v[32:35], v[108:111], v[176:179]
    ds_read_b128 v[108:111], v2 offset:22528
    v_mfma_f32_16x16x32_bf16 v[192:195], v[32:35], v[112:115], v[192:195]
    v_mfma_f32_16x16x32_bf16 v[196:199], v[36:39], v[112:115], v[196:199]
    v_mfma_f32_16x16x32_bf16 v[200:203], v[40:43], v[112:115], v[200:203]
    v_mfma_f32_16x16x32_bf16 v[204:207], v[44:47], v[112:115], v[204:207]
    ds_read_b128 v[112:115], v2 offset:24576
    s_waitcnt lgkmcnt(8)
    v_mfma_f32_16x16x32_bf16 v[220:223], v[44:47], v[116:119], v[220:223]
    v_mfma_f32_16x16x32_bf16 v[216:219], v[40:43], v[116:119], v[216:219]
    v_mfma_f32_16x16x32_bf16 v[212:215], v[36:39], v[116:119], v[212:215]
    v_mfma_f32_16x16x32_bf16 v[208:211], v[32:35], v[116:119], v[208:211]
    ds_read_b128 v[116:119], v2 offset:26624
    s_waitcnt lgkmcnt(8)
    v_mfma_f32_16x16x32_bf16 v[224:227], v[32:35], v[120:123], v[224:227]
    v_mfma_f32_16x16x32_bf16 v[228:231], v[36:39], v[120:123], v[228:231]
    v_mfma_f32_16x16x32_bf16 v[232:235], v[40:43], v[120:123], v[232:235]
    v_mfma_f32_16x16x32_bf16 v[236:239], v[44:47], v[120:123], v[236:239]
    ds_read_b128 v[120:123], v2 offset:28672
    s_waitcnt lgkmcnt(8)
    v_mfma_f32_16x16x32_bf16 v[252:255], v[44:47], v[124:127], v[252:255]
    v_mfma_f32_16x16x32_bf16 v[248:251], v[40:43], v[124:127], v[248:251]
    v_mfma_f32_16x16x32_bf16 v[244:247], v[36:39], v[124:127], v[244:247]
    v_mfma_f32_16x16x32_bf16 v[240:243], v[32:35], v[124:127], v[240:243]
    ds_read_b128 v[124:127], v2 offset:30720
    s_waitcnt vmcnt(15) lgkmcnt(7)
    v_mfma_f32_16x16x32_bf16 v[128:131], v[64:67], v[96:99], v[128:131]
    s_add_u32 s48, s49, 753664
    buffer_load_dwordx4 v[32:35], v1, s[80:83], s48 offen sc1
    s_waitcnt vmcnt(15)
    v_mfma_f32_16x16x32_bf16 v[132:135], v[68:71], v[96:99], v[132:135]
    s_waitcnt vmcnt(14)
    v_mfma_f32_16x16x32_bf16 v[136:139], v[72:75], v[96:99], v[136:139]
    buffer_load_dwordx4 v[36:39], v1, s[80:83], s48 offen offset:1024 sc1
    s_waitcnt vmcnt(14)
    v_mfma_f32_16x16x32_bf16 v[140:143], v[76:79], v[96:99], v[140:143]
    ds_read_b128 v[96:99], v3 offset:16384
    s_waitcnt lgkmcnt(7)
    v_mfma_f32_16x16x32_bf16 v[156:159], v[76:79], v[100:103], v[156:159]
    buffer_load_dwordx4 v[40:43], v1, s[80:83], s48 offen offset:2048 sc1
    v_mfma_f32_16x16x32_bf16 v[152:155], v[72:75], v[100:103], v[152:155]
    v_mfma_f32_16x16x32_bf16 v[148:151], v[68:71], v[100:103], v[148:151]
    buffer_load_dwordx4 v[44:47], v1, s[80:83], s48 offen offset:3072 sc1
    v_mfma_f32_16x16x32_bf16 v[144:147], v[64:67], v[100:103], v[144:147]
    ds_read_b128 v[100:103], v3 offset:18432
    s_waitcnt lgkmcnt(7)
    v_mfma_f32_16x16x32_bf16 v[160:163], v[64:67], v[104:107], v[160:163]
    v_mfma_f32_16x16x32_bf16 v[164:167], v[68:71], v[104:107], v[164:167]
    v_mfma_f32_16x16x32_bf16 v[168:171], v[72:75], v[104:107], v[168:171]
    v_mfma_f32_16x16x32_bf16 v[172:175], v[76:79], v[104:107], v[172:175]
    ds_read_b128 v[104:107], v3 offset:20480
    s_waitcnt lgkmcnt(7)
    v_mfma_f32_16x16x32_bf16 v[188:191], v[76:79], v[108:111], v[188:191]
    v_mfma_f32_16x16x32_bf16 v[184:187], v[72:75], v[108:111], v[184:187]
    v_mfma_f32_16x16x32_bf16 v[180:183], v[68:71], v[108:111], v[180:183]
    v_mfma_f32_16x16x32_bf16 v[176:179], v[64:67], v[108:111], v[176:179]
    ds_read_b128 v[108:111], v3 offset:22528
    s_waitcnt lgkmcnt(7)
    v_mfma_f32_16x16x32_bf16 v[192:195], v[64:67], v[112:115], v[192:195]
    v_mfma_f32_16x16x32_bf16 v[196:199], v[68:71], v[112:115], v[196:199]
    v_mfma_f32_16x16x32_bf16 v[200:203], v[72:75], v[112:115], v[200:203]
    v_mfma_f32_16x16x32_bf16 v[204:207], v[76:79], v[112:115], v[204:207]
    ds_read_b128 v[112:115], v3 offset:24576
    ds_read_b32 v10, v9
    s_waitcnt lgkmcnt(8)
    v_mfma_f32_16x16x32_bf16 v[220:223], v[76:79], v[116:119], v[220:223]
    v_mfma_f32_16x16x32_bf16 v[216:219], v[72:75], v[116:119], v[216:219]
    v_mfma_f32_16x16x32_bf16 v[212:215], v[68:71], v[116:119], v[212:215]
    v_mfma_f32_16x16x32_bf16 v[208:211], v[64:67], v[116:119], v[208:211]
    ds_read_b128 v[116:119], v3 offset:26624
    s_waitcnt lgkmcnt(8)
    v_mfma_f32_16x16x32_bf16 v[224:227], v[64:67], v[120:123], v[224:227]
    v_mfma_f32_16x16x32_bf16 v[228:231], v[68:71], v[120:123], v[228:231]
    v_mfma_f32_16x16x32_bf16 v[232:235], v[72:75], v[120:123], v[232:235]
    v_mfma_f32_16x16x32_bf16 v[236:239], v[76:79], v[120:123], v[236:239]
    ds_read_b128 v[120:123], v3 offset:28672
    s_waitcnt lgkmcnt(8)
    v_mfma_f32_16x16x32_bf16 v[252:255], v[76:79], v[124:127], v[252:255]
    v_mfma_f32_16x16x32_bf16 v[248:251], v[72:75], v[124:127], v[248:251]
    v_mfma_f32_16x16x32_bf16 v[244:247], v[68:71], v[124:127], v[244:247]
    v_mfma_f32_16x16x32_bf16 v[240:243], v[64:67], v[124:127], v[240:243]
    ds_read_b128 v[124:127], v3 offset:30720
    ds_add_u32 v7, v8 offset:16
    s_waitcnt vmcnt(15) lgkmcnt(9)
    v_mfma_f32_16x16x32_bf16 v[128:131], v[80:83], v[96:99], v[128:131]
    s_add_u32 s48, s49, 770048
    buffer_load_dwordx4 v[64:67], v1, s[80:83], s48 offen sc1
    s_waitcnt vmcnt(15)
    v_mfma_f32_16x16x32_bf16 v[132:135], v[84:87], v[96:99], v[132:135]
    s_waitcnt lgkmcnt(4)
    v_cmp_gt_u32 vcc, 23, v10
    s_waitcnt vmcnt(14)
    v_mfma_f32_16x16x32_bf16 v[136:139], v[88:91], v[96:99], v[136:139]
    s_cbranch_vccnz L_gs24
L_gb24:
    buffer_load_dwordx4 v[68:71], v1, s[80:83], s48 offen offset:1024 sc1
    s_waitcnt vmcnt(14)
    v_mfma_f32_16x16x32_bf16 v[140:143], v[92:95], v[96:99], v[140:143]
    ds_read_b128 v[96:99], v2 offset:32768
    v_mfma_f32_16x16x32_bf16 v[156:159], v[92:95], v[100:103], v[156:159]
    buffer_load_dwordx4 v[72:75], v1, s[80:83], s48 offen offset:2048 sc1
    v_mfma_f32_16x16x32_bf16 v[152:155], v[88:91], v[100:103], v[152:155]
    v_mfma_f32_16x16x32_bf16 v[148:151], v[84:87], v[100:103], v[148:151]
    buffer_load_dwordx4 v[76:79], v1, s[80:83], s48 offen offset:3072 sc1
    v_mfma_f32_16x16x32_bf16 v[144:147], v[80:83], v[100:103], v[144:147]
    ds_read_b128 v[100:103], v2 offset:34816
    v_mfma_f32_16x16x32_bf16 v[160:163], v[80:83], v[104:107], v[160:163]
    v_mfma_f32_16x16x32_bf16 v[164:167], v[84:87], v[104:107], v[164:167]
    v_mfma_f32_16x16x32_bf16 v[168:171], v[88:91], v[104:107], v[168:171]
    v_mfma_f32_16x16x32_bf16 v[172:175], v[92:95], v[104:107], v[172:175]
    ds_read_b128 v[104:107], v2 offset:36864
    v_mfma_f32_16x16x32_bf16 v[188:191], v[92:95], v[108:111], v[188:191]
    v_mfma_f32_16x16x32_bf16 v[184:187], v[88:91], v[108:111], v[184:187]
    v_mfma_f32_16x16x32_bf16 v[180:183], v[84:87], v[108:111], v[180:183]
    v_mfma_f32_16x16x32_bf16 v[176:179], v[80:83], v[108:111], v[176:179]
    ds_read_b128 v[108:111], v2 offset:38912
    v_mfma_f32_16x16x32_bf16 v[192:195], v[80:83], v[112:115], v[192:195]
    v_mfma_f32_16x16x32_bf16 v[196:199], v[84:87], v[112:115], v[196:199]
    v_mfma_f32_16x16x32_bf16 v[200:203], v[88:91], v[112:115], v[200:203]
    v_mfma_f32_16x16x32_bf16 v[204:207], v[92:95], v[112:115], v[204:207]
    ds_read_b128 v[112:115], v2 offset:40960
    s_waitcnt lgkmcnt(8)
    v_mfma_f32_16x16x32_bf16 v[220:223], v[92:95], v[116:119], v[220:223]
    v_mfma_f32_16x16x32_bf16 v[216:219], v[88:91], v[116:119], v[216:219]
    v_mfma_f32_16x16x32_bf16 v[212:215], v[84:87], v[116:119], v[212:215]
    v_mfma_f32_16x16x32_bf16 v[208:211], v[80:83], v[116:119], v[208:211]
    ds_read_b128 v[116:119], v2 offset:43008
    s_waitcnt lgkmcnt(8)
    v_mfma_f32_16x16x32_bf16 v[224:227], v[80:83], v[120:123], v[224:227]
    v_mfma_f32_16x16x32_bf16 v[228:231], v[84:87], v[120:123], v[228:231]
    v_mfma_f32_16x16x32_bf16 v[232:235], v[88:91], v[120:123], v[232:235]
    v_mfma_f32_16x16x32_bf16 v[236:239], v[92:95], v[120:123], v[236:239]
    ds_read_b128 v[120:123], v2 offset:45056
    s_waitcnt lgkmcnt(8)
    v_mfma_f32_16x16x32_bf16 v[252:255], v[92:95], v[124:127], v[252:255]
    v_mfma_f32_16x16x32_bf16 v[248:251], v[88:91], v[124:127], v[248:251]
    v_mfma_f32_16x16x32_bf16 v[244:247], v[84:87], v[124:127], v[244:247]
    v_mfma_f32_16x16x32_bf16 v[240:243], v[80:83], v[124:127], v[240:243]
    ds_read_b128 v[124:127], v2 offset:47104
    s_waitcnt vmcnt(15) lgkmcnt(7)
    v_mfma_f32_16x16x32_bf16 v[128:131], v[48:51], v[96:99], v[128:131]
    s_add_u32 s48, s49, 786432
    buffer_load_dwordx4 v[80:83], v1, s[80:83], s48 offen sc1
    s_waitcnt vmcnt(15)
    v_mfma_f32_16x16x32_bf16 v[132:135], v[52:55], v[96:99], v[132:135]
    s_waitcnt vmcnt(14)
    v_mfma_f32_16x16x32_bf16 v[136:139], v[56:59], v[96:99], v[136:139]
    buffer_load_dwordx4 v[84:87], v1, s[80:83], s48 offen offset:1024 sc1
    s_waitcnt vmcnt(14)
    v_mfma_f32_16x16x32_bf16 v[140:143], v[60:63], v[96:99], v[140:143]
    ds_read_b128 v[96:99], v3 offset:32768
    s_waitcnt lgkmcnt(7)
    v_mfma_f32_16x16x32_bf16 v[156:159], v[60:63], v[100:103], v[156:159]
    buffer_load_dwordx4 v[88:91], v1, s[80:83], s48 offen offset:2048 sc1
    v_mfma_f32_16x16x32_bf16 v[152:155], v[56:59], v[100:103], v[152:155]
    v_mfma_f32_16x16x32_bf16 v[148:151], v[52:55], v[100:103], v[148:151]
    buffer_load_dwordx4 v[92:95], v1, s[80:83], s48 offen offset:3072 sc1
    v_mfma_f32_16x16x32_bf16 v[144:147], v[48:51], v[100:103], v[144:147]
    ds_read_b128 v[100:103], v3 offset:34816
    s_waitcnt lgkmcnt(7)
    v_mfma_f32_16x16x32_bf16 v[160:163], v[48:51], v[104:107], v[160:163]
    v_mfma_f32_16x16x32_bf16 v[164:167], v[52:55], v[104:107], v[164:167]
    v_mfma_f32_16x16x32_bf16 v[168:171], v[56:59], v[104:107], v[168:171]
    v_mfma_f32_16x16x32_bf16 v[172:175], v[60:63], v[104:107], v[172:175]
    ds_read_b128 v[104:107], v3 offset:36864
    s_waitcnt lgkmcnt(7)
    v_mfma_f32_16x16x32_bf16 v[188:191], v[60:63], v[108:111], v[188:191]
    v_mfma_f32_16x16x32_bf16 v[184:187], v[56:59], v[108:111], v[184:187]
    v_mfma_f32_16x16x32_bf16 v[180:183], v[52:55], v[108:111], v[180:183]
    v_mfma_f32_16x16x32_bf16 v[176:179], v[48:51], v[108:111], v[176:179]
    ds_read_b128 v[108:111], v3 offset:38912
    s_waitcnt lgkmcnt(7)
    v_mfma_f32_16x16x32_bf16 v[192:195], v[48:51], v[112:115], v[192:195]
    v_mfma_f32_16x16x32_bf16 v[196:199], v[52:55], v[112:115], v[196:199]
    v_mfma_f32_16x16x32_bf16 v[200:203], v[56:59], v[112:115], v[200:203]
    v_mfma_f32_16x16x32_bf16 v[204:207], v[60:63], v[112:115], v[204:207]
    ds_read_b128 v[112:115], v3 offset:40960
    ds_read_b32 v10, v9
    s_waitcnt lgkmcnt(8)
    v_mfma_f32_16x16x32_bf16 v[220:223], v[60:63], v[116:119], v[220:223]
    v_mfma_f32_16x16x32_bf16 v[216:219], v[56:59], v[116:119], v[216:219]
    v_mfma_f32_16x16x32_bf16 v[212:215], v[52:55], v[116:119], v[212:215]
    v_mfma_f32_16x16x32_bf16 v[208:211], v[48:51], v[116:119], v[208:211]
    ds_read_b128 v[116:119], v3 offset:43008
    s_waitcnt lgkmcnt(8)
    v_mfma_f32_16x16x32_bf16 v[224:227], v[48:51], v[120:123], v[224:227]
    v_mfma_f32_16x16x32_bf16 v[228:231], v[52:55], v[120:123], v[228:231]
    v_mfma_f32_16x16x32_bf16 v[232:235], v[56:59], v[120:123], v[232:235]
    v_mfma_f32_16x16x32_bf16 v[236:239], v[60:63], v[120:123], v[236:239]
    ds_read_b128 v[120:123], v3 offset:45056
    s_waitcnt lgkmcnt(8)
    v_mfma_f32_16x16x32_bf16 v[252:255], v[60:63], v[124:127], v[252:255]
    v_mfma_f32_16x16x32_bf16 v[248:251], v[56:59], v[124:127], v[248:251]
    v_mfma_f32_16x16x32_bf16 v[244:247], v[52:55], v[124:127], v[244:247]
    v_mfma_f32_16x16x32_bf16 v[240:243], v[48:51], v[124:127], v[240:243]
    ds_read_b128 v[124:127], v3 offset:47104
    ds_add_u32 v7, v8 offset:16
    s_waitcnt vmcnt(15) lgkmcnt(9)
    v_mfma_f32_16x16x32_bf16 v[128:131], v[16:19], v[96:99], v[128:131]
    s_add_u32 s48, s49, 802816
    buffer_load_dwordx4 v[48:51], v1, s[80:83], s48 offen sc1
    s_waitcnt vmcnt(15)
    v_mfma_f32_16x16x32_bf16 v[132:135], v[20:23], v[96:99], v[132:135]
    s_waitcnt lgkmcnt(4)
    v_cmp_gt_u32 vcc, 24, v10
    s_waitcnt vmcnt(14)
    v_mfma_f32_16x16x32_bf16 v[136:139], v[24:27], v[96:99], v[136:139]
    s_cbranch_vccnz L_gs25
L_gb25:
    buffer_load_dwordx4 v[52:55], v1, s[80:83], s48 offen offset:1024 sc1
    s_waitcnt vmcnt(14)
    v_mfma_f32_16x16x32_bf16 v[140:143], v[28:31], v[96:99], v[140:143]
    ds_read_b128 v[96:99], v2 offset:49152
    v_mfma_f32_16x16x32_bf16 v[156:159], v[28:31], v[100:103], v[156:159]
    buffer_load_dwordx4 v[56:59], v1, s[80:83], s48 offen offset:2048 sc1
    v_mfma_f32_16x16x32_bf16 v[152:155], v[24:27], v[100:103], v[152:155]
    v_mfma_f32_16x16x32_bf16 v[148:151], v[20:23], v[100:103], v[148:151]
    buffer_load_dwordx4 v[60:63], v1, s[80:83], s48 offen offset:3072 sc1
    v_mfma_f32_16x16x32_bf16 v[144:147], v[16:19], v[100:103], v[144:147]
    ds_read_b128 v[100:103], v2 offset:51200
    v_mfma_f32_16x16x32_bf16 v[160:163], v[16:19], v[104:107], v[160:163]
    v_mfma_f32_16x16x32_bf16 v[164:167], v[20:23], v[104:107], v[164:167]
    v_mfma_f32_16x16x32_bf16 v[168:171], v[24:27], v[104:107], v[168:171]
    v_mfma_f32_16x16x32_bf16 v[172:175], v[28:31], v[104:107], v[172:175]
    ds_read_b128 v[104:107], v2 offset:53248
    v_mfma_f32_16x16x32_bf16 v[188:191], v[28:31], v[108:111], v[188:191]
    v_mfma_f32_16x16x32_bf16 v[184:187], v[24:27], v[108:111], v[184:187]
    v_mfma_f32_16x16x32_bf16 v[180:183], v[20:23], v[108:111], v[180:183]
    v_mfma_f32_16x16x32_bf16 v[176:179], v[16:19], v[108:111], v[176:179]
    ds_read_b128 v[108:111], v2 offset:55296
    v_mfma_f32_16x16x32_bf16 v[192:195], v[16:19], v[112:115], v[192:195]
    v_mfma_f32_16x16x32_bf16 v[196:199], v[20:23], v[112:115], v[196:199]
    v_mfma_f32_16x16x32_bf16 v[200:203], v[24:27], v[112:115], v[200:203]
    v_mfma_f32_16x16x32_bf16 v[204:207], v[28:31], v[112:115], v[204:207]
    ds_read_b128 v[112:115], v2 offset:57344
    s_waitcnt lgkmcnt(8)
    v_mfma_f32_16x16x32_bf16 v[220:223], v[28:31], v[116:119], v[220:223]
    v_mfma_f32_16x16x32_bf16 v[216:219], v[24:27], v[116:119], v[216:219]
    v_mfma_f32_16x16x32_bf16 v[212:215], v[20:23], v[116:119], v[212:215]
    v_mfma_f32_16x16x32_bf16 v[208:211], v[16:19], v[116:119], v[208:211]
    ds_read_b128 v[116:119], v2 offset:59392
    s_waitcnt lgkmcnt(8)
    v_mfma_f32_16x16x32_bf16 v[224:227], v[16:19], v[120:123], v[224:227]
    v_mfma_f32_16x16x32_bf16 v[228:231], v[20:23], v[120:123], v[228:231]
    v_mfma_f32_16x16x32_bf16 v[232:235], v[24:27], v[120:123], v[232:235]
    v_mfma_f32_16x16x32_bf16 v[236:239], v[28:31], v[120:123], v[236:239]
    ds_read_b128 v[120:123], v2 offset:61440
    s_waitcnt lgkmcnt(8)
    v_mfma_f32_16x16x32_bf16 v[252:255], v[28:31], v[124:127], v[252:255]
    v_mfma_f32_16x16x32_bf16 v[248:251], v[24:27], v[124:127], v[248:251]
    v_mfma_f32_16x16x32_bf16 v[244:247], v[20:23], v[124:127], v[244:247]
    v_mfma_f32_16x16x32_bf16 v[240:243], v[16:19], v[124:127], v[240:243]
    ds_read_b128 v[124:127], v2 offset:63488
    s_waitcnt vmcnt(15) lgkmcnt(7)
    v_mfma_f32_16x16x32_bf16 v[128:131], v[32:35], v[96:99], v[128:131]
    s_add_u32 s48, s49, 819200
    buffer_load_dwordx4 v[16:19], v1, s[80:83], s48 offen sc1
    s_waitcnt vmcnt(15)
    v_mfma_f32_16x16x32_bf16 v[132:135], v[36:39], v[96:99], v[132:135]
    s_waitcnt vmcnt(14)
    v_mfma_f32_16x16x32_bf16 v[136:139], v[40:43], v[96:99], v[136:139]
    buffer_load_dwordx4 v[20:23], v1, s[80:83], s48 offen offset:1024 sc1
    s_waitcnt vmcnt(14)
    v_mfma_f32_16x16x32_bf16 v[140:143], v[44:47], v[96:99], v[140:143]
    ds_read_b128 v[96:99], v3 offset:49152
    s_waitcnt lgkmcnt(7)
    v_mfma_f32_16x16x32_bf16 v[156:159], v[44:47], v[100:103], v[156:159]
    buffer_load_dwordx4 v[24:27], v1, s[80:83], s48 offen offset:2048 sc1
    v_mfma_f32_16x16x32_bf16 v[152:155], v[40:43], v[100:103], v[152:155]
    v_mfma_f32_16x16x32_bf16 v[148:151], v[36:39], v[100:103], v[148:151]
    buffer_load_dwordx4 v[28:31], v1, s[80:83], s48 offen offset:3072 sc1
    v_mfma_f32_16x16x32_bf16 v[144:147], v[32:35], v[100:103], v[144:147]
    ds_read_b128 v[100:103], v3 offset:51200
    s_waitcnt lgkmcnt(7)
    v_mfma_f32_16x16x32_bf16 v[160:163], v[32:35], v[104:107], v[160:163]
    v_mfma_f32_16x16x32_bf16 v[164:167], v[36:39], v[104:107], v[164:167]
    v_mfma_f32_16x16x32_bf16 v[168:171], v[40:43], v[104:107], v[168:171]
    v_mfma_f32_16x16x32_bf16 v[172:175], v[44:47], v[104:107], v[172:175]
    ds_read_b128 v[104:107], v3 offset:53248
    s_waitcnt lgkmcnt(7)
    v_mfma_f32_16x16x32_bf16 v[188:191], v[44:47], v[108:111], v[188:191]
    v_mfma_f32_16x16x32_bf16 v[184:187], v[40:43], v[108:111], v[184:187]
    v_mfma_f32_16x16x32_bf16 v[180:183], v[36:39], v[108:111], v[180:183]
    v_mfma_f32_16x16x32_bf16 v[176:179], v[32:35], v[108:111], v[176:179]
    ds_read_b128 v[108:111], v3 offset:55296
    s_waitcnt lgkmcnt(7)
    v_mfma_f32_16x16x32_bf16 v[192:195], v[32:35], v[112:115], v[192:195]
    v_mfma_f32_16x16x32_bf16 v[196:199], v[36:39], v[112:115], v[196:199]
    v_mfma_f32_16x16x32_bf16 v[200:203], v[40:43], v[112:115], v[200:203]
    v_mfma_f32_16x16x32_bf16 v[204:207], v[44:47], v[112:115], v[204:207]
    ds_read_b128 v[112:115], v3 offset:57344
    ds_read_b32 v10, v9
    s_waitcnt lgkmcnt(8)
    v_mfma_f32_16x16x32_bf16 v[220:223], v[44:47], v[116:119], v[220:223]
    v_mfma_f32_16x16x32_bf16 v[216:219], v[40:43], v[116:119], v[216:219]
    v_mfma_f32_16x16x32_bf16 v[212:215], v[36:39], v[116:119], v[212:215]
    v_mfma_f32_16x16x32_bf16 v[208:211], v[32:35], v[116:119], v[208:211]
    ds_read_b128 v[116:119], v3 offset:59392
    s_waitcnt lgkmcnt(8)
    v_mfma_f32_16x16x32_bf16 v[224:227], v[32:35], v[120:123], v[224:227]
    v_mfma_f32_16x16x32_bf16 v[228:231], v[36:39], v[120:123], v[228:231]
    v_mfma_f32_16x16x32_bf16 v[232:235], v[40:43], v[120:123], v[232:235]
    v_mfma_f32_16x16x32_bf16 v[236:239], v[44:47], v[120:123], v[236:239]
    ds_read_b128 v[120:123], v3 offset:61440
    s_waitcnt lgkmcnt(8)
    v_mfma_f32_16x16x32_bf16 v[252:255], v[44:47], v[124:127], v[252:255]
    v_mfma_f32_16x16x32_bf16 v[248:251], v[40:43], v[124:127], v[248:251]
    v_mfma_f32_16x16x32_bf16 v[244:247], v[36:39], v[124:127], v[244:247]
    v_mfma_f32_16x16x32_bf16 v[240:243], v[32:35], v[124:127], v[240:243]
    ds_read_b128 v[124:127], v3 offset:63488
    ds_add_u32 v7, v8 offset:16
    s_waitcnt vmcnt(15) lgkmcnt(9)
    v_mfma_f32_16x16x32_bf16 v[128:131], v[64:67], v[96:99], v[128:131]
    s_add_u32 s48, s49, 835584
    buffer_load_dwordx4 v[32:35], v1, s[80:83], s48 offen sc1
    s_waitcnt vmcnt(15)
    v_mfma_f32_16x16x32_bf16 v[132:135], v[68:71], v[96:99], v[132:135]
    s_waitcnt lgkmcnt(4)
    v_cmp_gt_u32 vcc, 25, v10
    s_waitcnt vmcnt(14)
    v_mfma_f32_16x16x32_bf16 v[136:139], v[72:75], v[96:99], v[136:139]
    s_cbranch_vccnz L_gs26
L_gb26:
    buffer_load_dwordx4 v[36:39], v1, s[80:83], s48 offen offset:1024 sc1
    s_waitcnt vmcnt(14)
    v_mfma_f32_16x16x32_bf16 v[140:143], v[76:79], v[96:99], v[140:143]
    ds_read_b128 v[96:99], v4 offset:0
    v_mfma_f32_16x16x32_bf16 v[156:159], v[76:79], v[100:103], v[156:159]
    buffer_load_dwordx4 v[40:43], v1, s[80:83], s48 offen offset:2048 sc1
    v_mfma_f32_16x16x32_bf16 v[152:155], v[72:75], v[100:103], v[152:155]
    v_mfma_f32_16x16x32_bf16 v[148:151], v[68:71], v[100:103], v[148:151]
    buffer_load_dwordx4 v[44:47], v1, s[80:83], s48 offen offset:3072 sc1
    v_mfma_f32_16x16x32_bf16 v[144:147], v[64:67], v[100:103], v[144:147]
    ds_read_b128 v[100:103], v4 offset:2048
    v_mfma_f32_16x16x32_bf16 v[160:163], v[64:67], v[104:107], v[160:163]
    v_mfma_f32_16x16x32_bf16 v[164:167], v[68:71], v[104:107], v[164:167]
    v_mfma_f32_16x16x32_bf16 v[168:171], v[72:75], v[104:107], v[168:171]
    v_mfma_f32_16x16x32_bf16 v[172:175], v[76:79], v[104:107], v[172:175]
    ds_read_b128 v[104:107], v4 offset:4096
    v_mfma_f32_16x16x32_bf16 v[188:191], v[76:79], v[108:111], v[188:191]
    v_mfma_f32_16x16x32_bf16 v[184:187], v[72:75], v[108:111], v[184:187]
    v_mfma_f32_16x16x32_bf16 v[180:183], v[68:71], v[108:111], v[180:183]
    v_mfma_f32_16x16x32_bf16 v[176:179], v[64:67], v[108:111], v[176:179]
    ds_read_b128 v[108:111], v4 offset:6144
    v_mfma_f32_16x16x32_bf16 v[192:195], v[64:67], v[112:115], v[192:195]
    v_mfma_f32_16x16x32_bf16 v[196:199], v[68:71], v[112:115], v[196:199]
    v_mfma_f32_16x16x32_bf16 v[200:203], v[72:75], v[112:115], v[200:203]
    v_mfma_f32_16x16x32_bf16 v[204:207], v[76:79], v[112:115], v[204:207]
    ds_read_b128 v[112:115], v4 offset:8192
    s_waitcnt lgkmcnt(8)
    v_mfma_f32_16x16x32_bf16 v[220:223], v[76:79], v[116:119], v[220:223]
    v_mfma_f32_16x16x32_bf16 v[216:219], v[72:75], v[116:119], v[216:219]
    v_mfma_f32_16x16x32_bf16 v[212:215], v[68:71], v[116:119], v[212:215]
    v_mfma_f32_16x16x32_bf16 v[208:211], v[64:67], v[116:119], v[208:211]
    ds_read_b128 v[116:119], v4 offset:10240
    s_waitcnt lgkmcnt(8)
    v_mfma_f32_16x16x32_bf16 v[224:227], v[64:67], v[120:123], v[224:227]
    v_mfma_f32_16x16x32_bf16 v[228:231], v[68:71], v[120:123], v[228:231]
    v_mfma_f32_16x16x32_bf16 v[232:235], v[72:75], v[120:123], v[232:235]
    v_mfma_f32_16x16x32_bf16 v[236:239], v[76:79], v[120:123], v[236:239]
    ds_read_b128 v[120:123], v4 offset:12288
    s_waitcnt lgkmcnt(8)
    v_mfma_f32_16x16x32_bf16 v[252:255], v[76:79], v[124:127], v[252:255]
    v_mfma_f32_16x16x32_bf16 v[248:251], v[72:75], v[124:127], v[248:251]
    v_mfma_f32_16x16x32_bf16 v[244:247], v[68:71], v[124:127], v[244:247]
    v_mfma_f32_16x16x32_bf16 v[240:243], v[64:67], v[124:127], v[240:243]
    ds_read_b128 v[124:127], v4 offset:14336
    s_waitcnt vmcnt(15) lgkmcnt(7)
    v_mfma_f32_16x16x32_bf16 v[128:131], v[80:83], v[96:99], v[128:131]
    s_add_u32 s48, s49, 851968
    buffer_load_dwordx4 v[64:67], v1, s[80:83], s48 offen sc1
    s_waitcnt vmcnt(15)
    v_mfma_f32_16x16x32_bf16 v[132:135], v[84:87], v[96:99], v[132:135]
    s_waitcnt vmcnt(14)
    v_mfma_f32_16x16x32_bf16 v[136:139], v[88:91], v[96:99], v[136:139]
    buffer_load_dwordx4 v[68:71], v1, s[80:83], s48 offen offset:1024 sc1
    s_waitcnt vmcnt(14)
    v_mfma_f32_16x16x32_bf16 v[140:143], v[92:95], v[96:99], v[140:143]
    ds_read_b128 v[96:99], v5 offset:0
    s_waitcnt lgkmcnt(7)
    v_mfma_f32_16x16x32_bf16 v[156:159], v[92:95], v[100:103], v[156:159]
    buffer_load_dwordx4 v[72:75], v1, s[80:83], s48 offen offset:2048 sc1
    v_mfma_f32_16x16x32_bf16 v[152:155], v[88:91], v[100:103], v[152:155]
    v_mfma_f32_16x16x32_bf16 v[148:151], v[84:87], v[100:103], v[148:151]
    buffer_load_dwordx4 v[76:79], v1, s[80:83], s48 offen offset:3072 sc1
    v_mfma_f32_16x16x32_bf16 v[144:147], v[80:83], v[100:103], v[144:147]
    ds_read_b128 v[100:103], v5 offset:2048
    s_waitcnt lgkmcnt(7)
    v_mfma_f32_16x16x32_bf16 v[160:163], v[80:83], v[104:107], v[160:163]
    v_mfma_f32_16x16x32_bf16 v[164:167], v[84:87], v[104:107], v[164:167]
    v_mfma_f32_16x16x32_bf16 v[168:171], v[88:91], v[104:107], v[168:171]
    v_mfma_f32_16x16x32_bf16 v[172:175], v[92:95], v[104:107], v[172:175]
    ds_read_b128 v[104:107], v5 offset:4096
    s_waitcnt lgkmcnt(7)
    v_mfma_f32_16x16x32_bf16 v[188:191], v[92:95], v[108:111], v[188:191]
    v_mfma_f32_16x16x32_bf16 v[184:187], v[88:91], v[108:111], v[184:187]
    v_mfma_f32_16x16x32_bf16 v[180:183], v[84:87], v[108:111], v[180:183]
    v_mfma_f32_16x16x32_bf16 v[176:179], v[80:83], v[108:111], v[176:179]
    ds_read_b128 v[108:111], v5 offset:6144
    s_waitcnt lgkmcnt(7)
    v_mfma_f32_16x16x32_bf16 v[192:195], v[80:83], v[112:115], v[192:195]
    v_mfma_f32_16x16x32_bf16 v[196:199], v[84:87], v[112:115], v[196:199]
    v_mfma_f32_16x16x32_bf16 v[200:203], v[88:91], v[112:115], v[200:203]
    v_mfma_f32_16x16x32_bf16 v[204:207], v[92:95], v[112:115], v[204:207]
    ds_read_b128 v[112:115], v5 offset:8192
    ds_read_b32 v10, v9
    s_waitcnt lgkmcnt(8)
    v_mfma_f32_16x16x32_bf16 v[220:223], v[92:95], v[116:119], v[220:223]
    v_mfma_f32_16x16x32_bf16 v[216:219], v[88:91], v[116:119], v[216:219]
    v_mfma_f32_16x16x32_bf16 v[212:215], v[84:87], v[116:119], v[212:215]
    v_mfma_f32_16x16x32_bf16 v[208:211], v[80:83], v[116:119], v[208:211]
    ds_read_b128 v[116:119], v5 offset:10240
    s_waitcnt lgkmcnt(8)
    v_mfma_f32_16x16x32_bf16 v[224:227], v[80:83], v[120:123], v[224:227]
    v_mfma_f32_16x16x32_bf16 v[228:231], v[84:87], v[120:123], v[228:231]
    v_mfma_f32_16x16x32_bf16 v[232:235], v[88:91], v[120:123], v[232:235]
    v_mfma_f32_16x16x32_bf16 v[236:239], v[92:95], v[120:123], v[236:239]
    ds_read_b128 v[120:123], v5 offset:12288
    s_waitcnt lgkmcnt(8)
    v_mfma_f32_16x16x32_bf16 v[252:255], v[92:95], v[124:127], v[252:255]
    v_mfma_f32_16x16x32_bf16 v[248:251], v[88:91], v[124:127], v[248:251]
    v_mfma_f32_16x16x32_bf16 v[244:247], v[84:87], v[124:127], v[244:247]
    v_mfma_f32_16x16x32_bf16 v[240:243], v[80:83], v[124:127], v[240:243]
    ds_read_b128 v[124:127], v5 offset:14336
    ds_add_u32 v7, v8 offset:16
    s_waitcnt vmcnt(15) lgkmcnt(9)
    v_mfma_f32_16x16x32_bf16 v[128:131], v[48:51], v[96:99], v[128:131]
    s_add_u32 s48, s49, 868352
    buffer_load_dwordx4 v[80:83], v1, s[80:83], s48 offen sc1
    s_waitcnt vmcnt(15)
    v_mfma_f32_16x16x32_bf16 v[132:135], v[52:55], v[96:99], v[132:135]
    s_waitcnt lgkmcnt(4)
    v_cmp_gt_u32 vcc, 26, v10
    s_waitcnt vmcnt(14)
    v_mfma_f32_16x16x32_bf16 v[136:139], v[56:59], v[96:99], v[136:139]
    s_cbranch_vccnz L_gs27
L_gb27:
    buffer_load_dwordx4 v[84:87], v1, s[80:83], s48 offen offset:1024 sc1
    s_waitcnt vmcnt(14)
    v_mfma_f32_16x16x32_bf16 v[140:143], v[60:63], v[96:99], v[140:143]
    ds_read_b128 v[96:99], v2 offset:0
    v_mfma_f32_16x16x32_bf16 v[156:159], v[60:63], v[100:103], v[156:159]
    buffer_load_dwordx4 v[88:91], v1, s[80:83], s48 offen offset:2048 sc1
    v_mfma_f32_16x16x32_bf16 v[152:155], v[56:59], v[100:103], v[152:155]
    v_mfma_f32_16x16x32_bf16 v[148:151], v[52:55], v[100:103], v[148:151]
    buffer_load_dwordx4 v[92:95], v1, s[80:83], s48 offen offset:3072 sc1
    v_mfma_f32_16x16x32_bf16 v[144:147], v[48:51], v[100:103], v[144:147]
    ds_read_b128 v[100:103], v2 offset:2048
    v_mfma_f32_16x16x32_bf16 v[160:163], v[48:51], v[104:107], v[160:163]
    v_mfma_f32_16x16x32_bf16 v[164:167], v[52:55], v[104:107], v[164:167]
    v_mfma_f32_16x16x32_bf16 v[168:171], v[56:59], v[104:107], v[168:171]
    v_mfma_f32_16x16x32_bf16 v[172:175], v[60:63], v[104:107], v[172:175]
    ds_read_b128 v[104:107], v2 offset:4096
    v_mfma_f32_16x16x32_bf16 v[188:191], v[60:63], v[108:111], v[188:191]
    v_mfma_f32_16x16x32_bf16 v[184:187], v[56:59], v[108:111], v[184:187]
    v_mfma_f32_16x16x32_bf16 v[180:183], v[52:55], v[108:111], v[180:183]
    v_mfma_f32_16x16x32_bf16 v[176:179], v[48:51], v[108:111], v[176:179]
    ds_read_b128 v[108:111], v2 offset:6144
    v_mfma_f32_16x16x32_bf16 v[192:195], v[48:51], v[112:115], v[192:195]
    v_mfma_f32_16x16x32_bf16 v[196:199], v[52:55], v[112:115], v[196:199]
    v_mfma_f32_16x16x32_bf16 v[200:203], v[56:59], v[112:115], v[200:203]
    v_mfma_f32_16x16x32_bf16 v[204:207], v[60:63], v[112:115], v[204:207]
    ds_read_b128 v[112:115], v2 offset:8192
    s_waitcnt lgkmcnt(8)
    v_mfma_f32_16x16x32_bf16 v[220:223], v[60:63], v[116:119], v[220:223]
    v_mfma_f32_16x16x32_bf16 v[216:219], v[56:59], v[116:119], v[216:219]
    v_mfma_f32_16x16x32_bf16 v[212:215], v[52:55], v[116:119], v[212:215]
    v_mfma_f32_16x16x32_bf16 v[208:211], v[48:51], v[116:119], v[208:211]
    ds_read_b128 v[116:119], v2 offset:10240
    s_waitcnt lgkmcnt(8)
    v_mfma_f32_16x16x32_bf16 v[224:227], v[48:51], v[120:123], v[224:227]
    v_mfma_f32_16x16x32_bf16 v[228:231], v[52:55], v[120:123], v[228:231]
    v_mfma_f32_16x16x32_bf16 v[232:235], v[56:59], v[120:123], v[232:235]
    v_mfma_f32_16x16x32_bf16 v[236:239], v[60:63], v[120:123], v[236:239]
    ds_read_b128 v[120:123], v2 offset:12288
    s_waitcnt lgkmcnt(8)
    v_mfma_f32_16x16x32_bf16 v[252:255], v[60:63], v[124:127], v[252:255]
    v_mfma_f32_16x16x32_bf16 v[248:251], v[56:59], v[124:127], v[248:251]
    v_mfma_f32_16x16x32_bf16 v[244:247], v[52:55], v[124:127], v[244:247]
    v_mfma_f32_16x16x32_bf16 v[240:243], v[48:51], v[124:127], v[240:243]
    ds_read_b128 v[124:127], v2 offset:14336
    s_waitcnt vmcnt(15) lgkmcnt(7)
    v_mfma_f32_16x16x32_bf16 v[128:131], v[16:19], v[96:99], v[128:131]
    s_add_u32 s48, s49, 884736
    buffer_load_dwordx4 v[48:51], v1, s[80:83], s48 offen sc1
    s_waitcnt vmcnt(15)
    v_mfma_f32_16x16x32_bf16 v[132:135], v[20:23], v[96:99], v[132:135]
    s_waitcnt vmcnt(14)
    v_mfma_f32_16x16x32_bf16 v[136:139], v[24:27], v[96:99], v[136:139]
    buffer_load_dwordx4 v[52:55], v1, s[80:83], s48 offen offset:1024 sc1
    s_waitcnt vmcnt(14)
    v_mfma_f32_16x16x32_bf16 v[140:143], v[28:31], v[96:99], v[140:143]
    ds_read_b128 v[96:99], v3 offset:0
    s_waitcnt lgkmcnt(7)
    v_mfma_f32_16x16x32_bf16 v[156:159], v[28:31], v[100:103], v[156:159]
    buffer_load_dwordx4 v[56:59], v1, s[80:83], s48 offen offset:2048 sc1
    v_mfma_f32_16x16x32_bf16 v[152:155], v[24:27], v[100:103], v[152:155]
    v_mfma_f32_16x16x32_bf16 v[148:151], v[20:23], v[100:103], v[148:151]
    buffer_load_dwordx4 v[60:63], v1, s[80:83], s48 offen offset:3072 sc1
    v_mfma_f32_16x16x32_bf16 v[144:147], v[16:19], v[100:103], v[144:147]
    ds_read_b128 v[100:103], v3 offset:2048
    s_waitcnt lgkmcnt(7)
    v_mfma_f32_16x16x32_bf16 v[160:163], v[16:19], v[104:107], v[160:163]
    v_mfma_f32_16x16x32_bf16 v[164:167], v[20:23], v[104:107], v[164:167]
    v_mfma_f32_16x16x32_bf16 v[168:171], v[24:27], v[104:107], v[168:171]
    v_mfma_f32_16x16x32_bf16 v[172:175], v[28:31], v[104:107], v[172:175]
    ds_read_b128 v[104:107], v3 offset:4096
    s_waitcnt lgkmcnt(7)
    v_mfma_f32_16x16x32_bf16 v[188:191], v[28:31], v[108:111], v[188:191]
    v_mfma_f32_16x16x32_bf16 v[184:187], v[24:27], v[108:111], v[184:187]
    v_mfma_f32_16x16x32_bf16 v[180:183], v[20:23], v[108:111], v[180:183]
    v_mfma_f32_16x16x32_bf16 v[176:179], v[16:19], v[108:111], v[176:179]
    ds_read_b128 v[108:111], v3 offset:6144
    s_waitcnt lgkmcnt(7)
    v_mfma_f32_16x16x32_bf16 v[192:195], v[16:19], v[112:115], v[192:195]
    v_mfma_f32_16x16x32_bf16 v[196:199], v[20:23], v[112:115], v[196:199]
    v_mfma_f32_16x16x32_bf16 v[200:203], v[24:27], v[112:115], v[200:203]
    v_mfma_f32_16x16x32_bf16 v[204:207], v[28:31], v[112:115], v[204:207]
    ds_read_b128 v[112:115], v3 offset:8192
    ds_read_b32 v10, v9
    s_waitcnt lgkmcnt(8)
    v_mfma_f32_16x16x32_bf16 v[220:223], v[28:31], v[116:119], v[220:223]
    v_mfma_f32_16x16x32_bf16 v[216:219], v[24:27], v[116:119], v[216:219]
    v_mfma_f32_16x16x32_bf16 v[212:215], v[20:23], v[116:119], v[212:215]
    v_mfma_f32_16x16x32_bf16 v[208:211], v[16:19], v[116:119], v[208:211]
    ds_read_b128 v[116:119], v3 offset:10240
    s_waitcnt lgkmcnt(8)
    v_mfma_f32_16x16x32_bf16 v[224:227], v[16:19], v[120:123], v[224:227]
    v_mfma_f32_16x16x32_bf16 v[228:231], v[20:23], v[120:123], v[228:231]
    v_mfma_f32_16x16x32_bf16 v[232:235], v[24:27], v[120:123], v[232:235]
    v_mfma_f32_16x16x32_bf16 v[236:239], v[28:31], v[120:123], v[236:239]
    ds_read_b128 v[120:123], v3 offset:12288
    s_waitcnt lgkmcnt(8)
    v_mfma_f32_16x16x32_bf16 v[252:255], v[28:31], v[124:127], v[252:255]
    v_mfma_f32_16x16x32_bf16 v[248:251], v[24:27], v[124:127], v[248:251]
    v_mfma_f32_16x16x32_bf16 v[244:247], v[20:23], v[124:127], v[244:247]
    v_mfma_f32_16x16x32_bf16 v[240:243], v[16:19], v[124:127], v[240:243]
    ds_read_b128 v[124:127], v3 offset:14336
    ds_add_u32 v7, v8 offset:16
    s_waitcnt vmcnt(15) lgkmcnt(9)
    v_mfma_f32_16x16x32_bf16 v[128:131], v[32:35], v[96:99], v[128:131]
    s_add_u32 s48, s49, 901120
    buffer_load_dwordx4 v[16:19], v1, s[80:83], s48 offen sc1
    s_waitcnt vmcnt(15)
    v_mfma_f32_16x16x32_bf16 v[132:135], v[36:39], v[96:99], v[132:135]
    s_waitcnt lgkmcnt(4)
    v_cmp_gt_u32 vcc, 27, v10
    s_waitcnt vmcnt(14)
    v_mfma_f32_16x16x32_bf16 v[136:139], v[40:43], v[96:99], v[136:139]
    s_cbranch_vccnz L_gs28
L_gb28:
    buffer_load_dwordx4 v[20:23], v1, s[80:83], s48 offen offset:1024 sc1
    s_waitcnt vmcnt(14)
    v_mfma_f32_16x16x32_bf16 v[140:143], v[44:47], v[96:99], v[140:143]
    ds_read_b128 v[96:99], v2 offset:16384
    v_mfma_f32_16x16x32_bf16 v[156:159], v[44:47], v[100:103], v[156:159]
    buffer_load_dwordx4 v[24:27], v1, s[80:83], s48 offen offset:2048 sc1
    v_mfma_f32_16x16x32_bf16 v[152:155], v[40:43], v[100:103], v[152:155]
    v_mfma_f32_16x16x32_bf16 v[148:151], v[36:39], v[100:103], v[148:151]
    buffer_load_dwordx4 v[28:31], v1, s[80:83], s48 offen offset:3072 sc1
    v_mfma_f32_16x16x32_bf16 v[144:147], v[32:35], v[100:103], v[144:147]
    ds_read_b128 v[100:103], v2 offset:18432
    v_mfma_f32_16x16x32_bf16 v[160:163], v[32:35], v[104:107], v[160:163]
    v_mfma_f32_16x16x32_bf16 v[164:167], v[36:39], v[104:107], v[164:167]
    v_mfma_f32_16x16x32_bf16 v[168:171], v[40:43], v[104:107], v[168:171]
    v_mfma_f32_16x16x32_bf16 v[172:175], v[44:47], v[104:107], v[172:175]
    ds_read_b128 v[104:107], v2 offset:20480
    v_mfma_f32_16x16x32_bf16 v[188:191], v[44:47], v[108:111], v[188:191]
    v_mfma_f32_16x16x32_bf16 v[184:187], v[40:43], v[108:111], v[184:187]
    v_mfma_f32_16x16x32_bf16 v[180:183], v[36:39], v[108:111], v[180:183]
    v_mfma_f32_16x16x32_bf16 v[176:179], v[32:35], v[108:111], v[176:179]
    ds_read_b128 v[108:111], v2 offset:22528
    v_mfma_f32_16x16x32_bf16 v[192:195], v[32:35], v[112:115], v[192:195]
    v_mfma_f32_16x16x32_bf16 v[196:199], v[36:39], v[112:115], v[196:199]
    v_mfma_f32_16x16x32_bf16 v[200:203], v[40:43], v[112:115], v[200:203]
    v_mfma_f32_16x16x32_bf16 v[204:207], v[44:47], v[112:115], v[204:207]
    ds_read_b128 v[112:115], v2 offset:24576
    s_waitcnt lgkmcnt(8)
    v_mfma_f32_16x16x32_bf16 v[220:223], v[44:47], v[116:119], v[220:223]
    v_mfma_f32_16x16x32_bf16 v[216:219], v[40:43], v[116:119], v[216:219]
    v_mfma_f32_16x16x32_bf16 v[212:215], v[36:39], v[116:119], v[212:215]
    v_mfma_f32_16x16x32_bf16 v[208:211], v[32:35], v[116:119], v[208:211]
    ds_read_b128 v[116:119], v2 offset:26624
    s_waitcnt lgkmcnt(8)
    v_mfma_f32_16x16x32_bf16 v[224:227], v[32:35], v[120:123], v[224:227]
    v_mfma_f32_16x16x32_bf16 v[228:231], v[36:39], v[120:123], v[228:231]
    v_mfma_f32_16x16x32_bf16 v[232:235], v[40:43], v[120:123], v[232:235]
    v_mfma_f32_16x16x32_bf16 v[236:239], v[44:47], v[120:123], v[236:239]
    ds_read_b128 v[120:123], v2 offset:28672
    s_waitcnt lgkmcnt(8)
    v_mfma_f32_16x16x32_bf16 v[252:255], v[44:47], v[124:127], v[252:255]
    v_mfma_f32_16x16x32_bf16 v[248:251], v[40:43], v[124:127], v[248:251]
    v_mfma_f32_16x16x32_bf16 v[244:247], v[36:39], v[124:127], v[244:247]
    v_mfma_f32_16x16x32_bf16 v[240:243], v[32:35], v[124:127], v[240:243]
    ds_read_b128 v[124:127], v2 offset:30720
    s_waitcnt vmcnt(15) lgkmcnt(7)
    v_mfma_f32_16x16x32_bf16 v[128:131], v[64:67], v[96:99], v[128:131]
    s_add_u32 s48, s49, 917504
    buffer_load_dwordx4 v[32:35], v1, s[80:83], s48 offen sc1
    s_waitcnt vmcnt(15)
    v_mfma_f32_16x16x32_bf16 v[132:135], v[68:71], v[96:99], v[132:135]
    s_waitcnt vmcnt(14)
    v_mfma_f32_16x16x32_bf16 v[136:139], v[72:75], v[96:99], v[136:139]
    buffer_load_dwordx4 v[36:39], v1, s[80:83], s48 offen offset:1024 sc1
    s_waitcnt vmcnt(14)
    v_mfma_f32_16x16x32_bf16 v[140:143], v[76:79], v[96:99], v[140:143]
    ds_read_b128 v[96:99], v3 offset:16384
    s_waitcnt lgkmcnt(7)
    v_mfma_f32_16x16x32_bf16 v[156:159], v[76:79], v[100:103], v[156:159]
    buffer_load_dwordx4 v[40:43], v1, s[80:83], s48 offen offset:2048 sc1
    v_mfma_f32_16x16x32_bf16 v[152:155], v[72:75], v[100:103], v[152:155]
    v_mfma_f32_16x16x32_bf16 v[148:151], v[68:71], v[100:103], v[148:151]
    buffer_load_dwordx4 v[44:47], v1, s[80:83], s48 offen offset:3072 sc1
    v_mfma_f32_16x16x32_bf16 v[144:147], v[64:67], v[100:103], v[144:147]
    ds_read_b128 v[100:103], v3 offset:18432
    s_waitcnt lgkmcnt(7)
    v_mfma_f32_16x16x32_bf16 v[160:163], v[64:67], v[104:107], v[160:163]
    v_mfma_f32_16x16x32_bf16 v[164:167], v[68:71], v[104:107], v[164:167]
    v_mfma_f32_16x16x32_bf16 v[168:171], v[72:75], v[104:107], v[168:171]
    v_mfma_f32_16x16x32_bf16 v[172:175], v[76:79], v[104:107], v[172:175]
    ds_read_b128 v[104:107], v3 offset:20480
    s_waitcnt lgkmcnt(7)
    v_mfma_f32_16x16x32_bf16 v[188:191], v[76:79], v[108:111], v[188:191]
    v_mfma_f32_16x16x32_bf16 v[184:187], v[72:75], v[108:111], v[184:187]
    v_mfma_f32_16x16x32_bf16 v[180:183], v[68:71], v[108:111], v[180:183]
    v_mfma_f32_16x16x32_bf16 v[176:179], v[64:67], v[108:111], v[176:179]
    ds_read_b128 v[108:111], v3 offset:22528
    s_waitcnt lgkmcnt(7)
    v_mfma_f32_16x16x32_bf16 v[192:195], v[64:67], v[112:115], v[192:195]
    v_mfma_f32_16x16x32_bf16 v[196:199], v[68:71], v[112:115], v[196:199]
    v_mfma_f32_16x16x32_bf16 v[200:203], v[72:75], v[112:115], v[200:203]
    v_mfma_f32_16x16x32_bf16 v[204:207], v[76:79], v[112:115], v[204:207]
    ds_read_b128 v[112:115], v3 offset:24576
    ds_read_b32 v10, v9
    s_waitcnt lgkmcnt(8)
    v_mfma_f32_16x16x32_bf16 v[220:223], v[76:79], v[116:119], v[220:223]
    v_mfma_f32_16x16x32_bf16 v[216:219], v[72:75], v[116:119], v[216:219]
    v_mfma_f32_16x16x32_bf16 v[212:215], v[68:71], v[116:119], v[212:215]
    v_mfma_f32_16x16x32_bf16 v[208:211], v[64:67], v[116:119], v[208:211]
    ds_read_b128 v[116:119], v3 offset:26624
    s_waitcnt lgkmcnt(8)
    v_mfma_f32_16x16x32_bf16 v[224:227], v[64:67], v[120:123], v[224:227]
    v_mfma_f32_16x16x32_bf16 v[228:231], v[68:71], v[120:123], v[228:231]
    v_mfma_f32_16x16x32_bf16 v[232:235], v[72:75], v[120:123], v[232:235]
    v_mfma_f32_16x16x32_bf16 v[236:239], v[76:79], v[120:123], v[236:239]
    ds_read_b128 v[120:123], v3 offset:28672
    s_waitcnt lgkmcnt(8)
    v_mfma_f32_16x16x32_bf16 v[252:255], v[76:79], v[124:127], v[252:255]
    v_mfma_f32_16x16x32_bf16 v[248:251], v[72:75], v[124:127], v[248:251]
    v_mfma_f32_16x16x32_bf16 v[244:247], v[68:71], v[124:127], v[244:247]
    v_mfma_f32_16x16x32_bf16 v[240:243], v[64:67], v[124:127], v[240:243]
    ds_read_b128 v[124:127], v3 offset:30720
    ds_add_u32 v7, v8 offset:16
    s_waitcnt vmcnt(15) lgkmcnt(9)
    v_mfma_f32_16x16x32_bf16 v[128:131], v[80:83], v[96:99], v[128:131]
    s_add_u32 s48, s49, 933888
    buffer_load_dwordx4 v[64:67], v1, s[80:83], s48 offen sc1
    s_waitcnt vmcnt(15)
    v_mfma_f32_16x16x32_bf16 v[132:135], v[84:87], v[96:99], v[132:135]
    s_waitcnt lgkmcnt(4)
    v_cmp_gt_u32 vcc, 28, v10
    s_waitcnt vmcnt(14)
    v_mfma_f32_16x16x32_bf16 v[136:139], v[88:91], v[96:99], v[136:139]
    s_cbranch_vccnz L_gs29
L_gb29:
    buffer_load_dwordx4 v[68:71], v1, s[80:83], s48 offen offset:1024 sc1
    s_waitcnt vmcnt(14)
    v_mfma_f32_16x16x32_bf16 v[140:143], v[92:95], v[96:99], v[140:143]
    ds_read_b128 v[96:99], v2 offset:32768
    v_mfma_f32_16x16x32_bf16 v[156:159], v[92:95], v[100:103], v[156:159]
    buffer_load_dwordx4 v[72:75], v1, s[80:83], s48 offen offset:2048 sc1
    v_mfma_f32_16x16x32_bf16 v[152:155], v[88:91], v[100:103], v[152:155]
    v_mfma_f32_16x16x32_bf16 v[148:151], v[84:87], v[100:103], v[148:151]
    buffer_load_dwordx4 v[76:79], v1, s[80:83], s48 offen offset:3072 sc1
    v_mfma_f32_16x16x32_bf16 v[144:147], v[80:83], v[100:103], v[144:147]
    ds_read_b128 v[100:103], v2 offset:34816
    v_mfma_f32_16x16x32_bf16 v[160:163], v[80:83], v[104:107], v[160:163]
    v_mfma_f32_16x16x32_bf16 v[164:167], v[84:87], v[104:107], v[164:167]
    v_mfma_f32_16x16x32_bf16 v[168:171], v[88:91], v[104:107], v[168:171]
    v_mfma_f32_16x16x32_bf16 v[172:175], v[92:95], v[104:107], v[172:175]
    ds_read_b128 v[104:107], v2 offset:36864
    v_mfma_f32_16x16x32_bf16 v[188:191], v[92:95], v[108:111], v[188:191]
    v_mfma_f32_16x16x32_bf16 v[184:187], v[88:91], v[108:111], v[184:187]
    v_mfma_f32_16x16x32_bf16 v[180:183], v[84:87], v[108:111], v[180:183]
    v_mfma_f32_16x16x32_bf16 v[176:179], v[80:83], v[108:111], v[176:179]
    ds_read_b128 v[108:111], v2 offset:38912
    v_mfma_f32_16x16x32_bf16 v[192:195], v[80:83], v[112:115], v[192:195]
    v_mfma_f32_16x16x32_bf16 v[196:199], v[84:87], v[112:115], v[196:199]
    v_mfma_f32_16x16x32_bf16 v[200:203], v[88:91], v[112:115], v[200:203]
    v_mfma_f32_16x16x32_bf16 v[204:207], v[92:95], v[112:115], v[204:207]
    ds_read_b128 v[112:115], v2 offset:40960
    s_waitcnt lgkmcnt(8)
    v_mfma_f32_16x16x32_bf16 v[220:223], v[92:95], v[116:119], v[220:223]
    v_mfma_f32_16x16x32_bf16 v[216:219], v[88:91], v[116:119], v[216:219]
    v_mfma_f32_16x16x32_bf16 v[212:215], v[84:87], v[116:119], v[212:215]
    v_mfma_f32_16x16x32_bf16 v[208:211], v[80:83], v[116:119], v[208:211]
    ds_read_b128 v[116:119], v2 offset:43008
    s_waitcnt lgkmcnt(8)
    v_mfma_f32_16x16x32_bf16 v[224:227], v[80:83], v[120:123], v[224:227]
    v_mfma_f32_16x16x32_bf16 v[228:231], v[84:87], v[120:123], v[228:231]
    v_mfma_f32_16x16x32_bf16 v[232:235], v[88:91], v[120:123], v[232:235]
    v_mfma_f32_16x16x32_bf16 v[236:239], v[92:95], v[120:123], v[236:239]
    ds_read_b128 v[120:123], v2 offset:45056
    s_waitcnt lgkmcnt(8)
    v_mfma_f32_16x16x32_bf16 v[252:255], v[92:95], v[124:127], v[252:255]
    v_mfma_f32_16x16x32_bf16 v[248:251], v[88:91], v[124:127], v[248:251]
    v_mfma_f32_16x16x32_bf16 v[244:247], v[84:87], v[124:127], v[244:247]
    v_mfma_f32_16x16x32_bf16 v[240:243], v[80:83], v[124:127], v[240:243]
    ds_read_b128 v[124:127], v2 offset:47104
    s_waitcnt vmcnt(15) lgkmcnt(7)
    v_mfma_f32_16x16x32_bf16 v[128:131], v[48:51], v[96:99], v[128:131]
    s_add_u32 s48, s49, 950272
    buffer_load_dwordx4 v[80:83], v1, s[80:83], s48 offen sc1
    s_waitcnt vmcnt(15)
    v_mfma_f32_16x16x32_bf16 v[132:135], v[52:55], v[96:99], v[132:135]
    s_waitcnt vmcnt(14)
    v_mfma_f32_16x16x32_bf16 v[136:139], v[56:59], v[96:99], v[136:139]
    buffer_load_dwordx4 v[84:87], v1, s[80:83], s48 offen offset:1024 sc1
    s_waitcnt vmcnt(14)
    v_mfma_f32_16x16x32_bf16 v[140:143], v[60:63], v[96:99], v[140:143]
    ds_read_b128 v[96:99], v3 offset:32768
    s_waitcnt lgkmcnt(7)
    v_mfma_f32_16x16x32_bf16 v[156:159], v[60:63], v[100:103], v[156:159]
    buffer_load_dwordx4 v[88:91], v1, s[80:83], s48 offen offset:2048 sc1
    v_mfma_f32_16x16x32_bf16 v[152:155], v[56:59], v[100:103], v[152:155]
    v_mfma_f32_16x16x32_bf16 v[148:151], v[52:55], v[100:103], v[148:151]
    buffer_load_dwordx4 v[92:95], v1, s[80:83], s48 offen offset:3072 sc1
    v_mfma_f32_16x16x32_bf16 v[144:147], v[48:51], v[100:103], v[144:147]
    ds_read_b128 v[100:103], v3 offset:34816
    s_waitcnt lgkmcnt(7)
    v_mfma_f32_16x16x32_bf16 v[160:163], v[48:51], v[104:107], v[160:163]
    v_mfma_f32_16x16x32_bf16 v[164:167], v[52:55], v[104:107], v[164:167]
    v_mfma_f32_16x16x32_bf16 v[168:171], v[56:59], v[104:107], v[168:171]
    v_mfma_f32_16x16x32_bf16 v[172:175], v[60:63], v[104:107], v[172:175]
    ds_read_b128 v[104:107], v3 offset:36864
    s_waitcnt lgkmcnt(7)
    v_mfma_f32_16x16x32_bf16 v[188:191], v[60:63], v[108:111], v[188:191]
    v_mfma_f32_16x16x32_bf16 v[184:187], v[56:59], v[108:111], v[184:187]
    v_mfma_f32_16x16x32_bf16 v[180:183], v[52:55], v[108:111], v[180:183]
    v_mfma_f32_16x16x32_bf16 v[176:179], v[48:51], v[108:111], v[176:179]
    ds_read_b128 v[108:111], v3 offset:38912
    s_waitcnt lgkmcnt(7)
    v_mfma_f32_16x16x32_bf16 v[192:195], v[48:51], v[112:115], v[192:195]
    v_mfma_f32_16x16x32_bf16 v[196:199], v[52:55], v[112:115], v[196:199]
    v_mfma_f32_16x16x32_bf16 v[200:203], v[56:59], v[112:115], v[200:203]
    v_mfma_f32_16x16x32_bf16 v[204:207], v[60:63], v[112:115], v[204:207]
    ds_read_b128 v[112:115], v3 offset:40960
    ds_read_b32 v10, v9
    s_waitcnt lgkmcnt(8)
    v_mfma_f32_16x16x32_bf16 v[220:223], v[60:63], v[116:119], v[220:223]
    v_mfma_f32_16x16x32_bf16 v[216:219], v[56:59], v[116:119], v[216:219]
    v_mfma_f32_16x16x32_bf16 v[212:215], v[52:55], v[116:119], v[212:215]
    v_mfma_f32_16x16x32_bf16 v[208:211], v[48:51], v[116:119], v[208:211]
    ds_read_b128 v[116:119], v3 offset:43008
    s_waitcnt lgkmcnt(8)
    v_mfma_f32_16x16x32_bf16 v[224:227], v[48:51], v[120:123], v[224:227]
    v_mfma_f32_16x16x32_bf16 v[228:231], v[52:55], v[120:123], v[228:231]
    v_mfma_f32_16x16x32_bf16 v[232:235], v[56:59], v[120:123], v[232:235]
    v_mfma_f32_16x16x32_bf16 v[236:239], v[60:63], v[120:123], v[236:239]
    ds_read_b128 v[120:123], v3 offset:45056
    s_waitcnt lgkmcnt(8)
    v_mfma_f32_16x16x32_bf16 v[252:255], v[60:63], v[124:127], v[252:255]
    v_mfma_f32_16x16x32_bf16 v[248:251], v[56:59], v[124:127], v[248:251]
    v_mfma_f32_16x16x32_bf16 v[244:247], v[52:55], v[124:127], v[244:247]
    v_mfma_f32_16x16x32_bf16 v[240:243], v[48:51], v[124:127], v[240:243]
    ds_read_b128 v[124:127], v3 offset:47104
    ds_add_u32 v7, v8 offset:16
    s_waitcnt vmcnt(15) lgkmcnt(9)
    v_mfma_f32_16x16x32_bf16 v[128:131], v[16:19], v[96:99], v[128:131]
    s_add_u32 s48, s49, 966656
    buffer_load_dwordx4 v[48:51], v1, s[80:83], s48 offen sc1
    s_waitcnt vmcnt(15)
    v_mfma_f32_16x16x32_bf16 v[132:135], v[20:23], v[96:99], v[132:135]
    s_waitcnt lgkmcnt(4)
    v_cmp_gt_u32 vcc, 29, v10
    s_waitcnt vmcnt(14)
    v_mfma_f32_16x16x32_bf16 v[136:139], v[24:27], v[96:99], v[136:139]
    s_cbranch_vccnz L_gs30
L_gb30:
    buffer_load_dwordx4 v[52:55], v1, s[80:83], s48 offen offset:1024 sc1
    s_waitcnt vmcnt(14)
    v_mfma_f32_16x16x32_bf16 v[140:143], v[28:31], v[96:99], v[140:143]
    ds_read_b128 v[96:99], v2 offset:49152
    v_mfma_f32_16x16x32_bf16 v[156:159], v[28:31], v[100:103], v[156:159]
    buffer_load_dwordx4 v[56:59], v1, s[80:83], s48 offen offset:2048 sc1
    v_mfma_f32_16x16x32_bf16 v[152:155], v[24:27], v[100:103], v[152:155]
    v_mfma_f32_16x16x32_bf16 v[148:151], v[20:23], v[100:103], v[148:151]
    buffer_load_dwordx4 v[60:63], v1, s[80:83], s48 offen offset:3072 sc1
    v_mfma_f32_16x16x32_bf16 v[144:147], v[16:19], v[100:103], v[144:147]
    ds_read_b128 v[100:103], v2 offset:51200
    v_mfma_f32_16x16x32_bf16 v[160:163], v[16:19], v[104:107], v[160:163]
    v_mfma_f32_16x16x32_bf16 v[164:167], v[20:23], v[104:107], v[164:167]
    v_mfma_f32_16x16x32_bf16 v[168:171], v[24:27], v[104:107], v[168:171]
    v_mfma_f32_16x16x32_bf16 v[172:175], v[28:31], v[104:107], v[172:175]
    ds_read_b128 v[104:107], v2 offset:53248
    v_mfma_f32_16x16x32_bf16 v[188:191], v[28:31], v[108:111], v[188:191]
    v_mfma_f32_16x16x32_bf16 v[184:187], v[24:27], v[108:111], v[184:187]
    v_mfma_f32_16x16x32_bf16 v[180:183], v[20:23], v[108:111], v[180:183]
    v_mfma_f32_16x16x32_bf16 v[176:179], v[16:19], v[108:111], v[176:179]
    ds_read_b128 v[108:111], v2 offset:55296
    v_mfma_f32_16x16x32_bf16 v[192:195], v[16:19], v[112:115], v[192:195]
    v_mfma_f32_16x16x32_bf16 v[196:199], v[20:23], v[112:115], v[196:199]
    v_mfma_f32_16x16x32_bf16 v[200:203], v[24:27], v[112:115], v[200:203]
    v_mfma_f32_16x16x32_bf16 v[204:207], v[28:31], v[112:115], v[204:207]
    ds_read_b128 v[112:115], v2 offset:57344
    s_waitcnt lgkmcnt(8)
    v_mfma_f32_16x16x32_bf16 v[220:223], v[28:31], v[116:119], v[220:223]
    v_mfma_f32_16x16x32_bf16 v[216:219], v[24:27], v[116:119], v[216:219]
    v_mfma_f32_16x16x32_bf16 v[212:215], v[20:23], v[116:119], v[212:215]
    v_mfma_f32_16x16x32_bf16 v[208:211], v[16:19], v[116:119], v[208:211]
    ds_read_b128 v[116:119], v2 offset:59392
    s_waitcnt lgkmcnt(8)
    v_mfma_f32_16x16x32_bf16 v[224:227], v[16:19], v[120:123], v[224:227]
    v_mfma_f32_16x16x32_bf16 v[228:231], v[20:23], v[120:123], v[228:231]
    v_mfma_f32_16x16x32_bf16 v[232:235], v[24:27], v[120:123], v[232:235]
    v_mfma_f32_16x16x32_bf16 v[236:239], v[28:31], v[120:123], v[236:239]
    ds_read_b128 v[120:123], v2 offset:61440
    s_waitcnt lgkmcnt(8)
    v_mfma_f32_16x16x32_bf16 v[252:255], v[28:31], v[124:127], v[252:255]
    v_mfma_f32_16x16x32_bf16 v[248:251], v[24:27], v[124:127], v[248:251]
    v_mfma_f32_16x16x32_bf16 v[244:247], v[20:23], v[124:127], v[244:247]
    v_mfma_f32_16x16x32_bf16 v[240:243], v[16:19], v[124:127], v[240:243]
    ds_read_b128 v[124:127], v2 offset:63488
    s_waitcnt vmcnt(15) lgkmcnt(7)
    v_mfma_f32_16x16x32_bf16 v[128:131], v[32:35], v[96:99], v[128:131]
    s_add_u32 s48, s49, 983040
    buffer_load_dwordx4 v[16:19], v1, s[80:83], s48 offen sc1
    s_waitcnt vmcnt(15)
    v_mfma_f32_16x16x32_bf16 v[132:135], v[36:39], v[96:99], v[132:135]
    s_waitcnt vmcnt(14)
    v_mfma_f32_16x16x32_bf16 v[136:139], v[40:43], v[96:99], v[136:139]
    buffer_load_dwordx4 v[20:23], v1, s[80:83], s48 offen offset:1024 sc1
    s_waitcnt vmcnt(14)
    v_mfma_f32_16x16x32_bf16 v[140:143], v[44:47], v[96:99], v[140:143]
    ds_read_b128 v[96:99], v3 offset:49152
    s_waitcnt lgkmcnt(7)
    v_mfma_f32_16x16x32_bf16 v[156:159], v[44:47], v[100:103], v[156:159]
    buffer_load_dwordx4 v[24:27], v1, s[80:83], s48 offen offset:2048 sc1
    v_mfma_f32_16x16x32_bf16 v[152:155], v[40:43], v[100:103], v[152:155]
    v_mfma_f32_16x16x32_bf16 v[148:151], v[36:39], v[100:103], v[148:151]
    buffer_load_dwordx4 v[28:31], v1, s[80:83], s48 offen offset:3072 sc1
    v_mfma_f32_16x16x32_bf16 v[144:147], v[32:35], v[100:103], v[144:147]
    ds_read_b128 v[100:103], v3 offset:51200
    s_waitcnt lgkmcnt(7)
    v_mfma_f32_16x16x32_bf16 v[160:163], v[32:35], v[104:107], v[160:163]
    v_mfma_f32_16x16x32_bf16 v[164:167], v[36:39], v[104:107], v[164:167]
    v_mfma_f32_16x16x32_bf16 v[168:171], v[40:43], v[104:107], v[168:171]
    v_mfma_f32_16x16x32_bf16 v[172:175], v[44:47], v[104:107], v[172:175]
    ds_read_b128 v[104:107], v3 offset:53248
    s_waitcnt lgkmcnt(7)
    v_mfma_f32_16x16x32_bf16 v[188:191], v[44:47], v[108:111], v[188:191]
    v_mfma_f32_16x16x32_bf16 v[184:187], v[40:43], v[108:111], v[184:187]
    v_mfma_f32_16x16x32_bf16 v[180:183], v[36:39], v[108:111], v[180:183]
    v_mfma_f32_16x16x32_bf16 v[176:179], v[32:35], v[108:111], v[176:179]
    ds_read_b128 v[108:111], v3 offset:55296
    s_waitcnt lgkmcnt(7)
    v_mfma_f32_16x16x32_bf16 v[192:195], v[32:35], v[112:115], v[192:195]
    v_mfma_f32_16x16x32_bf16 v[196:199], v[36:39], v[112:115], v[196:199]
    v_mfma_f32_16x16x32_bf16 v[200:203], v[40:43], v[112:115], v[200:203]
    v_mfma_f32_16x16x32_bf16 v[204:207], v[44:47], v[112:115], v[204:207]
    ds_read_b128 v[112:115], v3 offset:57344
    ds_read_b32 v10, v9
    s_waitcnt lgkmcnt(8)
    v_mfma_f32_16x16x32_bf16 v[220:223], v[44:47], v[116:119], v[220:223]
    v_mfma_f32_16x16x32_bf16 v[216:219], v[40:43], v[116:119], v[216:219]
    v_mfma_f32_16x16x32_bf16 v[212:215], v[36:39], v[116:119], v[212:215]
    v_mfma_f32_16x16x32_bf16 v[208:211], v[32:35], v[116:119], v[208:211]
    ds_read_b128 v[116:119], v3 offset:59392
    s_waitcnt lgkmcnt(8)
    v_mfma_f32_16x16x32_bf16 v[224:227], v[32:35], v[120:123], v[224:227]
    v_mfma_f32_16x16x32_bf16 v[228:231], v[36:39], v[120:123], v[228:231]
    v_mfma_f32_16x16x32_bf16 v[232:235], v[40:43], v[120:123], v[232:235]
    v_mfma_f32_16x16x32_bf16 v[236:239], v[44:47], v[120:123], v[236:239]
    ds_read_b128 v[120:123], v3 offset:61440
    s_waitcnt lgkmcnt(8)
    v_mfma_f32_16x16x32_bf16 v[252:255], v[44:47], v[124:127], v[252:255]
    v_mfma_f32_16x16x32_bf16 v[248:251], v[40:43], v[124:127], v[248:251]
    v_mfma_f32_16x16x32_bf16 v[244:247], v[36:39], v[124:127], v[244:247]
    v_mfma_f32_16x16x32_bf16 v[240:243], v[32:35], v[124:127], v[240:243]
    ds_read_b128 v[124:127], v3 offset:63488
    ds_add_u32 v7, v8 offset:16
    s_waitcnt vmcnt(15) lgkmcnt(9)
    v_mfma_f32_16x16x32_bf16 v[128:131], v[64:67], v[96:99], v[128:131]
    s_add_u32 s48, s49, 999424
    buffer_load_dwordx4 v[32:35], v1, s[80:83], s48 offen sc1
    s_waitcnt vmcnt(15)
    v_mfma_f32_16x16x32_bf16 v[132:135], v[68:71], v[96:99], v[132:135]
    s_waitcnt lgkmcnt(4)
    v_cmp_gt_u32 vcc, 30, v10
    s_waitcnt vmcnt(14)
    v_mfma_f32_16x16x32_bf16 v[136:139], v[72:75], v[96:99], v[136:139]
    s_cbranch_vccnz L_gs31
L_gb31:
    buffer_load_dwordx4 v[36:39], v1, s[80:83], s48 offen offset:1024 sc1
    s_waitcnt vmcnt(14)
    v_mfma_f32_16x16x32_bf16 v[140:143], v[76:79], v[96:99], v[140:143]
    ds_read_b128 v[96:99], v4 offset:0
    v_mfma_f32_16x16x32_bf16 v[156:159], v[76:79], v[100:103], v[156:159]
    buffer_load_dwordx4 v[40:43], v1, s[80:83], s48 offen offset:2048 sc1
    v_mfma_f32_16x16x32_bf16 v[152:155], v[72:75], v[100:103], v[152:155]
    v_mfma_f32_16x16x32_bf16 v[148:151], v[68:71], v[100:103], v[148:151]
    buffer_load_dwordx4 v[44:47], v1, s[80:83], s48 offen offset:3072 sc1
    v_mfma_f32_16x16x32_bf16 v[144:147], v[64:67], v[100:103], v[144:147]
    ds_read_b128 v[100:103], v4 offset:2048
    v_mfma_f32_16x16x32_bf16 v[160:163], v[64:67], v[104:107], v[160:163]
    v_mfma_f32_16x16x32_bf16 v[164:167], v[68:71], v[104:107], v[164:167]
    v_mfma_f32_16x16x32_bf16 v[168:171], v[72:75], v[104:107], v[168:171]
    v_mfma_f32_16x16x32_bf16 v[172:175], v[76:79], v[104:107], v[172:175]
    ds_read_b128 v[104:107], v4 offset:4096
    v_mfma_f32_16x16x32_bf16 v[188:191], v[76:79], v[108:111], v[188:191]
    v_mfma_f32_16x16x32_bf16 v[184:187], v[72:75], v[108:111], v[184:187]
    v_mfma_f32_16x16x32_bf16 v[180:183], v[68:71], v[108:111], v[180:183]
    v_mfma_f32_16x16x32_bf16 v[176:179], v[64:67], v[108:111], v[176:179]
    ds_read_b128 v[108:111], v4 offset:6144
    v_mfma_f32_16x16x32_bf16 v[192:195], v[64:67], v[112:115], v[192:195]
    v_mfma_f32_16x16x32_bf16 v[196:199], v[68:71], v[112:115], v[196:199]
    v_mfma_f32_16x16x32_bf16 v[200:203], v[72:75], v[112:115], v[200:203]
    v_mfma_f32_16x16x32_bf16 v[204:207], v[76:79], v[112:115], v[204:207]
    ds_read_b128 v[112:115], v4 offset:8192
    s_waitcnt lgkmcnt(8)
    v_mfma_f32_16x16x32_bf16 v[220:223], v[76:79], v[116:119], v[220:223]
    v_mfma_f32_16x16x32_bf16 v[216:219], v[72:75], v[116:119], v[216:219]
    v_mfma_f32_16x16x32_bf16 v[212:215], v[68:71], v[116:119], v[212:215]
    v_mfma_f32_16x16x32_bf16 v[208:211], v[64:67], v[116:119], v[208:211]
    ds_read_b128 v[116:119], v4 offset:10240
    s_waitcnt lgkmcnt(8)
    v_mfma_f32_16x16x32_bf16 v[224:227], v[64:67], v[120:123], v[224:227]
    v_mfma_f32_16x16x32_bf16 v[228:231], v[68:71], v[120:123], v[228:231]
    v_mfma_f32_16x16x32_bf16 v[232:235], v[72:75], v[120:123], v[232:235]
    v_mfma_f32_16x16x32_bf16 v[236:239], v[76:79], v[120:123], v[236:239]
    ds_read_b128 v[120:123], v4 offset:12288
    s_waitcnt lgkmcnt(8)
    v_mfma_f32_16x16x32_bf16 v[252:255], v[76:79], v[124:127], v[252:255]
    v_mfma_f32_16x16x32_bf16 v[248:251], v[72:75], v[124:127], v[248:251]
    v_mfma_f32_16x16x32_bf16 v[244:247], v[68:71], v[124:127], v[244:247]
    v_mfma_f32_16x16x32_bf16 v[240:243], v[64:67], v[124:127], v[240:243]
    ds_read_b128 v[124:127], v4 offset:14336
    s_waitcnt vmcnt(15) lgkmcnt(7)
    v_mfma_f32_16x16x32_bf16 v[128:131], v[80:83], v[96:99], v[128:131]
    s_add_u32 s48, s49, 1015808
    buffer_load_dwordx4 v[64:67], v1, s[80:83], s48 offen sc1
    s_waitcnt vmcnt(15)
    v_mfma_f32_16x16x32_bf16 v[132:135], v[84:87], v[96:99], v[132:135]
    s_waitcnt vmcnt(14)
    v_mfma_f32_16x16x32_bf16 v[136:139], v[88:91], v[96:99], v[136:139]
    buffer_load_dwordx4 v[68:71], v1, s[80:83], s48 offen offset:1024 sc1
    s_waitcnt vmcnt(14)
    v_mfma_f32_16x16x32_bf16 v[140:143], v[92:95], v[96:99], v[140:143]
    ds_read_b128 v[96:99], v5 offset:0
    s_waitcnt lgkmcnt(7)
    v_mfma_f32_16x16x32_bf16 v[156:159], v[92:95], v[100:103], v[156:159]
    buffer_load_dwordx4 v[72:75], v1, s[80:83], s48 offen offset:2048 sc1
    v_mfma_f32_16x16x32_bf16 v[152:155], v[88:91], v[100:103], v[152:155]
    v_mfma_f32_16x16x32_bf16 v[148:151], v[84:87], v[100:103], v[148:151]
    buffer_load_dwordx4 v[76:79], v1, s[80:83], s48 offen offset:3072 sc1
    v_mfma_f32_16x16x32_bf16 v[144:147], v[80:83], v[100:103], v[144:147]
    ds_read_b128 v[100:103], v5 offset:2048
    s_waitcnt lgkmcnt(7)
    v_mfma_f32_16x16x32_bf16 v[160:163], v[80:83], v[104:107], v[160:163]
    v_mfma_f32_16x16x32_bf16 v[164:167], v[84:87], v[104:107], v[164:167]
    v_mfma_f32_16x16x32_bf16 v[168:171], v[88:91], v[104:107], v[168:171]
    v_mfma_f32_16x16x32_bf16 v[172:175], v[92:95], v[104:107], v[172:175]
    ds_read_b128 v[104:107], v5 offset:4096
    s_waitcnt lgkmcnt(7)
    v_mfma_f32_16x16x32_bf16 v[188:191], v[92:95], v[108:111], v[188:191]
    v_mfma_f32_16x16x32_bf16 v[184:187], v[88:91], v[108:111], v[184:187]
    v_mfma_f32_16x16x32_bf16 v[180:183], v[84:87], v[108:111], v[180:183]
    v_mfma_f32_16x16x32_bf16 v[176:179], v[80:83], v[108:111], v[176:179]
    ds_read_b128 v[108:111], v5 offset:6144
    s_waitcnt lgkmcnt(7)
    v_mfma_f32_16x16x32_bf16 v[192:195], v[80:83], v[112:115], v[192:195]
    v_mfma_f32_16x16x32_bf16 v[196:199], v[84:87], v[112:115], v[196:199]
    v_mfma_f32_16x16x32_bf16 v[200:203], v[88:91], v[112:115], v[200:203]
    v_mfma_f32_16x16x32_bf16 v[204:207], v[92:95], v[112:115], v[204:207]
    ds_read_b128 v[112:115], v5 offset:8192
    ds_read_b32 v10, v9
    s_waitcnt lgkmcnt(8)
    v_mfma_f32_16x16x32_bf16 v[220:223], v[92:95], v[116:119], v[220:223]
    v_mfma_f32_16x16x32_bf16 v[216:219], v[88:91], v[116:119], v[216:219]
    v_mfma_f32_16x16x32_bf16 v[212:215], v[84:87], v[116:119], v[212:215]
    v_mfma_f32_16x16x32_bf16 v[208:211], v[80:83], v[116:119], v[208:211]
    ds_read_b128 v[116:119], v5 offset:10240
    s_waitcnt lgkmcnt(8)
    v_mfma_f32_16x16x32_bf16 v[224:227], v[80:83], v[120:123], v[224:227]
    v_mfma_f32_16x16x32_bf16 v[228:231], v[84:87], v[120:123], v[228:231]
    v_mfma_f32_16x16x32_bf16 v[232:235], v[88:91], v[120:123], v[232:235]
    v_mfma_f32_16x16x32_bf16 v[236:239], v[92:95], v[120:123], v[236:239]
    ds_read_b128 v[120:123], v5 offset:12288
    s_waitcnt lgkmcnt(8)
    v_mfma_f32_16x16x32_bf16 v[252:255], v[92:95], v[124:127], v[252:255]
    v_mfma_f32_16x16x32_bf16 v[248:251], v[88:91], v[124:127], v[248:251]
    v_mfma_f32_16x16x32_bf16 v[244:247], v[84:87], v[124:127], v[244:247]
    v_mfma_f32_16x16x32_bf16 v[240:243], v[80:83], v[124:127], v[240:243]
    ds_read_b128 v[124:127], v5 offset:14336
    ds_add_u32 v7, v8 offset:16
    s_waitcnt vmcnt(15) lgkmcnt(9)
    v_mfma_f32_16x16x32_bf16 v[128:131], v[48:51], v[96:99], v[128:131]
    s_add_u32 s48, s49, 1032192
    buffer_load_dwordx4 v[80:83], v1, s[80:83], s48 offen sc1
    s_waitcnt vmcnt(15)
    v_mfma_f32_16x16x32_bf16 v[132:135], v[52:55], v[96:99], v[132:135]
    s_waitcnt lgkmcnt(4)
    v_cmp_gt_u32 vcc, 31, v10
    s_waitcnt vmcnt(14)
    v_mfma_f32_16x16x32_bf16 v[136:139], v[56:59], v[96:99], v[136:139]
    s_cbranch_vccnz L_gs32
L_gb32:
    buffer_load_dwordx4 v[84:87], v1, s[80:83], s48 offen offset:1024 sc1
    s_waitcnt vmcnt(14)
    v_mfma_f32_16x16x32_bf16 v[140:143], v[60:63], v[96:99], v[140:143]
    ds_read_b128 v[96:99], v2 offset:0
    v_mfma_f32_16x16x32_bf16 v[156:159], v[60:63], v[100:103], v[156:159]
    buffer_load_dwordx4 v[88:91], v1, s[80:83], s48 offen offset:2048 sc1
    v_mfma_f32_16x16x32_bf16 v[152:155], v[56:59], v[100:103], v[152:155]
    v_mfma_f32_16x16x32_bf16 v[148:151], v[52:55], v[100:103], v[148:151]
    buffer_load_dwordx4 v[92:95], v1, s[80:83], s48 offen offset:3072 sc1
    v_mfma_f32_16x16x32_bf16 v[144:147], v[48:51], v[100:103], v[144:147]
    ds_read_b128 v[100:103], v2 offset:2048
    v_mfma_f32_16x16x32_bf16 v[160:163], v[48:51], v[104:107], v[160:163]
    v_mfma_f32_16x16x32_bf16 v[164:167], v[52:55], v[104:107], v[164:167]
    v_mfma_f32_16x16x32_bf16 v[168:171], v[56:59], v[104:107], v[168:171]
    v_mfma_f32_16x16x32_bf16 v[172:175], v[60:63], v[104:107], v[172:175]
    ds_read_b128 v[104:107], v2 offset:4096
    v_mfma_f32_16x16x32_bf16 v[188:191], v[60:63], v[108:111], v[188:191]
    v_mfma_f32_16x16x32_bf16 v[184:187], v[56:59], v[108:111], v[184:187]
    v_mfma_f32_16x16x32_bf16 v[180:183], v[52:55], v[108:111], v[180:183]
    v_mfma_f32_16x16x32_bf16 v[176:179], v[48:51], v[108:111], v[176:179]
    ds_read_b128 v[108:111], v2 offset:6144
    v_mfma_f32_16x16x32_bf16 v[192:195], v[48:51], v[112:115], v[192:195]
    v_mfma_f32_16x16x32_bf16 v[196:199], v[52:55], v[112:115], v[196:199]
    v_mfma_f32_16x16x32_bf16 v[200:203], v[56:59], v[112:115], v[200:203]
    v_mfma_f32_16x16x32_bf16 v[204:207], v[60:63], v[112:115], v[204:207]
    ds_read_b128 v[112:115], v2 offset:8192
    s_waitcnt lgkmcnt(8)
    v_mfma_f32_16x16x32_bf16 v[220:223], v[60:63], v[116:119], v[220:223]
    v_mfma_f32_16x16x32_bf16 v[216:219], v[56:59], v[116:119], v[216:219]
    v_mfma_f32_16x16x32_bf16 v[212:215], v[52:55], v[116:119], v[212:215]
    v_mfma_f32_16x16x32_bf16 v[208:211], v[48:51], v[116:119], v[208:211]
    ds_read_b128 v[116:119], v2 offset:10240
    s_waitcnt lgkmcnt(8)
    v_mfma_f32_16x16x32_bf16 v[224:227], v[48:51], v[120:123], v[224:227]
    v_mfma_f32_16x16x32_bf16 v[228:231], v[52:55], v[120:123], v[228:231]
    v_mfma_f32_16x16x32_bf16 v[232:235], v[56:59], v[120:123], v[232:235]
    v_mfma_f32_16x16x32_bf16 v[236:239], v[60:63], v[120:123], v[236:239]
    ds_read_b128 v[120:123], v2 offset:12288
    s_waitcnt lgkmcnt(8)
    v_mfma_f32_16x16x32_bf16 v[252:255], v[60:63], v[124:127], v[252:255]
    v_mfma_f32_16x16x32_bf16 v[248:251], v[56:59], v[124:127], v[248:251]
    v_mfma_f32_16x16x32_bf16 v[244:247], v[52:55], v[124:127], v[244:247]
    v_mfma_f32_16x16x32_bf16 v[240:243], v[48:51], v[124:127], v[240:243]
    ds_read_b128 v[124:127], v2 offset:14336
    s_waitcnt vmcnt(15) lgkmcnt(7)
    v_mfma_f32_16x16x32_bf16 v[128:131], v[16:19], v[96:99], v[128:131]
    s_add_u32 s48, s49, 1048576
    buffer_load_dwordx4 v[48:51], v1, s[80:83], s48 offen sc1
    s_waitcnt vmcnt(15)
    v_mfma_f32_16x16x32_bf16 v[132:135], v[20:23], v[96:99], v[132:135]
    s_waitcnt vmcnt(14)
    v_mfma_f32_16x16x32_bf16 v[136:139], v[24:27], v[96:99], v[136:139]
    buffer_load_dwordx4 v[52:55], v1, s[80:83], s48 offen offset:1024 sc1
    s_waitcnt vmcnt(14)
    v_mfma_f32_16x16x32_bf16 v[140:143], v[28:31], v[96:99], v[140:143]
    ds_read_b128 v[96:99], v3 offset:0
    s_waitcnt lgkmcnt(7)
    v_mfma_f32_16x16x32_bf16 v[156:159], v[28:31], v[100:103], v[156:159]
    buffer_load_dwordx4 v[56:59], v1, s[80:83], s48 offen offset:2048 sc1
    v_mfma_f32_16x16x32_bf16 v[152:155], v[24:27], v[100:103], v[152:155]
    v_mfma_f32_16x16x32_bf16 v[148:151], v[20:23], v[100:103], v[148:151]
    buffer_load_dwordx4 v[60:63], v1, s[80:83], s48 offen offset:3072 sc1
    v_mfma_f32_16x16x32_bf16 v[144:147], v[16:19], v[100:103], v[144:147]
    ds_read_b128 v[100:103], v3 offset:2048
    s_waitcnt lgkmcnt(7)
    v_mfma_f32_16x16x32_bf16 v[160:163], v[16:19], v[104:107], v[160:163]
    v_mfma_f32_16x16x32_bf16 v[164:167], v[20:23], v[104:107], v[164:167]
    v_mfma_f32_16x16x32_bf16 v[168:171], v[24:27], v[104:107], v[168:171]
    v_mfma_f32_16x16x32_bf16 v[172:175], v[28:31], v[104:107], v[172:175]
    ds_read_b128 v[104:107], v3 offset:4096
    s_waitcnt lgkmcnt(7)
    v_mfma_f32_16x16x32_bf16 v[188:191], v[28:31], v[108:111], v[188:191]
    v_mfma_f32_16x16x32_bf16 v[184:187], v[24:27], v[108:111], v[184:187]
    v_mfma_f32_16x16x32_bf16 v[180:183], v[20:23], v[108:111], v[180:183]
    v_mfma_f32_16x16x32_bf16 v[176:179], v[16:19], v[108:111], v[176:179]
    ds_read_b128 v[108:111], v3 offset:6144
    s_waitcnt lgkmcnt(7)
    v_mfma_f32_16x16x32_bf16 v[192:195], v[16:19], v[112:115], v[192:195]
    v_mfma_f32_16x16x32_bf16 v[196:199], v[20:23], v[112:115], v[196:199]
    v_mfma_f32_16x16x32_bf16 v[200:203], v[24:27], v[112:115], v[200:203]
    v_mfma_f32_16x16x32_bf16 v[204:207], v[28:31], v[112:115], v[204:207]
    ds_read_b128 v[112:115], v3 offset:8192
    ds_read_b32 v10, v9
    s_waitcnt lgkmcnt(8)
    v_mfma_f32_16x16x32_bf16 v[220:223], v[28:31], v[116:119], v[220:223]
    v_mfma_f32_16x16x32_bf16 v[216:219], v[24:27], v[116:119], v[216:219]
    v_mfma_f32_16x16x32_bf16 v[212:215], v[20:23], v[116:119], v[212:215]
    v_mfma_f32_16x16x32_bf16 v[208:211], v[16:19], v[116:119], v[208:211]
    ds_read_b128 v[116:119], v3 offset:10240
    s_waitcnt lgkmcnt(8)
    v_mfma_f32_16x16x32_bf16 v[224:227], v[16:19], v[120:123], v[224:227]
    v_mfma_f32_16x16x32_bf16 v[228:231], v[20:23], v[120:123], v[228:231]
    v_mfma_f32_16x16x32_bf16 v[232:235], v[24:27], v[120:123], v[232:235]
    v_mfma_f32_16x16x32_bf16 v[236:239], v[28:31], v[120:123], v[236:239]
    ds_read_b128 v[120:123], v3 offset:12288
    s_waitcnt lgkmcnt(8)
    v_mfma_f32_16x16x32_bf16 v[252:255], v[28:31], v[124:127], v[252:255]
    v_mfma_f32_16x16x32_bf16 v[248:251], v[24:27], v[124:127], v[248:251]
    v_mfma_f32_16x16x32_bf16 v[244:247], v[20:23], v[124:127], v[244:247]
    v_mfma_f32_16x16x32_bf16 v[240:243], v[16:19], v[124:127], v[240:243]
    ds_read_b128 v[124:127], v3 offset:14336
    ds_add_u32 v7, v8 offset:16
    s_waitcnt vmcnt(15) lgkmcnt(9)
    v_mfma_f32_16x16x32_bf16 v[128:131], v[32:35], v[96:99], v[128:131]
    s_add_u32 s48, s49, 1064960
    buffer_load_dwordx4 v[16:19], v1, s[80:83], s48 offen sc1
    s_waitcnt vmcnt(15)
    v_mfma_f32_16x16x32_bf16 v[132:135], v[36:39], v[96:99], v[132:135]
    s_waitcnt lgkmcnt(4)
    v_cmp_gt_u32 vcc, 32, v10
    s_waitcnt vmcnt(14)
    v_mfma_f32_16x16x32_bf16 v[136:139], v[40:43], v[96:99], v[136:139]
    s_cbranch_vccnz L_gs33
L_gb33:
    buffer_load_dwordx4 v[20:23], v1, s[80:83], s48 offen offset:1024 sc1
    s_waitcnt vmcnt(14)
    v_mfma_f32_16x16x32_bf16 v[140:143], v[44:47], v[96:99], v[140:143]
    ds_read_b128 v[96:99], v2 offset:16384
    v_mfma_f32_16x16x32_bf16 v[156:159], v[44:47], v[100:103], v[156:159]
    buffer_load_dwordx4 v[24:27], v1, s[80:83], s48 offen offset:2048 sc1
    v_mfma_f32_16x16x32_bf16 v[152:155], v[40:43], v[100:103], v[152:155]
    v_mfma_f32_16x16x32_bf16 v[148:151], v[36:39], v[100:103], v[148:151]
    buffer_load_dwordx4 v[28:31], v1, s[80:83], s48 offen offset:3072 sc1
    v_mfma_f32_16x16x32_bf16 v[144:147], v[32:35], v[100:103], v[144:147]
    ds_read_b128 v[100:103], v2 offset:18432
    v_mfma_f32_16x16x32_bf16 v[160:163], v[32:35], v[104:107], v[160:163]
    v_mfma_f32_16x16x32_bf16 v[164:167], v[36:39], v[104:107], v[164:167]
    v_mfma_f32_16x16x32_bf16 v[168:171], v[40:43], v[104:107], v[168:171]
    v_mfma_f32_16x16x32_bf16 v[172:175], v[44:47], v[104:107], v[172:175]
    ds_read_b128 v[104:107], v2 offset:20480
    v_mfma_f32_16x16x32_bf16 v[188:191], v[44:47], v[108:111], v[188:191]
    v_mfma_f32_16x16x32_bf16 v[184:187], v[40:43], v[108:111], v[184:187]
    v_mfma_f32_16x16x32_bf16 v[180:183], v[36:39], v[108:111], v[180:183]
    v_mfma_f32_16x16x32_bf16 v[176:179], v[32:35], v[108:111], v[176:179]
    ds_read_b128 v[108:111], v2 offset:22528
    v_mfma_f32_16x16x32_bf16 v[192:195], v[32:35], v[112:115], v[192:195]
    v_mfma_f32_16x16x32_bf16 v[196:199], v[36:39], v[112:115], v[196:199]
    v_mfma_f32_16x16x32_bf16 v[200:203], v[40:43], v[112:115], v[200:203]
    v_mfma_f32_16x16x32_bf16 v[204:207], v[44:47], v[112:115], v[204:207]
    ds_read_b128 v[112:115], v2 offset:24576
    s_waitcnt lgkmcnt(8)
    v_mfma_f32_16x16x32_bf16 v[220:223], v[44:47], v[116:119], v[220:223]
    v_mfma_f32_16x16x32_bf16 v[216:219], v[40:43], v[116:119], v[216:219]
    v_mfma_f32_16x16x32_bf16 v[212:215], v[36:39], v[116:119], v[212:215]
    v_mfma_f32_16x16x32_bf16 v[208:211], v[32:35], v[116:119], v[208:211]
    ds_read_b128 v[116:119], v2 offset:26624
    s_waitcnt lgkmcnt(8)
    v_mfma_f32_16x16x32_bf16 v[224:227], v[32:35], v[120:123], v[224:227]
    v_mfma_f32_16x16x32_bf16 v[228:231], v[36:39], v[120:123], v[228:231]
    v_mfma_f32_16x16x32_bf16 v[232:235], v[40:43], v[120:123], v[232:235]
    v_mfma_f32_16x16x32_bf16 v[236:239], v[44:47], v[120:123], v[236:239]
    ds_read_b128 v[120:123], v2 offset:28672
    s_waitcnt lgkmcnt(8)
    v_mfma_f32_16x16x32_bf16 v[252:255], v[44:47], v[124:127], v[252:255]
    v_mfma_f32_16x16x32_bf16 v[248:251], v[40:43], v[124:127], v[248:251]
    v_mfma_f32_16x16x32_bf16 v[244:247], v[36:39], v[124:127], v[244:247]
    v_mfma_f32_16x16x32_bf16 v[240:243], v[32:35], v[124:127], v[240:243]
    ds_read_b128 v[124:127], v2 offset:30720
    s_waitcnt vmcnt(15) lgkmcnt(7)
    v_mfma_f32_16x16x32_bf16 v[128:131], v[64:67], v[96:99], v[128:131]
    s_add_u32 s48, s49, 1081344
    buffer_load_dwordx4 v[32:35], v1, s[80:83], s48 offen sc1
    s_waitcnt vmcnt(15)
    v_mfma_f32_16x16x32_bf16 v[132:135], v[68:71], v[96:99], v[132:135]
    s_waitcnt vmcnt(14)
    v_mfma_f32_16x16x32_bf16 v[136:139], v[72:75], v[96:99], v[136:139]
    buffer_load_dwordx4 v[36:39], v1, s[80:83], s48 offen offset:1024 sc1
    s_waitcnt vmcnt(14)
    v_mfma_f32_16x16x32_bf16 v[140:143], v[76:79], v[96:99], v[140:143]
    ds_read_b128 v[96:99], v3 offset:16384
    s_waitcnt lgkmcnt(7)
    v_mfma_f32_16x16x32_bf16 v[156:159], v[76:79], v[100:103], v[156:159]
    buffer_load_dwordx4 v[40:43], v1, s[80:83], s48 offen offset:2048 sc1
    v_mfma_f32_16x16x32_bf16 v[152:155], v[72:75], v[100:103], v[152:155]
    v_mfma_f32_16x16x32_bf16 v[148:151], v[68:71], v[100:103], v[148:151]
    buffer_load_dwordx4 v[44:47], v1, s[80:83], s48 offen offset:3072 sc1
    v_mfma_f32_16x16x32_bf16 v[144:147], v[64:67], v[100:103], v[144:147]
    ds_read_b128 v[100:103], v3 offset:18432
    s_waitcnt lgkmcnt(7)
    v_mfma_f32_16x16x32_bf16 v[160:163], v[64:67], v[104:107], v[160:163]
    v_mfma_f32_16x16x32_bf16 v[164:167], v[68:71], v[104:107], v[164:167]
    v_mfma_f32_16x16x32_bf16 v[168:171], v[72:75], v[104:107], v[168:171]
    v_mfma_f32_16x16x32_bf16 v[172:175], v[76:79], v[104:107], v[172:175]
    ds_read_b128 v[104:107], v3 offset:20480
    s_waitcnt lgkmcnt(7)
    v_mfma_f32_16x16x32_bf16 v[188:191], v[76:79], v[108:111], v[188:191]
    v_mfma_f32_16x16x32_bf16 v[184:187], v[72:75], v[108:111], v[184:187]
    v_mfma_f32_16x16x32_bf16 v[180:183], v[68:71], v[108:111], v[180:183]
    v_mfma_f32_16x16x32_bf16 v[176:179], v[64:67], v[108:111], v[176:179]
    ds_read_b128 v[108:111], v3 offset:22528
    s_waitcnt lgkmcnt(7)
    v_mfma_f32_16x16x32_bf16 v[192:195], v[64:67], v[112:115], v[192:195]
    v_mfma_f32_16x16x32_bf16 v[196:199], v[68:71], v[112:115], v[196:199]
    v_mfma_f32_16x16x32_bf16 v[200:203], v[72:75], v[112:115], v[200:203]
    v_mfma_f32_16x16x32_bf16 v[204:207], v[76:79], v[112:115], v[204:207]
    ds_read_b128 v[112:115], v3 offset:24576
    ds_read_b32 v10, v9
    s_waitcnt lgkmcnt(8)
    v_mfma_f32_16x16x32_bf16 v[220:223], v[76:79], v[116:119], v[220:223]
    v_mfma_f32_16x16x32_bf16 v[216:219], v[72:75], v[116:119], v[216:219]
    v_mfma_f32_16x16x32_bf16 v[212:215], v[68:71], v[116:119], v[212:215]
    v_mfma_f32_16x16x32_bf16 v[208:211], v[64:67], v[116:119], v[208:211]
    ds_read_b128 v[116:119], v3 offset:26624
    s_waitcnt lgkmcnt(8)
    v_mfma_f32_16x16x32_bf16 v[224:227], v[64:67], v[120:123], v[224:227]
    v_mfma_f32_16x16x32_bf16 v[228:231], v[68:71], v[120:123], v[228:231]
    v_mfma_f32_16x16x32_bf16 v[232:235], v[72:75], v[120:123], v[232:235]
    v_mfma_f32_16x16x32_bf16 v[236:239], v[76:79], v[120:123], v[236:239]
    ds_read_b128 v[120:123], v3 offset:28672
    s_waitcnt lgkmcnt(8)
    v_mfma_f32_16x16x32_bf16 v[252:255], v[76:79], v[124:127], v[252:255]
    v_mfma_f32_16x16x32_bf16 v[248:251], v[72:75], v[124:127], v[248:251]
    v_mfma_f32_16x16x32_bf16 v[244:247], v[68:71], v[124:127], v[244:247]
    v_mfma_f32_16x16x32_bf16 v[240:243], v[64:67], v[124:127], v[240:243]
    ds_read_b128 v[124:127], v3 offset:30720
    ds_add_u32 v7, v8 offset:16
    s_waitcnt vmcnt(15) lgkmcnt(9)
    v_mfma_f32_16x16x32_bf16 v[128:131], v[80:83], v[96:99], v[128:131]
    s_add_u32 s48, s49, 1097728
    buffer_load_dwordx4 v[64:67], v1, s[80:83], s48 offen sc1
    s_waitcnt vmcnt(15)
    v_mfma_f32_16x16x32_bf16 v[132:135], v[84:87], v[96:99], v[132:135]
    s_waitcnt lgkmcnt(4)
    v_cmp_gt_u32 vcc, 33, v10
    s_waitcnt vmcnt(14)
    v_mfma_f32_16x16x32_bf16 v[136:139], v[88:91], v[96:99], v[136:139]
    s_cbranch_vccnz L_gs34
L_gb34:
    buffer_load_dwordx4 v[68:71], v1, s[80:83], s48 offen offset:1024 sc1
    s_waitcnt vmcnt(14)
    v_mfma_f32_16x16x32_bf16 v[140:143], v[92:95], v[96:99], v[140:143]
    ds_read_b128 v[96:99], v2 offset:32768
    v_mfma_f32_16x16x32_bf16 v[156:159], v[92:95], v[100:103], v[156:159]
    buffer_load_dwordx4 v[72:75], v1, s[80:83], s48 offen offset:2048 sc1
    v_mfma_f32_16x16x32_bf16 v[152:155], v[88:91], v[100:103], v[152:155]
    v_mfma_f32_16x16x32_bf16 v[148:151], v[84:87], v[100:103], v[148:151]
    buffer_load_dwordx4 v[76:79], v1, s[80:83], s48 offen offset:3072 sc1
    v_mfma_f32_16x16x32_bf16 v[144:147], v[80:83], v[100:103], v[144:147]
    ds_read_b128 v[100:103], v2 offset:34816
    v_mfma_f32_16x16x32_bf16 v[160:163], v[80:83], v[104:107], v[160:163]
    v_mfma_f32_16x16x32_bf16 v[164:167], v[84:87], v[104:107], v[164:167]
    v_mfma_f32_16x16x32_bf16 v[168:171], v[88:91], v[104:107], v[168:171]
    v_mfma_f32_16x16x32_bf16 v[172:175], v[92:95], v[104:107], v[172:175]
    ds_read_b128 v[104:107], v2 offset:36864
    v_mfma_f32_16x16x32_bf16 v[188:191], v[92:95], v[108:111], v[188:191]
    v_mfma_f32_16x16x32_bf16 v[184:187], v[88:91], v[108:111], v[184:187]
    v_mfma_f32_16x16x32_bf16 v[180:183], v[84:87], v[108:111], v[180:183]
    v_mfma_f32_16x16x32_bf16 v[176:179], v[80:83], v[108:111], v[176:179]
    ds_read_b128 v[108:111], v2 offset:38912
    v_mfma_f32_16x16x32_bf16 v[192:195], v[80:83], v[112:115], v[192:195]
    v_mfma_f32_16x16x32_bf16 v[196:199], v[84:87], v[112:115], v[196:199]
    v_mfma_f32_16x16x32_bf16 v[200:203], v[88:91], v[112:115], v[200:203]
    v_mfma_f32_16x16x32_bf16 v[204:207], v[92:95], v[112:115], v[204:207]
    ds_read_b128 v[112:115], v2 offset:40960
    s_waitcnt lgkmcnt(8)
    v_mfma_f32_16x16x32_bf16 v[220:223], v[92:95], v[116:119], v[220:223]
    v_mfma_f32_16x16x32_bf16 v[216:219], v[88:91], v[116:119], v[216:219]
    v_mfma_f32_16x16x32_bf16 v[212:215], v[84:87], v[116:119], v[212:215]
    v_mfma_f32_16x16x32_bf16 v[208:211], v[80:83], v[116:119], v[208:211]
    ds_read_b128 v[116:119], v2 offset:43008
    s_waitcnt lgkmcnt(8)
    v_mfma_f32_16x16x32_bf16 v[224:227], v[80:83], v[120:123], v[224:227]
    v_mfma_f32_16x16x32_bf16 v[228:231], v[84:87], v[120:123], v[228:231]
    v_mfma_f32_16x16x32_bf16 v[232:235], v[88:91], v[120:123], v[232:235]
    v_mfma_f32_16x16x32_bf16 v[236:239], v[92:95], v[120:123], v[236:239]
    ds_read_b128 v[120:123], v2 offset:45056
    s_waitcnt lgkmcnt(8)
    v_mfma_f32_16x16x32_bf16 v[252:255], v[92:95], v[124:127], v[252:255]
    v_mfma_f32_16x16x32_bf16 v[248:251], v[88:91], v[124:127], v[248:251]
    v_mfma_f32_16x16x32_bf16 v[244:247], v[84:87], v[124:127], v[244:247]
    v_mfma_f32_16x16x32_bf16 v[240:243], v[80:83], v[124:127], v[240:243]
    ds_read_b128 v[124:127], v2 offset:47104
    s_waitcnt vmcnt(15) lgkmcnt(7)
    v_mfma_f32_16x16x32_bf16 v[128:131], v[48:51], v[96:99], v[128:131]
    s_add_u32 s48, s49, 1114112
    buffer_load_dwordx4 v[80:83], v1, s[80:83], s48 offen sc1
    s_waitcnt vmcnt(15)
    v_mfma_f32_16x16x32_bf16 v[132:135], v[52:55], v[96:99], v[132:135]
    s_waitcnt vmcnt(14)
    v_mfma_f32_16x16x32_bf16 v[136:139], v[56:59], v[96:99], v[136:139]
    buffer_load_dwordx4 v[84:87], v1, s[80:83], s48 offen offset:1024 sc1
    s_waitcnt vmcnt(14)
    v_mfma_f32_16x16x32_bf16 v[140:143], v[60:63], v[96:99], v[140:143]
    ds_read_b128 v[96:99], v3 offset:32768
    s_waitcnt lgkmcnt(7)
    v_mfma_f32_16x16x32_bf16 v[156:159], v[60:63], v[100:103], v[156:159]
    buffer_load_dwordx4 v[88:91], v1, s[80:83], s48 offen offset:2048 sc1
    v_mfma_f32_16x16x32_bf16 v[152:155], v[56:59], v[100:103], v[152:155]
    v_mfma_f32_16x16x32_bf16 v[148:151], v[52:55], v[100:103], v[148:151]
    buffer_load_dwordx4 v[92:95], v1, s[80:83], s48 offen offset:3072 sc1
    v_mfma_f32_16x16x32_bf16 v[144:147], v[48:51], v[100:103], v[144:147]
    ds_read_b128 v[100:103], v3 offset:34816
    s_waitcnt lgkmcnt(7)
    v_mfma_f32_16x16x32_bf16 v[160:163], v[48:51], v[104:107], v[160:163]
    v_mfma_f32_16x16x32_bf16 v[164:167], v[52:55], v[104:107], v[164:167]
    v_mfma_f32_16x16x32_bf16 v[168:171], v[56:59], v[104:107], v[168:171]
    v_mfma_f32_16x16x32_bf16 v[172:175], v[60:63], v[104:107], v[172:175]
    ds_read_b128 v[104:107], v3 offset:36864
    s_waitcnt lgkmcnt(7)
    v_mfma_f32_16x16x32_bf16 v[188:191], v[60:63], v[108:111], v[188:191]
    v_mfma_f32_16x16x32_bf16 v[184:187], v[56:59], v[108:111], v[184:187]
    v_mfma_f32_16x16x32_bf16 v[180:183], v[52:55], v[108:111], v[180:183]
    v_mfma_f32_16x16x32_bf16 v[176:179], v[48:51], v[108:111], v[176:179]
    ds_read_b128 v[108:111], v3 offset:38912
    s_waitcnt lgkmcnt(7)
    v_mfma_f32_16x16x32_bf16 v[192:195], v[48:51], v[112:115], v[192:195]
    v_mfma_f32_16x16x32_bf16 v[196:199], v[52:55], v[112:115], v[196:199]
    v_mfma_f32_16x16x32_bf16 v[200:203], v[56:59], v[112:115], v[200:203]
    v_mfma_f32_16x16x32_bf16 v[204:207], v[60:63], v[112:115], v[204:207]
    ds_read_b128 v[112:115], v3 offset:40960
    ds_read_b32 v10, v9
    s_waitcnt lgkmcnt(8)
    v_mfma_f32_16x16x32_bf16 v[220:223], v[60:63], v[116:119], v[220:223]
    v_mfma_f32_16x16x32_bf16 v[216:219], v[56:59], v[116:119], v[216:219]
    v_mfma_f32_16x16x32_bf16 v[212:215], v[52:55], v[116:119], v[212:215]
    v_mfma_f32_16x16x32_bf16 v[208:211], v[48:51], v[116:119], v[208:211]
    ds_read_b128 v[116:119], v3 offset:43008
    s_waitcnt lgkmcnt(8)
    v_mfma_f32_16x16x32_bf16 v[224:227], v[48:51], v[120:123], v[224:227]
    v_mfma_f32_16x16x32_bf16 v[228:231], v[52:55], v[120:123], v[228:231]
    v_mfma_f32_16x16x32_bf16 v[232:235], v[56:59], v[120:123], v[232:235]
    v_mfma_f32_16x16x32_bf16 v[236:239], v[60:63], v[120:123], v[236:239]
    ds_read_b128 v[120:123], v3 offset:45056
    s_waitcnt lgkmcnt(8)
    v_mfma_f32_16x16x32_bf16 v[252:255], v[60:63], v[124:127], v[252:255]
    v_mfma_f32_16x16x32_bf16 v[248:251], v[56:59], v[124:127], v[248:251]
    v_mfma_f32_16x16x32_bf16 v[244:247], v[52:55], v[124:127], v[244:247]
    v_mfma_f32_16x16x32_bf16 v[240:243], v[48:51], v[124:127], v[240:243]
    ds_read_b128 v[124:127], v3 offset:47104
    ds_add_u32 v7, v8 offset:16
    s_waitcnt vmcnt(15) lgkmcnt(9)
    v_mfma_f32_16x16x32_bf16 v[128:131], v[16:19], v[96:99], v[128:131]
    s_add_u32 s48, s49, 1130496
    buffer_load_dwordx4 v[48:51], v1, s[80:83], s48 offen sc1
    s_waitcnt vmcnt(15)
    v_mfma_f32_16x16x32_bf16 v[132:135], v[20:23], v[96:99], v[132:135]
    s_waitcnt lgkmcnt(4)
    v_cmp_gt_u32 vcc, 34, v10
    s_waitcnt vmcnt(14)
    v_mfma_f32_16x16x32_bf16 v[136:139], v[24:27], v[96:99], v[136:139]
    s_cbranch_vccnz L_gs35
L_gb35:
    buffer_load_dwordx4 v[52:55], v1, s[80:83], s48 offen offset:1024 sc1
    s_waitcnt vmcnt(14)
    v_mfma_f32_16x16x32_bf16 v[140:143], v[28:31], v[96:99], v[140:143]
    ds_read_b128 v[96:99], v2 offset:49152
    v_mfma_f32_16x16x32_bf16 v[156:159], v[28:31], v[100:103], v[156:159]
    buffer_load_dwordx4 v[56:59], v1, s[80:83], s48 offen offset:2048 sc1
    v_mfma_f32_16x16x32_bf16 v[152:155], v[24:27], v[100:103], v[152:155]
    v_mfma_f32_16x16x32_bf16 v[148:151], v[20:23], v[100:103], v[148:151]
    buffer_load_dwordx4 v[60:63], v1, s[80:83], s48 offen offset:3072 sc1
    v_mfma_f32_16x16x32_bf16 v[144:147], v[16:19], v[100:103], v[144:147]
    ds_read_b128 v[100:103], v2 offset:51200
    v_mfma_f32_16x16x32_bf16 v[160:163], v[16:19], v[104:107], v[160:163]
    v_mfma_f32_16x16x32_bf16 v[164:167], v[20:23], v[104:107], v[164:167]
    v_mfma_f32_16x16x32_bf16 v[168:171], v[24:27], v[104:107], v[168:171]
    v_mfma_f32_16x16x32_bf16 v[172:175], v[28:31], v[104:107], v[172:175]
    ds_read_b128 v[104:107], v2 offset:53248
    v_mfma_f32_16x16x32_bf16 v[188:191], v[28:31], v[108:111], v[188:191]
    v_mfma_f32_16x16x32_bf16 v[184:187], v[24:27], v[108:111], v[184:187]
    v_mfma_f32_16x16x32_bf16 v[180:183], v[20:23], v[108:111], v[180:183]
    v_mfma_f32_16x16x32_bf16 v[176:179], v[16:19], v[108:111], v[176:179]
    ds_read_b128 v[108:111], v2 offset:55296
    v_mfma_f32_16x16x32_bf16 v[192:195], v[16:19], v[112:115], v[192:195]
    v_mfma_f32_16x16x32_bf16 v[196:199], v[20:23], v[112:115], v[196:199]
    v_mfma_f32_16x16x32_bf16 v[200:203], v[24:27], v[112:115], v[200:203]
    v_mfma_f32_16x16x32_bf16 v[204:207], v[28:31], v[112:115], v[204:207]
    ds_read_b128 v[112:115], v2 offset:57344
    s_waitcnt lgkmcnt(8)
    v_mfma_f32_16x16x32_bf16 v[220:223], v[28:31], v[116:119], v[220:223]
    v_mfma_f32_16x16x32_bf16 v[216:219], v[24:27], v[116:119], v[216:219]
    v_mfma_f32_16x16x32_bf16 v[212:215], v[20:23], v[116:119], v[212:215]
    v_mfma_f32_16x16x32_bf16 v[208:211], v[16:19], v[116:119], v[208:211]
    ds_read_b128 v[116:119], v2 offset:59392
    s_waitcnt lgkmcnt(8)
    v_mfma_f32_16x16x32_bf16 v[224:227], v[16:19], v[120:123], v[224:227]
    v_mfma_f32_16x16x32_bf16 v[228:231], v[20:23], v[120:123], v[228:231]
    v_mfma_f32_16x16x32_bf16 v[232:235], v[24:27], v[120:123], v[232:235]
    v_mfma_f32_16x16x32_bf16 v[236:239], v[28:31], v[120:123], v[236:239]
    ds_read_b128 v[120:123], v2 offset:61440
    s_waitcnt lgkmcnt(8)
    v_mfma_f32_16x16x32_bf16 v[252:255], v[28:31], v[124:127], v[252:255]
    v_mfma_f32_16x16x32_bf16 v[248:251], v[24:27], v[124:127], v[248:251]
    v_mfma_f32_16x16x32_bf16 v[244:247], v[20:23], v[124:127], v[244:247]
    v_mfma_f32_16x16x32_bf16 v[240:243], v[16:19], v[124:127], v[240:243]
    ds_read_b128 v[124:127], v2 offset:63488
    s_waitcnt vmcnt(15) lgkmcnt(7)
    v_mfma_f32_16x16x32_bf16 v[128:131], v[32:35], v[96:99], v[128:131]
    s_add_u32 s48, s49, 1146880
    buffer_load_dwordx4 v[16:19], v1, s[80:83], s48 offen sc1
    s_waitcnt vmcnt(15)
    v_mfma_f32_16x16x32_bf16 v[132:135], v[36:39], v[96:99], v[132:135]
    s_waitcnt vmcnt(14)
    v_mfma_f32_16x16x32_bf16 v[136:139], v[40:43], v[96:99], v[136:139]
    buffer_load_dwordx4 v[20:23], v1, s[80:83], s48 offen offset:1024 sc1
    s_waitcnt vmcnt(14)
    v_mfma_f32_16x16x32_bf16 v[140:143], v[44:47], v[96:99], v[140:143]
    ds_read_b128 v[96:99], v3 offset:49152
    s_waitcnt lgkmcnt(7)
    v_mfma_f32_16x16x32_bf16 v[156:159], v[44:47], v[100:103], v[156:159]
    buffer_load_dwordx4 v[24:27], v1, s[80:83], s48 offen offset:2048 sc1
    v_mfma_f32_16x16x32_bf16 v[152:155], v[40:43], v[100:103], v[152:155]
    v_mfma_f32_16x16x32_bf16 v[148:151], v[36:39], v[100:103], v[148:151]
    buffer_load_dwordx4 v[28:31], v1, s[80:83], s48 offen offset:3072 sc1
    v_mfma_f32_16x16x32_bf16 v[144:147], v[32:35], v[100:103], v[144:147]
    ds_read_b128 v[100:103], v3 offset:51200
    s_waitcnt lgkmcnt(7)
    v_mfma_f32_16x16x32_bf16 v[160:163], v[32:35], v[104:107], v[160:163]
    v_mfma_f32_16x16x32_bf16 v[164:167], v[36:39], v[104:107], v[164:167]
    v_mfma_f32_16x16x32_bf16 v[168:171], v[40:43], v[104:107], v[168:171]
    v_mfma_f32_16x16x32_bf16 v[172:175], v[44:47], v[104:107], v[172:175]
    ds_read_b128 v[104:107], v3 offset:53248
    s_waitcnt lgkmcnt(7)
    v_mfma_f32_16x16x32_bf16 v[188:191], v[44:47], v[108:111], v[188:191]
    v_mfma_f32_16x16x32_bf16 v[184:187], v[40:43], v[108:111], v[184:187]
    v_mfma_f32_16x16x32_bf16 v[180:183], v[36:39], v[108:111], v[180:183]
    v_mfma_f32_16x16x32_bf16 v[176:179], v[32:35], v[108:111], v[176:179]
    ds_read_b128 v[108:111], v3 offset:55296
    s_waitcnt lgkmcnt(7)
    v_mfma_f32_16x16x32_bf16 v[192:195], v[32:35], v[112:115], v[192:195]
    v_mfma_f32_16x16x32_bf16 v[196:199], v[36:39], v[112:115], v[196:199]
    v_mfma_f32_16x16x32_bf16 v[200:203], v[40:43], v[112:115], v[200:203]
    v_mfma_f32_16x16x32_bf16 v[204:207], v[44:47], v[112:115], v[204:207]
    ds_read_b128 v[112:115], v3 offset:57344
    ds_read_b32 v10, v9
    s_waitcnt lgkmcnt(8)
    v_mfma_f32_16x16x32_bf16 v[220:223], v[44:47], v[116:119], v[220:223]
    v_mfma_f32_16x16x32_bf16 v[216:219], v[40:43], v[116:119], v[216:219]
    v_mfma_f32_16x16x32_bf16 v[212:215], v[36:39], v[116:119], v[212:215]
    v_mfma_f32_16x16x32_bf16 v[208:211], v[32:35], v[116:119], v[208:211]
    ds_read_b128 v[116:119], v3 offset:59392
    s_waitcnt lgkmcnt(8)
    v_mfma_f32_16x16x32_bf16 v[224:227], v[32:35], v[120:123], v[224:227]
    v_mfma_f32_16x16x32_bf16 v[228:231], v[36:39], v[120:123], v[228:231]
    v_mfma_f32_16x16x32_bf16 v[232:235], v[40:43], v[120:123], v[232:235]
    v_mfma_f32_16x16x32_bf16 v[236:239], v[44:47], v[120:123], v[236:239]
    ds_read_b128 v[120:123], v3 offset:61440
    s_waitcnt lgkmcnt(8)
    v_mfma_f32_16x16x32_bf16 v[252:255], v[44:47], v[124:127], v[252:255]
    v_mfma_f32_16x16x32_bf16 v[248:251], v[40:43], v[124:127], v[248:251]
    v_mfma_f32_16x16x32_bf16 v[244:247], v[36:39], v[124:127], v[244:247]
    v_mfma_f32_16x16x32_bf16 v[240:243], v[32:35], v[124:127], v[240:243]
    ds_read_b128 v[124:127], v3 offset:63488
    ds_add_u32 v7, v8 offset:16
    s_waitcnt vmcnt(15) lgkmcnt(9)
    v_mfma_f32_16x16x32_bf16 v[128:131], v[64:67], v[96:99], v[128:131]
    s_add_u32 s48, s49, 1163264
    buffer_load_dwordx4 v[32:35], v1, s[80:83], s48 offen sc1
    s_waitcnt vmcnt(15)
    v_mfma_f32_16x16x32_bf16 v[132:135], v[68:71], v[96:99], v[132:135]
    s_waitcnt lgkmcnt(4)
    v_cmp_gt_u32 vcc, 35, v10
    s_waitcnt vmcnt(14)
    v_mfma_f32_16x16x32_bf16 v[136:139], v[72:75], v[96:99], v[136:139]
    s_cbranch_vccnz L_gs36
L_gb36:
    buffer_load_dwordx4 v[36:39], v1, s[80:83], s48 offen offset:1024 sc1
    s_waitcnt vmcnt(14)
    v_mfma_f32_16x16x32_bf16 v[140:143], v[76:79], v[96:99], v[140:143]
    ds_read_b128 v[96:99], v4 offset:0
    v_mfma_f32_16x16x32_bf16 v[156:159], v[76:79], v[100:103], v[156:159]
    buffer_load_dwordx4 v[40:43], v1, s[80:83], s48 offen offset:2048 sc1
    v_mfma_f32_16x16x32_bf16 v[152:155], v[72:75], v[100:103], v[152:155]
    v_mfma_f32_16x16x32_bf16 v[148:151], v[68:71], v[100:103], v[148:151]
    buffer_load_dwordx4 v[44:47], v1, s[80:83], s48 offen offset:3072 sc1
    v_mfma_f32_16x16x32_bf16 v[144:147], v[64:67], v[100:103], v[144:147]
    ds_read_b128 v[100:103], v4 offset:2048
    v_mfma_f32_16x16x32_bf16 v[160:163], v[64:67], v[104:107], v[160:163]
    v_mfma_f32_16x16x32_bf16 v[164:167], v[68:71], v[104:107], v[164:167]
    v_mfma_f32_16x16x32_bf16 v[168:171], v[72:75], v[104:107], v[168:171]
    v_mfma_f32_16x16x32_bf16 v[172:175], v[76:79], v[104:107], v[172:175]
    ds_read_b128 v[104:107], v4 offset:4096
    v_mfma_f32_16x16x32_bf16 v[188:191], v[76:79], v[108:111], v[188:191]
    v_mfma_f32_16x16x32_bf16 v[184:187], v[72:75], v[108:111], v[184:187]
    v_mfma_f32_16x16x32_bf16 v[180:183], v[68:71], v[108:111], v[180:183]
    v_mfma_f32_16x16x32_bf16 v[176:179], v[64:67], v[108:111], v[176:179]
    ds_read_b128 v[108:111], v4 offset:6144
    v_mfma_f32_16x16x32_bf16 v[192:195], v[64:67], v[112:115], v[192:195]
    v_mfma_f32_16x16x32_bf16 v[196:199], v[68:71], v[112:115], v[196:199]
    v_mfma_f32_16x16x32_bf16 v[200:203], v[72:75], v[112:115], v[200:203]
    v_mfma_f32_16x16x32_bf16 v[204:207], v[76:79], v[112:115], v[204:207]
    ds_read_b128 v[112:115], v4 offset:8192
    s_waitcnt lgkmcnt(8)
    v_mfma_f32_16x16x32_bf16 v[220:223], v[76:79], v[116:119], v[220:223]
    v_mfma_f32_16x16x32_bf16 v[216:219], v[72:75], v[116:119], v[216:219]
    v_mfma_f32_16x16x32_bf16 v[212:215], v[68:71], v[116:119], v[212:215]
    v_mfma_f32_16x16x32_bf16 v[208:211], v[64:67], v[116:119], v[208:211]
    ds_read_b128 v[116:119], v4 offset:10240
    s_waitcnt lgkmcnt(8)
    v_mfma_f32_16x16x32_bf16 v[224:227], v[64:67], v[120:123], v[224:227]
    v_mfma_f32_16x16x32_bf16 v[228:231], v[68:71], v[120:123], v[228:231]
    v_mfma_f32_16x16x32_bf16 v[232:235], v[72:75], v[120:123], v[232:235]
    v_mfma_f32_16x16x32_bf16 v[236:239], v[76:79], v[120:123], v[236:239]
    ds_read_b128 v[120:123], v4 offset:12288
    s_waitcnt lgkmcnt(8)
    v_mfma_f32_16x16x32_bf16 v[252:255], v[76:79], v[124:127], v[252:255]
    v_mfma_f32_16x16x32_bf16 v[248:251], v[72:75], v[124:127], v[248:251]
    v_mfma_f32_16x16x32_bf16 v[244:247], v[68:71], v[124:127], v[244:247]
    v_mfma_f32_16x16x32_bf16 v[240:243], v[64:67], v[124:127], v[240:243]
    ds_read_b128 v[124:127], v4 offset:14336
    s_waitcnt vmcnt(15) lgkmcnt(7)
    v_mfma_f32_16x16x32_bf16 v[128:131], v[80:83], v[96:99], v[128:131]
    s_add_u32 s48, s49, 1179648
    buffer_load_dwordx4 v[64:67], v1, s[80:83], s48 offen sc1
    s_waitcnt vmcnt(15)
    v_mfma_f32_16x16x32_bf16 v[132:135], v[84:87], v[96:99], v[132:135]
    s_waitcnt vmcnt(14)
    v_mfma_f32_16x16x32_bf16 v[136:139], v[88:91], v[96:99], v[136:139]
    buffer_load_dwordx4 v[68:71], v1, s[80:83], s48 offen offset:1024 sc1
    s_waitcnt vmcnt(14)
    v_mfma_f32_16x16x32_bf16 v[140:143], v[92:95], v[96:99], v[140:143]
    ds_read_b128 v[96:99], v5 offset:0
    s_waitcnt lgkmcnt(7)
    v_mfma_f32_16x16x32_bf16 v[156:159], v[92:95], v[100:103], v[156:159]
    buffer_load_dwordx4 v[72:75], v1, s[80:83], s48 offen offset:2048 sc1
    v_mfma_f32_16x16x32_bf16 v[152:155], v[88:91], v[100:103], v[152:155]
    v_mfma_f32_16x16x32_bf16 v[148:151], v[84:87], v[100:103], v[148:151]
    buffer_load_dwordx4 v[76:79], v1, s[80:83], s48 offen offset:3072 sc1
    v_mfma_f32_16x16x32_bf16 v[144:147], v[80:83], v[100:103], v[144:147]
    ds_read_b128 v[100:103], v5 offset:2048
    s_waitcnt lgkmcnt(7)
    v_mfma_f32_16x16x32_bf16 v[160:163], v[80:83], v[104:107], v[160:163]
    v_mfma_f32_16x16x32_bf16 v[164:167], v[84:87], v[104:107], v[164:167]
    v_mfma_f32_16x16x32_bf16 v[168:171], v[88:91], v[104:107], v[168:171]
    v_mfma_f32_16x16x32_bf16 v[172:175], v[92:95], v[104:107], v[172:175]
    ds_read_b128 v[104:107], v5 offset:4096
    s_waitcnt lgkmcnt(7)
    v_mfma_f32_16x16x32_bf16 v[188:191], v[92:95], v[108:111], v[188:191]
    v_mfma_f32_16x16x32_bf16 v[184:187], v[88:91], v[108:111], v[184:187]
    v_mfma_f32_16x16x32_bf16 v[180:183], v[84:87], v[108:111], v[180:183]
    v_mfma_f32_16x16x32_bf16 v[176:179], v[80:83], v[108:111], v[176:179]
    ds_read_b128 v[108:111], v5 offset:6144
    s_waitcnt lgkmcnt(7)
    v_mfma_f32_16x16x32_bf16 v[192:195], v[80:83], v[112:115], v[192:195]
    v_mfma_f32_16x16x32_bf16 v[196:199], v[84:87], v[112:115], v[196:199]
    v_mfma_f32_16x16x32_bf16 v[200:203], v[88:91], v[112:115], v[200:203]
    v_mfma_f32_16x16x32_bf16 v[204:207], v[92:95], v[112:115], v[204:207]
    ds_read_b128 v[112:115], v5 offset:8192
    ds_read_b32 v10, v9
    s_waitcnt lgkmcnt(8)
    v_mfma_f32_16x16x32_bf16 v[220:223], v[92:95], v[116:119], v[220:223]
    v_mfma_f32_16x16x32_bf16 v[216:219], v[88:91], v[116:119], v[216:219]
    v_mfma_f32_16x16x32_bf16 v[212:215], v[84:87], v[116:119], v[212:215]
    v_mfma_f32_16x16x32_bf16 v[208:211], v[80:83], v[116:119], v[208:211]
    ds_read_b128 v[116:119], v5 offset:10240
    s_waitcnt lgkmcnt(8)
    v_mfma_f32_16x16x32_bf16 v[224:227], v[80:83], v[120:123], v[224:227]
    v_mfma_f32_16x16x32_bf16 v[228:231], v[84:87], v[120:123], v[228:231]
    v_mfma_f32_16x16x32_bf16 v[232:235], v[88:91], v[120:123], v[232:235]
    v_mfma_f32_16x16x32_bf16 v[236:239], v[92:95], v[120:123], v[236:239]
    ds_read_b128 v[120:123], v5 offset:12288
    s_waitcnt lgkmcnt(8)
    v_mfma_f32_16x16x32_bf16 v[252:255], v[92:95], v[124:127], v[252:255]
    v_mfma_f32_16x16x32_bf16 v[248:251], v[88:91], v[124:127], v[248:251]
    v_mfma_f32_16x16x32_bf16 v[244:247], v[84:87], v[124:127], v[244:247]
    v_mfma_f32_16x16x32_bf16 v[240:243], v[80:83], v[124:127], v[240:243]
    ds_read_b128 v[124:127], v5 offset:14336
    ds_add_u32 v7, v8 offset:16
    s_waitcnt vmcnt(15) lgkmcnt(9)
    v_mfma_f32_16x16x32_bf16 v[128:131], v[48:51], v[96:99], v[128:131]
    s_add_u32 s48, s49, 1196032
    buffer_load_dwordx4 v[80:83], v1, s[80:83], s48 offen sc1
    s_waitcnt vmcnt(15)
    v_mfma_f32_16x16x32_bf16 v[132:135], v[52:55], v[96:99], v[132:135]
    s_waitcnt lgkmcnt(4)
    v_cmp_gt_u32 vcc, 36, v10
    s_waitcnt vmcnt(14)
    v_mfma_f32_16x16x32_bf16 v[136:139], v[56:59], v[96:99], v[136:139]
    s_cbranch_vccnz L_gs37
L_gb37:
    buffer_load_dwordx4 v[84:87], v1, s[80:83], s48 offen offset:1024 sc1
    s_waitcnt vmcnt(14)
    v_mfma_f32_16x16x32_bf16 v[140:143], v[60:63], v[96:99], v[140:143]
    ds_read_b128 v[96:99], v2 offset:0
    v_mfma_f32_16x16x32_bf16 v[156:159], v[60:63], v[100:103], v[156:159]
    buffer_load_dwordx4 v[88:91], v1, s[80:83], s48 offen offset:2048 sc1
    v_mfma_f32_16x16x32_bf16 v[152:155], v[56:59], v[100:103], v[152:155]
    v_mfma_f32_16x16x32_bf16 v[148:151], v[52:55], v[100:103], v[148:151]
    buffer_load_dwordx4 v[92:95], v1, s[80:83], s48 offen offset:3072 sc1
    v_mfma_f32_16x16x32_bf16 v[144:147], v[48:51], v[100:103], v[144:147]
    ds_read_b128 v[100:103], v2 offset:2048
    v_mfma_f32_16x16x32_bf16 v[160:163], v[48:51], v[104:107], v[160:163]
    v_mfma_f32_16x16x32_bf16 v[164:167], v[52:55], v[104:107], v[164:167]
    v_mfma_f32_16x16x32_bf16 v[168:171], v[56:59], v[104:107], v[168:171]
    v_mfma_f32_16x16x32_bf16 v[172:175], v[60:63], v[104:107], v[172:175]
    ds_read_b128 v[104:107], v2 offset:4096
    v_mfma_f32_16x16x32_bf16 v[188:191], v[60:63], v[108:111], v[188:191]
    v_mfma_f32_16x16x32_bf16 v[184:187], v[56:59], v[108:111], v[184:187]
    v_mfma_f32_16x16x32_bf16 v[180:183], v[52:55], v[108:111], v[180:183]
    v_mfma_f32_16x16x32_bf16 v[176:179], v[48:51], v[108:111], v[176:179]
    ds_read_b128 v[108:111], v2 offset:6144
    v_mfma_f32_16x16x32_bf16 v[192:195], v[48:51], v[112:115], v[192:195]
    v_mfma_f32_16x16x32_bf16 v[196:199], v[52:55], v[112:115], v[196:199]
    v_mfma_f32_16x16x32_bf16 v[200:203], v[56:59], v[112:115], v[200:203]
    v_mfma_f32_16x16x32_bf16 v[204:207], v[60:63], v[112:115], v[204:207]
    ds_read_b128 v[112:115], v2 offset:8192
    s_waitcnt lgkmcnt(8)
    v_mfma_f32_16x16x32_bf16 v[220:223], v[60:63], v[116:119], v[220:223]
    v_mfma_f32_16x16x32_bf16 v[216:219], v[56:59], v[116:119], v[216:219]
    v_mfma_f32_16x16x32_bf16 v[212:215], v[52:55], v[116:119], v[212:215]
    v_mfma_f32_16x16x32_bf16 v[208:211], v[48:51], v[116:119], v[208:211]
    ds_read_b128 v[116:119], v2 offset:10240
    s_waitcnt lgkmcnt(8)
    v_mfma_f32_16x16x32_bf16 v[224:227], v[48:51], v[120:123], v[224:227]
    v_mfma_f32_16x16x32_bf16 v[228:231], v[52:55], v[120:123], v[228:231]
    v_mfma_f32_16x16x32_bf16 v[232:235], v[56:59], v[120:123], v[232:235]
    v_mfma_f32_16x16x32_bf16 v[236:239], v[60:63], v[120:123], v[236:239]
    ds_read_b128 v[120:123], v2 offset:12288
    s_waitcnt lgkmcnt(8)
    v_mfma_f32_16x16x32_bf16 v[252:255], v[60:63], v[124:127], v[252:255]
    v_mfma_f32_16x16x32_bf16 v[248:251], v[56:59], v[124:127], v[248:251]
    v_mfma_f32_16x16x32_bf16 v[244:247], v[52:55], v[124:127], v[244:247]
    v_mfma_f32_16x16x32_bf16 v[240:243], v[48:51], v[124:127], v[240:243]
    ds_read_b128 v[124:127], v2 offset:14336
    s_waitcnt vmcnt(15) lgkmcnt(7)
    v_mfma_f32_16x16x32_bf16 v[128:131], v[16:19], v[96:99], v[128:131]
    s_add_u32 s48, s49, 1212416
    buffer_load_dwordx4 v[48:51], v1, s[80:83], s48 offen sc1
    s_waitcnt vmcnt(15)
    v_mfma_f32_16x16x32_bf16 v[132:135], v[20:23], v[96:99], v[132:135]
    s_waitcnt vmcnt(14)
    v_mfma_f32_16x16x32_bf16 v[136:139], v[24:27], v[96:99], v[136:139]
    buffer_load_dwordx4 v[52:55], v1, s[80:83], s48 offen offset:1024 sc1
    s_waitcnt vmcnt(14)
    v_mfma_f32_16x16x32_bf16 v[140:143], v[28:31], v[96:99], v[140:143]
    ds_read_b128 v[96:99], v3 offset:0
    s_waitcnt lgkmcnt(7)
    v_mfma_f32_16x16x32_bf16 v[156:159], v[28:31], v[100:103], v[156:159]
    buffer_load_dwordx4 v[56:59], v1, s[80:83], s48 offen offset:2048 sc1
    v_mfma_f32_16x16x32_bf16 v[152:155], v[24:27], v[100:103], v[152:155]
    v_mfma_f32_16x16x32_bf16 v[148:151], v[20:23], v[100:103], v[148:151]
    buffer_load_dwordx4 v[60:63], v1, s[80:83], s48 offen offset:3072 sc1
    v_mfma_f32_16x16x32_bf16 v[144:147], v[16:19], v[100:103], v[144:147]
    ds_read_b128 v[100:103], v3 offset:2048
    s_waitcnt lgkmcnt(7)
    v_mfma_f32_16x16x32_bf16 v[160:163], v[16:19], v[104:107], v[160:163]
    v_mfma_f32_16x16x32_bf16 v[164:167], v[20:23], v[104:107], v[164:167]
    v_mfma_f32_16x16x32_bf16 v[168:171], v[24:27], v[104:107], v[168:171]
    v_mfma_f32_16x16x32_bf16 v[172:175], v[28:31], v[104:107], v[172:175]
    ds_read_b128 v[104:107], v3 offset:4096
    s_waitcnt lgkmcnt(7)
    v_mfma_f32_16x16x32_bf16 v[188:191], v[28:31], v[108:111], v[188:191]
    v_mfma_f32_16x16x32_bf16 v[184:187], v[24:27], v[108:111], v[184:187]
    v_mfma_f32_16x16x32_bf16 v[180:183], v[20:23], v[108:111], v[180:183]
    v_mfma_f32_16x16x32_bf16 v[176:179], v[16:19], v[108:111], v[176:179]
    ds_read_b128 v[108:111], v3 offset:6144
    s_waitcnt lgkmcnt(7)
    v_mfma_f32_16x16x32_bf16 v[192:195], v[16:19], v[112:115], v[192:195]
    v_mfma_f32_16x16x32_bf16 v[196:199], v[20:23], v[112:115], v[196:199]
    v_mfma_f32_16x16x32_bf16 v[200:203], v[24:27], v[112:115], v[200:203]
    v_mfma_f32_16x16x32_bf16 v[204:207], v[28:31], v[112:115], v[204:207]
    ds_read_b128 v[112:115], v3 offset:8192
    ds_read_b32 v10, v9
    s_waitcnt lgkmcnt(8)
    v_mfma_f32_16x16x32_bf16 v[220:223], v[28:31], v[116:119], v[220:223]
    v_mfma_f32_16x16x32_bf16 v[216:219], v[24:27], v[116:119], v[216:219]
    v_mfma_f32_16x16x32_bf16 v[212:215], v[20:23], v[116:119], v[212:215]
    v_mfma_f32_16x16x32_bf16 v[208:211], v[16:19], v[116:119], v[208:211]
    ds_read_b128 v[116:119], v3 offset:10240
    s_waitcnt lgkmcnt(8)
    v_mfma_f32_16x16x32_bf16 v[224:227], v[16:19], v[120:123], v[224:227]
    v_mfma_f32_16x16x32_bf16 v[228:231], v[20:23], v[120:123], v[228:231]
    v_mfma_f32_16x16x32_bf16 v[232:235], v[24:27], v[120:123], v[232:235]
    v_mfma_f32_16x16x32_bf16 v[236:239], v[28:31], v[120:123], v[236:239]
    ds_read_b128 v[120:123], v3 offset:12288
    s_waitcnt lgkmcnt(8)
    v_mfma_f32_16x16x32_bf16 v[252:255], v[28:31], v[124:127], v[252:255]
    v_mfma_f32_16x16x32_bf16 v[248:251], v[24:27], v[124:127], v[248:251]
    v_mfma_f32_16x16x32_bf16 v[244:247], v[20:23], v[124:127], v[244:247]
    v_mfma_f32_16x16x32_bf16 v[240:243], v[16:19], v[124:127], v[240:243]
    ds_read_b128 v[124:127], v3 offset:14336
    ds_add_u32 v7, v8 offset:16
    s_waitcnt vmcnt(15) lgkmcnt(9)
    v_mfma_f32_16x16x32_bf16 v[128:131], v[32:35], v[96:99], v[128:131]
    s_add_u32 s48, s49, 1228800
    buffer_load_dwordx4 v[16:19], v1, s[80:83], s48 offen sc1
    s_waitcnt vmcnt(15)
    v_mfma_f32_16x16x32_bf16 v[132:135], v[36:39], v[96:99], v[132:135]
    s_waitcnt lgkmcnt(4)
    v_cmp_gt_u32 vcc, 37, v10
    s_waitcnt vmcnt(14)
    v_mfma_f32_16x16x32_bf16 v[136:139], v[40:43], v[96:99], v[136:139]
    s_cbranch_vccnz L_gs38
L_gb38:
    buffer_load_dwordx4 v[20:23], v1, s[80:83], s48 offen offset:1024 sc1
    s_waitcnt vmcnt(14)
    v_mfma_f32_16x16x32_bf16 v[140:143], v[44:47], v[96:99], v[140:143]
    ds_read_b128 v[96:99], v2 offset:16384
    v_mfma_f32_16x16x32_bf16 v[156:159], v[44:47], v[100:103], v[156:159]
    buffer_load_dwordx4 v[24:27], v1, s[80:83], s48 offen offset:2048 sc1
    v_mfma_f32_16x16x32_bf16 v[152:155], v[40:43], v[100:103], v[152:155]
    v_mfma_f32_16x16x32_bf16 v[148:151], v[36:39], v[100:103], v[148:151]
    buffer_load_dwordx4 v[28:31], v1, s[80:83], s48 offen offset:3072 sc1
    v_mfma_f32_16x16x32_bf16 v[144:147], v[32:35], v[100:103], v[144:147]
    ds_read_b128 v[100:103], v2 offset:18432
    v_mfma_f32_16x16x32_bf16 v[160:163], v[32:35], v[104:107], v[160:163]
    v_mfma_f32_16x16x32_bf16 v[164:167], v[36:39], v[104:107], v[164:167]
    v_mfma_f32_16x16x32_bf16 v[168:171], v[40:43], v[104:107], v[168:171]
    v_mfma_f32_16x16x32_bf16 v[172:175], v[44:47], v[104:107], v[172:175]
    ds_read_b128 v[104:107], v2 offset:20480
    v_mfma_f32_16x16x32_bf16 v[188:191], v[44:47], v[108:111], v[188:191]
    v_mfma_f32_16x16x32_bf16 v[184:187], v[40:43], v[108:111], v[184:187]
    v_mfma_f32_16x16x32_bf16 v[180:183], v[36:39], v[108:111], v[180:183]
    v_mfma_f32_16x16x32_bf16 v[176:179], v[32:35], v[108:111], v[176:179]
    ds_read_b128 v[108:111], v2 offset:22528
    v_mfma_f32_16x16x32_bf16 v[192:195], v[32:35], v[112:115], v[192:195]
    v_mfma_f32_16x16x32_bf16 v[196:199], v[36:39], v[112:115], v[196:199]
    v_mfma_f32_16x16x32_bf16 v[200:203], v[40:43], v[112:115], v[200:203]
    v_mfma_f32_16x16x32_bf16 v[204:207], v[44:47], v[112:115], v[204:207]
    ds_read_b128 v[112:115], v2 offset:24576
    s_waitcnt lgkmcnt(8)
    v_mfma_f32_16x16x32_bf16 v[220:223], v[44:47], v[116:119], v[220:223]
    v_mfma_f32_16x16x32_bf16 v[216:219], v[40:43], v[116:119], v[216:219]
    v_mfma_f32_16x16x32_bf16 v[212:215], v[36:39], v[116:119], v[212:215]
    v_mfma_f32_16x16x32_bf16 v[208:211], v[32:35], v[116:119], v[208:211]
    ds_read_b128 v[116:119], v2 offset:26624
    s_waitcnt lgkmcnt(8)
    v_mfma_f32_16x16x32_bf16 v[224:227], v[32:35], v[120:123], v[224:227]
    v_mfma_f32_16x16x32_bf16 v[228:231], v[36:39], v[120:123], v[228:231]
    v_mfma_f32_16x16x32_bf16 v[232:235], v[40:43], v[120:123], v[232:235]
    v_mfma_f32_16x16x32_bf16 v[236:239], v[44:47], v[120:123], v[236:239]
    ds_read_b128 v[120:123], v2 offset:28672
    s_waitcnt lgkmcnt(8)
    v_mfma_f32_16x16x32_bf16 v[252:255], v[44:47], v[124:127], v[252:255]
    v_mfma_f32_16x16x32_bf16 v[248:251], v[40:43], v[124:127], v[248:251]
    v_mfma_f32_16x16x32_bf16 v[244:247], v[36:39], v[124:127], v[244:247]
    v_mfma_f32_16x16x32_bf16 v[240:243], v[32:35], v[124:127], v[240:243]
    ds_read_b128 v[124:127], v2 offset:30720
    s_waitcnt vmcnt(15) lgkmcnt(7)
    v_mfma_f32_16x16x32_bf16 v[128:131], v[64:67], v[96:99], v[128:131]
    s_add_u32 s48, s49, 1245184
    buffer_load_dwordx4 v[32:35], v1, s[80:83], s48 offen sc1
    s_waitcnt vmcnt(15)
    v_mfma_f32_16x16x32_bf16 v[132:135], v[68:71], v[96:99], v[132:135]
    s_waitcnt vmcnt(14)
    v_mfma_f32_16x16x32_bf16 v[136:139], v[72:75], v[96:99], v[136:139]
    buffer_load_dwordx4 v[36:39], v1, s[80:83], s48 offen offset:1024 sc1
    s_waitcnt vmcnt(14)
    v_mfma_f32_16x16x32_bf16 v[140:143], v[76:79], v[96:99], v[140:143]
    ds_read_b128 v[96:99], v3 offset:16384
    s_waitcnt lgkmcnt(7)
    v_mfma_f32_16x16x32_bf16 v[156:159], v[76:79], v[100:103], v[156:159]
    buffer_load_dwordx4 v[40:43], v1, s[80:83], s48 offen offset:2048 sc1
    v_mfma_f32_16x16x32_bf16 v[152:155], v[72:75], v[100:103], v[152:155]
    v_mfma_f32_16x16x32_bf16 v[148:151], v[68:71], v[100:103], v[148:151]
    buffer_load_dwordx4 v[44:47], v1, s[80:83], s48 offen offset:3072 sc1
    v_mfma_f32_16x16x32_bf16 v[144:147], v[64:67], v[100:103], v[144:147]
    ds_read_b128 v[100:103], v3 offset:18432
    s_waitcnt lgkmcnt(7)
    v_mfma_f32_16x16x32_bf16 v[160:163], v[64:67], v[104:107], v[160:163]
    v_mfma_f32_16x16x32_bf16 v[164:167], v[68:71], v[104:107], v[164:167]
    v_mfma_f32_16x16x32_bf16 v[168:171], v[72:75], v[104:107], v[168:171]
    v_mfma_f32_16x16x32_bf16 v[172:175], v[76:79], v[104:107], v[172:175]
    ds_read_b128 v[104:107], v3 offset:20480
    s_waitcnt lgkmcnt(7)
    v_mfma_f32_16x16x32_bf16 v[188:191], v[76:79], v[108:111], v[188:191]
    v_mfma_f32_16x16x32_bf16 v[184:187], v[72:75], v[108:111], v[184:187]
    v_mfma_f32_16x16x32_bf16 v[180:183], v[68:71], v[108:111], v[180:183]
    v_mfma_f32_16x16x32_bf16 v[176:179], v[64:67], v[108:111], v[176:179]
    ds_read_b128 v[108:111], v3 offset:22528
    s_waitcnt lgkmcnt(7)
    v_mfma_f32_16x16x32_bf16 v[192:195], v[64:67], v[112:115], v[192:195]
    v_mfma_f32_16x16x32_bf16 v[196:199], v[68:71], v[112:115], v[196:199]
    v_mfma_f32_16x16x32_bf16 v[200:203], v[72:75], v[112:115], v[200:203]
    v_mfma_f32_16x16x32_bf16 v[204:207], v[76:79], v[112:115], v[204:207]
    ds_read_b128 v[112:115], v3 offset:24576
    ds_read_b32 v10, v9
    s_waitcnt lgkmcnt(8)
    v_mfma_f32_16x16x32_bf16 v[220:223], v[76:79], v[116:119], v[220:223]
    v_mfma_f32_16x16x32_bf16 v[216:219], v[72:75], v[116:119], v[216:219]
    v_mfma_f32_16x16x32_bf16 v[212:215], v[68:71], v[116:119], v[212:215]
    v_mfma_f32_16x16x32_bf16 v[208:211], v[64:67], v[116:119], v[208:211]
    ds_read_b128 v[116:119], v3 offset:26624
    s_waitcnt lgkmcnt(8)
    v_mfma_f32_16x16x32_bf16 v[224:227], v[64:67], v[120:123], v[224:227]
    v_mfma_f32_16x16x32_bf16 v[228:231], v[68:71], v[120:123], v[228:231]
    v_mfma_f32_16x16x32_bf16 v[232:235], v[72:75], v[120:123], v[232:235]
    v_mfma_f32_16x16x32_bf16 v[236:239], v[76:79], v[120:123], v[236:239]
    ds_read_b128 v[120:123], v3 offset:28672
    s_waitcnt lgkmcnt(8)
    v_mfma_f32_16x16x32_bf16 v[252:255], v[76:79], v[124:127], v[252:255]
    v_mfma_f32_16x16x32_bf16 v[248:251], v[72:75], v[124:127], v[248:251]
    v_mfma_f32_16x16x32_bf16 v[244:247], v[68:71], v[124:127], v[244:247]
    v_mfma_f32_16x16x32_bf16 v[240:243], v[64:67], v[124:127], v[240:243]
    ds_read_b128 v[124:127], v3 offset:30720
    ds_add_u32 v7, v8 offset:16
    s_waitcnt vmcnt(15) lgkmcnt(9)
    v_mfma_f32_16x16x32_bf16 v[128:131], v[80:83], v[96:99], v[128:131]
    s_add_u32 s48, s49, 1261568
    buffer_load_dwordx4 v[64:67], v1, s[80:83], s48 offen sc1
    s_waitcnt vmcnt(15)
    v_mfma_f32_16x16x32_bf16 v[132:135], v[84:87], v[96:99], v[132:135]
    s_waitcnt lgkmcnt(4)
    v_cmp_gt_u32 vcc, 38, v10
    s_waitcnt vmcnt(14)
    v_mfma_f32_16x16x32_bf16 v[136:139], v[88:91], v[96:99], v[136:139]
    s_cbranch_vccnz L_gs39
L_gb39:
    buffer_load_dwordx4 v[68:71], v1, s[80:83], s48 offen offset:1024 sc1
    s_waitcnt vmcnt(14)
    v_mfma_f32_16x16x32_bf16 v[140:143], v[92:95], v[96:99], v[140:143]
    ds_read_b128 v[96:99], v2 offset:32768
    v_mfma_f32_16x16x32_bf16 v[156:159], v[92:95], v[100:103], v[156:159]
    buffer_load_dwordx4 v[72:75], v1, s[80:83], s48 offen offset:2048 sc1
    v_mfma_f32_16x16x32_bf16 v[152:155], v[88:91], v[100:103], v[152:155]
    v_mfma_f32_16x16x32_bf16 v[148:151], v[84:87], v[100:103], v[148:151]
    buffer_load_dwordx4 v[76:79], v1, s[80:83], s48 offen offset:3072 sc1
    v_mfma_f32_16x16x32_bf16 v[144:147], v[80:83], v[100:103], v[144:147]
    ds_read_b128 v[100:103], v2 offset:34816
    v_mfma_f32_16x16x32_bf16 v[160:163], v[80:83], v[104:107], v[160:163]
    v_mfma_f32_16x16x32_bf16 v[164:167], v[84:87], v[104:107], v[164:167]
    v_mfma_f32_16x16x32_bf16 v[168:171], v[88:91], v[104:107], v[168:171]
    v_mfma_f32_16x16x32_bf16 v[172:175], v[92:95], v[104:107], v[172:175]
    ds_read_b128 v[104:107], v2 offset:36864
    v_mfma_f32_16x16x32_bf16 v[188:191], v[92:95], v[108:111], v[188:191]
    v_mfma_f32_16x16x32_bf16 v[184:187], v[88:91], v[108:111], v[184:187]
    v_mfma_f32_16x16x32_bf16 v[180:183], v[84:87], v[108:111], v[180:183]
    v_mfma_f32_16x16x32_bf16 v[176:179], v[80:83], v[108:111], v[176:179]
    ds_read_b128 v[108:111], v2 offset:38912
    v_mfma_f32_16x16x32_bf16 v[192:195], v[80:83], v[112:115], v[192:195]
    v_mfma_f32_16x16x32_bf16 v[196:199], v[84:87], v[112:115], v[196:199]
    v_mfma_f32_16x16x32_bf16 v[200:203], v[88:91], v[112:115], v[200:203]
    v_mfma_f32_16x16x32_bf16 v[204:207], v[92:95], v[112:115], v[204:207]
    ds_read_b128 v[112:115], v2 offset:40960
    s_waitcnt lgkmcnt(8)
    v_mfma_f32_16x16x32_bf16 v[220:223], v[92:95], v[116:119], v[220:223]
    v_mfma_f32_16x16x32_bf16 v[216:219], v[88:91], v[116:119], v[216:219]
    v_mfma_f32_16x16x32_bf16 v[212:215], v[84:87], v[116:119], v[212:215]
    v_mfma_f32_16x16x32_bf16 v[208:211], v[80:83], v[116:119], v[208:211]
    ds_read_b128 v[116:119], v2 offset:43008
    s_waitcnt lgkmcnt(8)
    v_mfma_f32_16x16x32_bf16 v[224:227], v[80:83], v[120:123], v[224:227]
    v_mfma_f32_16x16x32_bf16 v[228:231], v[84:87], v[120:123], v[228:231]
    v_mfma_f32_16x16x32_bf16 v[232:235], v[88:91], v[120:123], v[232:235]
    v_mfma_f32_16x16x32_bf16 v[236:239], v[92:95], v[120:123], v[236:239]
    ds_read_b128 v[120:123], v2 offset:45056
    s_waitcnt lgkmcnt(8)
    v_mfma_f32_16x16x32_bf16 v[252:255], v[92:95], v[124:127], v[252:255]
    v_mfma_f32_16x16x32_bf16 v[248:251], v[88:91], v[124:127], v[248:251]
    v_mfma_f32_16x16x32_bf16 v[244:247], v[84:87], v[124:127], v[244:247]
    v_mfma_f32_16x16x32_bf16 v[240:243], v[80:83], v[124:127], v[240:243]
    ds_read_b128 v[124:127], v2 offset:47104
    s_waitcnt vmcnt(15) lgkmcnt(7)
    v_mfma_f32_16x16x32_bf16 v[128:131], v[48:51], v[96:99], v[128:131]
    s_add_u32 s48, s49, 1277952
    buffer_load_dwordx4 v[80:83], v1, s[80:83], s48 offen sc1
    s_waitcnt vmcnt(15)
    v_mfma_f32_16x16x32_bf16 v[132:135], v[52:55], v[96:99], v[132:135]
    s_waitcnt vmcnt(14)
    v_mfma_f32_16x16x32_bf16 v[136:139], v[56:59], v[96:99], v[136:139]
    buffer_load_dwordx4 v[84:87], v1, s[80:83], s48 offen offset:1024 sc1
    s_waitcnt vmcnt(14)
    v_mfma_f32_16x16x32_bf16 v[140:143], v[60:63], v[96:99], v[140:143]
    ds_read_b128 v[96:99], v3 offset:32768
    s_waitcnt lgkmcnt(7)
    v_mfma_f32_16x16x32_bf16 v[156:159], v[60:63], v[100:103], v[156:159]
    buffer_load_dwordx4 v[88:91], v1, s[80:83], s48 offen offset:2048 sc1
    v_mfma_f32_16x16x32_bf16 v[152:155], v[56:59], v[100:103], v[152:155]
    v_mfma_f32_16x16x32_bf16 v[148:151], v[52:55], v[100:103], v[148:151]
    buffer_load_dwordx4 v[92:95], v1, s[80:83], s48 offen offset:3072 sc1
    v_mfma_f32_16x16x32_bf16 v[144:147], v[48:51], v[100:103], v[144:147]
    ds_read_b128 v[100:103], v3 offset:34816
    s_waitcnt lgkmcnt(7)
    v_mfma_f32_16x16x32_bf16 v[160:163], v[48:51], v[104:107], v[160:163]
    v_mfma_f32_16x16x32_bf16 v[164:167], v[52:55], v[104:107], v[164:167]
    v_mfma_f32_16x16x32_bf16 v[168:171], v[56:59], v[104:107], v[168:171]
    v_mfma_f32_16x16x32_bf16 v[172:175], v[60:63], v[104:107], v[172:175]
    ds_read_b128 v[104:107], v3 offset:36864
    s_waitcnt lgkmcnt(7)
    v_mfma_f32_16x16x32_bf16 v[188:191], v[60:63], v[108:111], v[188:191]
    v_mfma_f32_16x16x32_bf16 v[184:187], v[56:59], v[108:111], v[184:187]
    v_mfma_f32_16x16x32_bf16 v[180:183], v[52:55], v[108:111], v[180:183]
    v_mfma_f32_16x16x32_bf16 v[176:179], v[48:51], v[108:111], v[176:179]
    ds_read_b128 v[108:111], v3 offset:38912
    s_waitcnt lgkmcnt(7)
    v_mfma_f32_16x16x32_bf16 v[192:195], v[48:51], v[112:115], v[192:195]
    v_mfma_f32_16x16x32_bf16 v[196:199], v[52:55], v[112:115], v[196:199]
    v_mfma_f32_16x16x32_bf16 v[200:203], v[56:59], v[112:115], v[200:203]
    v_mfma_f32_16x16x32_bf16 v[204:207], v[60:63], v[112:115], v[204:207]
    ds_read_b128 v[112:115], v3 offset:40960
    ds_read_b32 v10, v9
    s_waitcnt lgkmcnt(8)
    v_mfma_f32_16x16x32_bf16 v[220:223], v[60:63], v[116:119], v[220:223]
    v_mfma_f32_16x16x32_bf16 v[216:219], v[56:59], v[116:119], v[216:219]
    v_mfma_f32_16x16x32_bf16 v[212:215], v[52:55], v[116:119], v[212:215]
    v_mfma_f32_16x16x32_bf16 v[208:211], v[48:51], v[116:119], v[208:211]
    ds_read_b128 v[116:119], v3 offset:43008
    s_waitcnt lgkmcnt(8)
    v_mfma_f32_16x16x32_bf16 v[224:227], v[48:51], v[120:123], v[224:227]
    v_mfma_f32_16x16x32_bf16 v[228:231], v[52:55], v[120:123], v[228:231]
    v_mfma_f32_16x16x32_bf16 v[232:235], v[56:59], v[120:123], v[232:235]
    v_mfma_f32_16x16x32_bf16 v[236:239], v[60:63], v[120:123], v[236:239]
    ds_read_b128 v[120:123], v3 offset:45056
    s_waitcnt lgkmcnt(8)
    v_mfma_f32_16x16x32_bf16 v[252:255], v[60:63], v[124:127], v[252:255]
    v_mfma_f32_16x16x32_bf16 v[248:251], v[56:59], v[124:127], v[248:251]
    v_mfma_f32_16x16x32_bf16 v[244:247], v[52:55], v[124:127], v[244:247]
    v_mfma_f32_16x16x32_bf16 v[240:243], v[48:51], v[124:127], v[240:243]
    ds_read_b128 v[124:127], v3 offset:47104
    ds_add_u32 v7, v8 offset:16
    s_waitcnt vmcnt(15) lgkmcnt(9)
    v_mfma_f32_16x16x32_bf16 v[128:131], v[16:19], v[96:99], v[128:131]
    s_add_u32 s48, s49, 1294336
    buffer_load_dwordx4 v[48:51], v1, s[80:83], s48 offen sc1
    s_waitcnt vmcnt(15)
    v_mfma_f32_16x16x32_bf16 v[132:135], v[20:23], v[96:99], v[132:135]
    s_waitcnt lgkmcnt(4)
    v_cmp_gt_u32 vcc, 39, v10
    s_waitcnt vmcnt(14)
    v_mfma_f32_16x16x32_bf16 v[136:139], v[24:27], v[96:99], v[136:139]
    s_cbranch_vccnz L_gs40
L_gb40:
    buffer_load_dwordx4 v[52:55], v1, s[80:83], s48 offen offset:1024 sc1
    s_waitcnt vmcnt(14)
    v_mfma_f32_16x16x32_bf16 v[140:143], v[28:31], v[96:99], v[140:143]
    ds_read_b128 v[96:99], v2 offset:49152
    v_mfma_f32_16x16x32_bf16 v[156:159], v[28:31], v[100:103], v[156:159]
    buffer_load_dwordx4 v[56:59], v1, s[80:83], s48 offen offset:2048 sc1
    v_mfma_f32_16x16x32_bf16 v[152:155], v[24:27], v[100:103], v[152:155]
    v_mfma_f32_16x16x32_bf16 v[148:151], v[20:23], v[100:103], v[148:151]
    buffer_load_dwordx4 v[60:63], v1, s[80:83], s48 offen offset:3072 sc1
    v_mfma_f32_16x16x32_bf16 v[144:147], v[16:19], v[100:103], v[144:147]
    ds_read_b128 v[100:103], v2 offset:51200
    v_mfma_f32_16x16x32_bf16 v[160:163], v[16:19], v[104:107], v[160:163]
    v_mfma_f32_16x16x32_bf16 v[164:167], v[20:23], v[104:107], v[164:167]
    v_mfma_f32_16x16x32_bf16 v[168:171], v[24:27], v[104:107], v[168:171]
    v_mfma_f32_16x16x32_bf16 v[172:175], v[28:31], v[104:107], v[172:175]
    ds_read_b128 v[104:107], v2 offset:53248
    v_mfma_f32_16x16x32_bf16 v[188:191], v[28:31], v[108:111], v[188:191]
    v_mfma_f32_16x16x32_bf16 v[184:187], v[24:27], v[108:111], v[184:187]
    v_mfma_f32_16x16x32_bf16 v[180:183], v[20:23], v[108:111], v[180:183]
    v_mfma_f32_16x16x32_bf16 v[176:179], v[16:19], v[108:111], v[176:179]
    ds_read_b128 v[108:111], v2 offset:55296
    v_mfma_f32_16x16x32_bf16 v[192:195], v[16:19], v[112:115], v[192:195]
    v_mfma_f32_16x16x32_bf16 v[196:199], v[20:23], v[112:115], v[196:199]
    v_mfma_f32_16x16x32_bf16 v[200:203], v[24:27], v[112:115], v[200:203]
    v_mfma_f32_16x16x32_bf16 v[204:207], v[28:31], v[112:115], v[204:207]
    ds_read_b128 v[112:115], v2 offset:57344
    s_waitcnt lgkmcnt(8)
    v_mfma_f32_16x16x32_bf16 v[220:223], v[28:31], v[116:119], v[220:223]
    v_mfma_f32_16x16x32_bf16 v[216:219], v[24:27], v[116:119], v[216:219]
    v_mfma_f32_16x16x32_bf16 v[212:215], v[20:23], v[116:119], v[212:215]
    v_mfma_f32_16x16x32_bf16 v[208:211], v[16:19], v[116:119], v[208:211]
    ds_read_b128 v[116:119], v2 offset:59392
    s_waitcnt lgkmcnt(8)
    v_mfma_f32_16x16x32_bf16 v[224:227], v[16:19], v[120:123], v[224:227]
    v_mfma_f32_16x16x32_bf16 v[228:231], v[20:23], v[120:123], v[228:231]
    v_mfma_f32_16x16x32_bf16 v[232:235], v[24:27], v[120:123], v[232:235]
    v_mfma_f32_16x16x32_bf16 v[236:239], v[28:31], v[120:123], v[236:239]
    ds_read_b128 v[120:123], v2 offset:61440
    s_waitcnt lgkmcnt(8)
    v_mfma_f32_16x16x32_bf16 v[252:255], v[28:31], v[124:127], v[252:255]
    v_mfma_f32_16x16x32_bf16 v[248:251], v[24:27], v[124:127], v[248:251]
    v_mfma_f32_16x16x32_bf16 v[244:247], v[20:23], v[124:127], v[244:247]
    v_mfma_f32_16x16x32_bf16 v[240:243], v[16:19], v[124:127], v[240:243]
    ds_read_b128 v[124:127], v2 offset:63488
    s_waitcnt vmcnt(15) lgkmcnt(7)
    v_mfma_f32_16x16x32_bf16 v[128:131], v[32:35], v[96:99], v[128:131]
    s_add_u32 s48, s49, 1310720
    buffer_load_dwordx4 v[16:19], v1, s[80:83], s48 offen sc1
    s_waitcnt vmcnt(15)
    v_mfma_f32_16x16x32_bf16 v[132:135], v[36:39], v[96:99], v[132:135]
    s_waitcnt vmcnt(14)
    v_mfma_f32_16x16x32_bf16 v[136:139], v[40:43], v[96:99], v[136:139]
    buffer_load_dwordx4 v[20:23], v1, s[80:83], s48 offen offset:1024 sc1
    s_waitcnt vmcnt(14)
    v_mfma_f32_16x16x32_bf16 v[140:143], v[44:47], v[96:99], v[140:143]
    ds_read_b128 v[96:99], v3 offset:49152
    s_waitcnt lgkmcnt(7)
    v_mfma_f32_16x16x32_bf16 v[156:159], v[44:47], v[100:103], v[156:159]
    buffer_load_dwordx4 v[24:27], v1, s[80:83], s48 offen offset:2048 sc1
    v_mfma_f32_16x16x32_bf16 v[152:155], v[40:43], v[100:103], v[152:155]
    v_mfma_f32_16x16x32_bf16 v[148:151], v[36:39], v[100:103], v[148:151]
    buffer_load_dwordx4 v[28:31], v1, s[80:83], s48 offen offset:3072 sc1
    v_mfma_f32_16x16x32_bf16 v[144:147], v[32:35], v[100:103], v[144:147]
    ds_read_b128 v[100:103], v3 offset:51200
    s_waitcnt lgkmcnt(7)
    v_mfma_f32_16x16x32_bf16 v[160:163], v[32:35], v[104:107], v[160:163]
    v_mfma_f32_16x16x32_bf16 v[164:167], v[36:39], v[104:107], v[164:167]
    v_mfma_f32_16x16x32_bf16 v[168:171], v[40:43], v[104:107], v[168:171]
    v_mfma_f32_16x16x32_bf16 v[172:175], v[44:47], v[104:107], v[172:175]
    ds_read_b128 v[104:107], v3 offset:53248
    s_waitcnt lgkmcnt(7)
    v_mfma_f32_16x16x32_bf16 v[188:191], v[44:47], v[108:111], v[188:191]
    v_mfma_f32_16x16x32_bf16 v[184:187], v[40:43], v[108:111], v[184:187]
    v_mfma_f32_16x16x32_bf16 v[180:183], v[36:39], v[108:111], v[180:183]
    v_mfma_f32_16x16x32_bf16 v[176:179], v[32:35], v[108:111], v[176:179]
    ds_read_b128 v[108:111], v3 offset:55296
    s_waitcnt lgkmcnt(7)
    v_mfma_f32_16x16x32_bf16 v[192:195], v[32:35], v[112:115], v[192:195]
    v_mfma_f32_16x16x32_bf16 v[196:199], v[36:39], v[112:115], v[196:199]
    v_mfma_f32_16x16x32_bf16 v[200:203], v[40:43], v[112:115], v[200:203]
    v_mfma_f32_16x16x32_bf16 v[204:207], v[44:47], v[112:115], v[204:207]
    ds_read_b128 v[112:115], v3 offset:57344
    ds_read_b32 v10, v9
    s_waitcnt lgkmcnt(8)
    v_mfma_f32_16x16x32_bf16 v[220:223], v[44:47], v[116:119], v[220:223]
    v_mfma_f32_16x16x32_bf16 v[216:219], v[40:43], v[116:119], v[216:219]
    v_mfma_f32_16x16x32_bf16 v[212:215], v[36:39], v[116:119], v[212:215]
    v_mfma_f32_16x16x32_bf16 v[208:211], v[32:35], v[116:119], v[208:211]
    ds_read_b128 v[116:119], v3 offset:59392
    s_waitcnt lgkmcnt(8)
    v_mfma_f32_16x16x32_bf16 v[224:227], v[32:35], v[120:123], v[224:227]
    v_mfma_f32_16x16x32_bf16 v[228:231], v[36:39], v[120:123], v[228:231]
    v_mfma_f32_16x16x32_bf16 v[232:235], v[40:43], v[120:123], v[232:235]
    v_mfma_f32_16x16x32_bf16 v[236:239], v[44:47], v[120:123], v[236:239]
    ds_read_b128 v[120:123], v3 offset:61440
    s_waitcnt lgkmcnt(8)
    v_mfma_f32_16x16x32_bf16 v[252:255], v[44:47], v[124:127], v[252:255]
    v_mfma_f32_16x16x32_bf16 v[248:251], v[40:43], v[124:127], v[248:251]
    v_mfma_f32_16x16x32_bf16 v[244:247], v[36:39], v[124:127], v[244:247]
    v_mfma_f32_16x16x32_bf16 v[240:243], v[32:35], v[124:127], v[240:243]
    ds_read_b128 v[124:127], v3 offset:63488
    ds_add_u32 v7, v8 offset:16
    s_waitcnt vmcnt(15) lgkmcnt(9)
    v_mfma_f32_16x16x32_bf16 v[128:131], v[64:67], v[96:99], v[128:131]
    s_add_u32 s48, s49, 1327104
    buffer_load_dwordx4 v[32:35], v1, s[80:83], s48 offen sc1
    s_waitcnt vmcnt(15)
    v_mfma_f32_16x16x32_bf16 v[132:135], v[68:71], v[96:99], v[132:135]
    s_waitcnt lgkmcnt(4)
    v_cmp_gt_u32 vcc, 40, v10
    s_waitcnt vmcnt(14)
    v_mfma_f32_16x16x32_bf16 v[136:139], v[72:75], v[96:99], v[136:139]
    s_cbranch_vccnz L_gs41
L_gb41:
    buffer_load_dwordx4 v[36:39], v1, s[80:83], s48 offen offset:1024 sc1
    s_waitcnt vmcnt(14)
    v_mfma_f32_16x16x32_bf16 v[140:143], v[76:79], v[96:99], v[140:143]
    ds_read_b128 v[96:99], v4 offset:0
    v_mfma_f32_16x16x32_bf16 v[156:159], v[76:79], v[100:103], v[156:159]
    buffer_load_dwordx4 v[40:43], v1, s[80:83], s48 offen offset:2048 sc1
    v_mfma_f32_16x16x32_bf16 v[152:155], v[72:75], v[100:103], v[152:155]
    v_mfma_f32_16x16x32_bf16 v[148:151], v[68:71], v[100:103], v[148:151]
    buffer_load_dwordx4 v[44:47], v1, s[80:83], s48 offen offset:3072 sc1
    v_mfma_f32_16x16x32_bf16 v[144:147], v[64:67], v[100:103], v[144:147]
    ds_read_b128 v[100:103], v4 offset:2048
    v_mfma_f32_16x16x32_bf16 v[160:163], v[64:67], v[104:107], v[160:163]
    v_mfma_f32_16x16x32_bf16 v[164:167], v[68:71], v[104:107], v[164:167]
    v_mfma_f32_16x16x32_bf16 v[168:171], v[72:75], v[104:107], v[168:171]
    v_mfma_f32_16x16x32_bf16 v[172:175], v[76:79], v[104:107], v[172:175]
    ds_read_b128 v[104:107], v4 offset:4096
    v_mfma_f32_16x16x32_bf16 v[188:191], v[76:79], v[108:111], v[188:191]
    v_mfma_f32_16x16x32_bf16 v[184:187], v[72:75], v[108:111], v[184:187]
    v_mfma_f32_16x16x32_bf16 v[180:183], v[68:71], v[108:111], v[180:183]
    v_mfma_f32_16x16x32_bf16 v[176:179], v[64:67], v[108:111], v[176:179]
    ds_read_b128 v[108:111], v4 offset:6144
    v_mfma_f32_16x16x32_bf16 v[192:195], v[64:67], v[112:115], v[192:195]
    v_mfma_f32_16x16x32_bf16 v[196:199], v[68:71], v[112:115], v[196:199]
    v_mfma_f32_16x16x32_bf16 v[200:203], v[72:75], v[112:115], v[200:203]
    v_mfma_f32_16x16x32_bf16 v[204:207], v[76:79], v[112:115], v[204:207]
    ds_read_b128 v[112:115], v4 offset:8192
    s_waitcnt lgkmcnt(8)
    v_mfma_f32_16x16x32_bf16 v[220:223], v[76:79], v[116:119], v[220:223]
    v_mfma_f32_16x16x32_bf16 v[216:219], v[72:75], v[116:119], v[216:219]
    v_mfma_f32_16x16x32_bf16 v[212:215], v[68:71], v[116:119], v[212:215]
    v_mfma_f32_16x16x32_bf16 v[208:211], v[64:67], v[116:119], v[208:211]
    ds_read_b128 v[116:119], v4 offset:10240
    s_waitcnt lgkmcnt(8)
    v_mfma_f32_16x16x32_bf16 v[224:227], v[64:67], v[120:123], v[224:227]
    v_mfma_f32_16x16x32_bf16 v[228:231], v[68:71], v[120:123], v[228:231]
    v_mfma_f32_16x16x32_bf16 v[232:235], v[72:75], v[120:123], v[232:235]
    v_mfma_f32_16x16x32_bf16 v[236:239], v[76:79], v[120:123], v[236:239]
    ds_read_b128 v[120:123], v4 offset:12288
    s_waitcnt lgkmcnt(8)
    v_mfma_f32_16x16x32_bf16 v[252:255], v[76:79], v[124:127], v[252:255]
    v_mfma_f32_16x16x32_bf16 v[248:251], v[72:75], v[124:127], v[248:251]
    v_mfma_f32_16x16x32_bf16 v[244:247], v[68:71], v[124:127], v[244:247]
    v_mfma_f32_16x16x32_bf16 v[240:243], v[64:67], v[124:127], v[240:243]
    ds_read_b128 v[124:127], v4 offset:14336
    s_waitcnt vmcnt(15) lgkmcnt(7)
    v_mfma_f32_16x16x32_bf16 v[128:131], v[80:83], v[96:99], v[128:131]
    s_add_u32 s48, s49, 1343488
    buffer_load_dwordx4 v[64:67], v1, s[80:83], s48 offen sc1
    s_waitcnt vmcnt(15)
    v_mfma_f32_16x16x32_bf16 v[132:135], v[84:87], v[96:99], v[132:135]
    s_waitcnt vmcnt(14)
    v_mfma_f32_16x16x32_bf16 v[136:139], v[88:91], v[96:99], v[136:139]
    buffer_load_dwordx4 v[68:71], v1, s[80:83], s48 offen offset:1024 sc1
    s_waitcnt vmcnt(14)
    v_mfma_f32_16x16x32_bf16 v[140:143], v[92:95], v[96:99], v[140:143]
    ds_read_b128 v[96:99], v5 offset:0
    s_waitcnt lgkmcnt(7)
    v_mfma_f32_16x16x32_bf16 v[156:159], v[92:95], v[100:103], v[156:159]
    buffer_load_dwordx4 v[72:75], v1, s[80:83], s48 offen offset:2048 sc1
    v_mfma_f32_16x16x32_bf16 v[152:155], v[88:91], v[100:103], v[152:155]
    v_mfma_f32_16x16x32_bf16 v[148:151], v[84:87], v[100:103], v[148:151]
    buffer_load_dwordx4 v[76:79], v1, s[80:83], s48 offen offset:3072 sc1
    v_mfma_f32_16x16x32_bf16 v[144:147], v[80:83], v[100:103], v[144:147]
    ds_read_b128 v[100:103], v5 offset:2048
    s_waitcnt lgkmcnt(7)
    v_mfma_f32_16x16x32_bf16 v[160:163], v[80:83], v[104:107], v[160:163]
    v_mfma_f32_16x16x32_bf16 v[164:167], v[84:87], v[104:107], v[164:167]
    v_mfma_f32_16x16x32_bf16 v[168:171], v[88:91], v[104:107], v[168:171]
    v_mfma_f32_16x16x32_bf16 v[172:175], v[92:95], v[104:107], v[172:175]
    ds_read_b128 v[104:107], v5 offset:4096
    s_waitcnt lgkmcnt(7)
    v_mfma_f32_16x16x32_bf16 v[188:191], v[92:95], v[108:111], v[188:191]
    v_mfma_f32_16x16x32_bf16 v[184:187], v[88:91], v[108:111], v[184:187]
    v_mfma_f32_16x16x32_bf16 v[180:183], v[84:87], v[108:111], v[180:183]
    v_mfma_f32_16x16x32_bf16 v[176:179], v[80:83], v[108:111], v[176:179]
    ds_read_b128 v[108:111], v5 offset:6144
    s_waitcnt lgkmcnt(7)
    v_mfma_f32_16x16x32_bf16 v[192:195], v[80:83], v[112:115], v[192:195]
    v_mfma_f32_16x16x32_bf16 v[196:199], v[84:87], v[112:115], v[196:199]
    v_mfma_f32_16x16x32_bf16 v[200:203], v[88:91], v[112:115], v[200:203]
    v_mfma_f32_16x16x32_bf16 v[204:207], v[92:95], v[112:115], v[204:207]
    ds_read_b128 v[112:115], v5 offset:8192
    ds_read_b32 v10, v9
    s_waitcnt lgkmcnt(8)
    v_mfma_f32_16x16x32_bf16 v[220:223], v[92:95], v[116:119], v[220:223]
    v_mfma_f32_16x16x32_bf16 v[216:219], v[88:91], v[116:119], v[216:219]
    v_mfma_f32_16x16x32_bf16 v[212:215], v[84:87], v[116:119], v[212:215]
    v_mfma_f32_16x16x32_bf16 v[208:211], v[80:83], v[116:119], v[208:211]
    ds_read_b128 v[116:119], v5 offset:10240
    s_waitcnt lgkmcnt(8)
    v_mfma_f32_16x16x32_bf16 v[224:227], v[80:83], v[120:123], v[224:227]
    v_mfma_f32_16x16x32_bf16 v[228:231], v[84:87], v[120:123], v[228:231]
    v_mfma_f32_16x16x32_bf16 v[232:235], v[88:91], v[120:123], v[232:235]
    v_mfma_f32_16x16x32_bf16 v[236:239], v[92:95], v[120:123], v[236:239]
    ds_read_b128 v[120:123], v5 offset:12288
    s_waitcnt lgkmcnt(8)
    v_mfma_f32_16x16x32_bf16 v[252:255], v[92:95], v[124:127], v[252:255]
    v_mfma_f32_16x16x32_bf16 v[248:251], v[88:91], v[124:127], v[248:251]
    v_mfma_f32_16x16x32_bf16 v[244:247], v[84:87], v[124:127], v[244:247]
    v_mfma_f32_16x16x32_bf16 v[240:243], v[80:83], v[124:127], v[240:243]
    ds_read_b128 v[124:127], v5 offset:14336
    ds_add_u32 v7, v8 offset:16
    s_waitcnt vmcnt(15) lgkmcnt(9)
    v_mfma_f32_16x16x32_bf16 v[128:131], v[48:51], v[96:99], v[128:131]
    s_add_u32 s48, s49, 1359872
    buffer_load_dwordx4 v[80:83], v1, s[80:83], s48 offen sc1
    s_waitcnt vmcnt(15)
    v_mfma_f32_16x16x32_bf16 v[132:135], v[52:55], v[96:99], v[132:135]
    s_waitcnt lgkmcnt(4)
    v_cmp_gt_u32 vcc, 41, v10
    s_waitcnt vmcnt(14)
    v_mfma_f32_16x16x32_bf16 v[136:139], v[56:59], v[96:99], v[136:139]
    s_cbranch_vccnz L_gs42
L_gb42:
    buffer_load_dwordx4 v[84:87], v1, s[80:83], s48 offen offset:1024 sc1
    s_waitcnt vmcnt(14)
    v_mfma_f32_16x16x32_bf16 v[140:143], v[60:63], v[96:99], v[140:143]
    ds_read_b128 v[96:99], v2 offset:0
    v_mfma_f32_16x16x32_bf16 v[156:159], v[60:63], v[100:103], v[156:159]
    buffer_load_dwordx4 v[88:91], v1, s[80:83], s48 offen offset:2048 sc1
    v_mfma_f32_16x16x32_bf16 v[152:155], v[56:59], v[100:103], v[152:155]
    v_mfma_f32_16x16x32_bf16 v[148:151], v[52:55], v[100:103], v[148:151]
    buffer_load_dwordx4 v[92:95], v1, s[80:83], s48 offen offset:3072 sc1
    v_mfma_f32_16x16x32_bf16 v[144:147], v[48:51], v[100:103], v[144:147]
    ds_read_b128 v[100:103], v2 offset:2048
    v_mfma_f32_16x16x32_bf16 v[160:163], v[48:51], v[104:107], v[160:163]
    v_mfma_f32_16x16x32_bf16 v[164:167], v[52:55], v[104:107], v[164:167]
    v_mfma_f32_16x16x32_bf16 v[168:171], v[56:59], v[104:107], v[168:171]
    v_mfma_f32_16x16x32_bf16 v[172:175], v[60:63], v[104:107], v[172:175]
    ds_read_b128 v[104:107], v2 offset:4096
    v_mfma_f32_16x16x32_bf16 v[188:191], v[60:63], v[108:111], v[188:191]
    v_mfma_f32_16x16x32_bf16 v[184:187], v[56:59], v[108:111], v[184:187]
    v_mfma_f32_16x16x32_bf16 v[180:183], v[52:55], v[108:111], v[180:183]
    v_mfma_f32_16x16x32_bf16 v[176:179], v[48:51], v[108:111], v[176:179]
    ds_read_b128 v[108:111], v2 offset:6144
    v_mfma_f32_16x16x32_bf16 v[192:195], v[48:51], v[112:115], v[192:195]
    v_mfma_f32_16x16x32_bf16 v[196:199], v[52:55], v[112:115], v[196:199]
    v_mfma_f32_16x16x32_bf16 v[200:203], v[56:59], v[112:115], v[200:203]
    v_mfma_f32_16x16x32_bf16 v[204:207], v[60:63], v[112:115], v[204:207]
    ds_read_b128 v[112:115], v2 offset:8192
    s_waitcnt lgkmcnt(8)
    v_mfma_f32_16x16x32_bf16 v[220:223], v[60:63], v[116:119], v[220:223]
    v_mfma_f32_16x16x32_bf16 v[216:219], v[56:59], v[116:119], v[216:219]
    v_mfma_f32_16x16x32_bf16 v[212:215], v[52:55], v[116:119], v[212:215]
    v_mfma_f32_16x16x32_bf16 v[208:211], v[48:51], v[116:119], v[208:211]
    ds_read_b128 v[116:119], v2 offset:10240
    s_waitcnt lgkmcnt(8)
    v_mfma_f32_16x16x32_bf16 v[224:227], v[48:51], v[120:123], v[224:227]
    v_mfma_f32_16x16x32_bf16 v[228:231], v[52:55], v[120:123], v[228:231]
    v_mfma_f32_16x16x32_bf16 v[232:235], v[56:59], v[120:123], v[232:235]
    v_mfma_f32_16x16x32_bf16 v[236:239], v[60:63], v[120:123], v[236:239]
    ds_read_b128 v[120:123], v2 offset:12288
    s_waitcnt lgkmcnt(8)
    v_mfma_f32_16x16x32_bf16 v[252:255], v[60:63], v[124:127], v[252:255]
    v_mfma_f32_16x16x32_bf16 v[248:251], v[56:59], v[124:127], v[248:251]
    v_mfma_f32_16x16x32_bf16 v[244:247], v[52:55], v[124:127], v[244:247]
    v_mfma_f32_16x16x32_bf16 v[240:243], v[48:51], v[124:127], v[240:243]
    ds_read_b128 v[124:127], v2 offset:14336
    s_waitcnt vmcnt(15) lgkmcnt(7)
    v_mfma_f32_16x16x32_bf16 v[128:131], v[16:19], v[96:99], v[128:131]
    s_add_u32 s48, s49, 1376256
    buffer_load_dwordx4 v[48:51], v1, s[80:83], s48 offen sc1
    s_waitcnt vmcnt(15)
    v_mfma_f32_16x16x32_bf16 v[132:135], v[20:23], v[96:99], v[132:135]
    s_waitcnt vmcnt(14)
    v_mfma_f32_16x16x32_bf16 v[136:139], v[24:27], v[96:99], v[136:139]
    buffer_load_dwordx4 v[52:55], v1, s[80:83], s48 offen offset:1024 sc1
    s_waitcnt vmcnt(14)
    v_mfma_f32_16x16x32_bf16 v[140:143], v[28:31], v[96:99], v[140:143]
    ds_read_b128 v[96:99], v3 offset:0
    s_waitcnt lgkmcnt(7)
    v_mfma_f32_16x16x32_bf16 v[156:159], v[28:31], v[100:103], v[156:159]
    buffer_load_dwordx4 v[56:59], v1, s[80:83], s48 offen offset:2048 sc1
    v_mfma_f32_16x16x32_bf16 v[152:155], v[24:27], v[100:103], v[152:155]
    v_mfma_f32_16x16x32_bf16 v[148:151], v[20:23], v[100:103], v[148:151]
    buffer_load_dwordx4 v[60:63], v1, s[80:83], s48 offen offset:3072 sc1
    v_mfma_f32_16x16x32_bf16 v[144:147], v[16:19], v[100:103], v[144:147]
    ds_read_b128 v[100:103], v3 offset:2048
    s_waitcnt lgkmcnt(7)
    v_mfma_f32_16x16x32_bf16 v[160:163], v[16:19], v[104:107], v[160:163]
    v_mfma_f32_16x16x32_bf16 v[164:167], v[20:23], v[104:107], v[164:167]
    v_mfma_f32_16x16x32_bf16 v[168:171], v[24:27], v[104:107], v[168:171]
    v_mfma_f32_16x16x32_bf16 v[172:175], v[28:31], v[104:107], v[172:175]
    ds_read_b128 v[104:107], v3 offset:4096
    s_waitcnt lgkmcnt(7)
    v_mfma_f32_16x16x32_bf16 v[188:191], v[28:31], v[108:111], v[188:191]
    v_mfma_f32_16x16x32_bf16 v[184:187], v[24:27], v[108:111], v[184:187]
    v_mfma_f32_16x16x32_bf16 v[180:183], v[20:23], v[108:111], v[180:183]
    v_mfma_f32_16x16x32_bf16 v[176:179], v[16:19], v[108:111], v[176:179]
    ds_read_b128 v[108:111], v3 offset:6144
    s_waitcnt lgkmcnt(7)
    v_mfma_f32_16x16x32_bf16 v[192:195], v[16:19], v[112:115], v[192:195]
    v_mfma_f32_16x16x32_bf16 v[196:199], v[20:23], v[112:115], v[196:199]
    v_mfma_f32_16x16x32_bf16 v[200:203], v[24:27], v[112:115], v[200:203]
    v_mfma_f32_16x16x32_bf16 v[204:207], v[28:31], v[112:115], v[204:207]
    ds_read_b128 v[112:115], v3 offset:8192
    ds_read_b32 v10, v9
    s_waitcnt lgkmcnt(8)
    v_mfma_f32_16x16x32_bf16 v[220:223], v[28:31], v[116:119], v[220:223]
    v_mfma_f32_16x16x32_bf16 v[216:219], v[24:27], v[116:119], v[216:219]
    v_mfma_f32_16x16x32_bf16 v[212:215], v[20:23], v[116:119], v[212:215]
    v_mfma_f32_16x16x32_bf16 v[208:211], v[16:19], v[116:119], v[208:211]
    ds_read_b128 v[116:119], v3 offset:10240
    s_waitcnt lgkmcnt(8)
    v_mfma_f32_16x16x32_bf16 v[224:227], v[16:19], v[120:123], v[224:227]
    v_mfma_f32_16x16x32_bf16 v[228:231], v[20:23], v[120:123], v[228:231]
    v_mfma_f32_16x16x32_bf16 v[232:235], v[24:27], v[120:123], v[232:235]
    v_mfma_f32_16x16x32_bf16 v[236:239], v[28:31], v[120:123], v[236:239]
    ds_read_b128 v[120:123], v3 offset:12288
    s_waitcnt lgkmcnt(8)
    v_mfma_f32_16x16x32_bf16 v[252:255], v[28:31], v[124:127], v[252:255]
    v_mfma_f32_16x16x32_bf16 v[248:251], v[24:27], v[124:127], v[248:251]
    v_mfma_f32_16x16x32_bf16 v[244:247], v[20:23], v[124:127], v[244:247]
    v_mfma_f32_16x16x32_bf16 v[240:243], v[16:19], v[124:127], v[240:243]
    ds_read_b128 v[124:127], v3 offset:14336
    ds_add_u32 v7, v8 offset:16
    s_waitcnt vmcnt(15) lgkmcnt(9)
    v_mfma_f32_16x16x32_bf16 v[128:131], v[32:35], v[96:99], v[128:131]
    s_add_u32 s48, s49, 1392640
    buffer_load_dwordx4 v[16:19], v1, s[80:83], s48 offen sc1
    s_waitcnt vmcnt(15)
    v_mfma_f32_16x16x32_bf16 v[132:135], v[36:39], v[96:99], v[132:135]
    s_waitcnt lgkmcnt(4)
    v_cmp_gt_u32 vcc, 42, v10
    s_waitcnt vmcnt(14)
    v_mfma_f32_16x16x32_bf16 v[136:139], v[40:43], v[96:99], v[136:139]
    s_cbranch_vccnz L_gs43
L_gb43:
    buffer_load_dwordx4 v[20:23], v1, s[80:83], s48 offen offset:1024 sc1
    s_waitcnt vmcnt(14)
    v_mfma_f32_16x16x32_bf16 v[140:143], v[44:47], v[96:99], v[140:143]
    ds_read_b128 v[96:99], v2 offset:16384
    v_mfma_f32_16x16x32_bf16 v[156:159], v[44:47], v[100:103], v[156:159]
    buffer_load_dwordx4 v[24:27], v1, s[80:83], s48 offen offset:2048 sc1
    v_mfma_f32_16x16x32_bf16 v[152:155], v[40:43], v[100:103], v[152:155]
    v_mfma_f32_16x16x32_bf16 v[148:151], v[36:39], v[100:103], v[148:151]
    buffer_load_dwordx4 v[28:31], v1, s[80:83], s48 offen offset:3072 sc1
    v_mfma_f32_16x16x32_bf16 v[144:147], v[32:35], v[100:103], v[144:147]
    ds_read_b128 v[100:103], v2 offset:18432
    v_mfma_f32_16x16x32_bf16 v[160:163], v[32:35], v[104:107], v[160:163]
    v_mfma_f32_16x16x32_bf16 v[164:167], v[36:39], v[104:107], v[164:167]
    v_mfma_f32_16x16x32_bf16 v[168:171], v[40:43], v[104:107], v[168:171]
    v_mfma_f32_16x16x32_bf16 v[172:175], v[44:47], v[104:107], v[172:175]
    ds_read_b128 v[104:107], v2 offset:20480
    v_mfma_f32_16x16x32_bf16 v[188:191], v[44:47], v[108:111], v[188:191]
    v_mfma_f32_16x16x32_bf16 v[184:187], v[40:43], v[108:111], v[184:187]
    v_mfma_f32_16x16x32_bf16 v[180:183], v[36:39], v[108:111], v[180:183]
    v_mfma_f32_16x16x32_bf16 v[176:179], v[32:35], v[108:111], v[176:179]
    ds_read_b128 v[108:111], v2 offset:22528
    v_mfma_f32_16x16x32_bf16 v[192:195], v[32:35], v[112:115], v[192:195]
    v_mfma_f32_16x16x32_bf16 v[196:199], v[36:39], v[112:115], v[196:199]
    v_mfma_f32_16x16x32_bf16 v[200:203], v[40:43], v[112:115], v[200:203]
    v_mfma_f32_16x16x32_bf16 v[204:207], v[44:47], v[112:115], v[204:207]
    ds_read_b128 v[112:115], v2 offset:24576
    s_waitcnt lgkmcnt(8)
    v_mfma_f32_16x16x32_bf16 v[220:223], v[44:47], v[116:119], v[220:223]
    v_mfma_f32_16x16x32_bf16 v[216:219], v[40:43], v[116:119], v[216:219]
    v_mfma_f32_16x16x32_bf16 v[212:215], v[36:39], v[116:119], v[212:215]
    v_mfma_f32_16x16x32_bf16 v[208:211], v[32:35], v[116:119], v[208:211]
    ds_read_b128 v[116:119], v2 offset:26624
    s_waitcnt lgkmcnt(8)
    v_mfma_f32_16x16x32_bf16 v[224:227], v[32:35], v[120:123], v[224:227]
    v_mfma_f32_16x16x32_bf16 v[228:231], v[36:39], v[120:123], v[228:231]
    v_mfma_f32_16x16x32_bf16 v[232:235], v[40:43], v[120:123], v[232:235]
    v_mfma_f32_16x16x32_bf16 v[236:239], v[44:47], v[120:123], v[236:239]
    ds_read_b128 v[120:123], v2 offset:28672
    s_waitcnt lgkmcnt(8)
    v_mfma_f32_16x16x32_bf16 v[252:255], v[44:47], v[124:127], v[252:255]
    v_mfma_f32_16x16x32_bf16 v[248:251], v[40:43], v[124:127], v[248:251]
    v_mfma_f32_16x16x32_bf16 v[244:247], v[36:39], v[124:127], v[244:247]
    v_mfma_f32_16x16x32_bf16 v[240:243], v[32:35], v[124:127], v[240:243]
    ds_read_b128 v[124:127], v2 offset:30720
    s_waitcnt vmcnt(15) lgkmcnt(7)
    v_mfma_f32_16x16x32_bf16 v[128:131], v[64:67], v[96:99], v[128:131]
    s_add_u32 s48, s49, 1409024
    buffer_load_dwordx4 v[32:35], v1, s[80:83], s48 offen sc1
    s_waitcnt vmcnt(15)
    v_mfma_f32_16x16x32_bf16 v[132:135], v[68:71], v[96:99], v[132:135]
    s_waitcnt vmcnt(14)
    v_mfma_f32_16x16x32_bf16 v[136:139], v[72:75], v[96:99], v[136:139]
    buffer_load_dwordx4 v[36:39], v1, s[80:83], s48 offen offset:1024 sc1
    s_waitcnt vmcnt(14)
    v_mfma_f32_16x16x32_bf16 v[140:143], v[76:79], v[96:99], v[140:143]
    ds_read_b128 v[96:99], v3 offset:16384
    s_waitcnt lgkmcnt(7)
    v_mfma_f32_16x16x32_bf16 v[156:159], v[76:79], v[100:103], v[156:159]
    buffer_load_dwordx4 v[40:43], v1, s[80:83], s48 offen offset:2048 sc1
    v_mfma_f32_16x16x32_bf16 v[152:155], v[72:75], v[100:103], v[152:155]
    v_mfma_f32_16x16x32_bf16 v[148:151], v[68:71], v[100:103], v[148:151]
    buffer_load_dwordx4 v[44:47], v1, s[80:83], s48 offen offset:3072 sc1
    v_mfma_f32_16x16x32_bf16 v[144:147], v[64:67], v[100:103], v[144:147]
    ds_read_b128 v[100:103], v3 offset:18432
    s_waitcnt lgkmcnt(7)
    v_mfma_f32_16x16x32_bf16 v[160:163], v[64:67], v[104:107], v[160:163]
    v_mfma_f32_16x16x32_bf16 v[164:167], v[68:71], v[104:107], v[164:167]
    v_mfma_f32_16x16x32_bf16 v[168:171], v[72:75], v[104:107], v[168:171]
    v_mfma_f32_16x16x32_bf16 v[172:175], v[76:79], v[104:107], v[172:175]
    ds_read_b128 v[104:107], v3 offset:20480
    s_waitcnt lgkmcnt(7)
    v_mfma_f32_16x16x32_bf16 v[188:191], v[76:79], v[108:111], v[188:191]
    v_mfma_f32_16x16x32_bf16 v[184:187], v[72:75], v[108:111], v[184:187]
    v_mfma_f32_16x16x32_bf16 v[180:183], v[68:71], v[108:111], v[180:183]
    v_mfma_f32_16x16x32_bf16 v[176:179], v[64:67], v[108:111], v[176:179]
    ds_read_b128 v[108:111], v3 offset:22528
    s_waitcnt lgkmcnt(7)
    v_mfma_f32_16x16x32_bf16 v[192:195], v[64:67], v[112:115], v[192:195]
    v_mfma_f32_16x16x32_bf16 v[196:199], v[68:71], v[112:115], v[196:199]
    v_mfma_f32_16x16x32_bf16 v[200:203], v[72:75], v[112:115], v[200:203]
    v_mfma_f32_16x16x32_bf16 v[204:207], v[76:79], v[112:115], v[204:207]
    ds_read_b128 v[112:115], v3 offset:24576
    ds_read_b32 v10, v9
    s_waitcnt lgkmcnt(8)
    v_mfma_f32_16x16x32_bf16 v[220:223], v[76:79], v[116:119], v[220:223]
    v_mfma_f32_16x16x32_bf16 v[216:219], v[72:75], v[116:119], v[216:219]
    v_mfma_f32_16x16x32_bf16 v[212:215], v[68:71], v[116:119], v[212:215]
    v_mfma_f32_16x16x32_bf16 v[208:211], v[64:67], v[116:119], v[208:211]
    ds_read_b128 v[116:119], v3 offset:26624
    s_waitcnt lgkmcnt(8)
    v_mfma_f32_16x16x32_bf16 v[224:227], v[64:67], v[120:123], v[224:227]
    v_mfma_f32_16x16x32_bf16 v[228:231], v[68:71], v[120:123], v[228:231]
    v_mfma_f32_16x16x32_bf16 v[232:235], v[72:75], v[120:123], v[232:235]
    v_mfma_f32_16x16x32_bf16 v[236:239], v[76:79], v[120:123], v[236:239]
    ds_read_b128 v[120:123], v3 offset:28672
    s_waitcnt lgkmcnt(8)
    v_mfma_f32_16x16x32_bf16 v[252:255], v[76:79], v[124:127], v[252:255]
    v_mfma_f32_16x16x32_bf16 v[248:251], v[72:75], v[124:127], v[248:251]
    v_mfma_f32_16x16x32_bf16 v[244:247], v[68:71], v[124:127], v[244:247]
    v_mfma_f32_16x16x32_bf16 v[240:243], v[64:67], v[124:127], v[240:243]
    ds_read_b128 v[124:127], v3 offset:30720
    ds_add_u32 v7, v8 offset:16
    s_waitcnt vmcnt(15) lgkmcnt(9)
    v_mfma_f32_16x16x32_bf16 v[128:131], v[80:83], v[96:99], v[128:131]
    s_add_u32 s48, s49, 1425408
    buffer_load_dwordx4 v[64:67], v1, s[80:83], s48 offen sc1
    s_waitcnt vmcnt(15)
    v_mfma_f32_16x16x32_bf16 v[132:135], v[84:87], v[96:99], v[132:135]
    s_waitcnt lgkmcnt(4)
    v_cmp_gt_u32 vcc, 43, v10
    s_waitcnt vmcnt(14)
    v_mfma_f32_16x16x32_bf16 v[136:139], v[88:91], v[96:99], v[136:139]
    s_cbranch_vccnz L_gs44
L_gb44:
    buffer_load_dwordx4 v[68:71], v1, s[80:83], s48 offen offset:1024 sc1
    s_waitcnt vmcnt(14)
    v_mfma_f32_16x16x32_bf16 v[140:143], v[92:95], v[96:99], v[140:143]
    ds_read_b128 v[96:99], v2 offset:32768
    v_mfma_f32_16x16x32_bf16 v[156:159], v[92:95], v[100:103], v[156:159]
    buffer_load_dwordx4 v[72:75], v1, s[80:83], s48 offen offset:2048 sc1
    v_mfma_f32_16x16x32_bf16 v[152:155], v[88:91], v[100:103], v[152:155]
    v_mfma_f32_16x16x32_bf16 v[148:151], v[84:87], v[100:103], v[148:151]
    buffer_load_dwordx4 v[76:79], v1, s[80:83], s48 offen offset:3072 sc1
    v_mfma_f32_16x16x32_bf16 v[144:147], v[80:83], v[100:103], v[144:147]
    ds_read_b128 v[100:103], v2 offset:34816
    v_mfma_f32_16x16x32_bf16 v[160:163], v[80:83], v[104:107], v[160:163]
    v_mfma_f32_16x16x32_bf16 v[164:167], v[84:87], v[104:107], v[164:167]
    v_mfma_f32_16x16x32_bf16 v[168:171], v[88:91], v[104:107], v[168:171]
    v_mfma_f32_16x16x32_bf16 v[172:175], v[92:95], v[104:107], v[172:175]
    ds_read_b128 v[104:107], v2 offset:36864
    v_mfma_f32_16x16x32_bf16 v[188:191], v[92:95], v[108:111], v[188:191]
    v_mfma_f32_16x16x32_bf16 v[184:187], v[88:91], v[108:111], v[184:187]
    v_mfma_f32_16x16x32_bf16 v[180:183], v[84:87], v[108:111], v[180:183]
    v_mfma_f32_16x16x32_bf16 v[176:179], v[80:83], v[108:111], v[176:179]
    ds_read_b128 v[108:111], v2 offset:38912
    v_mfma_f32_16x16x32_bf16 v[192:195], v[80:83], v[112:115], v[192:195]
    v_mfma_f32_16x16x32_bf16 v[196:199], v[84:87], v[112:115], v[196:199]
    v_mfma_f32_16x16x32_bf16 v[200:203], v[88:91], v[112:115], v[200:203]
    v_mfma_f32_16x16x32_bf16 v[204:207], v[92:95], v[112:115], v[204:207]
    ds_read_b128 v[112:115], v2 offset:40960
    s_waitcnt lgkmcnt(8)
    v_mfma_f32_16x16x32_bf16 v[220:223], v[92:95], v[116:119], v[220:223]
    v_mfma_f32_16x16x32_bf16 v[216:219], v[88:91], v[116:119], v[216:219]
    v_mfma_f32_16x16x32_bf16 v[212:215], v[84:87], v[116:119], v[212:215]
    v_mfma_f32_16x16x32_bf16 v[208:211], v[80:83], v[116:119], v[208:211]
    ds_read_b128 v[116:119], v2 offset:43008
    s_waitcnt lgkmcnt(8)
    v_mfma_f32_16x16x32_bf16 v[224:227], v[80:83], v[120:123], v[224:227]
    v_mfma_f32_16x16x32_bf16 v[228:231], v[84:87], v[120:123], v[228:231]
    v_mfma_f32_16x16x32_bf16 v[232:235], v[88:91], v[120:123], v[232:235]
    v_mfma_f32_16x16x32_bf16 v[236:239], v[92:95], v[120:123], v[236:239]
    ds_read_b128 v[120:123], v2 offset:45056
    s_waitcnt lgkmcnt(8)
    v_mfma_f32_16x16x32_bf16 v[252:255], v[92:95], v[124:127], v[252:255]
    v_mfma_f32_16x16x32_bf16 v[248:251], v[88:91], v[124:127], v[248:251]
    v_mfma_f32_16x16x32_bf16 v[244:247], v[84:87], v[124:127], v[244:247]
    v_mfma_f32_16x16x32_bf16 v[240:243], v[80:83], v[124:127], v[240:243]
    ds_read_b128 v[124:127], v2 offset:47104
    s_waitcnt vmcnt(15) lgkmcnt(7)
    v_mfma_f32_16x16x32_bf16 v[128:131], v[48:51], v[96:99], v[128:131]
    s_add_u32 s48, s49, 1441792
    buffer_load_dwordx4 v[80:83], v1, s[80:83], s48 offen sc1
    s_waitcnt vmcnt(15)
    v_mfma_f32_16x16x32_bf16 v[132:135], v[52:55], v[96:99], v[132:135]
    s_waitcnt vmcnt(14)
    v_mfma_f32_16x16x32_bf16 v[136:139], v[56:59], v[96:99], v[136:139]
    buffer_load_dwordx4 v[84:87], v1, s[80:83], s48 offen offset:1024 sc1
    s_waitcnt vmcnt(14)
    v_mfma_f32_16x16x32_bf16 v[140:143], v[60:63], v[96:99], v[140:143]
    ds_read_b128 v[96:99], v3 offset:32768
    s_waitcnt lgkmcnt(7)
    v_mfma_f32_16x16x32_bf16 v[156:159], v[60:63], v[100:103], v[156:159]
    buffer_load_dwordx4 v[88:91], v1, s[80:83], s48 offen offset:2048 sc1
    v_mfma_f32_16x16x32_bf16 v[152:155], v[56:59], v[100:103], v[152:155]
    v_mfma_f32_16x16x32_bf16 v[148:151], v[52:55], v[100:103], v[148:151]
    buffer_load_dwordx4 v[92:95], v1, s[80:83], s48 offen offset:3072 sc1
    v_mfma_f32_16x16x32_bf16 v[144:147], v[48:51], v[100:103], v[144:147]
    ds_read_b128 v[100:103], v3 offset:34816
    s_waitcnt lgkmcnt(7)
    v_mfma_f32_16x16x32_bf16 v[160:163], v[48:51], v[104:107], v[160:163]
    v_mfma_f32_16x16x32_bf16 v[164:167], v[52:55], v[104:107], v[164:167]
    v_mfma_f32_16x16x32_bf16 v[168:171], v[56:59], v[104:107], v[168:171]
    v_mfma_f32_16x16x32_bf16 v[172:175], v[60:63], v[104:107], v[172:175]
    ds_read_b128 v[104:107], v3 offset:36864
    s_waitcnt lgkmcnt(7)
    v_mfma_f32_16x16x32_bf16 v[188:191], v[60:63], v[108:111], v[188:191]
    v_mfma_f32_16x16x32_bf16 v[184:187], v[56:59], v[108:111], v[184:187]
    v_mfma_f32_16x16x32_bf16 v[180:183], v[52:55], v[108:111], v[180:183]
    v_mfma_f32_16x16x32_bf16 v[176:179], v[48:51], v[108:111], v[176:179]
    ds_read_b128 v[108:111], v3 offset:38912
    s_waitcnt lgkmcnt(7)
    v_mfma_f32_16x16x32_bf16 v[192:195], v[48:51], v[112:115], v[192:195]
    v_mfma_f32_16x16x32_bf16 v[196:199], v[52:55], v[112:115], v[196:199]
    v_mfma_f32_16x16x32_bf16 v[200:203], v[56:59], v[112:115], v[200:203]
    v_mfma_f32_16x16x32_bf16 v[204:207], v[60:63], v[112:115], v[204:207]
    ds_read_b128 v[112:115], v3 offset:40960
    ds_read_b32 v10, v9
    s_waitcnt lgkmcnt(8)
    v_mfma_f32_16x16x32_bf16 v[220:223], v[60:63], v[116:119], v[220:223]
    v_mfma_f32_16x16x32_bf16 v[216:219], v[56:59], v[116:119], v[216:219]
    v_mfma_f32_16x16x32_bf16 v[212:215], v[52:55], v[116:119], v[212:215]
    v_mfma_f32_16x16x32_bf16 v[208:211], v[48:51], v[116:119], v[208:211]
    ds_read_b128 v[116:119], v3 offset:43008
    s_waitcnt lgkmcnt(8)
    v_mfma_f32_16x16x32_bf16 v[224:227], v[48:51], v[120:123], v[224:227]
    v_mfma_f32_16x16x32_bf16 v[228:231], v[52:55], v[120:123], v[228:231]
    v_mfma_f32_16x16x32_bf16 v[232:235], v[56:59], v[120:123], v[232:235]
    v_mfma_f32_16x16x32_bf16 v[236:239], v[60:63], v[120:123], v[236:239]
    ds_read_b128 v[120:123], v3 offset:45056
    s_waitcnt lgkmcnt(8)
    v_mfma_f32_16x16x32_bf16 v[252:255], v[60:63], v[124:127], v[252:255]
    v_mfma_f32_16x16x32_bf16 v[248:251], v[56:59], v[124:127], v[248:251]
    v_mfma_f32_16x16x32_bf16 v[244:247], v[52:55], v[124:127], v[244:247]
    v_mfma_f32_16x16x32_bf16 v[240:243], v[48:51], v[124:127], v[240:243]
    ds_read_b128 v[124:127], v3 offset:47104
    ds_add_u32 v7, v8 offset:16
    s_waitcnt vmcnt(15) lgkmcnt(9)
    v_mfma_f32_16x16x32_bf16 v[128:131], v[16:19], v[96:99], v[128:131]
    s_add_u32 s48, s49, 1458176
    buffer_load_dwordx4 v[48:51], v1, s[80:83], s48 offen sc1
    s_waitcnt vmcnt(15)
    v_mfma_f32_16x16x32_bf16 v[132:135], v[20:23], v[96:99], v[132:135]
    s_waitcnt lgkmcnt(4)
    v_cmp_gt_u32 vcc, 44, v10
    s_waitcnt vmcnt(14)
    v_mfma_f32_16x16x32_bf16 v[136:139], v[24:27], v[96:99], v[136:139]
    s_cbranch_vccnz L_gs45
L_gb45:
    buffer_load_dwordx4 v[52:55], v1, s[80:83], s48 offen offset:1024 sc1
    s_waitcnt vmcnt(14)
    v_mfma_f32_16x16x32_bf16 v[140:143], v[28:31], v[96:99], v[140:143]
    ds_read_b128 v[96:99], v2 offset:49152
    v_mfma_f32_16x16x32_bf16 v[156:159], v[28:31], v[100:103], v[156:159]
    buffer_load_dwordx4 v[56:59], v1, s[80:83], s48 offen offset:2048 sc1
    v_mfma_f32_16x16x32_bf16 v[152:155], v[24:27], v[100:103], v[152:155]
    v_mfma_f32_16x16x32_bf16 v[148:151], v[20:23], v[100:103], v[148:151]
    buffer_load_dwordx4 v[60:63], v1, s[80:83], s48 offen offset:3072 sc1
    v_mfma_f32_16x16x32_bf16 v[144:147], v[16:19], v[100:103], v[144:147]
    ds_read_b128 v[100:103], v2 offset:51200
    v_mfma_f32_16x16x32_bf16 v[160:163], v[16:19], v[104:107], v[160:163]
    v_mfma_f32_16x16x32_bf16 v[164:167], v[20:23], v[104:107], v[164:167]
    v_mfma_f32_16x16x32_bf16 v[168:171], v[24:27], v[104:107], v[168:171]
    v_mfma_f32_16x16x32_bf16 v[172:175], v[28:31], v[104:107], v[172:175]
    ds_read_b128 v[104:107], v2 offset:53248
    v_mfma_f32_16x16x32_bf16 v[188:191], v[28:31], v[108:111], v[188:191]
    v_mfma_f32_16x16x32_bf16 v[184:187], v[24:27], v[108:111], v[184:187]
    v_mfma_f32_16x16x32_bf16 v[180:183], v[20:23], v[108:111], v[180:183]
    v_mfma_f32_16x16x32_bf16 v[176:179], v[16:19], v[108:111], v[176:179]
    ds_read_b128 v[108:111], v2 offset:55296
    v_mfma_f32_16x16x32_bf16 v[192:195], v[16:19], v[112:115], v[192:195]
    v_mfma_f32_16x16x32_bf16 v[196:199], v[20:23], v[112:115], v[196:199]
    v_mfma_f32_16x16x32_bf16 v[200:203], v[24:27], v[112:115], v[200:203]
    v_mfma_f32_16x16x32_bf16 v[204:207], v[28:31], v[112:115], v[204:207]
    ds_read_b128 v[112:115], v2 offset:57344
    s_waitcnt lgkmcnt(8)
    v_mfma_f32_16x16x32_bf16 v[220:223], v[28:31], v[116:119], v[220:223]
    v_mfma_f32_16x16x32_bf16 v[216:219], v[24:27], v[116:119], v[216:219]
    v_mfma_f32_16x16x32_bf16 v[212:215], v[20:23], v[116:119], v[212:215]
    v_mfma_f32_16x16x32_bf16 v[208:211], v[16:19], v[116:119], v[208:211]
    ds_read_b128 v[116:119], v2 offset:59392
    s_waitcnt lgkmcnt(8)
    v_mfma_f32_16x16x32_bf16 v[224:227], v[16:19], v[120:123], v[224:227]
    v_mfma_f32_16x16x32_bf16 v[228:231], v[20:23], v[120:123], v[228:231]
    v_mfma_f32_16x16x32_bf16 v[232:235], v[24:27], v[120:123], v[232:235]
    v_mfma_f32_16x16x32_bf16 v[236:239], v[28:31], v[120:123], v[236:239]
    ds_read_b128 v[120:123], v2 offset:61440
    s_waitcnt lgkmcnt(8)
    v_mfma_f32_16x16x32_bf16 v[252:255], v[28:31], v[124:127], v[252:255]
    v_mfma_f32_16x16x32_bf16 v[248:251], v[24:27], v[124:127], v[248:251]
    v_mfma_f32_16x16x32_bf16 v[244:247], v[20:23], v[124:127], v[244:247]
    v_mfma_f32_16x16x32_bf16 v[240:243], v[16:19], v[124:127], v[240:243]
    ds_read_b128 v[124:127], v2 offset:63488
    s_waitcnt vmcnt(15) lgkmcnt(7)
    v_mfma_f32_16x16x32_bf16 v[128:131], v[32:35], v[96:99], v[128:131]
    s_add_u32 s48, s49, 1474560
    buffer_load_dwordx4 v[16:19], v1, s[80:83], s48 offen sc1
    s_waitcnt vmcnt(15)
    v_mfma_f32_16x16x32_bf16 v[132:135], v[36:39], v[96:99], v[132:135]
    s_waitcnt vmcnt(14)
    v_mfma_f32_16x16x32_bf16 v[136:139], v[40:43], v[96:99], v[136:139]
    buffer_load_dwordx4 v[20:23], v1, s[80:83], s48 offen offset:1024 sc1
    s_waitcnt vmcnt(14)
    v_mfma_f32_16x16x32_bf16 v[140:143], v[44:47], v[96:99], v[140:143]
    ds_read_b128 v[96:99], v3 offset:49152
    s_waitcnt lgkmcnt(7)
    v_mfma_f32_16x16x32_bf16 v[156:159], v[44:47], v[100:103], v[156:159]
    buffer_load_dwordx4 v[24:27], v1, s[80:83], s48 offen offset:2048 sc1
    v_mfma_f32_16x16x32_bf16 v[152:155], v[40:43], v[100:103], v[152:155]
    v_mfma_f32_16x16x32_bf16 v[148:151], v[36:39], v[100:103], v[148:151]
    buffer_load_dwordx4 v[28:31], v1, s[80:83], s48 offen offset:3072 sc1
    v_mfma_f32_16x16x32_bf16 v[144:147], v[32:35], v[100:103], v[144:147]
    ds_read_b128 v[100:103], v3 offset:51200
    s_waitcnt lgkmcnt(7)
    v_mfma_f32_16x16x32_bf16 v[160:163], v[32:35], v[104:107], v[160:163]
    v_mfma_f32_16x16x32_bf16 v[164:167], v[36:39], v[104:107], v[164:167]
    v_mfma_f32_16x16x32_bf16 v[168:171], v[40:43], v[104:107], v[168:171]
    v_mfma_f32_16x16x32_bf16 v[172:175], v[44:47], v[104:107], v[172:175]
    ds_read_b128 v[104:107], v3 offset:53248
    s_waitcnt lgkmcnt(7)
    v_mfma_f32_16x16x32_bf16 v[188:191], v[44:47], v[108:111], v[188:191]
    v_mfma_f32_16x16x32_bf16 v[184:187], v[40:43], v[108:111], v[184:187]
    v_mfma_f32_16x16x32_bf16 v[180:183], v[36:39], v[108:111], v[180:183]
    v_mfma_f32_16x16x32_bf16 v[176:179], v[32:35], v[108:111], v[176:179]
    ds_read_b128 v[108:111], v3 offset:55296
    s_waitcnt lgkmcnt(7)
    v_mfma_f32_16x16x32_bf16 v[192:195], v[32:35], v[112:115], v[192:195]
    v_mfma_f32_16x16x32_bf16 v[196:199], v[36:39], v[112:115], v[196:199]
    v_mfma_f32_16x16x32_bf16 v[200:203], v[40:43], v[112:115], v[200:203]
    v_mfma_f32_16x16x32_bf16 v[204:207], v[44:47], v[112:115], v[204:207]
    ds_read_b128 v[112:115], v3 offset:57344
    ds_read_b32 v10, v9
    s_waitcnt lgkmcnt(8)
    v_mfma_f32_16x16x32_bf16 v[220:223], v[44:47], v[116:119], v[220:223]
    v_mfma_f32_16x16x32_bf16 v[216:219], v[40:43], v[116:119], v[216:219]
    v_mfma_f32_16x16x32_bf16 v[212:215], v[36:39], v[116:119], v[212:215]
    v_mfma_f32_16x16x32_bf16 v[208:211], v[32:35], v[116:119], v[208:211]
    ds_read_b128 v[116:119], v3 offset:59392
    s_waitcnt lgkmcnt(8)
    v_mfma_f32_16x16x32_bf16 v[224:227], v[32:35], v[120:123], v[224:227]
    v_mfma_f32_16x16x32_bf16 v[228:231], v[36:39], v[120:123], v[228:231]
    v_mfma_f32_16x16x32_bf16 v[232:235], v[40:43], v[120:123], v[232:235]
    v_mfma_f32_16x16x32_bf16 v[236:239], v[44:47], v[120:123], v[236:239]
    ds_read_b128 v[120:123], v3 offset:61440
    s_waitcnt lgkmcnt(8)
    v_mfma_f32_16x16x32_bf16 v[252:255], v[44:47], v[124:127], v[252:255]
    v_mfma_f32_16x16x32_bf16 v[248:251], v[40:43], v[124:127], v[248:251]
    v_mfma_f32_16x16x32_bf16 v[244:247], v[36:39], v[124:127], v[244:247]
    v_mfma_f32_16x16x32_bf16 v[240:243], v[32:35], v[124:127], v[240:243]
    ds_read_b128 v[124:127], v3 offset:63488
    ds_add_u32 v7, v8 offset:16
    s_waitcnt vmcnt(15) lgkmcnt(9)
    v_mfma_f32_16x16x32_bf16 v[128:131], v[64:67], v[96:99], v[128:131]
    s_add_u32 s48, s49, 1490944
    buffer_load_dwordx4 v[32:35], v1, s[80:83], s48 offen sc1
    s_waitcnt vmcnt(15)
    v_mfma_f32_16x16x32_bf16 v[132:135], v[68:71], v[96:99], v[132:135]
    s_waitcnt lgkmcnt(4)
    v_cmp_gt_u32 vcc, 45, v10
    s_waitcnt vmcnt(14)
    v_mfma_f32_16x16x32_bf16 v[136:139], v[72:75], v[96:99], v[136:139]
    s_cbranch_vccnz L_gs46
L_gb46:
    buffer_load_dwordx4 v[36:39], v1, s[80:83], s48 offen offset:1024 sc1
    s_waitcnt vmcnt(14)
    v_mfma_f32_16x16x32_bf16 v[140:143], v[76:79], v[96:99], v[140:143]
    ds_read_b128 v[96:99], v4 offset:0
    v_mfma_f32_16x16x32_bf16 v[156:159], v[76:79], v[100:103], v[156:159]
    buffer_load_dwordx4 v[40:43], v1, s[80:83], s48 offen offset:2048 sc1
    v_mfma_f32_16x16x32_bf16 v[152:155], v[72:75], v[100:103], v[152:155]
    v_mfma_f32_16x16x32_bf16 v[148:151], v[68:71], v[100:103], v[148:151]
    buffer_load_dwordx4 v[44:47], v1, s[80:83], s48 offen offset:3072 sc1
    v_mfma_f32_16x16x32_bf16 v[144:147], v[64:67], v[100:103], v[144:147]
    ds_read_b128 v[100:103], v4 offset:2048
    v_mfma_f32_16x16x32_bf16 v[160:163], v[64:67], v[104:107], v[160:163]
    v_mfma_f32_16x16x32_bf16 v[164:167], v[68:71], v[104:107], v[164:167]
    v_mfma_f32_16x16x32_bf16 v[168:171], v[72:75], v[104:107], v[168:171]
    v_mfma_f32_16x16x32_bf16 v[172:175], v[76:79], v[104:107], v[172:175]
    ds_read_b128 v[104:107], v4 offset:4096
    v_mfma_f32_16x16x32_bf16 v[188:191], v[76:79], v[108:111], v[188:191]
    v_mfma_f32_16x16x32_bf16 v[184:187], v[72:75], v[108:111], v[184:187]
    v_mfma_f32_16x16x32_bf16 v[180:183], v[68:71], v[108:111], v[180:183]
    v_mfma_f32_16x16x32_bf16 v[176:179], v[64:67], v[108:111], v[176:179]
    ds_read_b128 v[108:111], v4 offset:6144
    v_mfma_f32_16x16x32_bf16 v[192:195], v[64:67], v[112:115], v[192:195]
    v_mfma_f32_16x16x32_bf16 v[196:199], v[68:71], v[112:115], v[196:199]
    v_mfma_f32_16x16x32_bf16 v[200:203], v[72:75], v[112:115], v[200:203]
    v_mfma_f32_16x16x32_bf16 v[204:207], v[76:79], v[112:115], v[204:207]
    ds_read_b128 v[112:115], v4 offset:8192
    s_waitcnt lgkmcnt(8)
    v_mfma_f32_16x16x32_bf16 v[220:223], v[76:79], v[116:119], v[220:223]
    v_mfma_f32_16x16x32_bf16 v[216:219], v[72:75], v[116:119], v[216:219]
    v_mfma_f32_16x16x32_bf16 v[212:215], v[68:71], v[116:119], v[212:215]
    v_mfma_f32_16x16x32_bf16 v[208:211], v[64:67], v[116:119], v[208:211]
    ds_read_b128 v[116:119], v4 offset:10240
    s_waitcnt lgkmcnt(8)
    v_mfma_f32_16x16x32_bf16 v[224:227], v[64:67], v[120:123], v[224:227]
    v_mfma_f32_16x16x32_bf16 v[228:231], v[68:71], v[120:123], v[228:231]
    v_mfma_f32_16x16x32_bf16 v[232:235], v[72:75], v[120:123], v[232:235]
    v_mfma_f32_16x16x32_bf16 v[236:239], v[76:79], v[120:123], v[236:239]
    ds_read_b128 v[120:123], v4 offset:12288
    s_waitcnt lgkmcnt(8)
    v_mfma_f32_16x16x32_bf16 v[252:255], v[76:79], v[124:127], v[252:255]
    v_mfma_f32_16x16x32_bf16 v[248:251], v[72:75], v[124:127], v[248:251]
    v_mfma_f32_16x16x32_bf16 v[244:247], v[68:71], v[124:127], v[244:247]
    v_mfma_f32_16x16x32_bf16 v[240:243], v[64:67], v[124:127], v[240:243]
    ds_read_b128 v[124:127], v4 offset:14336
    s_waitcnt vmcnt(15) lgkmcnt(7)
    v_mfma_f32_16x16x32_bf16 v[128:131], v[80:83], v[96:99], v[128:131]
    s_add_u32 s48, s49, 1507328
    buffer_load_dwordx4 v[64:67], v1, s[80:83], s48 offen sc1
    s_waitcnt vmcnt(15)
    v_mfma_f32_16x16x32_bf16 v[132:135], v[84:87], v[96:99], v[132:135]
    s_waitcnt vmcnt(14)
    v_mfma_f32_16x16x32_bf16 v[136:139], v[88:91], v[96:99], v[136:139]
    buffer_load_dwordx4 v[68:71], v1, s[80:83], s48 offen offset:1024 sc1
    s_waitcnt vmcnt(14)
    v_mfma_f32_16x16x32_bf16 v[140:143], v[92:95], v[96:99], v[140:143]
    ds_read_b128 v[96:99], v5 offset:0
    s_waitcnt lgkmcnt(7)
    v_mfma_f32_16x16x32_bf16 v[156:159], v[92:95], v[100:103], v[156:159]
    buffer_load_dwordx4 v[72:75], v1, s[80:83], s48 offen offset:2048 sc1
    v_mfma_f32_16x16x32_bf16 v[152:155], v[88:91], v[100:103], v[152:155]
    v_mfma_f32_16x16x32_bf16 v[148:151], v[84:87], v[100:103], v[148:151]
    buffer_load_dwordx4 v[76:79], v1, s[80:83], s48 offen offset:3072 sc1
    v_mfma_f32_16x16x32_bf16 v[144:147], v[80:83], v[100:103], v[144:147]
    ds_read_b128 v[100:103], v5 offset:2048
    s_waitcnt lgkmcnt(7)
    v_mfma_f32_16x16x32_bf16 v[160:163], v[80:83], v[104:107], v[160:163]
    v_mfma_f32_16x16x32_bf16 v[164:167], v[84:87], v[104:107], v[164:167]
    v_mfma_f32_16x16x32_bf16 v[168:171], v[88:91], v[104:107], v[168:171]
    v_mfma_f32_16x16x32_bf16 v[172:175], v[92:95], v[104:107], v[172:175]
    ds_read_b128 v[104:107], v5 offset:4096
    s_waitcnt lgkmcnt(7)
    v_mfma_f32_16x16x32_bf16 v[188:191], v[92:95], v[108:111], v[188:191]
    v_mfma_f32_16x16x32_bf16 v[184:187], v[88:91], v[108:111], v[184:187]
    v_mfma_f32_16x16x32_bf16 v[180:183], v[84:87], v[108:111], v[180:183]
    v_mfma_f32_16x16x32_bf16 v[176:179], v[80:83], v[108:111], v[176:179]
    ds_read_b128 v[108:111], v5 offset:6144
    s_waitcnt lgkmcnt(7)
    v_mfma_f32_16x16x32_bf16 v[192:195], v[80:83], v[112:115], v[192:195]
    v_mfma_f32_16x16x32_bf16 v[196:199], v[84:87], v[112:115], v[196:199]
    v_mfma_f32_16x16x32_bf16 v[200:203], v[88:91], v[112:115], v[200:203]
    v_mfma_f32_16x16x32_bf16 v[204:207], v[92:95], v[112:115], v[204:207]
    ds_read_b128 v[112:115], v5 offset:8192
    ds_read_b32 v10, v9
    s_waitcnt lgkmcnt(8)
    v_mfma_f32_16x16x32_bf16 v[220:223], v[92:95], v[116:119], v[220:223]
    v_mfma_f32_16x16x32_bf16 v[216:219], v[88:91], v[116:119], v[216:219]
    v_mfma_f32_16x16x32_bf16 v[212:215], v[84:87], v[116:119], v[212:215]
    v_mfma_f32_16x16x32_bf16 v[208:211], v[80:83], v[116:119], v[208:211]
    ds_read_b128 v[116:119], v5 offset:10240
    s_waitcnt lgkmcnt(8)
    v_mfma_f32_16x16x32_bf16 v[224:227], v[80:83], v[120:123], v[224:227]
    v_mfma_f32_16x16x32_bf16 v[228:231], v[84:87], v[120:123], v[228:231]
    v_mfma_f32_16x16x32_bf16 v[232:235], v[88:91], v[120:123], v[232:235]
    v_mfma_f32_16x16x32_bf16 v[236:239], v[92:95], v[120:123], v[236:239]
    ds_read_b128 v[120:123], v5 offset:12288
    s_waitcnt lgkmcnt(8)
    v_mfma_f32_16x16x32_bf16 v[252:255], v[92:95], v[124:127], v[252:255]
    v_mfma_f32_16x16x32_bf16 v[248:251], v[88:91], v[124:127], v[248:251]
    v_mfma_f32_16x16x32_bf16 v[244:247], v[84:87], v[124:127], v[244:247]
    v_mfma_f32_16x16x32_bf16 v[240:243], v[80:83], v[124:127], v[240:243]
    ds_read_b128 v[124:127], v5 offset:14336
    ds_add_u32 v7, v8 offset:16
    s_waitcnt vmcnt(15) lgkmcnt(9)
    v_mfma_f32_16x16x32_bf16 v[128:131], v[48:51], v[96:99], v[128:131]
    s_add_u32 s48, s49, 1523712
    buffer_load_dwordx4 v[80:83], v1, s[80:83], s48 offen sc1
    s_waitcnt vmcnt(15)
    v_mfma_f32_16x16x32_bf16 v[132:135], v[52:55], v[96:99], v[132:135]
    s_waitcnt lgkmcnt(4)
    v_cmp_gt_u32 vcc, 46, v10
    s_waitcnt vmcnt(14)
    v_mfma_f32_16x16x32_bf16 v[136:139], v[56:59], v[96:99], v[136:139]
    s_cbranch_vccnz L_gs47
L_gb47:
    buffer_load_dwordx4 v[84:87], v1, s[80:83], s48 offen offset:1024 sc1
    s_waitcnt vmcnt(14)
    v_mfma_f32_16x16x32_bf16 v[140:143], v[60:63], v[96:99], v[140:143]
    ds_read_b128 v[96:99], v2 offset:0
    v_mfma_f32_16x16x32_bf16 v[156:159], v[60:63], v[100:103], v[156:159]
    buffer_load_dwordx4 v[88:91], v1, s[80:83], s48 offen offset:2048 sc1
    v_mfma_f32_16x16x32_bf16 v[152:155], v[56:59], v[100:103], v[152:155]
    v_mfma_f32_16x16x32_bf16 v[148:151], v[52:55], v[100:103], v[148:151]
    buffer_load_dwordx4 v[92:95], v1, s[80:83], s48 offen offset:3072 sc1
    v_mfma_f32_16x16x32_bf16 v[144:147], v[48:51], v[100:103], v[144:147]
    ds_read_b128 v[100:103], v2 offset:2048
    v_mfma_f32_16x16x32_bf16 v[160:163], v[48:51], v[104:107], v[160:163]
    v_mfma_f32_16x16x32_bf16 v[164:167], v[52:55], v[104:107], v[164:167]
    v_mfma_f32_16x16x32_bf16 v[168:171], v[56:59], v[104:107], v[168:171]
    v_mfma_f32_16x16x32_bf16 v[172:175], v[60:63], v[104:107], v[172:175]
    ds_read_b128 v[104:107], v2 offset:4096
    v_mfma_f32_16x16x32_bf16 v[188:191], v[60:63], v[108:111], v[188:191]
    v_mfma_f32_16x16x32_bf16 v[184:187], v[56:59], v[108:111], v[184:187]
    v_mfma_f32_16x16x32_bf16 v[180:183], v[52:55], v[108:111], v[180:183]
    v_mfma_f32_16x16x32_bf16 v[176:179], v[48:51], v[108:111], v[176:179]
    ds_read_b128 v[108:111], v2 offset:6144
    v_mfma_f32_16x16x32_bf16 v[192:195], v[48:51], v[112:115], v[192:195]
    v_mfma_f32_16x16x32_bf16 v[196:199], v[52:55], v[112:115], v[196:199]
    v_mfma_f32_16x16x32_bf16 v[200:203], v[56:59], v[112:115], v[200:203]
    v_mfma_f32_16x16x32_bf16 v[204:207], v[60:63], v[112:115], v[204:207]
    ds_read_b128 v[112:115], v2 offset:8192
    s_waitcnt lgkmcnt(8)
    v_mfma_f32_16x16x32_bf16 v[220:223], v[60:63], v[116:119], v[220:223]
    v_mfma_f32_16x16x32_bf16 v[216:219], v[56:59], v[116:119], v[216:219]
    v_mfma_f32_16x16x32_bf16 v[212:215], v[52:55], v[116:119], v[212:215]
    v_mfma_f32_16x16x32_bf16 v[208:211], v[48:51], v[116:119], v[208:211]
    ds_read_b128 v[116:119], v2 offset:10240
    s_waitcnt lgkmcnt(8)
    v_mfma_f32_16x16x32_bf16 v[224:227], v[48:51], v[120:123], v[224:227]
    v_mfma_f32_16x16x32_bf16 v[228:231], v[52:55], v[120:123], v[228:231]
    v_mfma_f32_16x16x32_bf16 v[232:235], v[56:59], v[120:123], v[232:235]
    v_mfma_f32_16x16x32_bf16 v[236:239], v[60:63], v[120:123], v[236:239]
    ds_read_b128 v[120:123], v2 offset:12288
    s_waitcnt lgkmcnt(8)
    v_mfma_f32_16x16x32_bf16 v[252:255], v[60:63], v[124:127], v[252:255]
    v_mfma_f32_16x16x32_bf16 v[248:251], v[56:59], v[124:127], v[248:251]
    v_mfma_f32_16x16x32_bf16 v[244:247], v[52:55], v[124:127], v[244:247]
    v_mfma_f32_16x16x32_bf16 v[240:243], v[48:51], v[124:127], v[240:243]
    ds_read_b128 v[124:127], v2 offset:14336
    s_waitcnt vmcnt(15) lgkmcnt(7)
    v_mfma_f32_16x16x32_bf16 v[128:131], v[16:19], v[96:99], v[128:131]
    s_add_u32 s48, s49, 1540096
    buffer_load_dwordx4 v[48:51], v1, s[80:83], s48 offen sc1
    s_waitcnt vmcnt(15)
    v_mfma_f32_16x16x32_bf16 v[132:135], v[20:23], v[96:99], v[132:135]
    s_waitcnt vmcnt(14)
    v_mfma_f32_16x16x32_bf16 v[136:139], v[24:27], v[96:99], v[136:139]
    buffer_load_dwordx4 v[52:55], v1, s[80:83], s48 offen offset:1024 sc1
    s_waitcnt vmcnt(14)
    v_mfma_f32_16x16x32_bf16 v[140:143], v[28:31], v[96:99], v[140:143]
    ds_read_b128 v[96:99], v3 offset:0
    s_waitcnt lgkmcnt(7)
    v_mfma_f32_16x16x32_bf16 v[156:159], v[28:31], v[100:103], v[156:159]
    buffer_load_dwordx4 v[56:59], v1, s[80:83], s48 offen offset:2048 sc1
    v_mfma_f32_16x16x32_bf16 v[152:155], v[24:27], v[100:103], v[152:155]
    v_mfma_f32_16x16x32_bf16 v[148:151], v[20:23], v[100:103], v[148:151]
    buffer_load_dwordx4 v[60:63], v1, s[80:83], s48 offen offset:3072 sc1
    v_mfma_f32_16x16x32_bf16 v[144:147], v[16:19], v[100:103], v[144:147]
    ds_read_b128 v[100:103], v3 offset:2048
    s_waitcnt lgkmcnt(7)
    v_mfma_f32_16x16x32_bf16 v[160:163], v[16:19], v[104:107], v[160:163]
    v_mfma_f32_16x16x32_bf16 v[164:167], v[20:23], v[104:107], v[164:167]
    v_mfma_f32_16x16x32_bf16 v[168:171], v[24:27], v[104:107], v[168:171]
    v_mfma_f32_16x16x32_bf16 v[172:175], v[28:31], v[104:107], v[172:175]
    ds_read_b128 v[104:107], v3 offset:4096
    s_mov_b32 s32, s16
    s_mov_b32 s33, s17
    s_mov_b32 s34, 2
    s_mov_b32 s35, 0x00020000
    v_mov_b32 v15, 0
    buffer_load_ushort v6, v15, s[32:35], 0 offen
    v_lshlrev_b32 v15, 3, v0
    s_mov_b32 s36, s12
    s_mov_b32 s37, s13
    s_mov_b32 s38, 512
    s_mov_b32 s39, 0x00020000
    buffer_load_dword v11, v15, s[36:39], 0 offen
    s_mov_b32 s36, s14
    s_mov_b32 s37, s15
    s_mov_b32 s38, 512
    s_mov_b32 s39, 0x00020000
    buffer_load_dword v14, v15, s[36:39], 0 offen
    s_waitcnt lgkmcnt(7)
    v_mfma_f32_16x16x32_bf16 v[188:191], v[28:31], v[108:111], v[188:191]
    v_mfma_f32_16x16x32_bf16 v[184:187], v[24:27], v[108:111], v[184:187]
    v_mfma_f32_16x16x32_bf16 v[180:183], v[20:23], v[108:111], v[180:183]
    v_mfma_f32_16x16x32_bf16 v[176:179], v[16:19], v[108:111], v[176:179]
    ds_read_b128 v[108:111], v3 offset:6144
    s_waitcnt lgkmcnt(7)
    v_mfma_f32_16x16x32_bf16 v[192:195], v[16:19], v[112:115], v[192:195]
    v_mfma_f32_16x16x32_bf16 v[196:199], v[20:23], v[112:115], v[196:199]
    v_mfma_f32_16x16x32_bf16 v[200:203], v[24:27], v[112:115], v[200:203]
    v_mfma_f32_16x16x32_bf16 v[204:207], v[28:31], v[112:115], v[204:207]
    ds_read_b128 v[112:115], v3 offset:8192
    ds_read_b32 v10, v9
    s_waitcnt lgkmcnt(8)
    v_mfma_f32_16x16x32_bf16 v[220:223], v[28:31], v[116:119], v[220:223]
    v_mfma_f32_16x16x32_bf16 v[216:219], v[24:27], v[116:119], v[216:219]
    v_mfma_f32_16x16x32_bf16 v[212:215], v[20:23], v[116:119], v[212:215]
    v_mfma_f32_16x16x32_bf16 v[208:211], v[16:19], v[116:119], v[208:211]
    ds_read_b128 v[116:119], v3 offset:10240
    s_waitcnt lgkmcnt(8)
    v_mfma_f32_16x16x32_bf16 v[224:227], v[16:19], v[120:123], v[224:227]
    v_mfma_f32_16x16x32_bf16 v[228:231], v[20:23], v[120:123], v[228:231]
    v_mfma_f32_16x16x32_bf16 v[232:235], v[24:27], v[120:123], v[232:235]
    v_mfma_f32_16x16x32_bf16 v[236:239], v[28:31], v[120:123], v[236:239]
    ds_read_b128 v[120:123], v3 offset:12288
    s_waitcnt lgkmcnt(8)
    v_mfma_f32_16x16x32_bf16 v[252:255], v[28:31], v[124:127], v[252:255]
    v_mfma_f32_16x16x32_bf16 v[248:251], v[24:27], v[124:127], v[248:251]
    v_mfma_f32_16x16x32_bf16 v[244:247], v[20:23], v[124:127], v[244:247]
    v_mfma_f32_16x16x32_bf16 v[240:243], v[16:19], v[124:127], v[240:243]
    ds_read_b128 v[124:127], v3 offset:14336
    s_waitcnt vmcnt(18) lgkmcnt(8)
    v_mfma_f32_16x16x32_bf16 v[128:131], v[32:35], v[96:99], v[128:131]
    s_add_u32 s48, s49, 1556480
    buffer_load_dwordx4 v[16:19], v1, s[80:83], s48 offen sc1
    s_waitcnt vmcnt(18)
    v_mfma_f32_16x16x32_bf16 v[132:135], v[36:39], v[96:99], v[132:135]
    s_waitcnt lgkmcnt(3)
    v_cmp_gt_u32 vcc, 47, v10
    s_waitcnt vmcnt(17)
    v_mfma_f32_16x16x32_bf16 v[136:139], v[40:43], v[96:99], v[136:139]
    s_cbranch_vccnz L_gs48
L_gb48:
    buffer_load_dwordx4 v[20:23], v1, s[80:83], s48 offen offset:1024 sc1
    s_waitcnt vmcnt(17)
    v_mfma_f32_16x16x32_bf16 v[140:143], v[44:47], v[96:99], v[140:143]
    ds_read_b128 v[96:99], v2 offset:16384
    v_mfma_f32_16x16x32_bf16 v[156:159], v[44:47], v[100:103], v[156:159]
    buffer_load_dwordx4 v[24:27], v1, s[80:83], s48 offen offset:2048 sc1
    v_mfma_f32_16x16x32_bf16 v[152:155], v[40:43], v[100:103], v[152:155]
    v_mfma_f32_16x16x32_bf16 v[148:151], v[36:39], v[100:103], v[148:151]
    buffer_load_dwordx4 v[28:31], v1, s[80:83], s48 offen offset:3072 sc1
    v_mfma_f32_16x16x32_bf16 v[144:147], v[32:35], v[100:103], v[144:147]
    ds_read_b128 v[100:103], v2 offset:18432
    v_mfma_f32_16x16x32_bf16 v[160:163], v[32:35], v[104:107], v[160:163]
    v_mfma_f32_16x16x32_bf16 v[164:167], v[36:39], v[104:107], v[164:167]
    v_mfma_f32_16x16x32_bf16 v[168:171], v[40:43], v[104:107], v[168:171]
    v_mfma_f32_16x16x32_bf16 v[172:175], v[44:47], v[104:107], v[172:175]
    ds_read_b128 v[104:107], v2 offset:20480
    v_mfma_f32_16x16x32_bf16 v[188:191], v[44:47], v[108:111], v[188:191]
    v_mfma_f32_16x16x32_bf16 v[184:187], v[40:43], v[108:111], v[184:187]
    v_mfma_f32_16x16x32_bf16 v[180:183], v[36:39], v[108:111], v[180:183]
    v_mfma_f32_16x16x32_bf16 v[176:179], v[32:35], v[108:111], v[176:179]
    ds_read_b128 v[108:111], v2 offset:22528
    v_mfma_f32_16x16x32_bf16 v[192:195], v[32:35], v[112:115], v[192:195]
    v_mfma_f32_16x16x32_bf16 v[196:199], v[36:39], v[112:115], v[196:199]
    v_mfma_f32_16x16x32_bf16 v[200:203], v[40:43], v[112:115], v[200:203]
    v_mfma_f32_16x16x32_bf16 v[204:207], v[44:47], v[112:115], v[204:207]
    ds_read_b128 v[112:115], v2 offset:24576
    s_waitcnt lgkmcnt(7)
    v_mfma_f32_16x16x32_bf16 v[220:223], v[44:47], v[116:119], v[220:223]
    v_mfma_f32_16x16x32_bf16 v[216:219], v[40:43], v[116:119], v[216:219]
    v_mfma_f32_16x16x32_bf16 v[212:215], v[36:39], v[116:119], v[212:215]
    v_mfma_f32_16x16x32_bf16 v[208:211], v[32:35], v[116:119], v[208:211]
    ds_read_b128 v[116:119], v2 offset:26624
    s_waitcnt lgkmcnt(7)
    v_mfma_f32_16x16x32_bf16 v[224:227], v[32:35], v[120:123], v[224:227]
    v_mfma_f32_16x16x32_bf16 v[228:231], v[36:39], v[120:123], v[228:231]
    v_mfma_f32_16x16x32_bf16 v[232:235], v[40:43], v[120:123], v[232:235]
    v_mfma_f32_16x16x32_bf16 v[236:239], v[44:47], v[120:123], v[236:239]
    ds_read_b128 v[120:123], v2 offset:28672
    s_waitcnt lgkmcnt(7)
    v_mfma_f32_16x16x32_bf16 v[252:255], v[44:47], v[124:127], v[252:255]
    v_mfma_f32_16x16x32_bf16 v[248:251], v[40:43], v[124:127], v[248:251]
    v_mfma_f32_16x16x32_bf16 v[244:247], v[36:39], v[124:127], v[244:247]
    v_mfma_f32_16x16x32_bf16 v[240:243], v[32:35], v[124:127], v[240:243]
    ds_read_b128 v[124:127], v2 offset:30720
    s_waitcnt vmcnt(18) lgkmcnt(7)
    v_mfma_f32_16x16x32_bf16 v[128:131], v[64:67], v[96:99], v[128:131]
    s_add_u32 s48, s49, 1572864
    buffer_load_dwordx4 v[32:35], v1, s[80:83], s48 offen sc1
    s_waitcnt vmcnt(18)
    v_mfma_f32_16x16x32_bf16 v[132:135], v[68:71], v[96:99], v[132:135]
    s_waitcnt vmcnt(17)
    v_mfma_f32_16x16x32_bf16 v[136:139], v[72:75], v[96:99], v[136:139]
    buffer_load_dwordx4 v[36:39], v1, s[80:83], s48 offen offset:1024 sc1
    s_waitcnt vmcnt(17)
    v_mfma_f32_16x16x32_bf16 v[140:143], v[76:79], v[96:99], v[140:143]
    ds_read_b128 v[96:99], v3 offset:16384
    s_waitcnt lgkmcnt(7)
    v_mfma_f32_16x16x32_bf16 v[156:159], v[76:79], v[100:103], v[156:159]
    buffer_load_dwordx4 v[40:43], v1, s[80:83], s48 offen offset:2048 sc1
    v_mfma_f32_16x16x32_bf16 v[152:155], v[72:75], v[100:103], v[152:155]
    v_mfma_f32_16x16x32_bf16 v[148:151], v[68:71], v[100:103], v[148:151]
    buffer_load_dwordx4 v[44:47], v1, s[80:83], s48 offen offset:3072 sc1
    v_mfma_f32_16x16x32_bf16 v[144:147], v[64:67], v[100:103], v[144:147]
    ds_read_b128 v[100:103], v3 offset:18432
    s_waitcnt lgkmcnt(7)
    v_mfma_f32_16x16x32_bf16 v[160:163], v[64:67], v[104:107], v[160:163]
    v_mfma_f32_16x16x32_bf16 v[164:167], v[68:71], v[104:107], v[164:167]
    v_mfma_f32_16x16x32_bf16 v[168:171], v[72:75], v[104:107], v[168:171]
    v_mfma_f32_16x16x32_bf16 v[172:175], v[76:79], v[104:107], v[172:175]
    ds_read_b128 v[104:107], v3 offset:20480
    s_waitcnt lgkmcnt(7)
    v_mfma_f32_16x16x32_bf16 v[188:191], v[76:79], v[108:111], v[188:191]
    v_mfma_f32_16x16x32_bf16 v[184:187], v[72:75], v[108:111], v[184:187]
    v_mfma_f32_16x16x32_bf16 v[180:183], v[68:71], v[108:111], v[180:183]
    v_mfma_f32_16x16x32_bf16 v[176:179], v[64:67], v[108:111], v[176:179]
    ds_read_b128 v[108:111], v3 offset:22528
    s_waitcnt lgkmcnt(7)
    v_mfma_f32_16x16x32_bf16 v[192:195], v[64:67], v[112:115], v[192:195]
    v_mfma_f32_16x16x32_bf16 v[196:199], v[68:71], v[112:115], v[196:199]
    v_mfma_f32_16x16x32_bf16 v[200:203], v[72:75], v[112:115], v[200:203]
    v_mfma_f32_16x16x32_bf16 v[204:207], v[76:79], v[112:115], v[204:207]
    ds_read_b128 v[112:115], v3 offset:24576
    ds_read_b32 v10, v9
    s_waitcnt lgkmcnt(8)
    v_mfma_f32_16x16x32_bf16 v[220:223], v[76:79], v[116:119], v[220:223]
    v_mfma_f32_16x16x32_bf16 v[216:219], v[72:75], v[116:119], v[216:219]
    v_mfma_f32_16x16x32_bf16 v[212:215], v[68:71], v[116:119], v[212:215]
    v_mfma_f32_16x16x32_bf16 v[208:211], v[64:67], v[116:119], v[208:211]
    ds_read_b128 v[116:119], v3 offset:26624
    s_waitcnt lgkmcnt(8)
    v_mfma_f32_16x16x32_bf16 v[224:227], v[64:67], v[120:123], v[224:227]
    v_mfma_f32_16x16x32_bf16 v[228:231], v[68:71], v[120:123], v[228:231]
    v_mfma_f32_16x16x32_bf16 v[232:235], v[72:75], v[120:123], v[232:235]
    v_mfma_f32_16x16x32_bf16 v[236:239], v[76:79], v[120:123], v[236:239]
    ds_read_b128 v[120:123], v3 offset:28672
    s_waitcnt lgkmcnt(8)
    v_mfma_f32_16x16x32_bf16 v[252:255], v[76:79], v[124:127], v[252:255]
    v_mfma_f32_16x16x32_bf16 v[248:251], v[72:75], v[124:127], v[248:251]
    v_mfma_f32_16x16x32_bf16 v[244:247], v[68:71], v[124:127], v[244:247]
    v_mfma_f32_16x16x32_bf16 v[240:243], v[64:67], v[124:127], v[240:243]
    ds_read_b128 v[124:127], v3 offset:30720
    s_waitcnt vmcnt(18) lgkmcnt(8)
    v_mfma_f32_16x16x32_bf16 v[128:131], v[80:83], v[96:99], v[128:131]
    s_add_u32 s48, s49, 1589248
    buffer_load_dwordx4 v[64:67], v1, s[80:83], s48 offen sc1
    s_waitcnt vmcnt(18)
    v_mfma_f32_16x16x32_bf16 v[132:135], v[84:87], v[96:99], v[132:135]
    s_waitcnt lgkmcnt(3)
    v_cmp_gt_u32 vcc, 48, v10
    s_waitcnt vmcnt(17)
    v_mfma_f32_16x16x32_bf16 v[136:139], v[88:91], v[96:99], v[136:139]
    s_cbranch_vccnz L_gs49
L_gb49:
    buffer_load_dwordx4 v[68:71], v1, s[80:83], s48 offen offset:1024 sc1
    s_waitcnt vmcnt(17)
    v_mfma_f32_16x16x32_bf16 v[140:143], v[92:95], v[96:99], v[140:143]
    ds_read_b128 v[96:99], v2 offset:32768
    v_mfma_f32_16x16x32_bf16 v[156:159], v[92:95], v[100:103], v[156:159]
    buffer_load_dwordx4 v[72:75], v1, s[80:83], s48 offen offset:2048 sc1
    v_mfma_f32_16x16x32_bf16 v[152:155], v[88:91], v[100:103], v[152:155]
    v_mfma_f32_16x16x32_bf16 v[148:151], v[84:87], v[100:103], v[148:151]
    buffer_load_dwordx4 v[76:79], v1, s[80:83], s48 offen offset:3072 sc1
    v_mfma_f32_16x16x32_bf16 v[144:147], v[80:83], v[100:103], v[144:147]
    ds_read_b128 v[100:103], v2 offset:34816
    v_mfma_f32_16x16x32_bf16 v[160:163], v[80:83], v[104:107], v[160:163]
    v_mfma_f32_16x16x32_bf16 v[164:167], v[84:87], v[104:107], v[164:167]
    v_mfma_f32_16x16x32_bf16 v[168:171], v[88:91], v[104:107], v[168:171]
    v_mfma_f32_16x16x32_bf16 v[172:175], v[92:95], v[104:107], v[172:175]
    ds_read_b128 v[104:107], v2 offset:36864
    v_mfma_f32_16x16x32_bf16 v[188:191], v[92:95], v[108:111], v[188:191]
    v_mfma_f32_16x16x32_bf16 v[184:187], v[88:91], v[108:111], v[184:187]
    v_mfma_f32_16x16x32_bf16 v[180:183], v[84:87], v[108:111], v[180:183]
    v_mfma_f32_16x16x32_bf16 v[176:179], v[80:83], v[108:111], v[176:179]
    ds_read_b128 v[108:111], v2 offset:38912
    v_mfma_f32_16x16x32_bf16 v[192:195], v[80:83], v[112:115], v[192:195]
    v_mfma_f32_16x16x32_bf16 v[196:199], v[84:87], v[112:115], v[196:199]
    v_mfma_f32_16x16x32_bf16 v[200:203], v[88:91], v[112:115], v[200:203]
    v_mfma_f32_16x16x32_bf16 v[204:207], v[92:95], v[112:115], v[204:207]
    ds_read_b128 v[112:115], v2 offset:40960
    s_waitcnt lgkmcnt(7)
    v_mfma_f32_16x16x32_bf16 v[220:223], v[92:95], v[116:119], v[220:223]
    v_mfma_f32_16x16x32_bf16 v[216:219], v[88:91], v[116:119], v[216:219]
    v_mfma_f32_16x16x32_bf16 v[212:215], v[84:87], v[116:119], v[212:215]
    v_mfma_f32_16x16x32_bf16 v[208:211], v[80:83], v[116:119], v[208:211]
    ds_read_b128 v[116:119], v2 offset:43008
    s_waitcnt lgkmcnt(7)
    v_mfma_f32_16x16x32_bf16 v[224:227], v[80:83], v[120:123], v[224:227]
    v_mfma_f32_16x16x32_bf16 v[228:231], v[84:87], v[120:123], v[228:231]
    v_mfma_f32_16x16x32_bf16 v[232:235], v[88:91], v[120:123], v[232:235]
    v_mfma_f32_16x16x32_bf16 v[236:239], v[92:95], v[120:123], v[236:239]
    ds_read_b128 v[120:123], v2 offset:45056
    s_waitcnt lgkmcnt(7)
    v_mfma_f32_16x16x32_bf16 v[252:255], v[92:95], v[124:127], v[252:255]
    v_mfma_f32_16x16x32_bf16 v[248:251], v[88:91], v[124:127], v[248:251]
    v_mfma_f32_16x16x32_bf16 v[244:247], v[84:87], v[124:127], v[244:247]
    v_mfma_f32_16x16x32_bf16 v[240:243], v[80:83], v[124:127], v[240:243]
    ds_read_b128 v[124:127], v2 offset:47104
    s_waitcnt vmcnt(18) lgkmcnt(7)
    v_mfma_f32_16x16x32_bf16 v[128:131], v[48:51], v[96:99], v[128:131]
    s_add_u32 s48, s49, 1605632
    buffer_load_dwordx4 v[80:83], v1, s[80:83], s48 offen sc1
    s_waitcnt vmcnt(18)
    v_mfma_f32_16x16x32_bf16 v[132:135], v[52:55], v[96:99], v[132:135]
    s_waitcnt vmcnt(17)
    v_mfma_f32_16x16x32_bf16 v[136:139], v[56:59], v[96:99], v[136:139]
    buffer_load_dwordx4 v[84:87], v1, s[80:83], s48 offen offset:1024 sc1
    s_waitcnt vmcnt(17)
    v_mfma_f32_16x16x32_bf16 v[140:143], v[60:63], v[96:99], v[140:143]
    ds_read_b128 v[96:99], v3 offset:32768
    s_waitcnt lgkmcnt(7)
    v_mfma_f32_16x16x32_bf16 v[156:159], v[60:63], v[100:103], v[156:159]
    buffer_load_dwordx4 v[88:91], v1, s[80:83], s48 offen offset:2048 sc1
    v_mfma_f32_16x16x32_bf16 v[152:155], v[56:59], v[100:103], v[152:155]
    v_mfma_f32_16x16x32_bf16 v[148:151], v[52:55], v[100:103], v[148:151]
    buffer_load_dwordx4 v[92:95], v1, s[80:83], s48 offen offset:3072 sc1
    v_mfma_f32_16x16x32_bf16 v[144:147], v[48:51], v[100:103], v[144:147]
    ds_read_b128 v[100:103], v3 offset:34816
    s_waitcnt lgkmcnt(7)
    v_mfma_f32_16x16x32_bf16 v[160:163], v[48:51], v[104:107], v[160:163]
    v_mfma_f32_16x16x32_bf16 v[164:167], v[52:55], v[104:107], v[164:167]
    v_mfma_f32_16x16x32_bf16 v[168:171], v[56:59], v[104:107], v[168:171]
    v_mfma_f32_16x16x32_bf16 v[172:175], v[60:63], v[104:107], v[172:175]
    ds_read_b128 v[104:107], v3 offset:36864
    s_waitcnt lgkmcnt(7)
    v_mfma_f32_16x16x32_bf16 v[188:191], v[60:63], v[108:111], v[188:191]
    v_mfma_f32_16x16x32_bf16 v[184:187], v[56:59], v[108:111], v[184:187]
    v_mfma_f32_16x16x32_bf16 v[180:183], v[52:55], v[108:111], v[180:183]
    v_mfma_f32_16x16x32_bf16 v[176:179], v[48:51], v[108:111], v[176:179]
    ds_read_b128 v[108:111], v3 offset:38912
    s_waitcnt lgkmcnt(7)
    v_mfma_f32_16x16x32_bf16 v[192:195], v[48:51], v[112:115], v[192:195]
    v_mfma_f32_16x16x32_bf16 v[196:199], v[52:55], v[112:115], v[196:199]
    v_mfma_f32_16x16x32_bf16 v[200:203], v[56:59], v[112:115], v[200:203]
    v_mfma_f32_16x16x32_bf16 v[204:207], v[60:63], v[112:115], v[204:207]
    ds_read_b128 v[112:115], v3 offset:40960
    ds_read_b32 v10, v9
    s_waitcnt lgkmcnt(8)
    v_mfma_f32_16x16x32_bf16 v[220:223], v[60:63], v[116:119], v[220:223]
    v_mfma_f32_16x16x32_bf16 v[216:219], v[56:59], v[116:119], v[216:219]
    v_mfma_f32_16x16x32_bf16 v[212:215], v[52:55], v[116:119], v[212:215]
    v_mfma_f32_16x16x32_bf16 v[208:211], v[48:51], v[116:119], v[208:211]
    ds_read_b128 v[116:119], v3 offset:43008
    s_waitcnt lgkmcnt(8)
    v_mfma_f32_16x16x32_bf16 v[224:227], v[48:51], v[120:123], v[224:227]
    v_mfma_f32_16x16x32_bf16 v[228:231], v[52:55], v[120:123], v[228:231]
    v_mfma_f32_16x16x32_bf16 v[232:235], v[56:59], v[120:123], v[232:235]
    v_mfma_f32_16x16x32_bf16 v[236:239], v[60:63], v[120:123], v[236:239]
    ds_read_b128 v[120:123], v3 offset:45056
    s_waitcnt lgkmcnt(8)
    v_mfma_f32_16x16x32_bf16 v[252:255], v[60:63], v[124:127], v[252:255]
    v_mfma_f32_16x16x32_bf16 v[248:251], v[56:59], v[124:127], v[248:251]
    v_mfma_f32_16x16x32_bf16 v[244:247], v[52:55], v[124:127], v[244:247]
    v_mfma_f32_16x16x32_bf16 v[240:243], v[48:51], v[124:127], v[240:243]
    ds_read_b128 v[124:127], v3 offset:47104
    s_waitcnt vmcnt(15) lgkmcnt(8)
    v_mfma_f32_16x16x32_bf16 v[128:131], v[16:19], v[96:99], v[128:131]
    s_add_u32 s48, s49, 1622016
    buffer_load_dwordx4 v[48:51], v1, s[80:83], s48 offen sc1
    s_waitcnt vmcnt(15)
    v_mfma_f32_16x16x32_bf16 v[132:135], v[20:23], v[96:99], v[132:135]
    s_waitcnt lgkmcnt(3)
    v_cmp_gt_u32 vcc, 50, v10
    s_waitcnt vmcnt(14)
    v_mfma_f32_16x16x32_bf16 v[136:139], v[24:27], v[96:99], v[136:139]
    s_cbranch_vccnz L_gs50
L_gb50:
    buffer_load_dwordx4 v[52:55], v1, s[80:83], s48 offen offset:1024 sc1
    s_waitcnt vmcnt(14)
    v_mfma_f32_16x16x32_bf16 v[140:143], v[28:31], v[96:99], v[140:143]
    ds_read_b128 v[96:99], v2 offset:57344
    v_mfma_f32_16x16x32_bf16 v[156:159], v[28:31], v[100:103], v[156:159]
    buffer_load_dwordx4 v[56:59], v1, s[80:83], s48 offen offset:2048 sc1
    v_mfma_f32_16x16x32_bf16 v[152:155], v[24:27], v[100:103], v[152:155]
    v_mfma_f32_16x16x32_bf16 v[148:151], v[20:23], v[100:103], v[148:151]
    buffer_load_dwordx4 v[60:63], v1, s[80:83], s48 offen offset:3072 sc1
    v_mfma_f32_16x16x32_bf16 v[144:147], v[16:19], v[100:103], v[144:147]
    ds_read_b128 v[100:103], v3 offset:57344
    v_mfma_f32_16x16x32_bf16 v[160:163], v[16:19], v[104:107], v[160:163]
    v_mfma_f32_16x16x32_bf16 v[164:167], v[20:23], v[104:107], v[164:167]
    v_mfma_f32_16x16x32_bf16 v[168:171], v[24:27], v[104:107], v[168:171]
    v_mfma_f32_16x16x32_bf16 v[172:175], v[28:31], v[104:107], v[172:175]
    ds_read_b128 v[104:107], v4 offset:8192
    v_mfma_f32_16x16x32_bf16 v[188:191], v[28:31], v[108:111], v[188:191]
    v_mfma_f32_16x16x32_bf16 v[184:187], v[24:27], v[108:111], v[184:187]
    v_mfma_f32_16x16x32_bf16 v[180:183], v[20:23], v[108:111], v[180:183]
    v_mfma_f32_16x16x32_bf16 v[176:179], v[16:19], v[108:111], v[176:179]
    ds_read_b128 v[108:111], v5 offset:8192
    v_mfma_f32_16x16x32_bf16 v[192:195], v[16:19], v[112:115], v[192:195]
    v_mfma_f32_16x16x32_bf16 v[196:199], v[20:23], v[112:115], v[196:199]
    v_mfma_f32_16x16x32_bf16 v[200:203], v[24:27], v[112:115], v[200:203]
    v_mfma_f32_16x16x32_bf16 v[204:207], v[28:31], v[112:115], v[204:207]
    ds_read_b128 v[112:115], v2 offset:59392
    s_waitcnt lgkmcnt(7)
    v_mfma_f32_16x16x32_bf16 v[220:223], v[28:31], v[116:119], v[220:223]
    v_mfma_f32_16x16x32_bf16 v[216:219], v[24:27], v[116:119], v[216:219]
    v_mfma_f32_16x16x32_bf16 v[212:215], v[20:23], v[116:119], v[212:215]
    v_mfma_f32_16x16x32_bf16 v[208:211], v[16:19], v[116:119], v[208:211]
    ds_read_b128 v[116:119], v3 offset:59392
    s_waitcnt lgkmcnt(7)
    v_mfma_f32_16x16x32_bf16 v[224:227], v[16:19], v[120:123], v[224:227]
    v_mfma_f32_16x16x32_bf16 v[228:231], v[20:23], v[120:123], v[228:231]
    v_mfma_f32_16x16x32_bf16 v[232:235], v[24:27], v[120:123], v[232:235]
    v_mfma_f32_16x16x32_bf16 v[236:239], v[28:31], v[120:123], v[236:239]
    ds_read_b128 v[120:123], v4 offset:10240
    s_waitcnt lgkmcnt(7)
    v_mfma_f32_16x16x32_bf16 v[252:255], v[28:31], v[124:127], v[252:255]
    v_mfma_f32_16x16x32_bf16 v[248:251], v[24:27], v[124:127], v[248:251]
    v_mfma_f32_16x16x32_bf16 v[244:247], v[20:23], v[124:127], v[244:247]
    v_mfma_f32_16x16x32_bf16 v[240:243], v[16:19], v[124:127], v[240:243]
    ds_read_b128 v[124:127], v5 offset:10240
    s_waitcnt vmcnt(15) lgkmcnt(7)
    v_mfma_f32_16x16x32_bf16 v[192:195], v[32:35], v[96:99], v[192:195]
    v_lshrrev_b32 v15, 4, v0
    s_lshl_b32 s29, s3, 7
    v_lshl_add_u32 v15, v15, 5, s29
    s_mov_b32 s32, s12
    s_mov_b32 s33, s13
    s_mov_b32 s34, 512
    s_mov_b32 s35, 0x00020000
    buffer_load_dwordx4 v[16:19], v15, s[32:35], 0 offen offset:0
    buffer_load_dwordx4 v[20:23], v15, s[32:35], 0 offen offset:16
    s_mov_b32 s36, s14
    s_mov_b32 s37, s15
    s_mov_b32 s38, 512
    s_mov_b32 s39, 0x00020000
    buffer_load_dwordx4 v[24:27], v15, s[36:39], 0 offen offset:0
    buffer_load_dwordx4 v[28:31], v15, s[36:39], 0 offen offset:16
    s_waitcnt vmcnt(18)
    v_mfma_f32_16x16x32_bf16 v[196:199], v[36:39], v[96:99], v[196:199]
    s_waitcnt vmcnt(17)
    v_mfma_f32_16x16x32_bf16 v[200:203], v[40:43], v[96:99], v[200:203]
    s_waitcnt vmcnt(16)
    v_mfma_f32_16x16x32_bf16 v[204:207], v[44:47], v[96:99], v[204:207]
    ds_read_b128 v[96:99], v2 offset:61440
    s_mov_b32 s40, 4096
    s_mov_b32 s41, 8192
    s_mov_b32 s42, 12288
    s_lshl_b32 s27, s2, 2
    s_add_u32 s27, s27, s3
    s_xor_b32 s28, s27, 32
    s_lshl_b32 s29, s27, 14
    v_lshl_add_u32 v14, v0, 4, s29
    s_lshl_b32 s29, s28, 8
    s_add_u32 s29, s29, 16777216
    v_mov_b32 v15, s29
    s_lshl_b32 s29, s27, 8
    s_add_u32 s29, s29, 16777216
    v_mov_b32 v11, s29
    s_waitcnt vmcnt(12) lgkmcnt(7)
    v_mfma_f32_16x16x32_bf16 v[204:207], v[76:79], v[100:103], v[204:207]
    v_mfma_f32_16x16x32_bf16 v[200:203], v[72:75], v[100:103], v[200:203]
    v_mfma_f32_16x16x32_bf16 v[196:199], v[68:71], v[100:103], v[196:199]
    v_mfma_f32_16x16x32_bf16 v[192:195], v[64:67], v[100:103], v[192:195]
    ds_read_b128 v[100:103], v3 offset:61440
    s_setprio 3
    s_waitcnt vmcnt(11) lgkmcnt(7)
    v_mfma_f32_16x16x32_bf16 v[192:195], v[80:83], v[104:107], v[192:195]
    s_waitcnt vmcnt(10)
    v_mfma_f32_16x16x32_bf16 v[196:199], v[84:87], v[104:107], v[196:199]
    s_waitcnt vmcnt(9)
    v_mfma_f32_16x16x32_bf16 v[200:203], v[88:91], v[104:107], v[200:203]
    s_waitcnt vmcnt(8)
    v_mfma_f32_16x16x32_bf16 v[204:207], v[92:95], v[104:107], v[204:207]
    ds_read_b128 v[104:107], v4 offset:12288
    s_waitcnt vmcnt(4) lgkmcnt(7)
    v_mfma_f32_16x16x32_bf16 v[204:207], v[60:63], v[108:111], v[204:207]
    v_mfma_f32_16x16x32_bf16 v[200:203], v[56:59], v[108:111], v[200:203]
    v_mfma_f32_16x16x32_bf16 v[196:199], v[52:55], v[108:111], v[196:199]
    v_mfma_f32_16x16x32_bf16 v[192:195], v[48:51], v[108:111], v[192:195]
    ds_read_b128 v[108:111], v5 offset:12288
    s_waitcnt lgkmcnt(7)
    v_mfma_f32_16x16x32_bf16 v[208:211], v[32:35], v[112:115], v[208:211]
    v_mfma_f32_16x16x32_bf16 v[212:215], v[36:39], v[112:115], v[212:215]
    v_mfma_f32_16x16x32_bf16 v[216:219], v[40:43], v[112:115], v[216:219]
    s_nop 2
    v_cvt_pk_f16_f32 v192, v192, v193
    v_cvt_pk_f16_f32 v193, v194, v195
    v_cvt_pk_f16_f32 v194, v196, v197
    v_cvt_pk_f16_f32 v195, v198, v199
    buffer_store_dwordx4 v[192:195], v14, s[80:83], 0 offen sc1
    v_mfma_f32_16x16x32_bf16 v[220:223], v[44:47], v[112:115], v[220:223]
    ds_read_b128 v[112:115], v2 offset:63488
    s_waitcnt lgkmcnt(7)
    v_mfma_f32_16x16x32_bf16 v[220:223], v[76:79], v[116:119], v[220:223]
    v_mfma_f32_16x16x32_bf16 v[216:219], v[72:75], v[116:119], v[216:219]
    v_mfma_f32_16x16x32_bf16 v[212:215], v[68:71], v[116:119], v[212:215]
    v_mfma_f32_16x16x32_bf16 v[208:211], v[64:67], v[116:119], v[208:211]
    ds_read_b128 v[116:119], v3 offset:63488
    s_waitcnt lgkmcnt(7)
    v_mfma_f32_16x16x32_bf16 v[208:211], v[80:83], v[120:123], v[208:211]
    v_cvt_pk_f16_f32 v200, v200, v201
    v_cvt_pk_f16_f32 v201, v202, v203
    v_cvt_pk_f16_f32 v202, v204, v205
    v_cvt_pk_f16_f32 v203, v206, v207
    buffer_store_dwordx4 v[200:203], v14, s[80:83], 0 offen offset:1024 sc1
    v_mfma_f32_16x16x32_bf16 v[212:215], v[84:87], v[120:123], v[212:215]
    v_mfma_f32_16x16x32_bf16 v[216:219], v[88:91], v[120:123], v[216:219]
    v_mfma_f32_16x16x32_bf16 v[220:223], v[92:95], v[120:123], v[220:223]
    ds_read_b128 v[120:123], v4 offset:14336
    s_waitcnt lgkmcnt(7)
    v_mfma_f32_16x16x32_bf16 v[220:223], v[60:63], v[124:127], v[220:223]
    v_mfma_f32_16x16x32_bf16 v[216:219], v[56:59], v[124:127], v[216:219]
    v_mfma_f32_16x16x32_bf16 v[212:215], v[52:55], v[124:127], v[212:215]
    v_mfma_f32_16x16x32_bf16 v[208:211], v[48:51], v[124:127], v[208:211]
    ds_read_b128 v[124:127], v5 offset:14336
    s_waitcnt lgkmcnt(7)
    v_mfma_f32_16x16x32_bf16 v[224:227], v[32:35], v[96:99], v[224:227]
    v_mfma_f32_16x16x32_bf16 v[228:231], v[36:39], v[96:99], v[228:231]
    v_mfma_f32_16x16x32_bf16 v[232:235], v[40:43], v[96:99], v[232:235]
    s_nop 2
    v_cvt_pk_f16_f32 v208, v208, v209
    v_cvt_pk_f16_f32 v209, v210, v211
    v_cvt_pk_f16_f32 v210, v212, v213
    v_cvt_pk_f16_f32 v211, v214, v215
    buffer_store_dwordx4 v[208:211], v14, s[80:83], 0 offen offset:2048 sc1
    v_mfma_f32_16x16x32_bf16 v[236:239], v[44:47], v[96:99], v[236:239]
    ds_read_b128 v[96:99], v2 offset:49152
    s_waitcnt lgkmcnt(7)
    v_mfma_f32_16x16x32_bf16 v[236:239], v[76:79], v[100:103], v[236:239]
    v_mfma_f32_16x16x32_bf16 v[232:235], v[72:75], v[100:103], v[232:235]
    v_mfma_f32_16x16x32_bf16 v[228:231], v[68:71], v[100:103], v[228:231]
    v_mfma_f32_16x16x32_bf16 v[224:227], v[64:67], v[100:103], v[224:227]
    ds_read_b128 v[100:103], v3 offset:49152
    s_waitcnt lgkmcnt(7)
    v_mfma_f32_16x16x32_bf16 v[224:227], v[80:83], v[104:107], v[224:227]
    v_cvt_pk_f16_f32 v216, v216, v217
    v_cvt_pk_f16_f32 v217, v218, v219
    v_cvt_pk_f16_f32 v218, v220, v221
    v_cvt_pk_f16_f32 v219, v222, v223
    buffer_store_dwordx4 v[216:219], v14, s[80:83], 0 offen offset:3072 sc1
    v_mfma_f32_16x16x32_bf16 v[228:231], v[84:87], v[104:107], v[228:231]
    v_mfma_f32_16x16x32_bf16 v[232:235], v[88:91], v[104:107], v[232:235]
    v_mfma_f32_16x16x32_bf16 v[236:239], v[92:95], v[104:107], v[236:239]
    ds_read_b128 v[104:107], v4 offset:0
    s_waitcnt lgkmcnt(7)
    v_mfma_f32_16x16x32_bf16 v[236:239], v[60:63], v[108:111], v[236:239]
    v_mfma_f32_16x16x32_bf16 v[232:235], v[56:59], v[108:111], v[232:235]
    v_mfma_f32_16x16x32_bf16 v[228:231], v[52:55], v[108:111], v[228:231]
    v_mfma_f32_16x16x32_bf16 v[224:227], v[48:51], v[108:111], v[224:227]
    ds_read_b128 v[108:111], v5 offset:0
    s_waitcnt lgkmcnt(7)
    v_mfma_f32_16x16x32_bf16 v[240:243], v[32:35], v[112:115], v[240:243]
    v_mfma_f32_16x16x32_bf16 v[244:247], v[36:39], v[112:115], v[244:247]
    v_mfma_f32_16x16x32_bf16 v[248:251], v[40:43], v[112:115], v[248:251]
    s_nop 2
    v_cvt_pk_f16_f32 v224, v224, v225
    v_cvt_pk_f16_f32 v225, v226, v227
    v_cvt_pk_f16_f32 v226, v228, v229
    v_cvt_pk_f16_f32 v227, v230, v231
    buffer_store_dwordx4 v[224:227], v14, s[80:83], s40 offen sc1
    v_mfma_f32_16x16x32_bf16 v[252:255], v[44:47], v[112:115], v[252:255]
    ds_read_b128 v[112:115], v2 offset:51200
    s_waitcnt lgkmcnt(7)
    v_mfma_f32_16x16x32_bf16 v[252:255], v[76:79], v[116:119], v[252:255]
    v_mfma_f32_16x16x32_bf16 v[248:251], v[72:75], v[116:119], v[248:251]
    v_mfma_f32_16x16x32_bf16 v[244:247], v[68:71], v[116:119], v[244:247]
    v_mfma_f32_16x16x32_bf16 v[240:243], v[64:67], v[116:119], v[240:243]
    ds_read_b128 v[116:119], v3 offset:51200
    s_waitcnt lgkmcnt(7)
    v_mfma_f32_16x16x32_bf16 v[240:243], v[80:83], v[120:123], v[240:243]
    v_cvt_pk_f16_f32 v232, v232, v233
    v_cvt_pk_f16_f32 v233, v234, v235
    v_cvt_pk_f16_f32 v234, v236, v237
    v_cvt_pk_f16_f32 v235, v238, v239
    buffer_store_dwordx4 v[232:235], v14, s[80:83], s40 offen offset:1024 sc1
    v_mfma_f32_16x16x32_bf16 v[244:247], v[84:87], v[120:123], v[244:247]
    v_mfma_f32_16x16x32_bf16 v[248:251], v[88:91], v[120:123], v[248:251]
    v_mfma_f32_16x16x32_bf16 v[252:255], v[92:95], v[120:123], v[252:255]
    ds_read_b128 v[120:123], v4 offset:2048
    s_waitcnt lgkmcnt(7)
    v_mfma_f32_16x16x32_bf16 v[252:255], v[60:63], v[124:127], v[252:255]
    v_mfma_f32_16x16x32_bf16 v[248:251], v[56:59], v[124:127], v[248:251]
    v_mfma_f32_16x16x32_bf16 v[244:247], v[52:55], v[124:127], v[244:247]
    v_mfma_f32_16x16x32_bf16 v[240:243], v[48:51], v[124:127], v[240:243]
    ds_read_b128 v[124:127], v5 offset:2048
    s_waitcnt lgkmcnt(7)
    v_mfma_f32_16x16x32_bf16 v[128:131], v[32:35], v[96:99], v[128:131]
    v_mfma_f32_16x16x32_bf16 v[132:135], v[36:39], v[96:99], v[132:135]
    v_mfma_f32_16x16x32_bf16 v[136:139], v[40:43], v[96:99], v[136:139]
    s_nop 2
    v_cvt_pk_f16_f32 v240, v240, v241
    v_cvt_pk_f16_f32 v241, v242, v243
    v_cvt_pk_f16_f32 v242, v244, v245
    v_cvt_pk_f16_f32 v243, v246, v247
    buffer_store_dwordx4 v[240:243], v14, s[80:83], s40 offen offset:2048 sc1
    v_mfma_f32_16x16x32_bf16 v[140:143], v[44:47], v[96:99], v[140:143]
    ds_read_b128 v[96:99], v2 offset:53248
    s_waitcnt lgkmcnt(7)
    v_mfma_f32_16x16x32_bf16 v[140:143], v[76:79], v[100:103], v[140:143]
    v_mfma_f32_16x16x32_bf16 v[136:139], v[72:75], v[100:103], v[136:139]
    v_mfma_f32_16x16x32_bf16 v[132:135], v[68:71], v[100:103], v[132:135]
    v_mfma_f32_16x16x32_bf16 v[128:131], v[64:67], v[100:103], v[128:131]
    ds_read_b128 v[100:103], v3 offset:53248
    s_waitcnt lgkmcnt(7)
    v_mfma_f32_16x16x32_bf16 v[128:131], v[80:83], v[104:107], v[128:131]
    v_cvt_pk_f16_f32 v248, v248, v249
    v_cvt_pk_f16_f32 v249, v250, v251
    v_cvt_pk_f16_f32 v250, v252, v253
    v_cvt_pk_f16_f32 v251, v254, v255
    buffer_store_dwordx4 v[248:251], v14, s[80:83], s40 offen offset:3072 sc1
    v_mfma_f32_16x16x32_bf16 v[132:135], v[84:87], v[104:107], v[132:135]
    v_mfma_f32_16x16x32_bf16 v[136:139], v[88:91], v[104:107], v[136:139]
    v_mfma_f32_16x16x32_bf16 v[140:143], v[92:95], v[104:107], v[140:143]
    ds_read_b128 v[104:107], v4 offset:4096
    s_waitcnt lgkmcnt(7)
    v_mfma_f32_16x16x32_bf16 v[140:143], v[60:63], v[108:111], v[140:143]
    v_mfma_f32_16x16x32_bf16 v[136:139], v[56:59], v[108:111], v[136:139]
    v_mfma_f32_16x16x32_bf16 v[132:135], v[52:55], v[108:111], v[132:135]
    v_mfma_f32_16x16x32_bf16 v[128:131], v[48:51], v[108:111], v[128:131]
    ds_read_b128 v[108:111], v5 offset:4096
    s_waitcnt lgkmcnt(7)
    v_mfma_f32_16x16x32_bf16 v[144:147], v[32:35], v[112:115], v[144:147]
    v_mfma_f32_16x16x32_bf16 v[148:151], v[36:39], v[112:115], v[148:151]
    v_mfma_f32_16x16x32_bf16 v[152:155], v[40:43], v[112:115], v[152:155]
    v_mfma_f32_16x16x32_bf16 v[156:159], v[44:47], v[112:115], v[156:159]
    ds_read_b128 v[112:115], v2 offset:55296
    s_waitcnt lgkmcnt(7)
    v_mfma_f32_16x16x32_bf16 v[156:159], v[76:79], v[116:119], v[156:159]
    v_mfma_f32_16x16x32_bf16 v[152:155], v[72:75], v[116:119], v[152:155]
    v_mfma_f32_16x16x32_bf16 v[148:151], v[68:71], v[116:119], v[148:151]
    v_mfma_f32_16x16x32_bf16 v[144:147], v[64:67], v[116:119], v[144:147]
    ds_read_b128 v[116:119], v3 offset:55296
    s_waitcnt lgkmcnt(7)
    v_mfma_f32_16x16x32_bf16 v[144:147], v[80:83], v[120:123], v[144:147]
    v_mfma_f32_16x16x32_bf16 v[148:151], v[84:87], v[120:123], v[148:151]
    v_mfma_f32_16x16x32_bf16 v[152:155], v[88:91], v[120:123], v[152:155]
    v_mfma_f32_16x16x32_bf16 v[156:159], v[92:95], v[120:123], v[156:159]
    ds_read_b128 v[120:123], v4 offset:6144
    s_waitcnt lgkmcnt(7)
    v_mfma_f32_16x16x32_bf16 v[156:159], v[60:63], v[124:127], v[156:159]
    v_mfma_f32_16x16x32_bf16 v[152:155], v[56:59], v[124:127], v[152:155]
    v_mfma_f32_16x16x32_bf16 v[148:151], v[52:55], v[124:127], v[148:151]
    v_mfma_f32_16x16x32_bf16 v[144:147], v[48:51], v[124:127], v[144:147]
    ds_read_b128 v[124:127], v5 offset:6144
    s_waitcnt lgkmcnt(7)
    v_mfma_f32_16x16x32_bf16 v[160:163], v[32:35], v[96:99], v[160:163]
    v_mfma_f32_16x16x32_bf16 v[164:167], v[36:39], v[96:99], v[164:167]
    v_mfma_f32_16x16x32_bf16 v[168:171], v[40:43], v[96:99], v[168:171]
    v_mfma_f32_16x16x32_bf16 v[172:175], v[44:47], v[96:99], v[172:175]
    s_waitcnt lgkmcnt(6)
    v_mfma_f32_16x16x32_bf16 v[172:175], v[76:79], v[100:103], v[172:175]
    v_mfma_f32_16x16x32_bf16 v[168:171], v[72:75], v[100:103], v[168:171]
    v_mfma_f32_16x16x32_bf16 v[164:167], v[68:71], v[100:103], v[164:167]
    v_mfma_f32_16x16x32_bf16 v[160:163], v[64:67], v[100:103], v[160:163]
    s_waitcnt lgkmcnt(5)
    v_mfma_f32_16x16x32_bf16 v[160:163], v[80:83], v[104:107], v[160:163]
    v_mfma_f32_16x16x32_bf16 v[164:167], v[84:87], v[104:107], v[164:167]
    v_mfma_f32_16x16x32_bf16 v[168:171], v[88:91], v[104:107], v[168:171]
    v_mfma_f32_16x16x32_bf16 v[172:175], v[92:95], v[104:107], v[172:175]
    s_waitcnt lgkmcnt(4)
    v_mfma_f32_16x16x32_bf16 v[172:175], v[60:63], v[108:111], v[172:175]
    v_mfma_f32_16x16x32_bf16 v[168:171], v[56:59], v[108:111], v[168:171]
    s_waitcnt vmcnt(2)
    s_mov_b64 exec, 1
    buffer_store_dword v8, v15, s[80:83], 0 offen sc1
    s_mov_b64 exec, -1
    v_mfma_f32_16x16x32_bf16 v[164:167], v[52:55], v[108:111], v[164:167]
    v_mfma_f32_16x16x32_bf16 v[160:163], v[48:51], v[108:111], v[160:163]
    s_waitcnt lgkmcnt(3)
    v_mfma_f32_16x16x32_bf16 v[176:179], v[32:35], v[112:115], v[176:179]
    v_mfma_f32_16x16x32_bf16 v[180:183], v[36:39], v[112:115], v[180:183]
    v_mfma_f32_16x16x32_bf16 v[184:187], v[40:43], v[112:115], v[184:187]
    v_mfma_f32_16x16x32_bf16 v[188:191], v[44:47], v[112:115], v[188:191]
    s_waitcnt lgkmcnt(2)
    v_mfma_f32_16x16x32_bf16 v[188:191], v[76:79], v[116:119], v[188:191]
    v_mfma_f32_16x16x32_bf16 v[184:187], v[72:75], v[116:119], v[184:187]
    v_mfma_f32_16x16x32_bf16 v[180:183], v[68:71], v[116:119], v[180:183]
    v_mfma_f32_16x16x32_bf16 v[176:179], v[64:67], v[116:119], v[176:179]
    s_waitcnt lgkmcnt(1)
    v_mfma_f32_16x16x32_bf16 v[176:179], v[80:83], v[120:123], v[176:179]
    v_mfma_f32_16x16x32_bf16 v[180:183], v[84:87], v[120:123], v[180:183]
    v_mfma_f32_16x16x32_bf16 v[184:187], v[88:91], v[120:123], v[184:187]
    v_mfma_f32_16x16x32_bf16 v[188:191], v[92:95], v[120:123], v[188:191]
    s_waitcnt lgkmcnt(0)
    v_mfma_f32_16x16x32_bf16 v[188:191], v[60:63], v[124:127], v[188:191]
    v_mfma_f32_16x16x32_bf16 v[184:187], v[56:59], v[124:127], v[184:187]
    v_mfma_f32_16x16x32_bf16 v[180:183], v[52:55], v[124:127], v[180:183]
    v_mfma_f32_16x16x32_bf16 v[176:179], v[48:51], v[124:127], v[176:179]
    v_mov_b32 v10, 0
    s_mov_b64 exec, 1
    buffer_atomic_umax v10, v11, s[80:83], 0 offen sc0 sc1
    s_mov_b64 exec, -1
    v_lshlrev_b32 v32, 16, v16
    v_and_b32 v36, 0xffff0000, v16
    v_lshlrev_b32 v40, 16, v17
    v_and_b32 v44, 0xffff0000, v17
    v_lshlrev_b32 v33, 16, v18
    v_and_b32 v37, 0xffff0000, v18
    v_lshlrev_b32 v41, 16, v19
    v_and_b32 v45, 0xffff0000, v19
    v_lshlrev_b32 v34, 16, v20
    v_and_b32 v38, 0xffff0000, v20
    v_lshlrev_b32 v42, 16, v21
    v_and_b32 v46, 0xffff0000, v21
    v_lshlrev_b32 v35, 16, v22
    v_and_b32 v39, 0xffff0000, v22
    v_lshlrev_b32 v43, 16, v23
    v_and_b32 v47, 0xffff0000, v23
    v_lshlrev_b32 v64, 16, v24
    v_and_b32 v68, 0xffff0000, v24
    v_lshlrev_b32 v72, 16, v25
    v_and_b32 v76, 0xffff0000, v25
    v_lshlrev_b32 v65, 16, v26
    v_and_b32 v69, 0xffff0000, v26
    v_lshlrev_b32 v73, 16, v27
    v_and_b32 v77, 0xffff0000, v27
    v_lshlrev_b32 v66, 16, v28
    v_and_b32 v70, 0xffff0000, v28
    v_lshlrev_b32 v74, 16, v29
    v_and_b32 v78, 0xffff0000, v29
    v_lshlrev_b32 v67, 16, v30
    v_and_b32 v71, 0xffff0000, v30
    v_lshlrev_b32 v75, 16, v31
    v_and_b32 v79, 0xffff0000, v31
    v_mov_b32 v86, 0xbdd2d3e8
    v_and_b32 v83, 15, v0
    v_lshrrev_b32 v84, 4, v0
    v_pk_add_f32 v[128:129], v[128:129], v[32:33]
    v_pk_add_f32 v[130:131], v[130:131], v[34:35]
    v_pk_add_f32 v[132:133], v[132:133], v[36:37]
    v_pk_add_f32 v[134:135], v[134:135], v[38:39]
    v_pk_add_f32 v[136:137], v[136:137], v[40:41]
    v_pk_add_f32 v[138:139], v[138:139], v[42:43]
    v_pk_add_f32 v[140:141], v[140:141], v[44:45]
    v_pk_add_f32 v[142:143], v[142:143], v[46:47]
    v_pk_add_f32 v[144:145], v[144:145], v[32:33]
    v_pk_add_f32 v[146:147], v[146:147], v[34:35]
    v_pk_add_f32 v[148:149], v[148:149], v[36:37]
    v_pk_add_f32 v[150:151], v[150:151], v[38:39]
    v_pk_add_f32 v[152:153], v[152:153], v[40:41]
    v_pk_add_f32 v[154:155], v[154:155], v[42:43]
    v_pk_add_f32 v[156:157], v[156:157], v[44:45]
    v_pk_add_f32 v[158:159], v[158:159], v[46:47]
    v_pk_add_f32 v[160:161], v[160:161], v[32:33]
    v_pk_add_f32 v[162:163], v[162:163], v[34:35]
    v_pk_add_f32 v[164:165], v[164:165], v[36:37]
    v_pk_add_f32 v[166:167], v[166:167], v[38:39]
    v_pk_add_f32 v[168:169], v[168:169], v[40:41]
    v_pk_add_f32 v[170:171], v[170:171], v[42:43]
    v_pk_add_f32 v[172:173], v[172:173], v[44:45]
    v_pk_add_f32 v[174:175], v[174:175], v[46:47]
    v_pk_add_f32 v[176:177], v[176:177], v[32:33]
    v_pk_add_f32 v[178:179], v[178:179], v[34:35]
    v_pk_add_f32 v[180:181], v[180:181], v[36:37]
    v_pk_add_f32 v[182:183], v[182:183], v[38:39]
    v_pk_add_f32 v[184:185], v[184:185], v[40:41]
    v_pk_add_f32 v[186:187], v[186:187], v[42:43]
    v_pk_add_f32 v[188:189], v[188:189], v[44:45]
    v_pk_add_f32 v[190:191], v[190:191], v[46:47]
    s_lshl_b32 s29, s28, 14
    v_lshl_add_u32 v14, v0, 4, s29
    s_waitcnt vmcnt(2)
    v_mov_b32 v8, 2
    s_mov_b64 exec, 1
    buffer_store_dword v8, v15, s[80:83], 0 offen sc1
    s_mov_b64 exec, -1
    s_mov_b64 exec, 1
    s_waitcnt vmcnt(1)
    v_cmp_gt_u32 vcc, 1, v10
    s_mov_b32 s51, 40000
    s_nop 0
    s_cbranch_vccz L_gx1b
L_gx1a:
    v_mov_b32 v10, 0
    buffer_atomic_umax v10, v11, s[80:83], 0 offen sc0 sc1
    s_waitcnt vmcnt(0)
    v_cmp_gt_u32 vcc, 1, v10
    s_sub_u32 s51, s51, 1
    s_cbranch_scc1 L_gx1b
    s_cbranch_vccnz L_gx1a
L_gx1b:
    s_mov_b64 exec, -1
    buffer_load_dwordx4 v[192:195], v14, s[80:83], 0 offen sc1
    buffer_load_dwordx4 v[196:199], v14, s[80:83], 0 offen offset:1024 sc1
    buffer_load_dwordx4 v[200:203], v14, s[80:83], 0 offen offset:2048 sc1
    buffer_load_dwordx4 v[204:207], v14, s[80:83], 0 offen offset:3072 sc1
    buffer_load_dwordx4 v[208:211], v14, s[80:83], s40 offen sc1
    buffer_load_dwordx4 v[212:215], v14, s[80:83], s40 offen offset:1024 sc1
    s_mov_b32 s44, 0xc0135761
    s_mov_b32 s45, 0xc0135761
    v_mov_b32 v87, v86
    v_mov_b32 v10, 0
    s_mov_b64 exec, 1
    buffer_atomic_umax v10, v11, s[80:83], 0 offen sc0 sc1
    s_mov_b64 exec, -1
    s_waitcnt vmcnt(6)
    v_fma_mix_f32 v128, v192, 1.0, v128 op_sel:[0,0,0] op_sel_hi:[1,0,0]
    v_fma_mix_f32 v129, v192, 1.0, v129 op_sel:[1,0,0] op_sel_hi:[1,0,0]
    v_fma_mix_f32 v130, v193, 1.0, v130 op_sel:[0,0,0] op_sel_hi:[1,0,0]
    v_fma_mix_f32 v131, v193, 1.0, v131 op_sel:[1,0,0] op_sel_hi:[1,0,0]
    v_pk_mul_f32 v[96:97], v[128:129], v[128:129]
    v_pk_mul_f32 v[98:99], v[130:131], v[130:131]
    v_pk_fma_f32 v[96:97], v[96:97], v[86:87], s[44:45]
    v_pk_fma_f32 v[98:99], v[98:99], v[86:87], s[44:45]
    v_pk_mul_f32 v[96:97], v[96:97], v[128:129]
    v_pk_mul_f32 v[98:99], v[98:99], v[130:131]
    v_exp_f32 v100, v96
    v_exp_f32 v101, v97
    v_exp_f32 v102, v98
    v_exp_f32 v103, v99
    v_pk_mul_f32 v[128:129], v[128:129], v[64:65]
    v_pk_mul_f32 v[130:131], v[130:131], v[66:67]
    v_pk_add_f32 v[100:101], v[100:101], 1.0 op_sel_hi:[1,0]
    v_pk_add_f32 v[102:103], v[102:103], 1.0 op_sel_hi:[1,0]
    v_rcp_f32 v100, v100
    v_rcp_f32 v101, v101
    v_rcp_f32 v102, v102
    v_rcp_f32 v103, v103
    v_pk_mul_f32 v[116:117], v[128:129], v[100:101]
    v_pk_fma_f32 v[116:117], v[130:131], v[102:103], v[116:117]
    v_fma_mix_f32 v132, v194, 1.0, v132 op_sel:[0,0,0] op_sel_hi:[1,0,0]
    v_fma_mix_f32 v133, v194, 1.0, v133 op_sel:[1,0,0] op_sel_hi:[1,0,0]
    v_fma_mix_f32 v134, v195, 1.0, v134 op_sel:[0,0,0] op_sel_hi:[1,0,0]
    v_fma_mix_f32 v135, v195, 1.0, v135 op_sel:[1,0,0] op_sel_hi:[1,0,0]
    v_pk_mul_f32 v[104:105], v[132:133], v[132:133]
    v_pk_mul_f32 v[106:107], v[134:135], v[134:135]
    v_pk_fma_f32 v[104:105], v[104:105], v[86:87], s[44:45]
    v_pk_fma_f32 v[106:107], v[106:107], v[86:87], s[44:45]
    v_pk_mul_f32 v[104:105], v[104:105], v[132:133]
    v_pk_mul_f32 v[106:107], v[106:107], v[134:135]
    v_exp_f32 v108, v104
    v_exp_f32 v109, v105
    v_exp_f32 v110, v106
    v_exp_f32 v111, v107
    v_pk_mul_f32 v[132:133], v[132:133], v[68:69]
    v_pk_mul_f32 v[134:135], v[134:135], v[70:71]
    v_pk_add_f32 v[108:109], v[108:109], 1.0 op_sel_hi:[1,0]
    v_pk_add_f32 v[110:111], v[110:111], 1.0 op_sel_hi:[1,0]
    v_rcp_f32 v108, v108
    v_rcp_f32 v109, v109
    v_rcp_f32 v110, v110
    v_rcp_f32 v111, v111
    v_pk_fma_f32 v[116:117], v[132:133], v[108:109], v[116:117]
    v_pk_fma_f32 v[116:117], v[134:135], v[110:111], v[116:117]
    s_waitcnt vmcnt(5)
    v_fma_mix_f32 v136, v196, 1.0, v136 op_sel:[0,0,0] op_sel_hi:[1,0,0]
    v_fma_mix_f32 v137, v196, 1.0, v137 op_sel:[1,0,0] op_sel_hi:[1,0,0]
    v_fma_mix_f32 v138, v197, 1.0, v138 op_sel:[0,0,0] op_sel_hi:[1,0,0]
    v_fma_mix_f32 v139, v197, 1.0, v139 op_sel:[1,0,0] op_sel_hi:[1,0,0]
    v_pk_mul_f32 v[96:97], v[136:137], v[136:137]
    v_pk_mul_f32 v[98:99], v[138:139], v[138:139]
    v_pk_fma_f32 v[96:97], v[96:97], v[86:87], s[44:45]
    v_pk_fma_f32 v[98:99], v[98:99], v[86:87], s[44:45]
    v_pk_mul_f32 v[96:97], v[96:97], v[136:137]
    v_pk_mul_f32 v[98:99], v[98:99], v[138:139]
    v_exp_f32 v100, v96
    v_exp_f32 v101, v97
    v_exp_f32 v102, v98
    v_exp_f32 v103, v99
    v_pk_mul_f32 v[136:137], v[136:137], v[72:73]
    v_pk_mul_f32 v[138:139], v[138:139], v[74:75]
    v_pk_add_f32 v[100:101], v[100:101], 1.0 op_sel_hi:[1,0]
    v_pk_add_f32 v[102:103], v[102:103], 1.0 op_sel_hi:[1,0]
    v_rcp_f32 v100, v100
    v_rcp_f32 v101, v101
    v_rcp_f32 v102, v102
    v_rcp_f32 v103, v103
    v_pk_fma_f32 v[116:117], v[136:137], v[100:101], v[116:117]
    v_pk_fma_f32 v[116:117], v[138:139], v[102:103], v[116:117]
    v_fma_mix_f32 v140, v198, 1.0, v140 op_sel:[0,0,0] op_sel_hi:[1,0,0]
    v_fma_mix_f32 v141, v198, 1.0, v141 op_sel:[1,0,0] op_sel_hi:[1,0,0]
    v_fma_mix_f32 v142, v199, 1.0, v142 op_sel:[0,0,0] op_sel_hi:[1,0,0]
    v_fma_mix_f32 v143, v199, 1.0, v143 op_sel:[1,0,0] op_sel_hi:[1,0,0]
    v_pk_mul_f32 v[104:105], v[140:141], v[140:141]
    v_pk_mul_f32 v[106:107], v[142:143], v[142:143]
    v_pk_fma_f32 v[104:105], v[104:105], v[86:87], s[44:45]
    v_pk_fma_f32 v[106:107], v[106:107], v[86:87], s[44:45]
    v_pk_mul_f32 v[104:105], v[104:105], v[140:141]
    v_pk_mul_f32 v[106:107], v[106:107], v[142:143]
    v_exp_f32 v108, v104
    v_exp_f32 v109, v105
    v_exp_f32 v110, v106
    v_exp_f32 v111, v107
    v_pk_mul_f32 v[140:141], v[140:141], v[76:77]
    v_pk_mul_f32 v[142:143], v[142:143], v[78:79]
    v_pk_add_f32 v[108:109], v[108:109], 1.0 op_sel_hi:[1,0]
    v_pk_add_f32 v[110:111], v[110:111], 1.0 op_sel_hi:[1,0]
    v_rcp_f32 v108, v108
    v_rcp_f32 v109, v109
    v_rcp_f32 v110, v110
    v_rcp_f32 v111, v111
    v_pk_fma_f32 v[116:117], v[140:141], v[108:109], v[116:117]
    v_pk_fma_f32 v[116:117], v[142:143], v[110:111], v[116:117]
    v_add_f32 v112, v116, v117
    s_mov_b64 exec, 1
    s_waitcnt vmcnt(0)
    v_cmp_gt_u32 vcc, 2, v10
    s_mov_b32 s51, 40000
    s_nop 0
    s_cbranch_vccz L_gx2b
L_gx2a:
    v_mov_b32 v10, 0
    buffer_atomic_umax v10, v11, s[80:83], 0 offen sc0 sc1
    s_waitcnt vmcnt(0)
    v_cmp_gt_u32 vcc, 2, v10
    s_sub_u32 s51, s51, 1
    s_cbranch_scc1 L_gx2b
    s_cbranch_vccnz L_gx2a
L_gx2b:
    s_mov_b64 exec, -1
    buffer_load_dwordx4 v[216:219], v14, s[80:83], s40 offen offset:2048 sc1
    buffer_load_dwordx4 v[220:223], v14, s[80:83], s40 offen offset:3072 sc1
    v_fma_mix_f32 v144, v200, 1.0, v144 op_sel:[0,0,0] op_sel_hi:[1,0,0]
    v_fma_mix_f32 v145, v200, 1.0, v145 op_sel:[1,0,0] op_sel_hi:[1,0,0]
    v_fma_mix_f32 v146, v201, 1.0, v146 op_sel:[0,0,0] op_sel_hi:[1,0,0]
    v_fma_mix_f32 v147, v201, 1.0, v147 op_sel:[1,0,0] op_sel_hi:[1,0,0]
    v_pk_mul_f32 v[96:97], v[144:145], v[144:145]
    v_pk_mul_f32 v[98:99], v[146:147], v[146:147]
    v_pk_fma_f32 v[96:97], v[96:97], v[86:87], s[44:45]
    v_pk_fma_f32 v[98:99], v[98:99], v[86:87], s[44:45]
    v_pk_mul_f32 v[96:97], v[96:97], v[144:145]
    v_pk_mul_f32 v[98:99], v[98:99], v[146:147]
    v_exp_f32 v100, v96
    v_exp_f32 v101, v97
    v_exp_f32 v102, v98
    v_exp_f32 v103, v99
    v_pk_mul_f32 v[144:145], v[144:145], v[64:65]
    v_pk_mul_f32 v[146:147], v[146:147], v[66:67]
    v_pk_add_f32 v[100:101], v[100:101], 1.0 op_sel_hi:[1,0]
    v_pk_add_f32 v[102:103], v[102:103], 1.0 op_sel_hi:[1,0]
    v_rcp_f32 v100, v100
    v_rcp_f32 v101, v101
    v_rcp_f32 v102, v102
    v_rcp_f32 v103, v103
    v_pk_mul_f32 v[118:119], v[144:145], v[100:101]
    v_pk_fma_f32 v[118:119], v[146:147], v[102:103], v[118:119]
    v_fma_mix_f32 v148, v202, 1.0, v148 op_sel:[0,0,0] op_sel_hi:[1,0,0]
    v_fma_mix_f32 v149, v202, 1.0, v149 op_sel:[1,0,0] op_sel_hi:[1,0,0]
    v_fma_mix_f32 v150, v203, 1.0, v150 op_sel:[0,0,0] op_sel_hi:[1,0,0]
    v_fma_mix_f32 v151, v203, 1.0, v151 op_sel:[1,0,0] op_sel_hi:[1,0,0]
    v_pk_mul_f32 v[104:105], v[148:149], v[148:149]
    v_pk_mul_f32 v[106:107], v[150:151], v[150:151]
    v_pk_fma_f32 v[104:105], v[104:105], v[86:87], s[44:45]
    v_pk_fma_f32 v[106:107], v[106:107], v[86:87], s[44:45]
    v_pk_mul_f32 v[104:105], v[104:105], v[148:149]
    v_pk_mul_f32 v[106:107], v[106:107], v[150:151]
    v_exp_f32 v108, v104
    v_exp_f32 v109, v105
    v_exp_f32 v110, v106
    v_exp_f32 v111, v107
    v_pk_mul_f32 v[148:149], v[148:149], v[68:69]
    v_pk_mul_f32 v[150:151], v[150:151], v[70:71]
    v_pk_add_f32 v[108:109], v[108:109], 1.0 op_sel_hi:[1,0]
    v_pk_add_f32 v[110:111], v[110:111], 1.0 op_sel_hi:[1,0]
    v_rcp_f32 v108, v108
    v_rcp_f32 v109, v109
    v_rcp_f32 v110, v110
    v_rcp_f32 v111, v111
    v_pk_fma_f32 v[118:119], v[148:149], v[108:109], v[118:119]
    v_pk_fma_f32 v[118:119], v[150:151], v[110:111], v[118:119]
    v_fma_mix_f32 v152, v204, 1.0, v152 op_sel:[0,0,0] op_sel_hi:[1,0,0]
    v_fma_mix_f32 v153, v204, 1.0, v153 op_sel:[1,0,0] op_sel_hi:[1,0,0]
    v_fma_mix_f32 v154, v205, 1.0, v154 op_sel:[0,0,0] op_sel_hi:[1,0,0]
    v_fma_mix_f32 v155, v205, 1.0, v155 op_sel:[1,0,0] op_sel_hi:[1,0,0]
    v_pk_mul_f32 v[96:97], v[152:153], v[152:153]
    v_pk_mul_f32 v[98:99], v[154:155], v[154:155]
    v_pk_fma_f32 v[96:97], v[96:97], v[86:87], s[44:45]
    v_pk_fma_f32 v[98:99], v[98:99], v[86:87], s[44:45]
    v_pk_mul_f32 v[96:97], v[96:97], v[152:153]
    v_pk_mul_f32 v[98:99], v[98:99], v[154:155]
    v_exp_f32 v100, v96
    v_exp_f32 v101, v97
    v_exp_f32 v102, v98
    v_exp_f32 v103, v99
    v_pk_mul_f32 v[152:153], v[152:153], v[72:73]
    v_pk_mul_f32 v[154:155], v[154:155], v[74:75]
    v_pk_add_f32 v[100:101], v[100:101], 1.0 op_sel_hi:[1,0]
    v_pk_add_f32 v[102:103], v[102:103], 1.0 op_sel_hi:[1,0]
    v_rcp_f32 v100, v100
    v_rcp_f32 v101, v101
    v_rcp_f32 v102, v102
    v_rcp_f32 v103, v103
    v_pk_fma_f32 v[118:119], v[152:153], v[100:101], v[118:119]
    v_pk_fma_f32 v[118:119], v[154:155], v[102:103], v[118:119]
    v_fma_mix_f32 v156, v206, 1.0, v156 op_sel:[0,0,0] op_sel_hi:[1,0,0]
    v_fma_mix_f32 v157, v206, 1.0, v157 op_sel:[1,0,0] op_sel_hi:[1,0,0]
    v_fma_mix_f32 v158, v207, 1.0, v158 op_sel:[0,0,0] op_sel_hi:[1,0,0]
    v_fma_mix_f32 v159, v207, 1.0, v159 op_sel:[1,0,0] op_sel_hi:[1,0,0]
    v_pk_mul_f32 v[104:105], v[156:157], v[156:157]
    v_pk_mul_f32 v[106:107], v[158:159], v[158:159]
    v_pk_fma_f32 v[104:105], v[104:105], v[86:87], s[44:45]
    v_pk_fma_f32 v[106:107], v[106:107], v[86:87], s[44:45]
    v_pk_mul_f32 v[104:105], v[104:105], v[156:157]
    v_pk_mul_f32 v[106:107], v[106:107], v[158:159]
    v_exp_f32 v108, v104
    v_exp_f32 v109, v105
    v_exp_f32 v110, v106
    v_exp_f32 v111, v107
    v_pk_mul_f32 v[156:157], v[156:157], v[76:77]
    v_pk_mul_f32 v[158:159], v[158:159], v[78:79]
    v_pk_add_f32 v[108:109], v[108:109], 1.0 op_sel_hi:[1,0]
    v_pk_add_f32 v[110:111], v[110:111], 1.0 op_sel_hi:[1,0]
    v_rcp_f32 v108, v108
    v_rcp_f32 v109, v109
    v_rcp_f32 v110, v110
    v_rcp_f32 v111, v111
    v_pk_fma_f32 v[118:119], v[156:157], v[108:109], v[118:119]
    v_pk_fma_f32 v[118:119], v[158:159], v[110:111], v[118:119]
    v_add_f32 v113, v118, v119
    v_fma_mix_f32 v160, v208, 1.0, v160 op_sel:[0,0,0] op_sel_hi:[1,0,0]
    v_fma_mix_f32 v161, v208, 1.0, v161 op_sel:[1,0,0] op_sel_hi:[1,0,0]
    v_fma_mix_f32 v162, v209, 1.0, v162 op_sel:[0,0,0] op_sel_hi:[1,0,0]
    v_fma_mix_f32 v163, v209, 1.0, v163 op_sel:[1,0,0] op_sel_hi:[1,0,0]
    v_pk_mul_f32 v[96:97], v[160:161], v[160:161]
    v_pk_mul_f32 v[98:99], v[162:163], v[162:163]
    v_pk_fma_f32 v[96:97], v[96:97], v[86:87], s[44:45]
    v_pk_fma_f32 v[98:99], v[98:99], v[86:87], s[44:45]
    v_pk_mul_f32 v[96:97], v[96:97], v[160:161]
    v_pk_mul_f32 v[98:99], v[98:99], v[162:163]
    v_exp_f32 v100, v96
    v_exp_f32 v101, v97
    v_exp_f32 v102, v98
    v_exp_f32 v103, v99
    v_pk_mul_f32 v[160:161], v[160:161], v[64:65]
    v_pk_mul_f32 v[162:163], v[162:163], v[66:67]
    v_pk_add_f32 v[100:101], v[100:101], 1.0 op_sel_hi:[1,0]
    v_pk_add_f32 v[102:103], v[102:103], 1.0 op_sel_hi:[1,0]
    v_rcp_f32 v100, v100
    v_rcp_f32 v101, v101
    v_rcp_f32 v102, v102
    v_rcp_f32 v103, v103
    v_pk_mul_f32 v[120:121], v[160:161], v[100:101]
    v_pk_fma_f32 v[120:121], v[162:163], v[102:103], v[120:121]
    v_fma_mix_f32 v164, v210, 1.0, v164 op_sel:[0,0,0] op_sel_hi:[1,0,0]
    v_fma_mix_f32 v165, v210, 1.0, v165 op_sel:[1,0,0] op_sel_hi:[1,0,0]
    v_fma_mix_f32 v166, v211, 1.0, v166 op_sel:[0,0,0] op_sel_hi:[1,0,0]
    v_fma_mix_f32 v167, v211, 1.0, v167 op_sel:[1,0,0] op_sel_hi:[1,0,0]
    v_pk_mul_f32 v[104:105], v[164:165], v[164:165]
    v_pk_mul_f32 v[106:107], v[166:167], v[166:167]
    v_pk_fma_f32 v[104:105], v[104:105], v[86:87], s[44:45]
    v_pk_fma_f32 v[106:107], v[106:107], v[86:87], s[44:45]
    v_pk_mul_f32 v[104:105], v[104:105], v[164:165]
    v_pk_mul_f32 v[106:107], v[106:107], v[166:167]
    v_exp_f32 v108, v104
    v_exp_f32 v109, v105
    v_exp_f32 v110, v106
    v_exp_f32 v111, v107
    v_pk_mul_f32 v[164:165], v[164:165], v[68:69]
    v_pk_mul_f32 v[166:167], v[166:167], v[70:71]
    v_pk_add_f32 v[108:109], v[108:109], 1.0 op_sel_hi:[1,0]
    v_pk_add_f32 v[110:111], v[110:111], 1.0 op_sel_hi:[1,0]
    v_rcp_f32 v108, v108
    v_rcp_f32 v109, v109
    v_rcp_f32 v110, v110
    v_rcp_f32 v111, v111
    v_pk_fma_f32 v[120:121], v[164:165], v[108:109], v[120:121]
    v_pk_fma_f32 v[120:121], v[166:167], v[110:111], v[120:121]
    v_fma_mix_f32 v168, v212, 1.0, v168 op_sel:[0,0,0] op_sel_hi:[1,0,0]
    v_fma_mix_f32 v169, v212, 1.0, v169 op_sel:[1,0,0] op_sel_hi:[1,0,0]
    v_fma_mix_f32 v170, v213, 1.0, v170 op_sel:[0,0,0] op_sel_hi:[1,0,0]
    v_fma_mix_f32 v171, v213, 1.0, v171 op_sel:[1,0,0] op_sel_hi:[1,0,0]
    v_pk_mul_f32 v[96:97], v[168:169], v[168:169]
    v_pk_mul_f32 v[98:99], v[170:171], v[170:171]
    v_pk_fma_f32 v[96:97], v[96:97], v[86:87], s[44:45]
    v_pk_fma_f32 v[98:99], v[98:99], v[86:87], s[44:45]
    v_pk_mul_f32 v[96:97], v[96:97], v[168:169]
    v_pk_mul_f32 v[98:99], v[98:99], v[170:171]
    v_exp_f32 v100, v96
    v_exp_f32 v101, v97
    v_exp_f32 v102, v98
    v_exp_f32 v103, v99
    v_pk_mul_f32 v[168:169], v[168:169], v[72:73]
    v_pk_mul_f32 v[170:171], v[170:171], v[74:75]
    v_pk_add_f32 v[100:101], v[100:101], 1.0 op_sel_hi:[1,0]
    v_pk_add_f32 v[102:103], v[102:103], 1.0 op_sel_hi:[1,0]
    v_rcp_f32 v100, v100
    v_rcp_f32 v101, v101
    v_rcp_f32 v102, v102
    v_rcp_f32 v103, v103
    v_pk_fma_f32 v[120:121], v[168:169], v[100:101], v[120:121]
    v_pk_fma_f32 v[120:121], v[170:171], v[102:103], v[120:121]
    v_fma_mix_f32 v172, v214, 1.0, v172 op_sel:[0,0,0] op_sel_hi:[1,0,0]
    v_fma_mix_f32 v173, v214, 1.0, v173 op_sel:[1,0,0] op_sel_hi:[1,0,0]
    v_fma_mix_f32 v174, v215, 1.0, v174 op_sel:[0,0,0] op_sel_hi:[1,0,0]
    v_fma_mix_f32 v175, v215, 1.0, v175 op_sel:[1,0,0] op_sel_hi:[1,0,0]
    v_pk_mul_f32 v[104:105], v[172:173], v[172:173]
    v_pk_mul_f32 v[106:107], v[174:175], v[174:175]
    v_pk_fma_f32 v[104:105], v[104:105], v[86:87], s[44:45]
    v_pk_fma_f32 v[106:107], v[106:107], v[86:87], s[44:45]
    v_pk_mul_f32 v[104:105], v[104:105], v[172:173]
    v_pk_mul_f32 v[106:107], v[106:107], v[174:175]
    v_exp_f32 v108, v104
    v_exp_f32 v109, v105
    v_exp_f32 v110, v106
    v_exp_f32 v111, v107
    v_pk_mul_f32 v[172:173], v[172:173], v[76:77]
    v_pk_mul_f32 v[174:175], v[174:175], v[78:79]
    v_pk_add_f32 v[108:109], v[108:109], 1.0 op_sel_hi:[1,0]
    v_pk_add_f32 v[110:111], v[110:111], 1.0 op_sel_hi:[1,0]
    v_rcp_f32 v108, v108
    v_rcp_f32 v109, v109
    v_rcp_f32 v110, v110
    v_rcp_f32 v111, v111
    v_pk_fma_f32 v[120:121], v[172:173], v[108:109], v[120:121]
    v_pk_fma_f32 v[120:121], v[174:175], v[110:111], v[120:121]
    v_add_f32 v114, v120, v121
    s_waitcnt vmcnt(1)
    v_fma_mix_f32 v176, v216, 1.0, v176 op_sel:[0,0,0] op_sel_hi:[1,0,0]
    v_fma_mix_f32 v177, v216, 1.0, v177 op_sel:[1,0,0] op_sel_hi:[1,0,0]
    v_fma_mix_f32 v178, v217, 1.0, v178 op_sel:[0,0,0] op_sel_hi:[1,0,0]
    v_fma_mix_f32 v179, v217, 1.0, v179 op_sel:[1,0,0] op_sel_hi:[1,0,0]
    v_pk_mul_f32 v[96:97], v[176:177], v[176:177]
    v_pk_mul_f32 v[98:99], v[178:179], v[178:179]
    v_pk_fma_f32 v[96:97], v[96:97], v[86:87], s[44:45]
    v_pk_fma_f32 v[98:99], v[98:99], v[86:87], s[44:45]
    v_pk_mul_f32 v[96:97], v[96:97], v[176:177]
    v_pk_mul_f32 v[98:99], v[98:99], v[178:179]
    v_exp_f32 v100, v96
    v_exp_f32 v101, v97
    v_exp_f32 v102, v98
    v_exp_f32 v103, v99
    v_pk_mul_f32 v[176:177], v[176:177], v[64:65]
    v_pk_mul_f32 v[178:179], v[178:179], v[66:67]
    v_pk_add_f32 v[100:101], v[100:101], 1.0 op_sel_hi:[1,0]
    v_pk_add_f32 v[102:103], v[102:103], 1.0 op_sel_hi:[1,0]
    v_rcp_f32 v100, v100
    v_rcp_f32 v101, v101
    v_rcp_f32 v102, v102
    v_rcp_f32 v103, v103
    v_pk_mul_f32 v[122:123], v[176:177], v[100:101]
    v_pk_fma_f32 v[122:123], v[178:179], v[102:103], v[122:123]
    v_fma_mix_f32 v180, v218, 1.0, v180 op_sel:[0,0,0] op_sel_hi:[1,0,0]
    v_fma_mix_f32 v181, v218, 1.0, v181 op_sel:[1,0,0] op_sel_hi:[1,0,0]
    v_fma_mix_f32 v182, v219, 1.0, v182 op_sel:[0,0,0] op_sel_hi:[1,0,0]
    v_fma_mix_f32 v183, v219, 1.0, v183 op_sel:[1,0,0] op_sel_hi:[1,0,0]
    v_pk_mul_f32 v[104:105], v[180:181], v[180:181]
    v_pk_mul_f32 v[106:107], v[182:183], v[182:183]
    v_pk_fma_f32 v[104:105], v[104:105], v[86:87], s[44:45]
    v_pk_fma_f32 v[106:107], v[106:107], v[86:87], s[44:45]
    v_pk_mul_f32 v[104:105], v[104:105], v[180:181]
    v_pk_mul_f32 v[106:107], v[106:107], v[182:183]
    v_exp_f32 v108, v104
    v_exp_f32 v109, v105
    v_exp_f32 v110, v106
    v_exp_f32 v111, v107
    v_pk_mul_f32 v[180:181], v[180:181], v[68:69]
    v_pk_mul_f32 v[182:183], v[182:183], v[70:71]
    v_pk_add_f32 v[108:109], v[108:109], 1.0 op_sel_hi:[1,0]
    v_pk_add_f32 v[110:111], v[110:111], 1.0 op_sel_hi:[1,0]
    v_rcp_f32 v108, v108
    v_rcp_f32 v109, v109
    v_rcp_f32 v110, v110
    v_rcp_f32 v111, v111
    v_pk_fma_f32 v[122:123], v[180:181], v[108:109], v[122:123]
    v_pk_fma_f32 v[122:123], v[182:183], v[110:111], v[122:123]
    s_waitcnt vmcnt(0)
    v_fma_mix_f32 v184, v220, 1.0, v184 op_sel:[0,0,0] op_sel_hi:[1,0,0]
    v_fma_mix_f32 v185, v220, 1.0, v185 op_sel:[1,0,0] op_sel_hi:[1,0,0]
    v_fma_mix_f32 v186, v221, 1.0, v186 op_sel:[0,0,0] op_sel_hi:[1,0,0]
    v_fma_mix_f32 v187, v221, 1.0, v187 op_sel:[1,0,0] op_sel_hi:[1,0,0]
    v_pk_mul_f32 v[96:97], v[184:185], v[184:185]
    v_pk_mul_f32 v[98:99], v[186:187], v[186:187]
    v_pk_fma_f32 v[96:97], v[96:97], v[86:87], s[44:45]
    v_pk_fma_f32 v[98:99], v[98:99], v[86:87], s[44:45]
    v_pk_mul_f32 v[96:97], v[96:97], v[184:185]
    v_pk_mul_f32 v[98:99], v[98:99], v[186:187]
    v_exp_f32 v100, v96
    v_exp_f32 v101, v97
    v_exp_f32 v102, v98
    v_exp_f32 v103, v99
    v_pk_mul_f32 v[184:185], v[184:185], v[72:73]
    v_pk_mul_f32 v[186:187], v[186:187], v[74:75]
    v_pk_add_f32 v[100:101], v[100:101], 1.0 op_sel_hi:[1,0]
    v_pk_add_f32 v[102:103], v[102:103], 1.0 op_sel_hi:[1,0]
    v_rcp_f32 v100, v100
    v_rcp_f32 v101, v101
    v_rcp_f32 v102, v102
    v_rcp_f32 v103, v103
    v_pk_fma_f32 v[122:123], v[184:185], v[100:101], v[122:123]
    v_pk_fma_f32 v[122:123], v[186:187], v[102:103], v[122:123]
    v_fma_mix_f32 v188, v222, 1.0, v188 op_sel:[0,0,0] op_sel_hi:[1,0,0]
    v_fma_mix_f32 v189, v222, 1.0, v189 op_sel:[1,0,0] op_sel_hi:[1,0,0]
    v_fma_mix_f32 v190, v223, 1.0, v190 op_sel:[0,0,0] op_sel_hi:[1,0,0]
    v_fma_mix_f32 v191, v223, 1.0, v191 op_sel:[1,0,0] op_sel_hi:[1,0,0]
    v_pk_mul_f32 v[104:105], v[188:189], v[188:189]
    v_pk_mul_f32 v[106:107], v[190:191], v[190:191]
    v_pk_fma_f32 v[104:105], v[104:105], v[86:87], s[44:45]
    v_pk_fma_f32 v[106:107], v[106:107], v[86:87], s[44:45]
    v_pk_mul_f32 v[104:105], v[104:105], v[188:189]
    v_pk_mul_f32 v[106:107], v[106:107], v[190:191]
    v_exp_f32 v108, v104
    v_exp_f32 v109, v105
    v_exp_f32 v110, v106
    v_exp_f32 v111, v107
    v_pk_mul_f32 v[188:189], v[188:189], v[76:77]
    v_pk_mul_f32 v[190:191], v[190:191], v[78:79]
    v_pk_add_f32 v[108:109], v[108:109], 1.0 op_sel_hi:[1,0]
    v_pk_add_f32 v[110:111], v[110:111], 1.0 op_sel_hi:[1,0]
    v_rcp_f32 v108, v108
    v_rcp_f32 v109, v109
    v_rcp_f32 v110, v110
    v_rcp_f32 v111, v111
    v_pk_fma_f32 v[122:123], v[188:189], v[108:109], v[122:123]
    v_pk_fma_f32 v[122:123], v[190:191], v[110:111], v[122:123]
    v_add_f32 v115, v122, v123
    v_permlane32_swap_b32 v112, v113
    s_nop 0
    v_permlane32_swap_b32 v114, v115
    v_add_f32 v112, v112, v113
    v_add_f32 v114, v114, v115
    s_nop 1
    v_permlane16_swap_b32 v112, v114
    v_add_f32 v112, v112, v114
    v_and_b32 v80, 1, v84
    v_lshrrev_b32 v81, 1, v84
    v_lshl_or_b32 v80, v80, 1, v81
    v_lshl_or_b32 v80, v80, 4, v83
    s_lshl_b32 s29, s3, 8
    s_add_u32 s29, s29, 95232
    v_lshl_add_u32 v80, v80, 2, s29
    ds_write_b32 v80, v112
    s_waitcnt lgkmcnt(0)
    s_barrier
    s_cmp_lg_u32 s3, 0
    s_cbranch_scc1 L_gdone
    v_lshlrev_b32 v80, 2, v0
    v_add_u32 v80, 95232, v80
    ds_read_b32 v48, v80 offset:0
    ds_read_b32 v49, v80 offset:256
    ds_read_b32 v50, v80 offset:512
    ds_read_b32 v51, v80 offset:768
    ds_read_b32 v52, v80 offset:1024
    s_mov_b32 s32, s18
    s_mov_b32 s33, s19
    s_mov_b32 s34, 32768
    s_mov_b32 s35, 0x00020000
    s_lshl_b32 s29, s25, 6
    s_add_u32 s29, s29, s26
    s_lshl_b32 s29, s29, 1
    v_lshl_add_u32 v81, v0, 1, s29
    s_waitcnt lgkmcnt(3)
    v_add_f32 v48, v48, v49
    s_waitcnt lgkmcnt(1)
    v_add_f32 v50, v50, v51
    v_add_f32 v48, v48, v50
    s_waitcnt lgkmcnt(0)
    v_cvt_pk_bf16_f32 v48, v48, v52
    v_lshlrev_b32 v49, 16, v48
    v_and_b32 v50, 0xffff0000, v48
    v_lshlrev_b32 v6, 16, v6
    v_add_f32 v49, v49, v6
    v_cvt_pk_bf16_f32 v49, v49, v49
    v_lshlrev_b32 v49, 16, v49
    v_add_f32 v49, v49, v50
    v_cvt_pk_bf16_f32 v49, v49, v49
    buffer_store_short v49, v81, s[32:35], 0 offen
L_gdone:
    s_nop 1
    s_endpgm
L_gs0:
    ds_read_b32 v10, v9 offset:32
    s_waitcnt lgkmcnt(0)
    v_cmp_gt_u32 vcc, 1, v10
    s_sub_i32 s51, s51, 1
    s_cmp_lt_i32 s51, 0
    s_cbranch_scc1 L_gb0
    s_cbranch_vccnz L_gs0
    s_branch L_gb0
L_gs1:
    ds_read_b32 v10, v9
    s_waitcnt lgkmcnt(0)
    v_cmp_gt_u32 vcc, 1, v10
    s_sub_i32 s51, s51, 1
    s_cmp_lt_i32 s51, 0
    s_cbranch_scc1 L_gb1
    s_cbranch_vccnz L_gs1
    s_branch L_gb1
L_gs2:
    ds_read_b32 v10, v9
    s_waitcnt lgkmcnt(0)
    v_cmp_gt_u32 vcc, 2, v10
    s_sub_i32 s51, s51, 1
    s_cmp_lt_i32 s51, 0
    s_cbranch_scc1 L_gb2
    s_cbranch_vccnz L_gs2
    s_branch L_gb2
L_gs3:
    ds_read_b32 v10, v9
    s_waitcnt lgkmcnt(0)
    v_cmp_gt_u32 vcc, 3, v10
    s_sub_i32 s51, s51, 1
    s_cmp_lt_i32 s51, 0
    s_cbranch_scc1 L_gb3
    s_cbranch_vccnz L_gs3
    s_branch L_gb3
L_gs4:
    ds_read_b32 v10, v9
    s_waitcnt lgkmcnt(0)
    v_cmp_gt_u32 vcc, 4, v10
    s_sub_i32 s51, s51, 1
    s_cmp_lt_i32 s51, 0
    s_cbranch_scc1 L_gb4
    s_cbranch_vccnz L_gs4
    s_branch L_gb4
L_gs5:
    ds_read_b32 v10, v9
    s_waitcnt lgkmcnt(0)
    v_cmp_gt_u32 vcc, 5, v10
    s_sub_i32 s51, s51, 1
    s_cmp_lt_i32 s51, 0
    s_cbranch_scc1 L_gb5
    s_cbranch_vccnz L_gs5
    s_branch L_gb5
L_gs6:
    ds_read_b32 v10, v9
    s_waitcnt lgkmcnt(0)
    v_cmp_gt_u32 vcc, 6, v10
    s_sub_i32 s51, s51, 1
    s_cmp_lt_i32 s51, 0
    s_cbranch_scc1 L_gb6
    s_cbranch_vccnz L_gs6
    s_branch L_gb6
L_gs7:
    ds_read_b32 v15, v9 offset:64
    s_waitcnt lgkmcnt(0)
    v_cmp_gt_u32 vcc, 1, v15
    s_sub_i32 s51, s51, 1
    s_cmp_lt_i32 s51, 0
    s_cbranch_scc1 L_gb7
    s_cbranch_vccnz L_gs7
    s_branch L_gb7
L_gs8:
    ds_read_b32 v10, v9
    s_waitcnt lgkmcnt(0)
    v_cmp_gt_u32 vcc, 7, v10
    s_sub_i32 s51, s51, 1
    s_cmp_lt_i32 s51, 0
    s_cbranch_scc1 L_gb8
    s_cbranch_vccnz L_gs8
    s_branch L_gb8
L_gs9:
    ds_read_b32 v10, v9
    s_waitcnt lgkmcnt(0)
    v_cmp_gt_u32 vcc, 8, v10
    s_sub_i32 s51, s51, 1
    s_cmp_lt_i32 s51, 0
    s_cbranch_scc1 L_gb9
    s_cbranch_vccnz L_gs9
    s_branch L_gb9
L_gs10:
    ds_read_b32 v10, v9
    s_waitcnt lgkmcnt(0)
    v_cmp_gt_u32 vcc, 9, v10
    s_sub_i32 s51, s51, 1
    s_cmp_lt_i32 s51, 0
    s_cbranch_scc1 L_gb10
    s_cbranch_vccnz L_gs10
    s_branch L_gb10
L_gs11:
    ds_read_b32 v10, v9
    s_waitcnt lgkmcnt(0)
    v_cmp_gt_u32 vcc, 10, v10
    s_sub_i32 s51, s51, 1
    s_cmp_lt_i32 s51, 0
    s_cbranch_scc1 L_gb11
    s_cbranch_vccnz L_gs11
    s_branch L_gb11
L_gs12:
    ds_read_b32 v10, v9
    s_waitcnt lgkmcnt(0)
    v_cmp_gt_u32 vcc, 11, v10
    s_sub_i32 s51, s51, 1
    s_cmp_lt_i32 s51, 0
    s_cbranch_scc1 L_gb12
    s_cbranch_vccnz L_gs12
    s_branch L_gb12
L_gs13:
    ds_read_b32 v10, v9
    s_waitcnt lgkmcnt(0)
    v_cmp_gt_u32 vcc, 12, v10
    s_sub_i32 s51, s51, 1
    s_cmp_lt_i32 s51, 0
    s_cbranch_scc1 L_gb13
    s_cbranch_vccnz L_gs13
    s_branch L_gb13
L_gs14:
    ds_read_b32 v10, v9
    s_waitcnt lgkmcnt(0)
    v_cmp_gt_u32 vcc, 13, v10
    s_sub_i32 s51, s51, 1
    s_cmp_lt_i32 s51, 0
    s_cbranch_scc1 L_gb14
    s_cbranch_vccnz L_gs14
    s_branch L_gb14
L_gs15:
    ds_read_b32 v10, v9
    s_waitcnt lgkmcnt(0)
    v_cmp_gt_u32 vcc, 14, v10
    s_sub_i32 s51, s51, 1
    s_cmp_lt_i32 s51, 0
    s_cbranch_scc1 L_gb15
    s_cbranch_vccnz L_gs15
    s_branch L_gb15
L_gs16:
    ds_read_b32 v10, v9
    s_waitcnt lgkmcnt(0)
    v_cmp_gt_u32 vcc, 15, v10
    s_sub_i32 s51, s51, 1
    s_cmp_lt_i32 s51, 0
    s_cbranch_scc1 L_gb16
    s_cbranch_vccnz L_gs16
    s_branch L_gb16
L_gs17:
    ds_read_b32 v10, v9
    s_waitcnt lgkmcnt(0)
    v_cmp_gt_u32 vcc, 16, v10
    s_sub_i32 s51, s51, 1
    s_cmp_lt_i32 s51, 0
    s_cbranch_scc1 L_gb17
    s_cbranch_vccnz L_gs17
    s_branch L_gb17
L_gs18:
    ds_read_b32 v10, v9
    s_waitcnt lgkmcnt(0)
    v_cmp_gt_u32 vcc, 17, v10
    s_sub_i32 s51, s51, 1
    s_cmp_lt_i32 s51, 0
    s_cbranch_scc1 L_gb18
    s_cbranch_vccnz L_gs18
    s_branch L_gb18
L_gs19:
    ds_read_b32 v10, v9
    s_waitcnt lgkmcnt(0)
    v_cmp_gt_u32 vcc, 18, v10
    s_sub_i32 s51, s51, 1
    s_cmp_lt_i32 s51, 0
    s_cbranch_scc1 L_gb19
    s_cbranch_vccnz L_gs19
    s_branch L_gb19
L_gs20:
    ds_read_b32 v10, v9
    s_waitcnt lgkmcnt(0)
    v_cmp_gt_u32 vcc, 19, v10
    s_sub_i32 s51, s51, 1
    s_cmp_lt_i32 s51, 0
    s_cbranch_scc1 L_gb20
    s_cbranch_vccnz L_gs20
    s_branch L_gb20
L_gs21:
    ds_read_b32 v10, v9
    s_waitcnt lgkmcnt(0)
    v_cmp_gt_u32 vcc, 20, v10
    s_sub_i32 s51, s51, 1
    s_cmp_lt_i32 s51, 0
    s_cbranch_scc1 L_gb21
    s_cbranch_vccnz L_gs21
    s_branch L_gb21
L_gs22:
    ds_read_b32 v10, v9
    s_waitcnt lgkmcnt(0)
    v_cmp_gt_u32 vcc, 21, v10
    s_sub_i32 s51, s51, 1
    s_cmp_lt_i32 s51, 0
    s_cbranch_scc1 L_gb22
    s_cbranch_vccnz L_gs22
    s_branch L_gb22
L_gs23:
    ds_read_b32 v10, v9
    s_waitcnt lgkmcnt(0)
    v_cmp_gt_u32 vcc, 22, v10
    s_sub_i32 s51, s51, 1
    s_cmp_lt_i32 s51, 0
    s_cbranch_scc1 L_gb23
    s_cbranch_vccnz L_gs23
    s_branch L_gb23
L_gs24:
    ds_read_b32 v10, v9
    s_waitcnt lgkmcnt(0)
    v_cmp_gt_u32 vcc, 23, v10
    s_sub_i32 s51, s51, 1
    s_cmp_lt_i32 s51, 0
    s_cbranch_scc1 L_gb24
    s_cbranch_vccnz L_gs24
    s_branch L_gb24
L_gs25:
    ds_read_b32 v10, v9
    s_waitcnt lgkmcnt(0)
    v_cmp_gt_u32 vcc, 24, v10
    s_sub_i32 s51, s51, 1
    s_cmp_lt_i32 s51, 0
    s_cbranch_scc1 L_gb25
    s_cbranch_vccnz L_gs25
    s_branch L_gb25
L_gs26:
    ds_read_b32 v10, v9
    s_waitcnt lgkmcnt(0)
    v_cmp_gt_u32 vcc, 25, v10
    s_sub_i32 s51, s51, 1
    s_cmp_lt_i32 s51, 0
    s_cbranch_scc1 L_gb26
    s_cbranch_vccnz L_gs26
    s_branch L_gb26
L_gs27:
    ds_read_b32 v10, v9
    s_waitcnt lgkmcnt(0)
    v_cmp_gt_u32 vcc, 26, v10
    s_sub_i32 s51, s51, 1
    s_cmp_lt_i32 s51, 0
    s_cbranch_scc1 L_gb27
    s_cbranch_vccnz L_gs27
    s_branch L_gb27
L_gs28:
    ds_read_b32 v10, v9
    s_waitcnt lgkmcnt(0)
    v_cmp_gt_u32 vcc, 27, v10
    s_sub_i32 s51, s51, 1
    s_cmp_lt_i32 s51, 0
    s_cbranch_scc1 L_gb28
    s_cbranch_vccnz L_gs28
    s_branch L_gb28
L_gs29:
    ds_read_b32 v10, v9
    s_waitcnt lgkmcnt(0)
    v_cmp_gt_u32 vcc, 28, v10
    s_sub_i32 s51, s51, 1
    s_cmp_lt_i32 s51, 0
    s_cbranch_scc1 L_gb29
    s_cbranch_vccnz L_gs29
    s_branch L_gb29
L_gs30:
    ds_read_b32 v10, v9
    s_waitcnt lgkmcnt(0)
    v_cmp_gt_u32 vcc, 29, v10
    s_sub_i32 s51, s51, 1
    s_cmp_lt_i32 s51, 0
    s_cbranch_scc1 L_gb30
    s_cbranch_vccnz L_gs30
    s_branch L_gb30
L_gs31:
    ds_read_b32 v10, v9
    s_waitcnt lgkmcnt(0)
    v_cmp_gt_u32 vcc, 30, v10
    s_sub_i32 s51, s51, 1
    s_cmp_lt_i32 s51, 0
    s_cbranch_scc1 L_gb31
    s_cbranch_vccnz L_gs31
    s_branch L_gb31
L_gs32:
    ds_read_b32 v10, v9
    s_waitcnt lgkmcnt(0)
    v_cmp_gt_u32 vcc, 31, v10
    s_sub_i32 s51, s51, 1
    s_cmp_lt_i32 s51, 0
    s_cbranch_scc1 L_gb32
    s_cbranch_vccnz L_gs32
    s_branch L_gb32
L_gs33:
    ds_read_b32 v10, v9
    s_waitcnt lgkmcnt(0)
    v_cmp_gt_u32 vcc, 32, v10
    s_sub_i32 s51, s51, 1
    s_cmp_lt_i32 s51, 0
    s_cbranch_scc1 L_gb33
    s_cbranch_vccnz L_gs33
    s_branch L_gb33
L_gs34:
    ds_read_b32 v10, v9
    s_waitcnt lgkmcnt(0)
    v_cmp_gt_u32 vcc, 33, v10
    s_sub_i32 s51, s51, 1
    s_cmp_lt_i32 s51, 0
    s_cbranch_scc1 L_gb34
    s_cbranch_vccnz L_gs34
    s_branch L_gb34
L_gs35:
    ds_read_b32 v10, v9
    s_waitcnt lgkmcnt(0)
    v_cmp_gt_u32 vcc, 34, v10
    s_sub_i32 s51, s51, 1
    s_cmp_lt_i32 s51, 0
    s_cbranch_scc1 L_gb35
    s_cbranch_vccnz L_gs35
    s_branch L_gb35
L_gs36:
    ds_read_b32 v10, v9
    s_waitcnt lgkmcnt(0)
    v_cmp_gt_u32 vcc, 35, v10
    s_sub_i32 s51, s51, 1
    s_cmp_lt_i32 s51, 0
    s_cbranch_scc1 L_gb36
    s_cbranch_vccnz L_gs36
    s_branch L_gb36
L_gs37:
    ds_read_b32 v10, v9
    s_waitcnt lgkmcnt(0)
    v_cmp_gt_u32 vcc, 36, v10
    s_sub_i32 s51, s51, 1
    s_cmp_lt_i32 s51, 0
    s_cbranch_scc1 L_gb37
    s_cbranch_vccnz L_gs37
    s_branch L_gb37
L_gs38:
    ds_read_b32 v10, v9
    s_waitcnt lgkmcnt(0)
    v_cmp_gt_u32 vcc, 37, v10
    s_sub_i32 s51, s51, 1
    s_cmp_lt_i32 s51, 0
    s_cbranch_scc1 L_gb38
    s_cbranch_vccnz L_gs38
    s_branch L_gb38
L_gs39:
    ds_read_b32 v10, v9
    s_waitcnt lgkmcnt(0)
    v_cmp_gt_u32 vcc, 38, v10
    s_sub_i32 s51, s51, 1
    s_cmp_lt_i32 s51, 0
    s_cbranch_scc1 L_gb39
    s_cbranch_vccnz L_gs39
    s_branch L_gb39
L_gs40:
    ds_read_b32 v10, v9
    s_waitcnt lgkmcnt(0)
    v_cmp_gt_u32 vcc, 39, v10
    s_sub_i32 s51, s51, 1
    s_cmp_lt_i32 s51, 0
    s_cbranch_scc1 L_gb40
    s_cbranch_vccnz L_gs40
    s_branch L_gb40
L_gs41:
    ds_read_b32 v10, v9
    s_waitcnt lgkmcnt(0)
    v_cmp_gt_u32 vcc, 40, v10
    s_sub_i32 s51, s51, 1
    s_cmp_lt_i32 s51, 0
    s_cbranch_scc1 L_gb41
    s_cbranch_vccnz L_gs41
    s_branch L_gb41
L_gs42:
    ds_read_b32 v10, v9
    s_waitcnt lgkmcnt(0)
    v_cmp_gt_u32 vcc, 41, v10
    s_sub_i32 s51, s51, 1
    s_cmp_lt_i32 s51, 0
    s_cbranch_scc1 L_gb42
    s_cbranch_vccnz L_gs42
    s_branch L_gb42
L_gs43:
    ds_read_b32 v10, v9
    s_waitcnt lgkmcnt(0)
    v_cmp_gt_u32 vcc, 42, v10
    s_sub_i32 s51, s51, 1
    s_cmp_lt_i32 s51, 0
    s_cbranch_scc1 L_gb43
    s_cbranch_vccnz L_gs43
    s_branch L_gb43
L_gs44:
    ds_read_b32 v10, v9
    s_waitcnt lgkmcnt(0)
    v_cmp_gt_u32 vcc, 43, v10
    s_sub_i32 s51, s51, 1
    s_cmp_lt_i32 s51, 0
    s_cbranch_scc1 L_gb44
    s_cbranch_vccnz L_gs44
    s_branch L_gb44
L_gs45:
    ds_read_b32 v10, v9
    s_waitcnt lgkmcnt(0)
    v_cmp_gt_u32 vcc, 44, v10
    s_sub_i32 s51, s51, 1
    s_cmp_lt_i32 s51, 0
    s_cbranch_scc1 L_gb45
    s_cbranch_vccnz L_gs45
    s_branch L_gb45
L_gs46:
    ds_read_b32 v10, v9
    s_waitcnt lgkmcnt(0)
    v_cmp_gt_u32 vcc, 45, v10
    s_sub_i32 s51, s51, 1
    s_cmp_lt_i32 s51, 0
    s_cbranch_scc1 L_gb46
    s_cbranch_vccnz L_gs46
    s_branch L_gb46
L_gs47:
    ds_read_b32 v10, v9
    s_waitcnt lgkmcnt(0)
    v_cmp_gt_u32 vcc, 46, v10
    s_sub_i32 s51, s51, 1
    s_cmp_lt_i32 s51, 0
    s_cbranch_scc1 L_gb47
    s_cbranch_vccnz L_gs47
    s_branch L_gb47
L_gs48:
    ds_read_b32 v10, v9
    s_waitcnt lgkmcnt(0)
    v_cmp_gt_u32 vcc, 47, v10
    s_sub_i32 s51, s51, 1
    s_cmp_lt_i32 s51, 0
    s_cbranch_scc1 L_gb48
    s_cbranch_vccnz L_gs48
    s_branch L_gb48
L_gs49:
    ds_read_b32 v10, v9
    s_waitcnt lgkmcnt(0)
    v_cmp_gt_u32 vcc, 48, v10
    s_sub_i32 s51, s51, 1
    s_cmp_lt_i32 s51, 0
    s_cbranch_scc1 L_gb49
    s_cbranch_vccnz L_gs49
    s_branch L_gb49
L_gs50:
    ds_read_b32 v10, v9
    s_waitcnt lgkmcnt(0)
    v_cmp_gt_u32 vcc, 50, v10
    s_sub_i32 s51, s51, 1
    s_cmp_lt_i32 s51, 0
    s_cbranch_scc1 L_gb50
    s_cbranch_vccnz L_gs50
    s_branch L_gb50
.section .rodata,"a"
.p2align 6
.amdhsa_kernel standalone__deep_cross_pnn__recsys_kernel
  .amdhsa_next_free_vgpr 256
  .amdhsa_next_free_sgpr 88
  .amdhsa_accum_offset 256
  .amdhsa_group_segment_fixed_size 0
  .amdhsa_kernarg_size 80
  .amdhsa_user_sgpr_count 2
  .amdhsa_user_sgpr_kernarg_segment_ptr 1
  .amdhsa_system_sgpr_workgroup_id_x 1
  .amdhsa_float_denorm_mode_32 3
.end_amdhsa_kernel
```
